```python
import torch

def _softmax(x, axis=-1):
    return torch.softmax(x, dim=axis)
def _gelu(x):
    return torch.nn.functional.gelu(x, approximate="tanh")
def _silu(x):
    return torch.nn.functional.silu(x)
def _sigmoid(x):
    return torch.sigmoid(x)
def _layernorm(x, axis=-1, eps=1e-5):
    m = x.mean(dim=axis, keepdim=True)
    v = x.var(dim=axis, keepdim=True, unbiased=False)
    return (x - m) / torch.sqrt(v + eps)
def _scatter_add(tgt, idx, src, axis=0):
    return tgt.clone().index_add_(axis, idx, src)
def _segment_sum(src, seg, n):
    out = torch.zeros((n,) + src.shape[1:], dtype=src.dtype)
    return out.index_add_(0, seg, src)
def _pad(x, pw):
    flat = tuple(v for pair in reversed(pw) for v in pair)
    return torch.nn.functional.pad(x, flat)

kernel_name = 'gated_mix__compressed_kv_cla__sliding_local_dilated__prompt'

def setup_inputs():

    _w = (lambda a: (lambda t: t.to(torch.bfloat16) if t.is_floating_point() else t)(torch.as_tensor(a)))
    def _A_setup():
        B, H, Sq, Sk, D, M = 1, 16, 2048, 2048, 256, 448
        Dc = 4 * D
        return {
            "x": _w((lambda *s: torch.randn(*s, dtype=torch.bfloat16) * 0.05)(B, Sq, M)),
            "c_kv": _w((lambda *s: torch.randn(*s, dtype=torch.bfloat16) * 1.6)(B, Sk, Dc)),
            "w_q": _w((lambda *s: torch.randn(*s, dtype=torch.bfloat16) * 3.2)(M, H, D) * (M ** -0.5)),
            "w_uk": _w((lambda *s: torch.randn(*s, dtype=torch.bfloat16) * 3.2)(Dc, H, D) * (Dc ** -0.5)),
            "w_uv": _w((lambda *s: torch.randn(*s, dtype=torch.bfloat16) * 1.6)(Dc, H, D) * (Dc ** -0.5)),
            "w_o": _w((lambda *s: torch.randn(*s, dtype=torch.bfloat16) * 1.6)(H, D, M) * ((H * D) ** -0.5)),
        }
    _A_in = _A_setup()

    def _B_setup():
        B, S, D = 1, 2048, 448
        return {
            "x": _w((lambda *s: torch.randn(*s, dtype=torch.bfloat16) * 0.05)(B, S, D)),
            "wqkv": _w((lambda *s: torch.randn(*s, dtype=torch.bfloat16) * 1.6)(D, 3 * D)),
            "wo": _w((lambda *s: torch.randn(*s, dtype=torch.bfloat16) * 0.05)(D, D)),
        }
    _B_in = _B_setup()

    return {
        "A_x": _A_in["x"],
        "A_c_kv": _A_in["c_kv"],
        "A_w_q": _A_in["w_q"],
        "A_w_uk": _A_in["w_uk"],
        "A_w_uv": _A_in["w_uv"],
        "A_w_o": _A_in["w_o"],
        "B_x": _B_in["x"],
        "B_wqkv": _B_in["wqkv"],
        "B_wo": _B_in["wo"],
        "gate_w": _w((lambda *s: torch.randn(*s, dtype=torch.bfloat16) * 0.05)(448) * 16.0),
    }

def reference(A_x, A_c_kv, A_w_q, A_w_uk, A_w_uv, A_w_o, B_x, B_wqkv, B_wo, gate_w):
    def _A_ref(x, c_kv, w_q, w_uk, w_uv, w_o):
        B, Sq, M = x.shape[0], x.shape[1], x.shape[2]
        Sk = c_kv.shape[1]
        H, D = w_q.shape[1], w_q.shape[2]
        q = torch.einsum("bqm,mhd->bhqd", x, w_q)
        k = torch.einsum("bkc,chd->bhkd", c_kv, w_uk)
        v = torch.einsum("bkc,chd->bhkd", c_kv, w_uv)
        scores = torch.einsum("bhqd,bhkd->bhqk", q, k) * (D ** -0.5)
        off = Sk - Sq
        qi = torch.arange(Sq)[:, None]
        kj = torch.arange(Sk)[None, :]
        cmask = kj <= (qi + off)
        scores = torch.where(cmask[None, None], scores, -1e9)
        p = _softmax(scores, axis=-1)
        ctx = torch.einsum("bhqk,bhkd->bhqd", p, v)
        return torch.einsum("bhqd,hdm->bqm", ctx, w_o)

    def _B_ref(x, wqkv, wo):
        B, S, D = x.shape
        H = 16; Dh = D // H
        W, dil = 8, 2
        qkv = (lambda x, *d: x.permute(*d))((x @ wqkv).reshape(B, S, 3, H, Dh), 2, 0, 3, 1, 4)
        q, k, v = qkv[0], qkv[1], qkv[2]
        scale = Dh ** -0.5
        pos = torch.arange(S)
        off = torch.arange(W) * dil
        idx = pos[:, None] - off[None, :]
        mask = idx >= 0
        idx_c = torch.where(mask, idx, 0).reshape(-1)
        kg = k[:, :, idx_c, :].reshape(B, H, S, W, Dh)
        vg = v[:, :, idx_c, :].reshape(B, H, S, W, Dh)
        logits = torch.einsum("bhsd,bhswd->bhsw", q, kg) * scale
        logits = torch.where(mask[None, None, :, :], logits, -1e9)
        attn = _softmax(logits, axis=-1)
        o = torch.einsum("bhsw,bhswd->bhsd", attn, vg)
        return (lambda x, *d: x.permute(*d))(o, 0, 2, 1, 3).reshape(B, S, D) @ wo

    x = A_x
    g = _sigmoid((x * gate_w).sum(-1, keepdims=True))
    a = _A_ref(x, A_c_kv, A_w_q, A_w_uk, A_w_uv, A_w_o)
    b = _B_ref(x, B_wqkv, B_wo)
    return g * a + (1 - g) * b
```

```asm
; @launch grid=(256,1,1) block=(256,1,1) lds=163840
.amdgcn_target "amdgcn-amd-amdhsa--gfx950"
.text
.globl gated_mix__compressed_kv_cla__sliding_local_dilated__prompt_kernel
.p2align 8
.type gated_mix__compressed_kv_cla__sliding_local_dilated__prompt_kernel,@function
gated_mix__compressed_kv_cla__sliding_local_dilated__prompt_kernel:
s_load_dwordx4 s[4:7], s[0:1], 0
s_load_dwordx4 s[32:35], s[0:1], 24
s_load_dwordx2 s[78:79], s[0:1], 72
s_cmp_ge_u32 s2, 256
s_cbranch_scc1 L_k1_end
v_lshrrev_b32 v28, 6, v0
v_and_b32 v1, 63, v0
v_readfirstlane_b32 s27, v28
s_lshr_b32 s37, s2, 3
s_mov_b32 s3, 0
v_lshlrev_b32 v112, 6, v1
s_lshl_b32 s28, s37, 2
s_add_u32 s29, s28, s27
s_getpc_b64 s[92:93]
L_pc_1:
s_sub_u32 s92, s92, L_pc_1-gated_mix__compressed_kv_cla__sliding_local_dilated__prompt_kernel
s_subb_u32 s93, s93, 0
s_mov_b32 s94, L_code_end-gated_mix__compressed_kv_cla__sliding_local_dilated__prompt_kernel
s_mov_b32 s95, 0x20000
s_lshl_b32 s28, s29, 12
buffer_load_dword v113, v112, s[92:95], s28 offen
s_and_b32 s36, s2, 7
s_and_b32 s38, s37, 1
s_lshl_b32 s39, s36, 1
s_add_u32 s38, s38, s39
s_bfe_u32 s39, s37, 0x10001
s_lshr_b32 s40, s37, 2
s_lshl_b32 s30, s27, 13
s_add_u32 s31, s30, 4096
s_lshl_b32 s58, s27, 12
v_lshrrev_b32 v29, 4, v1
v_and_b32 v30, 7, v1
v_xor_b32 v31, v29, v30
v_lshlrev_b32 v31, 4, v31
v_lshrrev_b32 v28, 3, v1
s_lshl_b32 s28, s27, 6
v_add_u32 v28, s28, v28
v_lshlrev_b32 v28, 11, v28
v_xor_b32 v29, 64, v31
v_add_u32 v29, v29, v28
v_add_u32 v28, v31, v28
v_add_u32 v2, 0, v28
v_add_u32 v3, 15360, v29
v_add_u32 v4, 30720, v28
v_add_u32 v5, 46080, v29
v_add_u32 v6, 65536, v28
v_add_u32 v7, 80896, v29
v_add_u32 v8, 96256, v28
v_add_u32 v9, 111616, v29
v_lshrrev_b32 v28, 5, v1
s_lshl_b32 s28, s27, 3
v_add_u32 v29, s28, v28
v_lshlrev_b32 v29, 13, v29
v_and_b32 v30, 31, v1
v_lshlrev_b32 v28, 1, v28
v_xor_b32 v30, v30, v28
s_and_b32 s28, s28, 8
v_xor_b32 v30, s28, v30
v_xor_b32 v28, 0, v30
v_lshl_add_u32 v28, v28, 4, v29
v_add_u32 v10, 0, v28
v_xor_b32 v28, 4, v30
v_lshl_add_u32 v28, v28, 4, v29
v_add_u32 v11, 15360, v28
v_xor_b32 v28, 0, v30
v_lshl_add_u32 v28, v28, 4, v29
v_add_u32 v12, 30720, v28
v_xor_b32 v28, 4, v30
v_lshl_add_u32 v28, v28, 4, v29
v_add_u32 v13, 46080, v28
s_waitcnt lgkmcnt(0)
s_lshl_b32 s28, s40, 19
s_add_u32 s12, s6, s28
s_addc_u32 s13, s7, 0
s_mov_b32 s14, 0x80000
s_mov_b32 s15, 0x20000
s_mov_b32 s44, s12
s_mov_b32 s45, s13
s_mov_b32 s46, s14
s_mov_b32 s47, 0x20000
s_cmp_lg_u32 s39, 0
s_cselect_b32 s10, s34, s32
s_cselect_b32 s11, s35, s33
s_lshl_b32 s28, s38, 9
s_add_u32 s16, s10, s28
s_addc_u32 s17, s11, 0
s_sub_u32 s18, 0x800000, s28
s_mov_b32 s19, 0x20000
s_mov_b32 s24, 0
s_mov_b32 s25, 0
s_mov_b32 s56, 0
s_mov_b32 s57, 128
s_add_u32 s74, s30, 65536
s_add_u32 s75, s31, 65536
s_mov_b32 m0, s74
s_nop 0
buffer_load_dwordx4 v2, s[12:15], s24 offen offset:0 lds
buffer_load_dwordx4 v3, s[12:15], s24 offen offset:1024 lds
buffer_load_dwordx4 v4, s[12:15], s24 offen offset:2048 lds
buffer_load_dwordx4 v5, s[12:15], s24 offen offset:3072 lds
s_add_u32 s24, s24, 128
s_mov_b32 m0, s75
s_nop 0
buffer_load_dwordx4 v6, s[44:47], s56 offen offset:0 lds
buffer_load_dwordx4 v7, s[44:47], s56 offen offset:1024 lds
buffer_load_dwordx4 v8, s[44:47], s56 offen offset:2048 lds
buffer_load_dwordx4 v9, s[44:47], s56 offen offset:3072 lds
s_add_u32 s56, s56, s57
s_mov_b32 m0, s58
s_nop 0
buffer_load_dwordx4 v10, s[16:19], s25 offen offset:0 lds
buffer_load_dwordx4 v11, s[16:19], s25 offen offset:1024 lds
buffer_load_dwordx4 v12, s[16:19], s25 offen offset:2048 lds
buffer_load_dwordx4 v13, s[16:19], s25 offen offset:3072 lds
s_add_u32 s25, s25, 262144
s_mov_b32 s92, s4
s_mov_b32 s93, s5
s_mov_b32 s94, 1835008
s_mov_b32 s95, 0x20000
v_lshrrev_b32 v144, 5, v0
s_lshl_b32 s28, s2, 3
v_add_u32 v144, s28, v144
v_and_b32 v145, 31, v0
v_mul_u32_u24 v145, 28, v145
v_mul_u32_u24 v146, 896, v144
v_add_u32 v146, v146, v145
buffer_load_dwordx4 v[128:131], v146, s[92:95], 0 offen
buffer_load_dwordx3 v[132:134], v146, s[92:95], 0 offen offset:16
s_mov_b32 s92, s78
s_mov_b32 s93, s79
s_mov_b32 s94, 896
buffer_load_dwordx4 v[136:139], v145, s[92:95], 0 offen
buffer_load_dwordx3 v[140:142], v145, s[92:95], 0 offen offset:16
s_add_u32 s74, s30, 98304
s_add_u32 s75, s31, 98304
s_add_u32 m0, s58, 16384
s_nop 0
buffer_load_dwordx4 v10, s[16:19], s25 offen offset:0 lds
buffer_load_dwordx4 v11, s[16:19], s25 offen offset:1024 lds
buffer_load_dwordx4 v12, s[16:19], s25 offen offset:2048 lds
buffer_load_dwordx4 v13, s[16:19], s25 offen offset:3072 lds
s_add_u32 s25, s25, 262144
s_mov_b32 m0, s74
s_nop 0
buffer_load_dwordx4 v2, s[12:15], s24 offen offset:0 lds
buffer_load_dwordx4 v3, s[12:15], s24 offen offset:1024 lds
buffer_load_dwordx4 v4, s[12:15], s24 offen offset:2048 lds
buffer_load_dwordx4 v5, s[12:15], s24 offen offset:3072 lds
s_add_u32 s24, s24, 128
s_load_dwordx2 s[68:69], s[0:1], 16
s_load_dwordx2 s[76:77], s[0:1], 40
s_load_dwordx4 s[48:51], s[0:1], 56
s_load_dwordx4 s[96:99], s[0:1], 88
s_mov_b32 s73, 65536
v_lshlrev_b32 v19, 4, v1
s_lshr_b32 s43, s37, 1
s_add_u32 s28, s43, 8
s_sub_u32 s29, 15, s43
s_cmp_lt_u32 s43, 8
s_cselect_b32 s43, s28, s29
s_mul_i32 s72, s38, 56
s_and_b32 s41, s72, 8
v_lshrrev_b32 v29, 4, v1
v_and_b32 v30, 7, v1
v_xor_b32 v31, v29, v30
v_lshlrev_b32 v31, 4, v31
v_lshrrev_b32 v28, 3, v1
s_lshl_b32 s28, s27, 5
v_add_u32 v28, s28, v28
v_mul_u32_u24 v28, 896, v28
v_xor_b32 v29, 64, v31
v_add_u32 v29, v29, v28
v_add_u32 v28, v31, v28
v_add_u32 v96, 0, v28
v_add_u32 v97, 6144, v29
v_add_u32 v98, 12288, v28
v_add_u32 v99, 18432, v29
s_mul_i32 s28, s27, 43008
v_add_u32 v28, 0, v1
v_mul_u32_u24 v29, 43691, v28
v_lshrrev_b32 v29, 19, v29
v_mul_u32_u24 v30, 12, v29
v_sub_u32 v28, v28, v30
v_mul_u32_u24 v29, 2688, v29
v_lshrrev_b32 v30, 2, v28
v_mul_u32_u24 v30, 896, v30
v_and_b32 v28, 3, v28
v_lshl_add_u32 v28, v28, 4, v30
v_add3_u32 v28, v28, v29, s28
v_subrev_u32 v100, 0, v28
v_add_u32 v28, 64, v1
v_mul_u32_u24 v29, 43691, v28
v_lshrrev_b32 v29, 19, v29
v_mul_u32_u24 v30, 12, v29
v_sub_u32 v28, v28, v30
v_mul_u32_u24 v29, 2688, v29
v_lshrrev_b32 v30, 2, v28
v_mul_u32_u24 v30, 896, v30
v_and_b32 v28, 3, v28
v_lshl_add_u32 v28, v28, 4, v30
v_add3_u32 v28, v28, v29, s28
v_subrev_u32 v101, 1024, v28
v_add_u32 v28, 128, v1
v_mul_u32_u24 v29, 43691, v28
v_lshrrev_b32 v29, 19, v29
v_mul_u32_u24 v30, 12, v29
v_sub_u32 v28, v28, v30
v_mul_u32_u24 v29, 2688, v29
v_lshrrev_b32 v30, 2, v28
v_mul_u32_u24 v30, 896, v30
v_and_b32 v28, 3, v28
v_lshl_add_u32 v28, v28, 4, v30
v_add3_u32 v28, v28, v29, s28
v_subrev_u32 v102, 2048, v28
v_mov_b32 v103, 0x40000000
v_and_b32 v28, 15, v1
v_lshrrev_b32 v29, 4, v1
v_lshrrev_b32 v30, 1, v28
v_xor_b32 v30, v30, v29
v_lshlrev_b32 v30, 4, v30
v_lshl_add_u32 v30, v28, 7, v30
s_lshr_b32 s28, s27, 1
s_lshl_b32 s29, s28, 14
v_add_u32 v110, s29, v30
v_xor_b32 v111, 64, v110
s_lshl_b32 s29, s28, 13
v_add_u32 v104, s29, v30
v_xor_b32 v105, 64, v104
v_mul_u32_u24 v109, 896, v28
v_lshl_add_u32 v109, v29, 4, v109
s_lshl_b32 s42, s28, 6
s_and_b32 s28, s27, 1
v_lshrrev_b32 v30, 2, v28
v_and_b32 v31, 1, v29
v_lshl_add_u32 v31, v31, 3, v30
v_mul_u32_u24 v31, 192, v31
v_lshrrev_b32 v30, 1, v29
v_lshl_add_u32 v31, v30, 12, v31
v_and_b32 v30, 3, v28
v_lshl_add_u32 v31, v30, 3, v31
s_lshl_b32 s29, s28, 5
s_add_u32 s29, s29, s41
s_add_u32 s29, s29, 16384
v_add_u32 v106, s29, v31
s_add_u32 s71, s42, 64
v_add_u32 v107, s71, v106
s_sub_u32 s71, 128, s42
v_add_u32 v108, s71, v106
v_lshrrev_b32 v30, 2, v28
v_lshl_add_u32 v31, v29, 3, v30
v_and_b32 v29, 1, v29
v_lshlrev_b32 v29, 3, v29
v_lshl_add_u32 v29, v30, 1, v29
v_and_b32 v30, 3, v28
v_lshlrev_b32 v126, 9, v31
v_lshl_add_u32 v126, v30, 3, v126
s_lshl_b32 s29, s28, 8
v_add_u32 v126, s29, v126
v_xor_b32 v28, 0, v29
v_lshl_add_u32 v20, v28, 4, v126
v_xor_b32 v28, 2, v29
v_lshl_add_u32 v21, v28, 4, v126
v_xor_b32 v28, 4, v29
v_lshl_add_u32 v22, v28, 4, v126
v_xor_b32 v28, 6, v29
v_lshl_add_u32 v23, v28, 4, v126
v_xor_b32 v28, 8, v29
v_lshl_add_u32 v24, v28, 4, v126
v_xor_b32 v28, 10, v29
v_lshl_add_u32 v25, v28, 4, v126
v_xor_b32 v28, 12, v29
v_lshl_add_u32 v26, v28, 4, v126
v_xor_b32 v28, 14, v29
v_lshl_add_u32 v27, v28, 4, v126
v_add_u32 v14, s73, v110
v_add_u32 v15, s73, v111
s_waitcnt lgkmcnt(0)
s_mov_b32 s8, s98
s_mov_b32 s9, s99
s_mov_b32 s100, s96
s_mov_b32 s101, s97
s_lshl_b32 s28, s39, 24
s_lshl_b32 s29, s38, 20
s_add_u32 s28, s28, s29
s_lshl_b32 s29, s40, 17
s_add_u32 s28, s28, s29
s_lshr_b32 s29, s27, 1
s_lshl_b32 s29, s29, 16
s_add_u32 s28, s28, s29
s_and_b32 s29, s27, 1
s_lshl_b32 s29, s29, 12
s_lshl_b32 s29, s29, s39
s_add_u32 s28, s28, s29
s_add_u32 s20, s8, s28
s_addc_u32 s21, s9, 0
s_mov_b32 s22, 0x10000
s_mov_b32 s23, 0x20000
s_mov_b32 s59, 1035512379
s_lshl_b32 s28, s38, 20
s_lshl_b32 s29, s43, 16
s_add_u32 s28, s28, s29
s_lshr_b32 s29, s27, 1
s_lshl_b32 s29, s29, 15
s_add_u32 s28, s28, s29
s_and_b32 s29, s27, 1
s_lshl_b32 s29, s29, 12
s_add_u32 s28, s28, s29
s_add_u32 s28, s28, 33554432
s_add_u32 s60, s8, s28
s_addc_u32 s61, s9, 0
s_mov_b32 s62, 0x8000
s_mov_b32 s63, 0x20000
s_max_u32 s28, s43, 1
s_mul_i32 s28, s28, 114688
s_sub_u32 s28, s28, 14336
s_add_u32 s64, s4, s28
s_addc_u32 s65, s5, 0
s_cmp_eq_u32 s43, 0
s_cselect_b32 s66, 0, 14336
s_mov_b32 s67, 0x20000
s_cmp_eq_u32 s27, 0
s_cselect_b32 s52, s68, s76
s_cselect_b32 s53, s69, s77
s_mov_b32 s29, 14336
s_cmp_eq_u32 s27, 2
s_cselect_b32 s52, s4, s52
s_cselect_b32 s53, s5, s53
s_cselect_b32 s29, 7168, s29
s_cmp_eq_u32 s27, 3
s_cselect_b32 s52, s48, s52
s_cselect_b32 s53, s49, s53
s_cselect_b32 s29, 4704, s29
s_mul_i32 s28, s29, s2
s_add_u32 s52, s52, s28
s_addc_u32 s53, s53, 0
s_mov_b32 s54, s29
s_mov_b32 s55, 0x20000
s_mov_b32 s70, 0x100000
s_and_b32 s28, s27, 1
s_lshl_b32 s29, s28, 6
s_lshl_b32 s36, s40, 3
s_add_u32 s29, s29, s36
v_lshrrev_b32 v28, 3, v1
v_add_u32 v28, s29, v28
v_lshlrev_b32 v28, 13, v28
v_and_b32 v29, 7, v1
v_lshl_add_u32 v28, v29, 6, v28
s_and_b32 s29, s37, 3
s_lshl_b32 s29, s29, 6
v_add_u32 v29, s29, v1
v_lshlrev_b32 v29, 11, v29
s_lshl_b32 s28, s28, 7
v_add_u32 v29, s28, v29
s_cmp_lt_u32 s27, 2
s_cselect_b64 vcc, -1, 0
s_cselect_b32 s32, s16, s12
s_cselect_b32 s33, s17, s13
s_cselect_b32 s34, s18, 0
s_mov_b32 s35, 0x20000
s_mov_b32 s40, 256
s_cselect_b32 s40, 1048576, s40
v_cndmask_b32 v126, v29, v28, vcc
s_and_b32 s28, s27, 1
s_lshl_b32 s29, s28, 6
s_add_u32 s29, s29, s36
v_lshrrev_b32 v28, 2, v1
v_add_u32 v28, s29, v28
v_lshlrev_b32 v28, 13, v28
v_and_b32 v29, 3, v1
v_lshl_add_u32 v28, v29, 7, v28
v_lshrrev_b32 v29, 5, v1
v_lshl_add_u32 v126, v29, 30, v28
s_mul_i32 s36, s40, 2
s_add_u32 m0, s58, 32768
s_nop 0
buffer_load_dwordx4 v10, s[16:19], s25 offen offset:0 lds
buffer_load_dwordx4 v11, s[16:19], s25 offen offset:1024 lds
buffer_load_dwordx4 v12, s[16:19], s25 offen offset:2048 lds
buffer_load_dwordx4 v13, s[16:19], s25 offen offset:3072 lds
s_add_u32 s25, s25, 262144
s_mov_b32 m0, s75
s_nop 0
buffer_load_dwordx4 v6, s[44:47], s56 offen offset:0 lds
buffer_load_dwordx4 v7, s[44:47], s56 offen offset:1024 lds
buffer_load_dwordx4 v8, s[44:47], s56 offen offset:2048 lds
buffer_load_dwordx4 v9, s[44:47], s56 offen offset:3072 lds
s_add_u32 s56, s56, s57
s_waitcnt vmcnt(16)
s_barrier
ds_read_b128 v[32:35], v14
ds_read_b64_tr_b16 v[64:65], v20 offset:0
ds_read_b64_tr_b16 v[66:67], v20 offset:2048
ds_read_b64_tr_b16 v[68:69], v21 offset:0
ds_read_b64_tr_b16 v[70:71], v21 offset:2048
ds_read_b64_tr_b16 v[72:73], v22 offset:0
ds_read_b64_tr_b16 v[74:75], v22 offset:2048
ds_read_b64_tr_b16 v[76:77], v23 offset:0
ds_read_b64_tr_b16 v[78:79], v23 offset:2048
ds_read_b64_tr_b16 v[80:81], v24 offset:0
ds_read_b64_tr_b16 v[82:83], v24 offset:2048
ds_read_b64_tr_b16 v[84:85], v25 offset:0
ds_read_b64_tr_b16 v[86:87], v25 offset:2048
ds_read_b64_tr_b16 v[88:89], v26 offset:0
ds_read_b64_tr_b16 v[90:91], v26 offset:2048
ds_read_b64_tr_b16 v[92:93], v27 offset:0
ds_read_b64_tr_b16 v[94:95], v27 offset:2048
ds_read_b128 v[36:39], v14 offset:2048
ds_read_b128 v[40:43], v14 offset:4096
ds_read_b128 v[44:47], v14 offset:6144
ds_read_b128 v[48:51], v14 offset:8192
ds_read_b128 v[52:55], v14 offset:10240
ds_read_b128 v[56:59], v14 offset:12288
ds_read_b128 v[60:63], v14 offset:14336
v_dot2_f32_bf16 v147, v128, v136, 0
v_dot2_f32_bf16 v147, v129, v137, v147
v_dot2_f32_bf16 v147, v130, v138, v147
v_dot2_f32_bf16 v147, v131, v139, v147
v_dot2_f32_bf16 v147, v132, v140, v147
v_dot2_f32_bf16 v147, v133, v141, v147
v_dot2_f32_bf16 v147, v134, v142, v147
s_nop 2
v_add_f32_dpp v147, v147, v147 quad_perm:[1,0,3,2] row_mask:0xf bank_mask:0xf
s_nop 1
v_add_f32_dpp v147, v147, v147 quad_perm:[2,3,0,1] row_mask:0xf bank_mask:0xf
s_nop 1
v_add_f32_dpp v147, v147, v147 row_half_mirror row_mask:0xf bank_mask:0xf
s_nop 1
v_add_f32_dpp v147, v147, v147 row_mirror row_mask:0xf bank_mask:0xf
s_nop 1
v_mov_b32 v148, v147
s_nop 1
v_permlane16_swap_b32 v148, v147
v_add_f32 v147, v147, v148
v_mul_f32 v147, 3216550459, v147
v_exp_f32 v147, v147
s_add_u32 s92, s8, 105906176
s_addc_u32 s93, s9, 0
s_mov_b32 s94, 8192
v_add_f32 v147, 1.0, v147
v_rcp_f32 v147, v147
v_lshlrev_b32 v196, 2, v144
v_mov_b32 v197, v147
s_mov_b32 s26, 1
s_cmp_lg_u32 s39, 0
s_cbranch_scc1 L_k1_v
s_waitcnt lgkmcnt(0)
v_mfma_f32_16x16x32_bf16 a[0:3], v[64:67], v[32:35], 0
v_mfma_f32_16x16x32_bf16 a[4:7], v[68:71], v[32:35], 0
v_mfma_f32_16x16x32_bf16 a[8:11], v[72:75], v[32:35], 0
s_waitcnt vmcnt(12)
s_barrier
v_mfma_f32_16x16x32_bf16 a[12:15], v[76:79], v[32:35], 0
s_add_u32 m0, s58, 49152
ds_read_b128 v[128:131], v15
v_mfma_f32_16x16x32_bf16 a[16:19], v[80:83], v[32:35], 0
buffer_load_dwordx4 v10, s[16:19], s25 offen offset:0 lds
v_mfma_f32_16x16x32_bf16 a[20:23], v[84:87], v[32:35], 0
ds_read_b64_tr_b16 v[160:161], v20 offset:16384
v_mfma_f32_16x16x32_bf16 a[24:27], v[88:91], v[32:35], 0
v_mfma_f32_16x16x32_bf16 a[28:31], v[92:95], v[32:35], 0
ds_read_b64_tr_b16 v[162:163], v20 offset:18432
v_mfma_f32_16x16x32_bf16 a[32:35], v[64:67], v[36:39], 0
buffer_load_dwordx4 v11, s[16:19], s25 offen offset:1024 lds
v_mfma_f32_16x16x32_bf16 a[36:39], v[68:71], v[36:39], 0
ds_read_b64_tr_b16 v[164:165], v21 offset:16384
v_mfma_f32_16x16x32_bf16 a[40:43], v[72:75], v[36:39], 0
v_mfma_f32_16x16x32_bf16 a[44:47], v[76:79], v[36:39], 0
ds_read_b64_tr_b16 v[166:167], v21 offset:18432
v_mfma_f32_16x16x32_bf16 a[48:51], v[80:83], v[36:39], 0
buffer_load_dwordx4 v12, s[16:19], s25 offen offset:2048 lds
v_mfma_f32_16x16x32_bf16 a[52:55], v[84:87], v[36:39], 0
ds_read_b64_tr_b16 v[168:169], v22 offset:16384
v_mfma_f32_16x16x32_bf16 a[56:59], v[88:91], v[36:39], 0
v_mfma_f32_16x16x32_bf16 a[60:63], v[92:95], v[36:39], 0
ds_read_b64_tr_b16 v[170:171], v22 offset:18432
v_mfma_f32_16x16x32_bf16 a[64:67], v[64:67], v[40:43], 0
v_mfma_f32_16x16x32_bf16 a[68:71], v[68:71], v[40:43], 0
buffer_load_dwordx4 v13, s[16:19], s25 offen offset:3072 lds
v_mfma_f32_16x16x32_bf16 a[72:75], v[72:75], v[40:43], 0
s_add_u32 s25, s25, 262144
ds_read_b64_tr_b16 v[172:173], v23 offset:16384
v_mfma_f32_16x16x32_bf16 a[76:79], v[76:79], v[40:43], 0
ds_read_b64_tr_b16 v[174:175], v23 offset:18432
v_mfma_f32_16x16x32_bf16 a[80:83], v[80:83], v[40:43], 0
s_add_u32 m0, s30, 131072
v_mfma_f32_16x16x32_bf16 a[84:87], v[84:87], v[40:43], 0
buffer_load_dwordx4 v2, s[12:15], s24 offen offset:0 lds
v_mfma_f32_16x16x32_bf16 a[88:91], v[88:91], v[40:43], 0
ds_read_b64_tr_b16 v[176:177], v24 offset:16384
v_mfma_f32_16x16x32_bf16 a[92:95], v[92:95], v[40:43], 0
ds_read_b64_tr_b16 v[178:179], v24 offset:18432
v_mfma_f32_16x16x32_bf16 a[96:99], v[64:67], v[44:47], 0
v_mfma_f32_16x16x32_bf16 a[100:103], v[68:71], v[44:47], 0
ds_read_b64_tr_b16 v[180:181], v25 offset:16384
v_mfma_f32_16x16x32_bf16 a[104:107], v[72:75], v[44:47], 0
buffer_load_dwordx4 v3, s[12:15], s24 offen offset:1024 lds
v_mfma_f32_16x16x32_bf16 a[108:111], v[76:79], v[44:47], 0
ds_read_b64_tr_b16 v[182:183], v25 offset:18432
v_mfma_f32_16x16x32_bf16 a[112:115], v[80:83], v[44:47], 0
v_mfma_f32_16x16x32_bf16 a[116:119], v[84:87], v[44:47], 0
ds_read_b64_tr_b16 v[184:185], v26 offset:16384
v_mfma_f32_16x16x32_bf16 a[120:123], v[88:91], v[44:47], 0
buffer_load_dwordx4 v4, s[12:15], s24 offen offset:2048 lds
v_mfma_f32_16x16x32_bf16 a[124:127], v[92:95], v[44:47], 0
ds_read_b64_tr_b16 v[186:187], v26 offset:18432
v_mfma_f32_16x16x32_bf16 a[128:131], v[64:67], v[48:51], 0
v_mfma_f32_16x16x32_bf16 a[132:135], v[68:71], v[48:51], 0
ds_read_b64_tr_b16 v[188:189], v27 offset:16384
v_mfma_f32_16x16x32_bf16 a[136:139], v[72:75], v[48:51], 0
buffer_load_dwordx4 v5, s[12:15], s24 offen offset:3072 lds
v_mfma_f32_16x16x32_bf16 a[140:143], v[76:79], v[48:51], 0
s_add_u32 s24, s24, 128
ds_read_b64_tr_b16 v[190:191], v27 offset:18432
v_mfma_f32_16x16x32_bf16 a[144:147], v[80:83], v[48:51], 0
v_mfma_f32_16x16x32_bf16 a[148:151], v[84:87], v[48:51], 0
ds_read_b128 v[132:135], v15 offset:2048
v_mfma_f32_16x16x32_bf16 a[152:155], v[88:91], v[48:51], 0
s_add_u32 m0, s31, 131072
v_mfma_f32_16x16x32_bf16 a[156:159], v[92:95], v[48:51], 0
buffer_load_dwordx4 v6, s[44:47], s56 offen offset:0 lds
v_mfma_f32_16x16x32_bf16 a[160:163], v[64:67], v[52:55], 0
ds_read_b128 v[136:139], v15 offset:4096
v_mfma_f32_16x16x32_bf16 a[164:167], v[68:71], v[52:55], 0
ds_read_b128 v[140:143], v15 offset:6144
v_mfma_f32_16x16x32_bf16 a[168:171], v[72:75], v[52:55], 0
v_mfma_f32_16x16x32_bf16 a[172:175], v[76:79], v[52:55], 0
buffer_load_dwordx4 v7, s[44:47], s56 offen offset:1024 lds
v_mfma_f32_16x16x32_bf16 a[176:179], v[80:83], v[52:55], 0
ds_read_b128 v[144:147], v15 offset:8192
v_mfma_f32_16x16x32_bf16 a[180:183], v[84:87], v[52:55], 0
ds_read_b128 v[148:151], v15 offset:10240
v_mfma_f32_16x16x32_bf16 a[184:187], v[88:91], v[52:55], 0
v_mfma_f32_16x16x32_bf16 a[188:191], v[92:95], v[52:55], 0
ds_read_b128 v[152:155], v15 offset:12288
v_mfma_f32_16x16x32_bf16 a[192:195], v[64:67], v[56:59], 0
buffer_load_dwordx4 v8, s[44:47], s56 offen offset:2048 lds
v_mfma_f32_16x16x32_bf16 a[196:199], v[68:71], v[56:59], 0
ds_read_b128 v[156:159], v15 offset:14336
v_mfma_f32_16x16x32_bf16 a[200:203], v[72:75], v[56:59], 0
v_mfma_f32_16x16x32_bf16 a[204:207], v[76:79], v[56:59], 0
v_mfma_f32_16x16x32_bf16 a[208:211], v[80:83], v[56:59], 0
buffer_load_dwordx4 v9, s[44:47], s56 offen offset:3072 lds
v_mfma_f32_16x16x32_bf16 a[212:215], v[84:87], v[56:59], 0
s_add_u32 s56, s56, s57
v_mfma_f32_16x16x32_bf16 a[216:219], v[88:91], v[56:59], 0
v_mfma_f32_16x16x32_bf16 a[220:223], v[92:95], v[56:59], 0
v_mfma_f32_16x16x32_bf16 a[224:227], v[64:67], v[60:63], 0
v_mfma_f32_16x16x32_bf16 a[228:231], v[68:71], v[60:63], 0
v_mfma_f32_16x16x32_bf16 a[232:235], v[72:75], v[60:63], 0
v_mfma_f32_16x16x32_bf16 a[236:239], v[76:79], v[60:63], 0
s_add_u32 s74, s73, s30
s_add_u32 s75, s73, s31
v_mfma_f32_16x16x32_bf16 a[240:243], v[80:83], v[60:63], 0
s_add_u32 s73, s73, 32768
s_cmp_eq_u32 s73, 163840
v_mfma_f32_16x16x32_bf16 a[244:247], v[84:87], v[60:63], 0
s_cselect_b32 s73, 65536, s73
v_add_u32 v14, s73, v110
v_mfma_f32_16x16x32_bf16 a[248:251], v[88:91], v[60:63], 0
v_add_u32 v15, s73, v111
v_mfma_f32_16x16x32_bf16 a[252:255], v[92:95], v[60:63], 0
s_waitcnt lgkmcnt(0)
v_mfma_f32_16x16x32_bf16 a[0:3], v[160:163], v[128:131], a[0:3]
v_mfma_f32_16x16x32_bf16 a[4:7], v[164:167], v[128:131], a[4:7]
v_mfma_f32_16x16x32_bf16 a[8:11], v[168:171], v[128:131], a[8:11]
s_waitcnt vmcnt(12)
s_barrier
v_mfma_f32_16x16x32_bf16 a[12:15], v[172:175], v[128:131], a[12:15]
s_mov_b32 m0, s58
ds_read_b128 v[32:35], v14
v_mfma_f32_16x16x32_bf16 a[16:19], v[176:179], v[128:131], a[16:19]
buffer_load_dwordx4 v10, s[16:19], s25 offen offset:0 lds
v_mfma_f32_16x16x32_bf16 a[20:23], v[180:183], v[128:131], a[20:23]
ds_read_b64_tr_b16 v[64:65], v20 offset:32768
v_mfma_f32_16x16x32_bf16 a[24:27], v[184:187], v[128:131], a[24:27]
v_mfma_f32_16x16x32_bf16 a[28:31], v[188:191], v[128:131], a[28:31]
ds_read_b64_tr_b16 v[66:67], v20 offset:34816
v_mfma_f32_16x16x32_bf16 a[32:35], v[160:163], v[132:135], a[32:35]
buffer_load_dwordx4 v11, s[16:19], s25 offen offset:1024 lds
v_mfma_f32_16x16x32_bf16 a[36:39], v[164:167], v[132:135], a[36:39]
ds_read_b64_tr_b16 v[68:69], v21 offset:32768
v_mfma_f32_16x16x32_bf16 a[40:43], v[168:171], v[132:135], a[40:43]
v_mfma_f32_16x16x32_bf16 a[44:47], v[172:175], v[132:135], a[44:47]
ds_read_b64_tr_b16 v[70:71], v21 offset:34816
v_mfma_f32_16x16x32_bf16 a[48:51], v[176:179], v[132:135], a[48:51]
v_mfma_f32_16x16x32_bf16 a[52:55], v[180:183], v[132:135], a[52:55]
buffer_load_dwordx4 v12, s[16:19], s25 offen offset:2048 lds
v_mfma_f32_16x16x32_bf16 a[56:59], v[184:187], v[132:135], a[56:59]
ds_read_b64_tr_b16 v[72:73], v22 offset:32768
v_mfma_f32_16x16x32_bf16 a[60:63], v[188:191], v[132:135], a[60:63]
ds_read_b64_tr_b16 v[74:75], v22 offset:34816
v_mfma_f32_16x16x32_bf16 a[64:67], v[160:163], v[136:139], a[64:67]
v_mfma_f32_16x16x32_bf16 a[68:71], v[164:167], v[136:139], a[68:71]
ds_read_b64_tr_b16 v[76:77], v23 offset:32768
v_mfma_f32_16x16x32_bf16 a[72:75], v[168:171], v[136:139], a[72:75]
buffer_load_dwordx4 v13, s[16:19], s25 offen offset:3072 lds
v_mfma_f32_16x16x32_bf16 a[76:79], v[172:175], v[136:139], a[76:79]
s_add_u32 s25, s25, 262144
ds_read_b64_tr_b16 v[78:79], v23 offset:34816
v_mfma_f32_16x16x32_bf16 a[80:83], v[176:179], v[136:139], a[80:83]
v_mfma_f32_16x16x32_bf16 a[84:87], v[180:183], v[136:139], a[84:87]
ds_read_b64_tr_b16 v[80:81], v24 offset:32768
v_mfma_f32_16x16x32_bf16 a[88:91], v[184:187], v[136:139], a[88:91]
s_add_u32 m0, s58, 16384
v_mfma_f32_16x16x32_bf16 a[92:95], v[188:191], v[136:139], a[92:95]
buffer_load_dwordx4 v10, s[16:19], s25 offen offset:0 lds
v_mfma_f32_16x16x32_bf16 a[96:99], v[160:163], v[140:143], a[96:99]
ds_read_b64_tr_b16 v[82:83], v24 offset:34816
v_mfma_f32_16x16x32_bf16 a[100:103], v[164:167], v[140:143], a[100:103]
ds_read_b64_tr_b16 v[84:85], v25 offset:32768
v_mfma_f32_16x16x32_bf16 a[104:107], v[168:171], v[140:143], a[104:107]
v_mfma_f32_16x16x32_bf16 a[108:111], v[172:175], v[140:143], a[108:111]
buffer_load_dwordx4 v11, s[16:19], s25 offen offset:1024 lds
v_mfma_f32_16x16x32_bf16 a[112:115], v[176:179], v[140:143], a[112:115]
ds_read_b64_tr_b16 v[86:87], v25 offset:34816
v_mfma_f32_16x16x32_bf16 a[116:119], v[180:183], v[140:143], a[116:119]
ds_read_b64_tr_b16 v[88:89], v26 offset:32768
v_mfma_f32_16x16x32_bf16 a[120:123], v[184:187], v[140:143], a[120:123]
v_mfma_f32_16x16x32_bf16 a[124:127], v[188:191], v[140:143], a[124:127]
ds_read_b64_tr_b16 v[90:91], v26 offset:34816
v_mfma_f32_16x16x32_bf16 a[128:131], v[160:163], v[144:147], a[128:131]
buffer_load_dwordx4 v12, s[16:19], s25 offen offset:2048 lds
v_mfma_f32_16x16x32_bf16 a[132:135], v[164:167], v[144:147], a[132:135]
ds_read_b64_tr_b16 v[92:93], v27 offset:32768
v_mfma_f32_16x16x32_bf16 a[136:139], v[168:171], v[144:147], a[136:139]
v_mfma_f32_16x16x32_bf16 a[140:143], v[172:175], v[144:147], a[140:143]
ds_read_b64_tr_b16 v[94:95], v27 offset:34816
v_mfma_f32_16x16x32_bf16 a[144:147], v[176:179], v[144:147], a[144:147]
v_mfma_f32_16x16x32_bf16 a[148:151], v[180:183], v[144:147], a[148:151]
buffer_load_dwordx4 v13, s[16:19], s25 offen offset:3072 lds
v_mfma_f32_16x16x32_bf16 a[152:155], v[184:187], v[144:147], a[152:155]
s_add_u32 s25, s25, 262144
ds_read_b128 v[36:39], v14 offset:2048
v_mfma_f32_16x16x32_bf16 a[156:159], v[188:191], v[144:147], a[156:159]
ds_read_b128 v[40:43], v14 offset:4096
v_mfma_f32_16x16x32_bf16 a[160:163], v[160:163], v[148:151], a[160:163]
v_mfma_f32_16x16x32_bf16 a[164:167], v[164:167], v[148:151], a[164:167]
s_add_u32 m0, s30, 65536
ds_read_b128 v[44:47], v14 offset:6144
v_mfma_f32_16x16x32_bf16 a[168:171], v[168:171], v[148:151], a[168:171]
buffer_load_dwordx4 v2, s[12:15], s24 offen offset:0 lds
v_mfma_f32_16x16x32_bf16 a[172:175], v[172:175], v[148:151], a[172:175]
ds_read_b128 v[48:51], v14 offset:8192
v_mfma_f32_16x16x32_bf16 a[176:179], v[176:179], v[148:151], a[176:179]
v_mfma_f32_16x16x32_bf16 a[180:183], v[180:183], v[148:151], a[180:183]
ds_read_b128 v[52:55], v14 offset:10240
v_mfma_f32_16x16x32_bf16 a[184:187], v[184:187], v[148:151], a[184:187]
buffer_load_dwordx4 v3, s[12:15], s24 offen offset:1024 lds
v_mfma_f32_16x16x32_bf16 a[188:191], v[188:191], v[148:151], a[188:191]
ds_read_b128 v[56:59], v14 offset:12288
v_mfma_f32_16x16x32_bf16 a[192:195], v[160:163], v[152:155], a[192:195]
v_mfma_f32_16x16x32_bf16 a[196:199], v[164:167], v[152:155], a[196:199]
ds_read_b128 v[60:63], v14 offset:14336
v_mfma_f32_16x16x32_bf16 a[200:203], v[168:171], v[152:155], a[200:203]
v_mfma_f32_16x16x32_bf16 a[204:207], v[172:175], v[152:155], a[204:207]
buffer_load_dwordx4 v4, s[12:15], s24 offen offset:2048 lds
v_mfma_f32_16x16x32_bf16 a[208:211], v[176:179], v[152:155], a[208:211]
v_mfma_f32_16x16x32_bf16 a[212:215], v[180:183], v[152:155], a[212:215]
v_mfma_f32_16x16x32_bf16 a[216:219], v[184:187], v[152:155], a[216:219]
v_mfma_f32_16x16x32_bf16 a[220:223], v[188:191], v[152:155], a[220:223]
v_mfma_f32_16x16x32_bf16 a[224:227], v[160:163], v[156:159], a[224:227]
buffer_load_dwordx4 v5, s[12:15], s24 offen offset:3072 lds
v_mfma_f32_16x16x32_bf16 a[228:231], v[164:167], v[156:159], a[228:231]
s_add_u32 s24, s24, 128
v_mfma_f32_16x16x32_bf16 a[232:235], v[168:171], v[156:159], a[232:235]
v_mfma_f32_16x16x32_bf16 a[236:239], v[172:175], v[156:159], a[236:239]
v_mfma_f32_16x16x32_bf16 a[240:243], v[176:179], v[156:159], a[240:243]
v_mfma_f32_16x16x32_bf16 a[244:247], v[180:183], v[156:159], a[244:247]
v_mfma_f32_16x16x32_bf16 a[248:251], v[184:187], v[156:159], a[248:251]
v_mfma_f32_16x16x32_bf16 a[252:255], v[188:191], v[156:159], a[252:255]
s_waitcnt lgkmcnt(0)
v_mfma_f32_16x16x32_bf16 a[0:3], v[64:67], v[32:35], a[0:3]
v_mfma_f32_16x16x32_bf16 a[4:7], v[68:71], v[32:35], a[4:7]
v_mfma_f32_16x16x32_bf16 a[8:11], v[72:75], v[32:35], a[8:11]
s_waitcnt vmcnt(20)
s_barrier
v_mfma_f32_16x16x32_bf16 a[12:15], v[76:79], v[32:35], a[12:15]
s_add_u32 m0, s31, 65536
ds_read_b128 v[128:131], v15
v_mfma_f32_16x16x32_bf16 a[16:19], v[80:83], v[32:35], a[16:19]
buffer_load_dwordx4 v6, s[44:47], s56 offen offset:0 lds
v_mfma_f32_16x16x32_bf16 a[20:23], v[84:87], v[32:35], a[20:23]
ds_read_b64_tr_b16 v[160:161], v20 offset:49152
v_mfma_f32_16x16x32_bf16 a[24:27], v[88:91], v[32:35], a[24:27]
v_mfma_f32_16x16x32_bf16 a[28:31], v[92:95], v[32:35], a[28:31]
ds_read_b64_tr_b16 v[162:163], v20 offset:51200
v_mfma_f32_16x16x32_bf16 a[32:35], v[64:67], v[36:39], a[32:35]
v_mfma_f32_16x16x32_bf16 a[36:39], v[68:71], v[36:39], a[36:39]
ds_read_b64_tr_b16 v[164:165], v21 offset:49152
v_mfma_f32_16x16x32_bf16 a[40:43], v[72:75], v[36:39], a[40:43]
buffer_load_dwordx4 v7, s[44:47], s56 offen offset:1024 lds
v_mfma_f32_16x16x32_bf16 a[44:47], v[76:79], v[36:39], a[44:47]
ds_read_b64_tr_b16 v[166:167], v21 offset:51200
v_mfma_f32_16x16x32_bf16 a[48:51], v[80:83], v[36:39], a[48:51]
v_mfma_f32_16x16x32_bf16 a[52:55], v[84:87], v[36:39], a[52:55]
ds_read_b64_tr_b16 v[168:169], v22 offset:49152
v_mfma_f32_16x16x32_bf16 a[56:59], v[88:91], v[36:39], a[56:59]
v_mfma_f32_16x16x32_bf16 a[60:63], v[92:95], v[36:39], a[60:63]
ds_read_b64_tr_b16 v[170:171], v22 offset:51200
v_mfma_f32_16x16x32_bf16 a[64:67], v[64:67], v[40:43], a[64:67]
v_mfma_f32_16x16x32_bf16 a[68:71], v[68:71], v[40:43], a[68:71]
buffer_load_dwordx4 v8, s[44:47], s56 offen offset:2048 lds
v_mfma_f32_16x16x32_bf16 a[72:75], v[72:75], v[40:43], a[72:75]
ds_read_b64_tr_b16 v[172:173], v23 offset:49152
v_mfma_f32_16x16x32_bf16 a[76:79], v[76:79], v[40:43], a[76:79]
ds_read_b64_tr_b16 v[174:175], v23 offset:51200
v_mfma_f32_16x16x32_bf16 a[80:83], v[80:83], v[40:43], a[80:83]
v_mfma_f32_16x16x32_bf16 a[84:87], v[84:87], v[40:43], a[84:87]
ds_read_b64_tr_b16 v[176:177], v24 offset:49152
v_mfma_f32_16x16x32_bf16 a[88:91], v[88:91], v[40:43], a[88:91]
v_mfma_f32_16x16x32_bf16 a[92:95], v[92:95], v[40:43], a[92:95]
buffer_load_dwordx4 v9, s[44:47], s56 offen offset:3072 lds
v_mfma_f32_16x16x32_bf16 a[96:99], v[64:67], v[44:47], a[96:99]
s_add_u32 s56, s56, s57
ds_read_b64_tr_b16 v[178:179], v24 offset:51200
v_mfma_f32_16x16x32_bf16 a[100:103], v[68:71], v[44:47], a[100:103]
ds_read_b64_tr_b16 v[180:181], v25 offset:49152
v_mfma_f32_16x16x32_bf16 a[104:107], v[72:75], v[44:47], a[104:107]
v_mfma_f32_16x16x32_bf16 a[108:111], v[76:79], v[44:47], a[108:111]
ds_read_b64_tr_b16 v[182:183], v25 offset:51200
v_mfma_f32_16x16x32_bf16 a[112:115], v[80:83], v[44:47], a[112:115]
v_mfma_f32_16x16x32_bf16 a[116:119], v[84:87], v[44:47], a[116:119]
s_add_u32 m0, s58, 32768
ds_read_b64_tr_b16 v[184:185], v26 offset:49152
v_mfma_f32_16x16x32_bf16 a[120:123], v[88:91], v[44:47], a[120:123]
buffer_load_dwordx4 v10, s[16:19], s25 offen offset:0 lds
v_mfma_f32_16x16x32_bf16 a[124:127], v[92:95], v[44:47], a[124:127]
ds_read_b64_tr_b16 v[186:187], v26 offset:51200
v_mfma_f32_16x16x32_bf16 a[128:131], v[64:67], v[48:51], a[128:131]
v_mfma_f32_16x16x32_bf16 a[132:135], v[68:71], v[48:51], a[132:135]
ds_read_b64_tr_b16 v[188:189], v27 offset:49152
v_mfma_f32_16x16x32_bf16 a[136:139], v[72:75], v[48:51], a[136:139]
v_mfma_f32_16x16x32_bf16 a[140:143], v[76:79], v[48:51], a[140:143]
ds_read_b64_tr_b16 v[190:191], v27 offset:51200
v_mfma_f32_16x16x32_bf16 a[144:147], v[80:83], v[48:51], a[144:147]
v_mfma_f32_16x16x32_bf16 a[148:151], v[84:87], v[48:51], a[148:151]
buffer_load_dwordx4 v11, s[16:19], s25 offen offset:1024 lds
v_mfma_f32_16x16x32_bf16 a[152:155], v[88:91], v[48:51], a[152:155]
ds_read_b128 v[132:135], v15 offset:2048
v_mfma_f32_16x16x32_bf16 a[156:159], v[92:95], v[48:51], a[156:159]
ds_read_b128 v[136:139], v15 offset:4096
v_mfma_f32_16x16x32_bf16 a[160:163], v[64:67], v[52:55], a[160:163]
v_mfma_f32_16x16x32_bf16 a[164:167], v[68:71], v[52:55], a[164:167]
ds_read_b128 v[140:143], v15 offset:6144
v_mfma_f32_16x16x32_bf16 a[168:171], v[72:75], v[52:55], a[168:171]
v_mfma_f32_16x16x32_bf16 a[172:175], v[76:79], v[52:55], a[172:175]
buffer_load_dwordx4 v12, s[16:19], s25 offen offset:2048 lds
v_mfma_f32_16x16x32_bf16 a[176:179], v[80:83], v[52:55], a[176:179]
ds_read_b128 v[144:147], v15 offset:8192
v_mfma_f32_16x16x32_bf16 a[180:183], v[84:87], v[52:55], a[180:183]
ds_read_b128 v[148:151], v15 offset:10240
v_mfma_f32_16x16x32_bf16 a[184:187], v[88:91], v[52:55], a[184:187]
v_mfma_f32_16x16x32_bf16 a[188:191], v[92:95], v[52:55], a[188:191]
ds_read_b128 v[152:155], v15 offset:12288
v_mfma_f32_16x16x32_bf16 a[192:195], v[64:67], v[56:59], a[192:195]
v_mfma_f32_16x16x32_bf16 a[196:199], v[68:71], v[56:59], a[196:199]
ds_read_b128 v[156:159], v15 offset:14336
v_mfma_f32_16x16x32_bf16 a[200:203], v[72:75], v[56:59], a[200:203]
buffer_load_dwordx4 v13, s[16:19], s25 offen offset:3072 lds
v_mfma_f32_16x16x32_bf16 a[204:207], v[76:79], v[56:59], a[204:207]
s_add_u32 s25, s25, 262144
v_mfma_f32_16x16x32_bf16 a[208:211], v[80:83], v[56:59], a[208:211]
v_mfma_f32_16x16x32_bf16 a[212:215], v[84:87], v[56:59], a[212:215]
v_mfma_f32_16x16x32_bf16 a[216:219], v[88:91], v[56:59], a[216:219]
v_mfma_f32_16x16x32_bf16 a[220:223], v[92:95], v[56:59], a[220:223]
v_mfma_f32_16x16x32_bf16 a[224:227], v[64:67], v[60:63], a[224:227]
v_mfma_f32_16x16x32_bf16 a[228:231], v[68:71], v[60:63], a[228:231]
v_mfma_f32_16x16x32_bf16 a[232:235], v[72:75], v[60:63], a[232:235]
v_mfma_f32_16x16x32_bf16 a[236:239], v[76:79], v[60:63], a[236:239]
s_add_u32 s74, s73, s30
s_add_u32 s75, s73, s31
v_mfma_f32_16x16x32_bf16 a[240:243], v[80:83], v[60:63], a[240:243]
s_add_u32 s73, s73, 32768
s_cmp_eq_u32 s73, 163840
v_mfma_f32_16x16x32_bf16 a[244:247], v[84:87], v[60:63], a[244:247]
s_cselect_b32 s73, 65536, s73
v_add_u32 v14, s73, v110
v_mfma_f32_16x16x32_bf16 a[248:251], v[88:91], v[60:63], a[248:251]
v_add_u32 v15, s73, v111
v_mfma_f32_16x16x32_bf16 a[252:255], v[92:95], v[60:63], a[252:255]
s_waitcnt lgkmcnt(0)
v_mfma_f32_16x16x32_bf16 a[0:3], v[160:163], v[128:131], a[0:3]
v_mfma_f32_16x16x32_bf16 a[4:7], v[164:167], v[128:131], a[4:7]
v_mfma_f32_16x16x32_bf16 a[8:11], v[168:171], v[128:131], a[8:11]
s_waitcnt vmcnt(16)
s_barrier
v_mfma_f32_16x16x32_bf16 a[12:15], v[172:175], v[128:131], a[12:15]
s_add_u32 m0, s58, 49152
ds_read_b128 v[32:35], v14
v_mfma_f32_16x16x32_bf16 a[16:19], v[176:179], v[128:131], a[16:19]
buffer_load_dwordx4 v10, s[16:19], s25 offen offset:0 lds
v_mfma_f32_16x16x32_bf16 a[20:23], v[180:183], v[128:131], a[20:23]
ds_read_b64_tr_b16 v[64:65], v20 offset:0
v_mfma_f32_16x16x32_bf16 a[24:27], v[184:187], v[128:131], a[24:27]
v_mfma_f32_16x16x32_bf16 a[28:31], v[188:191], v[128:131], a[28:31]
ds_read_b64_tr_b16 v[66:67], v20 offset:2048
v_mfma_f32_16x16x32_bf16 a[32:35], v[160:163], v[132:135], a[32:35]
v_mfma_f32_16x16x32_bf16 a[36:39], v[164:167], v[132:135], a[36:39]
ds_read_b64_tr_b16 v[68:69], v21 offset:0
v_mfma_f32_16x16x32_bf16 a[40:43], v[168:171], v[132:135], a[40:43]
v_mfma_f32_16x16x32_bf16 a[44:47], v[172:175], v[132:135], a[44:47]
buffer_load_dwordx4 v11, s[16:19], s25 offen offset:1024 lds
v_mfma_f32_16x16x32_bf16 a[48:51], v[176:179], v[132:135], a[48:51]
ds_read_b64_tr_b16 v[70:71], v21 offset:2048
v_mfma_f32_16x16x32_bf16 a[52:55], v[180:183], v[132:135], a[52:55]
ds_read_b64_tr_b16 v[72:73], v22 offset:0
v_mfma_f32_16x16x32_bf16 a[56:59], v[184:187], v[132:135], a[56:59]
v_mfma_f32_16x16x32_bf16 a[60:63], v[188:191], v[132:135], a[60:63]
ds_read_b64_tr_b16 v[74:75], v22 offset:2048
v_mfma_f32_16x16x32_bf16 a[64:67], v[160:163], v[136:139], a[64:67]
v_mfma_f32_16x16x32_bf16 a[68:71], v[164:167], v[136:139], a[68:71]
ds_read_b64_tr_b16 v[76:77], v23 offset:0
v_mfma_f32_16x16x32_bf16 a[72:75], v[168:171], v[136:139], a[72:75]
buffer_load_dwordx4 v12, s[16:19], s25 offen offset:2048 lds
v_mfma_f32_16x16x32_bf16 a[76:79], v[172:175], v[136:139], a[76:79]
ds_read_b64_tr_b16 v[78:79], v23 offset:2048
v_mfma_f32_16x16x32_bf16 a[80:83], v[176:179], v[136:139], a[80:83]
v_mfma_f32_16x16x32_bf16 a[84:87], v[180:183], v[136:139], a[84:87]
ds_read_b64_tr_b16 v[80:81], v24 offset:0
v_mfma_f32_16x16x32_bf16 a[88:91], v[184:187], v[136:139], a[88:91]
v_mfma_f32_16x16x32_bf16 a[92:95], v[188:191], v[136:139], a[92:95]
ds_read_b64_tr_b16 v[82:83], v24 offset:2048
v_mfma_f32_16x16x32_bf16 a[96:99], v[160:163], v[140:143], a[96:99]
v_mfma_f32_16x16x32_bf16 a[100:103], v[164:167], v[140:143], a[100:103]
buffer_load_dwordx4 v13, s[16:19], s25 offen offset:3072 lds
v_mfma_f32_16x16x32_bf16 a[104:107], v[168:171], v[140:143], a[104:107]
s_add_u32 s25, s25, 262144
ds_read_b64_tr_b16 v[84:85], v25 offset:0
v_mfma_f32_16x16x32_bf16 a[108:111], v[172:175], v[140:143], a[108:111]
ds_read_b64_tr_b16 v[86:87], v25 offset:2048
v_mfma_f32_16x16x32_bf16 a[112:115], v[176:179], v[140:143], a[112:115]
v_mfma_f32_16x16x32_bf16 a[116:119], v[180:183], v[140:143], a[116:119]
ds_read_b64_tr_b16 v[88:89], v26 offset:0
v_mfma_f32_16x16x32_bf16 a[120:123], v[184:187], v[140:143], a[120:123]
v_mfma_f32_16x16x32_bf16 a[124:127], v[188:191], v[140:143], a[124:127]
s_mov_b32 m0, s74
ds_read_b64_tr_b16 v[90:91], v26 offset:2048
v_mfma_f32_16x16x32_bf16 a[128:131], v[160:163], v[144:147], a[128:131]
buffer_load_dwordx4 v2, s[12:15], s24 offen offset:0 lds
v_mfma_f32_16x16x32_bf16 a[132:135], v[164:167], v[144:147], a[132:135]
ds_read_b64_tr_b16 v[92:93], v27 offset:0
v_mfma_f32_16x16x32_bf16 a[136:139], v[168:171], v[144:147], a[136:139]
v_mfma_f32_16x16x32_bf16 a[140:143], v[172:175], v[144:147], a[140:143]
ds_read_b64_tr_b16 v[94:95], v27 offset:2048
v_mfma_f32_16x16x32_bf16 a[144:147], v[176:179], v[144:147], a[144:147]
v_mfma_f32_16x16x32_bf16 a[148:151], v[180:183], v[144:147], a[148:151]
ds_read_b128 v[36:39], v14 offset:2048
v_mfma_f32_16x16x32_bf16 a[152:155], v[184:187], v[144:147], a[152:155]
v_mfma_f32_16x16x32_bf16 a[156:159], v[188:191], v[144:147], a[156:159]
buffer_load_dwordx4 v3, s[12:15], s24 offen offset:1024 lds
v_mfma_f32_16x16x32_bf16 a[160:163], v[160:163], v[148:151], a[160:163]
ds_read_b128 v[40:43], v14 offset:4096
v_mfma_f32_16x16x32_bf16 a[164:167], v[164:167], v[148:151], a[164:167]
ds_read_b128 v[44:47], v14 offset:6144
v_mfma_f32_16x16x32_bf16 a[168:171], v[168:171], v[148:151], a[168:171]
v_mfma_f32_16x16x32_bf16 a[172:175], v[172:175], v[148:151], a[172:175]
ds_read_b128 v[48:51], v14 offset:8192
v_mfma_f32_16x16x32_bf16 a[176:179], v[176:179], v[148:151], a[176:179]
v_mfma_f32_16x16x32_bf16 a[180:183], v[180:183], v[148:151], a[180:183]
ds_read_b128 v[52:55], v14 offset:10240
v_mfma_f32_16x16x32_bf16 a[184:187], v[184:187], v[148:151], a[184:187]
buffer_load_dwordx4 v4, s[12:15], s24 offen offset:2048 lds
v_mfma_f32_16x16x32_bf16 a[188:191], v[188:191], v[148:151], a[188:191]
ds_read_b128 v[56:59], v14 offset:12288
v_mfma_f32_16x16x32_bf16 a[192:195], v[160:163], v[152:155], a[192:195]
v_mfma_f32_16x16x32_bf16 a[196:199], v[164:167], v[152:155], a[196:199]
ds_read_b128 v[60:63], v14 offset:14336
v_mfma_f32_16x16x32_bf16 a[200:203], v[168:171], v[152:155], a[200:203]
v_mfma_f32_16x16x32_bf16 a[204:207], v[172:175], v[152:155], a[204:207]
v_mfma_f32_16x16x32_bf16 a[208:211], v[176:179], v[152:155], a[208:211]
v_mfma_f32_16x16x32_bf16 a[212:215], v[180:183], v[152:155], a[212:215]
buffer_load_dwordx4 v5, s[12:15], s24 offen offset:3072 lds
v_mfma_f32_16x16x32_bf16 a[216:219], v[184:187], v[152:155], a[216:219]
s_add_u32 s24, s24, 128
v_mfma_f32_16x16x32_bf16 a[220:223], v[188:191], v[152:155], a[220:223]
v_mfma_f32_16x16x32_bf16 a[224:227], v[160:163], v[156:159], a[224:227]
v_mfma_f32_16x16x32_bf16 a[228:231], v[164:167], v[156:159], a[228:231]
v_mfma_f32_16x16x32_bf16 a[232:235], v[168:171], v[156:159], a[232:235]
v_mfma_f32_16x16x32_bf16 a[236:239], v[172:175], v[156:159], a[236:239]
v_mfma_f32_16x16x32_bf16 a[240:243], v[176:179], v[156:159], a[240:243]
v_mfma_f32_16x16x32_bf16 a[244:247], v[180:183], v[156:159], a[244:247]
v_mfma_f32_16x16x32_bf16 a[248:251], v[184:187], v[156:159], a[248:251]
s_add_u32 s36, s36, s40
v_mfma_f32_16x16x32_bf16 a[252:255], v[188:191], v[156:159], a[252:255]
L_kloop_2:
s_waitcnt lgkmcnt(0)
v_mfma_f32_16x16x32_bf16 a[0:3], v[64:67], v[32:35], a[0:3]
v_mfma_f32_16x16x32_bf16 a[4:7], v[68:71], v[32:35], a[4:7]
v_mfma_f32_16x16x32_bf16 a[8:11], v[72:75], v[32:35], a[8:11]
s_waitcnt vmcnt(17)
s_barrier
v_mfma_f32_16x16x32_bf16 a[12:15], v[76:79], v[32:35], a[12:15]
s_cmp_lt_u32 s26, 6
s_cselect_b32 s34, s34, 0
v_mfma_f32_16x16x32_bf16 a[16:19], v[80:83], v[32:35], a[16:19]
buffer_load_dword v127, v126, s[32:35], s36 offen
v_mfma_f32_16x16x32_bf16 a[20:23], v[84:87], v[32:35], a[20:23]
s_add_u32 s36, s36, s40
ds_read_b128 v[128:131], v15
v_mfma_f32_16x16x32_bf16 a[24:27], v[88:91], v[32:35], a[24:27]
ds_read_b64_tr_b16 v[160:161], v20 offset:16384
v_mfma_f32_16x16x32_bf16 a[28:31], v[92:95], v[32:35], a[28:31]
ds_read_b64_tr_b16 v[162:163], v20 offset:18432
v_mfma_f32_16x16x32_bf16 a[32:35], v[64:67], v[36:39], a[32:35]
s_mov_b32 m0, s58
v_mfma_f32_16x16x32_bf16 a[36:39], v[68:71], v[36:39], a[36:39]
buffer_load_dwordx4 v10, s[16:19], s25 offen offset:0 lds
v_mfma_f32_16x16x32_bf16 a[40:43], v[72:75], v[36:39], a[40:43]
ds_read_b64_tr_b16 v[164:165], v21 offset:16384
v_mfma_f32_16x16x32_bf16 a[44:47], v[76:79], v[36:39], a[44:47]
ds_read_b64_tr_b16 v[166:167], v21 offset:18432
v_mfma_f32_16x16x32_bf16 a[48:51], v[80:83], v[36:39], a[48:51]
v_mfma_f32_16x16x32_bf16 a[52:55], v[84:87], v[36:39], a[52:55]
ds_read_b64_tr_b16 v[168:169], v22 offset:16384
v_mfma_f32_16x16x32_bf16 a[56:59], v[88:91], v[36:39], a[56:59]
v_mfma_f32_16x16x32_bf16 a[60:63], v[92:95], v[36:39], a[60:63]
buffer_load_dwordx4 v11, s[16:19], s25 offen offset:1024 lds
v_mfma_f32_16x16x32_bf16 a[64:67], v[64:67], v[40:43], a[64:67]
ds_read_b64_tr_b16 v[170:171], v22 offset:18432
v_mfma_f32_16x16x32_bf16 a[68:71], v[68:71], v[40:43], a[68:71]
ds_read_b64_tr_b16 v[172:173], v23 offset:16384
v_mfma_f32_16x16x32_bf16 a[72:75], v[72:75], v[40:43], a[72:75]
v_mfma_f32_16x16x32_bf16 a[76:79], v[76:79], v[40:43], a[76:79]
ds_read_b64_tr_b16 v[174:175], v23 offset:18432
v_mfma_f32_16x16x32_bf16 a[80:83], v[80:83], v[40:43], a[80:83]
v_mfma_f32_16x16x32_bf16 a[84:87], v[84:87], v[40:43], a[84:87]
buffer_load_dwordx4 v12, s[16:19], s25 offen offset:2048 lds
v_mfma_f32_16x16x32_bf16 a[88:91], v[88:91], v[40:43], a[88:91]
ds_read_b64_tr_b16 v[176:177], v24 offset:16384
v_mfma_f32_16x16x32_bf16 a[92:95], v[92:95], v[40:43], a[92:95]
ds_read_b64_tr_b16 v[178:179], v24 offset:18432
v_mfma_f32_16x16x32_bf16 a[96:99], v[64:67], v[44:47], a[96:99]
v_mfma_f32_16x16x32_bf16 a[100:103], v[68:71], v[44:47], a[100:103]
ds_read_b64_tr_b16 v[180:181], v25 offset:16384
v_mfma_f32_16x16x32_bf16 a[104:107], v[72:75], v[44:47], a[104:107]
v_mfma_f32_16x16x32_bf16 a[108:111], v[76:79], v[44:47], a[108:111]
buffer_load_dwordx4 v13, s[16:19], s25 offen offset:3072 lds
v_mfma_f32_16x16x32_bf16 a[112:115], v[80:83], v[44:47], a[112:115]
s_add_u32 s25, s25, 262144
ds_read_b64_tr_b16 v[182:183], v25 offset:18432
v_mfma_f32_16x16x32_bf16 a[116:119], v[84:87], v[44:47], a[116:119]
ds_read_b64_tr_b16 v[184:185], v26 offset:16384
v_mfma_f32_16x16x32_bf16 a[120:123], v[88:91], v[44:47], a[120:123]
v_mfma_f32_16x16x32_bf16 a[124:127], v[92:95], v[44:47], a[124:127]
ds_read_b64_tr_b16 v[186:187], v26 offset:18432
v_mfma_f32_16x16x32_bf16 a[128:131], v[64:67], v[48:51], a[128:131]
s_mov_b32 m0, s75
v_mfma_f32_16x16x32_bf16 a[132:135], v[68:71], v[48:51], a[132:135]
buffer_load_dwordx4 v6, s[44:47], s56 offen offset:0 lds
v_mfma_f32_16x16x32_bf16 a[136:139], v[72:75], v[48:51], a[136:139]
ds_read_b64_tr_b16 v[188:189], v27 offset:16384
v_mfma_f32_16x16x32_bf16 a[140:143], v[76:79], v[48:51], a[140:143]
ds_read_b64_tr_b16 v[190:191], v27 offset:18432
v_mfma_f32_16x16x32_bf16 a[144:147], v[80:83], v[48:51], a[144:147]
v_mfma_f32_16x16x32_bf16 a[148:151], v[84:87], v[48:51], a[148:151]
ds_read_b128 v[132:135], v15 offset:2048
v_mfma_f32_16x16x32_bf16 a[152:155], v[88:91], v[48:51], a[152:155]
v_mfma_f32_16x16x32_bf16 a[156:159], v[92:95], v[48:51], a[156:159]
buffer_load_dwordx4 v7, s[44:47], s56 offen offset:1024 lds
v_mfma_f32_16x16x32_bf16 a[160:163], v[64:67], v[52:55], a[160:163]
ds_read_b128 v[136:139], v15 offset:4096
v_mfma_f32_16x16x32_bf16 a[164:167], v[68:71], v[52:55], a[164:167]
ds_read_b128 v[140:143], v15 offset:6144
v_mfma_f32_16x16x32_bf16 a[168:171], v[72:75], v[52:55], a[168:171]
v_mfma_f32_16x16x32_bf16 a[172:175], v[76:79], v[52:55], a[172:175]
ds_read_b128 v[144:147], v15 offset:8192
v_mfma_f32_16x16x32_bf16 a[176:179], v[80:83], v[52:55], a[176:179]
v_mfma_f32_16x16x32_bf16 a[180:183], v[84:87], v[52:55], a[180:183]
buffer_load_dwordx4 v8, s[44:47], s56 offen offset:2048 lds
v_mfma_f32_16x16x32_bf16 a[184:187], v[88:91], v[52:55], a[184:187]
ds_read_b128 v[148:151], v15 offset:10240
v_mfma_f32_16x16x32_bf16 a[188:191], v[92:95], v[52:55], a[188:191]
ds_read_b128 v[152:155], v15 offset:12288
v_mfma_f32_16x16x32_bf16 a[192:195], v[64:67], v[56:59], a[192:195]
v_mfma_f32_16x16x32_bf16 a[196:199], v[68:71], v[56:59], a[196:199]
ds_read_b128 v[156:159], v15 offset:14336
v_mfma_f32_16x16x32_bf16 a[200:203], v[72:75], v[56:59], a[200:203]
v_mfma_f32_16x16x32_bf16 a[204:207], v[76:79], v[56:59], a[204:207]
buffer_load_dwordx4 v9, s[44:47], s56 offen offset:3072 lds
v_mfma_f32_16x16x32_bf16 a[208:211], v[80:83], v[56:59], a[208:211]
s_add_u32 s56, s56, s57
v_mfma_f32_16x16x32_bf16 a[212:215], v[84:87], v[56:59], a[212:215]
v_mfma_f32_16x16x32_bf16 a[216:219], v[88:91], v[56:59], a[216:219]
v_mfma_f32_16x16x32_bf16 a[220:223], v[92:95], v[56:59], a[220:223]
v_mfma_f32_16x16x32_bf16 a[224:227], v[64:67], v[60:63], a[224:227]
v_mfma_f32_16x16x32_bf16 a[228:231], v[68:71], v[60:63], a[228:231]
v_mfma_f32_16x16x32_bf16 a[232:235], v[72:75], v[60:63], a[232:235]
v_mfma_f32_16x16x32_bf16 a[236:239], v[76:79], v[60:63], a[236:239]
s_add_u32 s74, s73, s30
s_add_u32 s75, s73, s31
v_mfma_f32_16x16x32_bf16 a[240:243], v[80:83], v[60:63], a[240:243]
s_add_u32 s73, s73, 32768
s_cmp_eq_u32 s73, 163840
v_mfma_f32_16x16x32_bf16 a[244:247], v[84:87], v[60:63], a[244:247]
s_cselect_b32 s73, 65536, s73
v_add_u32 v14, s73, v110
v_mfma_f32_16x16x32_bf16 a[248:251], v[88:91], v[60:63], a[248:251]
v_add_u32 v15, s73, v111
v_mfma_f32_16x16x32_bf16 a[252:255], v[92:95], v[60:63], a[252:255]
s_waitcnt lgkmcnt(0)
v_mfma_f32_16x16x32_bf16 a[0:3], v[160:163], v[128:131], a[0:3]
v_mfma_f32_16x16x32_bf16 a[4:7], v[164:167], v[128:131], a[4:7]
v_mfma_f32_16x16x32_bf16 a[8:11], v[168:171], v[128:131], a[8:11]
s_waitcnt vmcnt(17)
s_barrier
v_mfma_f32_16x16x32_bf16 a[12:15], v[172:175], v[128:131], a[12:15]
s_add_u32 m0, s58, 16384
ds_read_b128 v[32:35], v14
v_mfma_f32_16x16x32_bf16 a[16:19], v[176:179], v[128:131], a[16:19]
buffer_load_dwordx4 v10, s[16:19], s25 offen offset:0 lds
v_mfma_f32_16x16x32_bf16 a[20:23], v[180:183], v[128:131], a[20:23]
ds_read_b64_tr_b16 v[64:65], v20 offset:32768
v_mfma_f32_16x16x32_bf16 a[24:27], v[184:187], v[128:131], a[24:27]
v_mfma_f32_16x16x32_bf16 a[28:31], v[188:191], v[128:131], a[28:31]
ds_read_b64_tr_b16 v[66:67], v20 offset:34816
v_mfma_f32_16x16x32_bf16 a[32:35], v[160:163], v[132:135], a[32:35]
v_mfma_f32_16x16x32_bf16 a[36:39], v[164:167], v[132:135], a[36:39]
ds_read_b64_tr_b16 v[68:69], v21 offset:32768
v_mfma_f32_16x16x32_bf16 a[40:43], v[168:171], v[132:135], a[40:43]
v_mfma_f32_16x16x32_bf16 a[44:47], v[172:175], v[132:135], a[44:47]
buffer_load_dwordx4 v11, s[16:19], s25 offen offset:1024 lds
v_mfma_f32_16x16x32_bf16 a[48:51], v[176:179], v[132:135], a[48:51]
ds_read_b64_tr_b16 v[70:71], v21 offset:34816
v_mfma_f32_16x16x32_bf16 a[52:55], v[180:183], v[132:135], a[52:55]
ds_read_b64_tr_b16 v[72:73], v22 offset:32768
v_mfma_f32_16x16x32_bf16 a[56:59], v[184:187], v[132:135], a[56:59]
v_mfma_f32_16x16x32_bf16 a[60:63], v[188:191], v[132:135], a[60:63]
ds_read_b64_tr_b16 v[74:75], v22 offset:34816
v_mfma_f32_16x16x32_bf16 a[64:67], v[160:163], v[136:139], a[64:67]
v_mfma_f32_16x16x32_bf16 a[68:71], v[164:167], v[136:139], a[68:71]
ds_read_b64_tr_b16 v[76:77], v23 offset:32768
v_mfma_f32_16x16x32_bf16 a[72:75], v[168:171], v[136:139], a[72:75]
buffer_load_dwordx4 v12, s[16:19], s25 offen offset:2048 lds
v_mfma_f32_16x16x32_bf16 a[76:79], v[172:175], v[136:139], a[76:79]
ds_read_b64_tr_b16 v[78:79], v23 offset:34816
v_mfma_f32_16x16x32_bf16 a[80:83], v[176:179], v[136:139], a[80:83]
v_mfma_f32_16x16x32_bf16 a[84:87], v[180:183], v[136:139], a[84:87]
ds_read_b64_tr_b16 v[80:81], v24 offset:32768
v_mfma_f32_16x16x32_bf16 a[88:91], v[184:187], v[136:139], a[88:91]
v_mfma_f32_16x16x32_bf16 a[92:95], v[188:191], v[136:139], a[92:95]
ds_read_b64_tr_b16 v[82:83], v24 offset:34816
v_mfma_f32_16x16x32_bf16 a[96:99], v[160:163], v[140:143], a[96:99]
v_mfma_f32_16x16x32_bf16 a[100:103], v[164:167], v[140:143], a[100:103]
buffer_load_dwordx4 v13, s[16:19], s25 offen offset:3072 lds
v_mfma_f32_16x16x32_bf16 a[104:107], v[168:171], v[140:143], a[104:107]
s_add_u32 s25, s25, 262144
ds_read_b64_tr_b16 v[84:85], v25 offset:32768
v_mfma_f32_16x16x32_bf16 a[108:111], v[172:175], v[140:143], a[108:111]
ds_read_b64_tr_b16 v[86:87], v25 offset:34816
v_mfma_f32_16x16x32_bf16 a[112:115], v[176:179], v[140:143], a[112:115]
v_mfma_f32_16x16x32_bf16 a[116:119], v[180:183], v[140:143], a[116:119]
ds_read_b64_tr_b16 v[88:89], v26 offset:32768
v_mfma_f32_16x16x32_bf16 a[120:123], v[184:187], v[140:143], a[120:123]
v_mfma_f32_16x16x32_bf16 a[124:127], v[188:191], v[140:143], a[124:127]
s_mov_b32 m0, s74
ds_read_b64_tr_b16 v[90:91], v26 offset:34816
v_mfma_f32_16x16x32_bf16 a[128:131], v[160:163], v[144:147], a[128:131]
buffer_load_dwordx4 v2, s[12:15], s24 offen offset:0 lds
v_mfma_f32_16x16x32_bf16 a[132:135], v[164:167], v[144:147], a[132:135]
ds_read_b64_tr_b16 v[92:93], v27 offset:32768
v_mfma_f32_16x16x32_bf16 a[136:139], v[168:171], v[144:147], a[136:139]
v_mfma_f32_16x16x32_bf16 a[140:143], v[172:175], v[144:147], a[140:143]
ds_read_b64_tr_b16 v[94:95], v27 offset:34816
v_mfma_f32_16x16x32_bf16 a[144:147], v[176:179], v[144:147], a[144:147]
v_mfma_f32_16x16x32_bf16 a[148:151], v[180:183], v[144:147], a[148:151]
ds_read_b128 v[36:39], v14 offset:2048
v_mfma_f32_16x16x32_bf16 a[152:155], v[184:187], v[144:147], a[152:155]
v_mfma_f32_16x16x32_bf16 a[156:159], v[188:191], v[144:147], a[156:159]
buffer_load_dwordx4 v3, s[12:15], s24 offen offset:1024 lds
v_mfma_f32_16x16x32_bf16 a[160:163], v[160:163], v[148:151], a[160:163]
ds_read_b128 v[40:43], v14 offset:4096
v_mfma_f32_16x16x32_bf16 a[164:167], v[164:167], v[148:151], a[164:167]
ds_read_b128 v[44:47], v14 offset:6144
v_mfma_f32_16x16x32_bf16 a[168:171], v[168:171], v[148:151], a[168:171]
v_mfma_f32_16x16x32_bf16 a[172:175], v[172:175], v[148:151], a[172:175]
ds_read_b128 v[48:51], v14 offset:8192
v_mfma_f32_16x16x32_bf16 a[176:179], v[176:179], v[148:151], a[176:179]
v_mfma_f32_16x16x32_bf16 a[180:183], v[180:183], v[148:151], a[180:183]
ds_read_b128 v[52:55], v14 offset:10240
v_mfma_f32_16x16x32_bf16 a[184:187], v[184:187], v[148:151], a[184:187]
buffer_load_dwordx4 v4, s[12:15], s24 offen offset:2048 lds
v_mfma_f32_16x16x32_bf16 a[188:191], v[188:191], v[148:151], a[188:191]
ds_read_b128 v[56:59], v14 offset:12288
v_mfma_f32_16x16x32_bf16 a[192:195], v[160:163], v[152:155], a[192:195]
v_mfma_f32_16x16x32_bf16 a[196:199], v[164:167], v[152:155], a[196:199]
ds_read_b128 v[60:63], v14 offset:14336
v_mfma_f32_16x16x32_bf16 a[200:203], v[168:171], v[152:155], a[200:203]
v_mfma_f32_16x16x32_bf16 a[204:207], v[172:175], v[152:155], a[204:207]
v_mfma_f32_16x16x32_bf16 a[208:211], v[176:179], v[152:155], a[208:211]
v_mfma_f32_16x16x32_bf16 a[212:215], v[180:183], v[152:155], a[212:215]
buffer_load_dwordx4 v5, s[12:15], s24 offen offset:3072 lds
v_mfma_f32_16x16x32_bf16 a[216:219], v[184:187], v[152:155], a[216:219]
s_add_u32 s24, s24, 128
v_mfma_f32_16x16x32_bf16 a[220:223], v[188:191], v[152:155], a[220:223]
v_mfma_f32_16x16x32_bf16 a[224:227], v[160:163], v[156:159], a[224:227]
v_mfma_f32_16x16x32_bf16 a[228:231], v[164:167], v[156:159], a[228:231]
v_mfma_f32_16x16x32_bf16 a[232:235], v[168:171], v[156:159], a[232:235]
v_mfma_f32_16x16x32_bf16 a[236:239], v[172:175], v[156:159], a[236:239]
v_mfma_f32_16x16x32_bf16 a[240:243], v[176:179], v[156:159], a[240:243]
v_mfma_f32_16x16x32_bf16 a[244:247], v[180:183], v[156:159], a[244:247]
v_mfma_f32_16x16x32_bf16 a[248:251], v[184:187], v[156:159], a[248:251]
v_mfma_f32_16x16x32_bf16 a[252:255], v[188:191], v[156:159], a[252:255]
s_waitcnt lgkmcnt(0)
v_mfma_f32_16x16x32_bf16 a[0:3], v[64:67], v[32:35], a[0:3]
v_mfma_f32_16x16x32_bf16 a[4:7], v[68:71], v[32:35], a[4:7]
v_mfma_f32_16x16x32_bf16 a[8:11], v[72:75], v[32:35], a[8:11]
s_waitcnt vmcnt(17)
s_barrier
v_mfma_f32_16x16x32_bf16 a[12:15], v[76:79], v[32:35], a[12:15]
s_cmp_eq_u32 s26, 3
s_cselect_b32 s70, 0, s70
v_mfma_f32_16x16x32_bf16 a[16:19], v[80:83], v[32:35], a[16:19]
buffer_load_dword v113, v112, s[52:55], s70 offen
v_mfma_f32_16x16x32_bf16 a[20:23], v[84:87], v[32:35], a[20:23]
s_add_u32 s70, s70, 4096
ds_read_b128 v[128:131], v15
v_mfma_f32_16x16x32_bf16 a[24:27], v[88:91], v[32:35], a[24:27]
ds_read_b64_tr_b16 v[160:161], v20 offset:49152
v_mfma_f32_16x16x32_bf16 a[28:31], v[92:95], v[32:35], a[28:31]
ds_read_b64_tr_b16 v[162:163], v20 offset:51200
v_mfma_f32_16x16x32_bf16 a[32:35], v[64:67], v[36:39], a[32:35]
s_add_u32 m0, s58, 32768
v_mfma_f32_16x16x32_bf16 a[36:39], v[68:71], v[36:39], a[36:39]
buffer_load_dwordx4 v10, s[16:19], s25 offen offset:0 lds
v_mfma_f32_16x16x32_bf16 a[40:43], v[72:75], v[36:39], a[40:43]
ds_read_b64_tr_b16 v[164:165], v21 offset:49152
v_mfma_f32_16x16x32_bf16 a[44:47], v[76:79], v[36:39], a[44:47]
ds_read_b64_tr_b16 v[166:167], v21 offset:51200
v_mfma_f32_16x16x32_bf16 a[48:51], v[80:83], v[36:39], a[48:51]
v_mfma_f32_16x16x32_bf16 a[52:55], v[84:87], v[36:39], a[52:55]
ds_read_b64_tr_b16 v[168:169], v22 offset:49152
v_mfma_f32_16x16x32_bf16 a[56:59], v[88:91], v[36:39], a[56:59]
v_mfma_f32_16x16x32_bf16 a[60:63], v[92:95], v[36:39], a[60:63]
buffer_load_dwordx4 v11, s[16:19], s25 offen offset:1024 lds
v_mfma_f32_16x16x32_bf16 a[64:67], v[64:67], v[40:43], a[64:67]
ds_read_b64_tr_b16 v[170:171], v22 offset:51200
v_mfma_f32_16x16x32_bf16 a[68:71], v[68:71], v[40:43], a[68:71]
ds_read_b64_tr_b16 v[172:173], v23 offset:49152
v_mfma_f32_16x16x32_bf16 a[72:75], v[72:75], v[40:43], a[72:75]
v_mfma_f32_16x16x32_bf16 a[76:79], v[76:79], v[40:43], a[76:79]
ds_read_b64_tr_b16 v[174:175], v23 offset:51200
v_mfma_f32_16x16x32_bf16 a[80:83], v[80:83], v[40:43], a[80:83]
v_mfma_f32_16x16x32_bf16 a[84:87], v[84:87], v[40:43], a[84:87]
buffer_load_dwordx4 v12, s[16:19], s25 offen offset:2048 lds
v_mfma_f32_16x16x32_bf16 a[88:91], v[88:91], v[40:43], a[88:91]
ds_read_b64_tr_b16 v[176:177], v24 offset:49152
v_mfma_f32_16x16x32_bf16 a[92:95], v[92:95], v[40:43], a[92:95]
ds_read_b64_tr_b16 v[178:179], v24 offset:51200
v_mfma_f32_16x16x32_bf16 a[96:99], v[64:67], v[44:47], a[96:99]
v_mfma_f32_16x16x32_bf16 a[100:103], v[68:71], v[44:47], a[100:103]
ds_read_b64_tr_b16 v[180:181], v25 offset:49152
v_mfma_f32_16x16x32_bf16 a[104:107], v[72:75], v[44:47], a[104:107]
v_mfma_f32_16x16x32_bf16 a[108:111], v[76:79], v[44:47], a[108:111]
buffer_load_dwordx4 v13, s[16:19], s25 offen offset:3072 lds
v_mfma_f32_16x16x32_bf16 a[112:115], v[80:83], v[44:47], a[112:115]
s_add_u32 s25, s25, 262144
ds_read_b64_tr_b16 v[182:183], v25 offset:51200
v_mfma_f32_16x16x32_bf16 a[116:119], v[84:87], v[44:47], a[116:119]
ds_read_b64_tr_b16 v[184:185], v26 offset:49152
v_mfma_f32_16x16x32_bf16 a[120:123], v[88:91], v[44:47], a[120:123]
v_mfma_f32_16x16x32_bf16 a[124:127], v[92:95], v[44:47], a[124:127]
s_mov_b32 m0, s75
ds_read_b64_tr_b16 v[186:187], v26 offset:51200
v_mfma_f32_16x16x32_bf16 a[128:131], v[64:67], v[48:51], a[128:131]
buffer_load_dwordx4 v6, s[44:47], s56 offen offset:0 lds
v_mfma_f32_16x16x32_bf16 a[132:135], v[68:71], v[48:51], a[132:135]
ds_read_b64_tr_b16 v[188:189], v27 offset:49152
v_mfma_f32_16x16x32_bf16 a[136:139], v[72:75], v[48:51], a[136:139]
v_mfma_f32_16x16x32_bf16 a[140:143], v[76:79], v[48:51], a[140:143]
ds_read_b64_tr_b16 v[190:191], v27 offset:51200
v_mfma_f32_16x16x32_bf16 a[144:147], v[80:83], v[48:51], a[144:147]
v_mfma_f32_16x16x32_bf16 a[148:151], v[84:87], v[48:51], a[148:151]
ds_read_b128 v[132:135], v15 offset:2048
v_mfma_f32_16x16x32_bf16 a[152:155], v[88:91], v[48:51], a[152:155]
buffer_load_dwordx4 v7, s[44:47], s56 offen offset:1024 lds
v_mfma_f32_16x16x32_bf16 a[156:159], v[92:95], v[48:51], a[156:159]
ds_read_b128 v[136:139], v15 offset:4096
v_mfma_f32_16x16x32_bf16 a[160:163], v[64:67], v[52:55], a[160:163]
v_mfma_f32_16x16x32_bf16 a[164:167], v[68:71], v[52:55], a[164:167]
ds_read_b128 v[140:143], v15 offset:6144
v_mfma_f32_16x16x32_bf16 a[168:171], v[72:75], v[52:55], a[168:171]
v_mfma_f32_16x16x32_bf16 a[172:175], v[76:79], v[52:55], a[172:175]
ds_read_b128 v[144:147], v15 offset:8192
v_mfma_f32_16x16x32_bf16 a[176:179], v[80:83], v[52:55], a[176:179]
buffer_load_dwordx4 v8, s[44:47], s56 offen offset:2048 lds
v_mfma_f32_16x16x32_bf16 a[180:183], v[84:87], v[52:55], a[180:183]
ds_read_b128 v[148:151], v15 offset:10240
v_mfma_f32_16x16x32_bf16 a[184:187], v[88:91], v[52:55], a[184:187]
v_mfma_f32_16x16x32_bf16 a[188:191], v[92:95], v[52:55], a[188:191]
ds_read_b128 v[152:155], v15 offset:12288
v_mfma_f32_16x16x32_bf16 a[192:195], v[64:67], v[56:59], a[192:195]
v_mfma_f32_16x16x32_bf16 a[196:199], v[68:71], v[56:59], a[196:199]
ds_read_b128 v[156:159], v15 offset:14336
v_mfma_f32_16x16x32_bf16 a[200:203], v[72:75], v[56:59], a[200:203]
buffer_load_dwordx4 v9, s[44:47], s56 offen offset:3072 lds
v_mfma_f32_16x16x32_bf16 a[204:207], v[76:79], v[56:59], a[204:207]
s_add_u32 s56, s56, s57
v_mfma_f32_16x16x32_bf16 a[208:211], v[80:83], v[56:59], a[208:211]
v_mfma_f32_16x16x32_bf16 a[212:215], v[84:87], v[56:59], a[212:215]
v_mfma_f32_16x16x32_bf16 a[216:219], v[88:91], v[56:59], a[216:219]
v_mfma_f32_16x16x32_bf16 a[220:223], v[92:95], v[56:59], a[220:223]
v_mfma_f32_16x16x32_bf16 a[224:227], v[64:67], v[60:63], a[224:227]
v_mfma_f32_16x16x32_bf16 a[228:231], v[68:71], v[60:63], a[228:231]
v_mfma_f32_16x16x32_bf16 a[232:235], v[72:75], v[60:63], a[232:235]
s_cmp_eq_u32 s26, 6
s_cbranch_scc1 L_swA_3
L_swA_3_b:
v_mfma_f32_16x16x32_bf16 a[236:239], v[76:79], v[60:63], a[236:239]
s_add_u32 s74, s73, s30
s_add_u32 s75, s73, s31
v_mfma_f32_16x16x32_bf16 a[240:243], v[80:83], v[60:63], a[240:243]
s_add_u32 s73, s73, 32768
s_cmp_eq_u32 s73, 163840
v_mfma_f32_16x16x32_bf16 a[244:247], v[84:87], v[60:63], a[244:247]
s_cselect_b32 s73, 65536, s73
v_add_u32 v14, s73, v110
v_mfma_f32_16x16x32_bf16 a[248:251], v[88:91], v[60:63], a[248:251]
v_add_u32 v15, s73, v111
v_mfma_f32_16x16x32_bf16 a[252:255], v[92:95], v[60:63], a[252:255]
s_waitcnt lgkmcnt(0)
v_mfma_f32_16x16x32_bf16 a[0:3], v[160:163], v[128:131], a[0:3]
v_mfma_f32_16x16x32_bf16 a[4:7], v[164:167], v[128:131], a[4:7]
v_mfma_f32_16x16x32_bf16 a[8:11], v[168:171], v[128:131], a[8:11]
s_waitcnt vmcnt(17)
s_barrier
v_mfma_f32_16x16x32_bf16 a[12:15], v[172:175], v[128:131], a[12:15]
s_add_u32 m0, s58, 49152
ds_read_b128 v[32:35], v14
v_mfma_f32_16x16x32_bf16 a[16:19], v[176:179], v[128:131], a[16:19]
buffer_load_dwordx4 v10, s[16:19], s25 offen offset:0 lds
v_mfma_f32_16x16x32_bf16 a[20:23], v[180:183], v[128:131], a[20:23]
ds_read_b64_tr_b16 v[64:65], v20 offset:0
v_mfma_f32_16x16x32_bf16 a[24:27], v[184:187], v[128:131], a[24:27]
v_mfma_f32_16x16x32_bf16 a[28:31], v[188:191], v[128:131], a[28:31]
ds_read_b64_tr_b16 v[66:67], v20 offset:2048
v_mfma_f32_16x16x32_bf16 a[32:35], v[160:163], v[132:135], a[32:35]
v_mfma_f32_16x16x32_bf16 a[36:39], v[164:167], v[132:135], a[36:39]
ds_read_b64_tr_b16 v[68:69], v21 offset:0
v_mfma_f32_16x16x32_bf16 a[40:43], v[168:171], v[132:135], a[40:43]
buffer_load_dwordx4 v11, s[16:19], s25 offen offset:1024 lds
v_mfma_f32_16x16x32_bf16 a[44:47], v[172:175], v[132:135], a[44:47]
ds_read_b64_tr_b16 v[70:71], v21 offset:2048
v_mfma_f32_16x16x32_bf16 a[48:51], v[176:179], v[132:135], a[48:51]
v_mfma_f32_16x16x32_bf16 a[52:55], v[180:183], v[132:135], a[52:55]
ds_read_b64_tr_b16 v[72:73], v22 offset:0
v_mfma_f32_16x16x32_bf16 a[56:59], v[184:187], v[132:135], a[56:59]
v_mfma_f32_16x16x32_bf16 a[60:63], v[188:191], v[132:135], a[60:63]
ds_read_b64_tr_b16 v[74:75], v22 offset:2048
v_mfma_f32_16x16x32_bf16 a[64:67], v[160:163], v[136:139], a[64:67]
v_mfma_f32_16x16x32_bf16 a[68:71], v[164:167], v[136:139], a[68:71]
buffer_load_dwordx4 v12, s[16:19], s25 offen offset:2048 lds
v_mfma_f32_16x16x32_bf16 a[72:75], v[168:171], v[136:139], a[72:75]
ds_read_b64_tr_b16 v[76:77], v23 offset:0
v_mfma_f32_16x16x32_bf16 a[76:79], v[172:175], v[136:139], a[76:79]
ds_read_b64_tr_b16 v[78:79], v23 offset:2048
v_mfma_f32_16x16x32_bf16 a[80:83], v[176:179], v[136:139], a[80:83]
v_mfma_f32_16x16x32_bf16 a[84:87], v[180:183], v[136:139], a[84:87]
ds_read_b64_tr_b16 v[80:81], v24 offset:0
v_mfma_f32_16x16x32_bf16 a[88:91], v[184:187], v[136:139], a[88:91]
v_mfma_f32_16x16x32_bf16 a[92:95], v[188:191], v[136:139], a[92:95]
ds_read_b64_tr_b16 v[82:83], v24 offset:2048
v_mfma_f32_16x16x32_bf16 a[96:99], v[160:163], v[140:143], a[96:99]
buffer_load_dwordx4 v13, s[16:19], s25 offen offset:3072 lds
v_mfma_f32_16x16x32_bf16 a[100:103], v[164:167], v[140:143], a[100:103]
s_add_u32 s25, s25, 262144
ds_read_b64_tr_b16 v[84:85], v25 offset:0
v_mfma_f32_16x16x32_bf16 a[104:107], v[168:171], v[140:143], a[104:107]
v_mfma_f32_16x16x32_bf16 a[108:111], v[172:175], v[140:143], a[108:111]
ds_read_b64_tr_b16 v[86:87], v25 offset:2048
v_mfma_f32_16x16x32_bf16 a[112:115], v[176:179], v[140:143], a[112:115]
v_mfma_f32_16x16x32_bf16 a[116:119], v[180:183], v[140:143], a[116:119]
ds_read_b64_tr_b16 v[88:89], v26 offset:0
v_mfma_f32_16x16x32_bf16 a[120:123], v[184:187], v[140:143], a[120:123]
s_mov_b32 m0, s74
v_mfma_f32_16x16x32_bf16 a[124:127], v[188:191], v[140:143], a[124:127]
buffer_load_dwordx4 v2, s[12:15], s24 offen offset:0 lds
v_mfma_f32_16x16x32_bf16 a[128:131], v[160:163], v[144:147], a[128:131]
ds_read_b64_tr_b16 v[90:91], v26 offset:2048
v_mfma_f32_16x16x32_bf16 a[132:135], v[164:167], v[144:147], a[132:135]
ds_read_b64_tr_b16 v[92:93], v27 offset:0
v_mfma_f32_16x16x32_bf16 a[136:139], v[168:171], v[144:147], a[136:139]
v_mfma_f32_16x16x32_bf16 a[140:143], v[172:175], v[144:147], a[140:143]
ds_read_b64_tr_b16 v[94:95], v27 offset:2048
v_mfma_f32_16x16x32_bf16 a[144:147], v[176:179], v[144:147], a[144:147]
v_mfma_f32_16x16x32_bf16 a[148:151], v[180:183], v[144:147], a[148:151]
buffer_load_dwordx4 v3, s[12:15], s24 offen offset:1024 lds
v_mfma_f32_16x16x32_bf16 a[152:155], v[184:187], v[144:147], a[152:155]
ds_read_b128 v[36:39], v14 offset:2048
v_mfma_f32_16x16x32_bf16 a[156:159], v[188:191], v[144:147], a[156:159]
ds_read_b128 v[40:43], v14 offset:4096
v_mfma_f32_16x16x32_bf16 a[160:163], v[160:163], v[148:151], a[160:163]
v_mfma_f32_16x16x32_bf16 a[164:167], v[164:167], v[148:151], a[164:167]
ds_read_b128 v[44:47], v14 offset:6144
v_mfma_f32_16x16x32_bf16 a[168:171], v[168:171], v[148:151], a[168:171]
v_mfma_f32_16x16x32_bf16 a[172:175], v[172:175], v[148:151], a[172:175]
ds_read_b128 v[48:51], v14 offset:8192
v_mfma_f32_16x16x32_bf16 a[176:179], v[176:179], v[148:151], a[176:179]
buffer_load_dwordx4 v4, s[12:15], s24 offen offset:2048 lds
v_mfma_f32_16x16x32_bf16 a[180:183], v[180:183], v[148:151], a[180:183]
ds_read_b128 v[52:55], v14 offset:10240
v_mfma_f32_16x16x32_bf16 a[184:187], v[184:187], v[148:151], a[184:187]
v_mfma_f32_16x16x32_bf16 a[188:191], v[188:191], v[148:151], a[188:191]
ds_read_b128 v[56:59], v14 offset:12288
v_mfma_f32_16x16x32_bf16 a[192:195], v[160:163], v[152:155], a[192:195]
v_mfma_f32_16x16x32_bf16 a[196:199], v[164:167], v[152:155], a[196:199]
ds_read_b128 v[60:63], v14 offset:14336
v_mfma_f32_16x16x32_bf16 a[200:203], v[168:171], v[152:155], a[200:203]
v_mfma_f32_16x16x32_bf16 a[204:207], v[172:175], v[152:155], a[204:207]
buffer_load_dwordx4 v5, s[12:15], s24 offen offset:3072 lds
v_mfma_f32_16x16x32_bf16 a[208:211], v[176:179], v[152:155], a[208:211]
s_add_u32 s24, s24, 128
v_mfma_f32_16x16x32_bf16 a[212:215], v[180:183], v[152:155], a[212:215]
v_mfma_f32_16x16x32_bf16 a[216:219], v[184:187], v[152:155], a[216:219]
v_mfma_f32_16x16x32_bf16 a[220:223], v[188:191], v[152:155], a[220:223]
v_mfma_f32_16x16x32_bf16 a[224:227], v[160:163], v[156:159], a[224:227]
v_mfma_f32_16x16x32_bf16 a[228:231], v[164:167], v[156:159], a[228:231]
v_mfma_f32_16x16x32_bf16 a[232:235], v[168:171], v[156:159], a[232:235]
v_mfma_f32_16x16x32_bf16 a[236:239], v[172:175], v[156:159], a[236:239]
v_mfma_f32_16x16x32_bf16 a[240:243], v[176:179], v[156:159], a[240:243]
s_cmp_eq_u32 s26, 6
s_cbranch_scc1 L_swB_4
L_swB_4_b:
v_mfma_f32_16x16x32_bf16 a[244:247], v[180:183], v[156:159], a[244:247]
s_add_u32 s26, s26, 1
s_cmp_lt_u32 s26, 8
v_mfma_f32_16x16x32_bf16 a[248:251], v[184:187], v[156:159], a[248:251]
v_mfma_f32_16x16x32_bf16 a[252:255], v[188:191], v[156:159], a[252:255]
s_cbranch_scc1 L_kloop_2
buffer_load_dwordx4 v[114:117], v109, s[64:67], 0 offen offset:0
buffer_load_dwordx4 v[118:121], v109, s[64:67], 0 offen offset:64
buffer_load_dwordx4 v[122:125], v109, s[64:67], 0 offen offset:128
s_add_u32 s92, s8, 104857600
s_addc_u32 s93, s9, 0
s_mov_b32 s94, 65536
v_lshlrev_b32 v28, 16, v0
v_mov_b32 v29, 0
s_lshr_b32 s28, s37, 1
s_lshl_b32 s29, s38, 4
s_add_u32 s28, s28, s29
s_lshl_b32 s29, s28, 7
buffer_store_dword v29, v28, s[92:95], s29 offen sc1
s_lshl_b32 s29, s28, 4
s_add_u32 s29, s29, 32768
buffer_store_dword v29, v28, s[92:95], s29 offen sc1
s_lshl_b32 s28, s43, 2
s_add_u32 s28, s28, s27
s_lshl_b32 s28, s28, 4
s_add_u32 s28, s28, s38
s_lshl_b32 s29, s28, 4
s_add_u32 s29, s29, 36864
v_lshlrev_b32 v28, 16, v1
buffer_store_dword v29, v28, s[92:95], s29 offen sc1
s_lshl_b32 s29, s43, 7
s_add_u32 s29, s29, 57344
s_or_b32 s28, s38, s27
s_cmp_eq_u32 s28, 0
s_cselect_b32 s29, s29, 0x10000
buffer_store_dword v29, v28, s[92:95], s29 offen sc1
s_add_u32 s92, s8, 105906176
s_addc_u32 s93, s9, 0
s_mov_b32 s94, 8192
buffer_store_dword v197, v196, s[92:95], 0 offen sc1
s_waitcnt lgkmcnt(0)
v_add_u32 v14, s73, v104
v_add_u32 v15, s73, v105
v_add_u32 v16, s73, v106
v_add_u32 v17, s73, v107
v_add_u32 v18, s73, v108
ds_read_b128 v[32:35], v14
ds_read_b64_tr_b16 v[64:65], v20 offset:0
ds_read_b64_tr_b16 v[66:67], v20 offset:2048
ds_read_b64_tr_b16 v[68:69], v21 offset:0
ds_read_b64_tr_b16 v[70:71], v21 offset:2048
ds_read_b64_tr_b16 v[72:73], v22 offset:0
ds_read_b64_tr_b16 v[74:75], v22 offset:2048
ds_read_b64_tr_b16 v[76:77], v23 offset:0
ds_read_b64_tr_b16 v[78:79], v23 offset:2048
ds_read_b64_tr_b16 v[80:81], v24 offset:0
ds_read_b64_tr_b16 v[82:83], v24 offset:2048
ds_read_b64_tr_b16 v[84:85], v25 offset:0
ds_read_b64_tr_b16 v[86:87], v25 offset:2048
ds_read_b64_tr_b16 v[88:89], v26 offset:0
ds_read_b64_tr_b16 v[90:91], v26 offset:2048
ds_read_b64_tr_b16 v[92:93], v27 offset:0
ds_read_b64_tr_b16 v[94:95], v27 offset:2048
ds_read_b64_tr_b16 v[48:49], v16 offset:0
ds_read_b64_tr_b16 v[50:51], v16 offset:768
ds_read_b64_tr_b16 v[52:53], v17 offset:0
ds_read_b64_tr_b16 v[54:55], v17 offset:768
ds_read_b64_tr_b16 v[56:57], v18 offset:0
ds_read_b64_tr_b16 v[58:59], v18 offset:768
ds_read_b128 v[36:39], v14 offset:2048
ds_read_b128 v[40:43], v14 offset:4096
ds_read_b128 v[44:47], v14 offset:6144
s_lshr_b32 s29, 8192, s39
s_nop 7
v_accvgpr_read_b32 v28, a0
v_accvgpr_read_b32 v29, a1
v_accvgpr_read_b32 v30, a2
v_accvgpr_read_b32 v31, a3
v_cvt_pk_bf16_f32 v128, v28, v29
v_cvt_pk_bf16_f32 v129, v30, v31
v_accvgpr_read_b32 v28, a4
v_accvgpr_read_b32 v29, a5
v_accvgpr_read_b32 v30, a6
v_accvgpr_read_b32 v31, a7
v_cvt_pk_bf16_f32 v130, v28, v29
v_cvt_pk_bf16_f32 v131, v30, v31
v_accvgpr_read_b32 v28, a8
v_accvgpr_read_b32 v29, a9
v_accvgpr_read_b32 v30, a10
v_accvgpr_read_b32 v31, a11
v_cvt_pk_bf16_f32 v132, v28, v29
v_cvt_pk_bf16_f32 v133, v30, v31
v_accvgpr_read_b32 v28, a12
v_accvgpr_read_b32 v29, a13
v_accvgpr_read_b32 v30, a14
v_accvgpr_read_b32 v31, a15
v_cvt_pk_bf16_f32 v134, v28, v29
v_cvt_pk_bf16_f32 v135, v30, v31
v_accvgpr_read_b32 v28, a16
v_accvgpr_read_b32 v29, a17
v_accvgpr_read_b32 v30, a18
v_accvgpr_read_b32 v31, a19
v_cvt_pk_bf16_f32 v136, v28, v29
v_cvt_pk_bf16_f32 v137, v30, v31
v_accvgpr_read_b32 v28, a20
v_accvgpr_read_b32 v29, a21
v_accvgpr_read_b32 v30, a22
v_accvgpr_read_b32 v31, a23
v_cvt_pk_bf16_f32 v138, v28, v29
v_cvt_pk_bf16_f32 v139, v30, v31
v_accvgpr_read_b32 v28, a24
v_accvgpr_read_b32 v29, a25
v_accvgpr_read_b32 v30, a26
v_accvgpr_read_b32 v31, a27
v_cvt_pk_bf16_f32 v140, v28, v29
v_cvt_pk_bf16_f32 v141, v30, v31
v_accvgpr_read_b32 v28, a28
v_accvgpr_read_b32 v29, a29
v_accvgpr_read_b32 v30, a30
v_accvgpr_read_b32 v31, a31
v_cvt_pk_bf16_f32 v142, v28, v29
v_cvt_pk_bf16_f32 v143, v30, v31
s_mov_b32 s28, 0
buffer_store_dwordx4 v[128:131], v19, s[20:23], s28 offen offset:0 sc1
v_accvgpr_read_b32 v28, a32
v_accvgpr_read_b32 v29, a33
v_accvgpr_read_b32 v30, a34
v_accvgpr_read_b32 v31, a35
v_cvt_pk_bf16_f32 v144, v28, v29
v_cvt_pk_bf16_f32 v145, v30, v31
v_accvgpr_read_b32 v28, a36
v_accvgpr_read_b32 v29, a37
v_accvgpr_read_b32 v30, a38
v_accvgpr_read_b32 v31, a39
v_cvt_pk_bf16_f32 v146, v28, v29
v_cvt_pk_bf16_f32 v147, v30, v31
v_accvgpr_read_b32 v28, a40
v_accvgpr_read_b32 v29, a41
v_accvgpr_read_b32 v30, a42
v_accvgpr_read_b32 v31, a43
v_cvt_pk_bf16_f32 v148, v28, v29
v_cvt_pk_bf16_f32 v149, v30, v31
v_accvgpr_read_b32 v28, a44
v_accvgpr_read_b32 v29, a45
v_accvgpr_read_b32 v30, a46
v_accvgpr_read_b32 v31, a47
v_cvt_pk_bf16_f32 v150, v28, v29
v_cvt_pk_bf16_f32 v151, v30, v31
v_accvgpr_read_b32 v28, a48
v_accvgpr_read_b32 v29, a49
v_accvgpr_read_b32 v30, a50
v_accvgpr_read_b32 v31, a51
v_cvt_pk_bf16_f32 v152, v28, v29
v_cvt_pk_bf16_f32 v153, v30, v31
v_accvgpr_read_b32 v28, a52
v_accvgpr_read_b32 v29, a53
v_accvgpr_read_b32 v30, a54
v_accvgpr_read_b32 v31, a55
v_cvt_pk_bf16_f32 v154, v28, v29
v_cvt_pk_bf16_f32 v155, v30, v31
buffer_store_dwordx4 v[132:135], v19, s[20:23], s28 offen offset:1024 sc1
v_accvgpr_read_b32 v28, a56
v_accvgpr_read_b32 v29, a57
v_accvgpr_read_b32 v30, a58
v_accvgpr_read_b32 v31, a59
v_cvt_pk_bf16_f32 v156, v28, v29
v_cvt_pk_bf16_f32 v157, v30, v31
v_accvgpr_read_b32 v28, a60
v_accvgpr_read_b32 v29, a61
v_accvgpr_read_b32 v30, a62
v_accvgpr_read_b32 v31, a63
v_cvt_pk_bf16_f32 v158, v28, v29
v_cvt_pk_bf16_f32 v159, v30, v31
v_accvgpr_read_b32 v28, a64
v_accvgpr_read_b32 v29, a65
v_accvgpr_read_b32 v30, a66
v_accvgpr_read_b32 v31, a67
v_cvt_pk_bf16_f32 v160, v28, v29
v_cvt_pk_bf16_f32 v161, v30, v31
v_accvgpr_read_b32 v28, a68
v_accvgpr_read_b32 v29, a69
v_accvgpr_read_b32 v30, a70
v_accvgpr_read_b32 v31, a71
v_cvt_pk_bf16_f32 v162, v28, v29
v_cvt_pk_bf16_f32 v163, v30, v31
v_accvgpr_read_b32 v28, a72
v_accvgpr_read_b32 v29, a73
v_accvgpr_read_b32 v30, a74
v_accvgpr_read_b32 v31, a75
v_cvt_pk_bf16_f32 v164, v28, v29
v_cvt_pk_bf16_f32 v165, v30, v31
v_accvgpr_read_b32 v28, a76
v_accvgpr_read_b32 v29, a77
v_accvgpr_read_b32 v30, a78
v_accvgpr_read_b32 v31, a79
v_cvt_pk_bf16_f32 v166, v28, v29
v_cvt_pk_bf16_f32 v167, v30, v31
buffer_store_dwordx4 v[136:139], v19, s[20:23], s28 offen offset:2048 sc1
v_accvgpr_read_b32 v28, a80
v_accvgpr_read_b32 v29, a81
v_accvgpr_read_b32 v30, a82
v_accvgpr_read_b32 v31, a83
v_cvt_pk_bf16_f32 v168, v28, v29
v_cvt_pk_bf16_f32 v169, v30, v31
v_accvgpr_read_b32 v28, a84
v_accvgpr_read_b32 v29, a85
v_accvgpr_read_b32 v30, a86
v_accvgpr_read_b32 v31, a87
v_cvt_pk_bf16_f32 v170, v28, v29
v_cvt_pk_bf16_f32 v171, v30, v31
v_accvgpr_read_b32 v28, a88
v_accvgpr_read_b32 v29, a89
v_accvgpr_read_b32 v30, a90
v_accvgpr_read_b32 v31, a91
v_cvt_pk_bf16_f32 v172, v28, v29
v_cvt_pk_bf16_f32 v173, v30, v31
v_accvgpr_read_b32 v28, a92
v_accvgpr_read_b32 v29, a93
v_accvgpr_read_b32 v30, a94
v_accvgpr_read_b32 v31, a95
v_cvt_pk_bf16_f32 v174, v28, v29
v_cvt_pk_bf16_f32 v175, v30, v31
v_accvgpr_read_b32 v28, a96
v_accvgpr_read_b32 v29, a97
v_accvgpr_read_b32 v30, a98
v_accvgpr_read_b32 v31, a99
v_cvt_pk_bf16_f32 v176, v28, v29
v_cvt_pk_bf16_f32 v177, v30, v31
v_accvgpr_read_b32 v28, a100
v_accvgpr_read_b32 v29, a101
v_accvgpr_read_b32 v30, a102
v_accvgpr_read_b32 v31, a103
v_cvt_pk_bf16_f32 v178, v28, v29
v_cvt_pk_bf16_f32 v179, v30, v31
buffer_store_dwordx4 v[140:143], v19, s[20:23], s28 offen offset:3072 sc1
v_accvgpr_read_b32 v28, a104
v_accvgpr_read_b32 v29, a105
v_accvgpr_read_b32 v30, a106
v_accvgpr_read_b32 v31, a107
v_cvt_pk_bf16_f32 v180, v28, v29
v_cvt_pk_bf16_f32 v181, v30, v31
v_accvgpr_read_b32 v28, a108
v_accvgpr_read_b32 v29, a109
v_accvgpr_read_b32 v30, a110
v_accvgpr_read_b32 v31, a111
v_cvt_pk_bf16_f32 v182, v28, v29
v_cvt_pk_bf16_f32 v183, v30, v31
v_accvgpr_read_b32 v28, a112
v_accvgpr_read_b32 v29, a113
v_accvgpr_read_b32 v30, a114
v_accvgpr_read_b32 v31, a115
v_cvt_pk_bf16_f32 v184, v28, v29
v_cvt_pk_bf16_f32 v185, v30, v31
v_accvgpr_read_b32 v28, a116
v_accvgpr_read_b32 v29, a117
v_accvgpr_read_b32 v30, a118
v_accvgpr_read_b32 v31, a119
v_cvt_pk_bf16_f32 v186, v28, v29
v_cvt_pk_bf16_f32 v187, v30, v31
v_accvgpr_read_b32 v28, a120
v_accvgpr_read_b32 v29, a121
v_accvgpr_read_b32 v30, a122
v_accvgpr_read_b32 v31, a123
v_cvt_pk_bf16_f32 v188, v28, v29
v_cvt_pk_bf16_f32 v189, v30, v31
v_accvgpr_read_b32 v28, a124
v_accvgpr_read_b32 v29, a125
v_accvgpr_read_b32 v30, a126
v_accvgpr_read_b32 v31, a127
v_cvt_pk_bf16_f32 v190, v28, v29
v_cvt_pk_bf16_f32 v191, v30, v31
s_add_u32 s28, s29, 0
buffer_store_dwordx4 v[144:147], v19, s[20:23], s28 offen offset:0 sc1
v_accvgpr_read_b32 v28, a128
v_accvgpr_read_b32 v29, a129
v_accvgpr_read_b32 v30, a130
v_accvgpr_read_b32 v31, a131
v_cvt_pk_bf16_f32 v192, v28, v29
v_cvt_pk_bf16_f32 v193, v30, v31
v_accvgpr_read_b32 v28, a132
v_accvgpr_read_b32 v29, a133
v_accvgpr_read_b32 v30, a134
v_accvgpr_read_b32 v31, a135
v_cvt_pk_bf16_f32 v194, v28, v29
v_cvt_pk_bf16_f32 v195, v30, v31
v_accvgpr_read_b32 v28, a136
v_accvgpr_read_b32 v29, a137
v_accvgpr_read_b32 v30, a138
v_accvgpr_read_b32 v31, a139
v_cvt_pk_bf16_f32 v196, v28, v29
v_cvt_pk_bf16_f32 v197, v30, v31
v_accvgpr_read_b32 v28, a140
v_accvgpr_read_b32 v29, a141
v_accvgpr_read_b32 v30, a142
v_accvgpr_read_b32 v31, a143
v_cvt_pk_bf16_f32 v198, v28, v29
v_cvt_pk_bf16_f32 v199, v30, v31
v_accvgpr_read_b32 v28, a144
v_accvgpr_read_b32 v29, a145
v_accvgpr_read_b32 v30, a146
v_accvgpr_read_b32 v31, a147
v_cvt_pk_bf16_f32 v200, v28, v29
v_cvt_pk_bf16_f32 v201, v30, v31
v_accvgpr_read_b32 v28, a148
v_accvgpr_read_b32 v29, a149
v_accvgpr_read_b32 v30, a150
v_accvgpr_read_b32 v31, a151
v_cvt_pk_bf16_f32 v202, v28, v29
v_cvt_pk_bf16_f32 v203, v30, v31
v_accvgpr_read_b32 v28, a152
v_accvgpr_read_b32 v29, a153
v_accvgpr_read_b32 v30, a154
v_accvgpr_read_b32 v31, a155
v_cvt_pk_bf16_f32 v204, v28, v29
v_cvt_pk_bf16_f32 v205, v30, v31
v_accvgpr_read_b32 v28, a156
v_accvgpr_read_b32 v29, a157
v_accvgpr_read_b32 v30, a158
v_accvgpr_read_b32 v31, a159
v_cvt_pk_bf16_f32 v206, v28, v29
v_cvt_pk_bf16_f32 v207, v30, v31
buffer_store_dwordx4 v[148:151], v19, s[20:23], s28 offen offset:1024 sc1
v_accvgpr_read_b32 v28, a160
v_accvgpr_read_b32 v29, a161
v_accvgpr_read_b32 v30, a162
v_accvgpr_read_b32 v31, a163
v_cvt_pk_bf16_f32 v208, v28, v29
v_cvt_pk_bf16_f32 v209, v30, v31
v_accvgpr_read_b32 v28, a164
v_accvgpr_read_b32 v29, a165
v_accvgpr_read_b32 v30, a166
v_accvgpr_read_b32 v31, a167
v_cvt_pk_bf16_f32 v210, v28, v29
v_cvt_pk_bf16_f32 v211, v30, v31
v_accvgpr_read_b32 v28, a168
v_accvgpr_read_b32 v29, a169
v_accvgpr_read_b32 v30, a170
v_accvgpr_read_b32 v31, a171
v_cvt_pk_bf16_f32 v212, v28, v29
v_cvt_pk_bf16_f32 v213, v30, v31
v_accvgpr_read_b32 v28, a172
v_accvgpr_read_b32 v29, a173
v_accvgpr_read_b32 v30, a174
v_accvgpr_read_b32 v31, a175
v_cvt_pk_bf16_f32 v214, v28, v29
v_cvt_pk_bf16_f32 v215, v30, v31
v_accvgpr_read_b32 v28, a176
v_accvgpr_read_b32 v29, a177
v_accvgpr_read_b32 v30, a178
v_accvgpr_read_b32 v31, a179
v_cvt_pk_bf16_f32 v216, v28, v29
v_cvt_pk_bf16_f32 v217, v30, v31
v_accvgpr_read_b32 v28, a180
v_accvgpr_read_b32 v29, a181
v_accvgpr_read_b32 v30, a182
v_accvgpr_read_b32 v31, a183
v_cvt_pk_bf16_f32 v218, v28, v29
v_cvt_pk_bf16_f32 v219, v30, v31
buffer_store_dwordx4 v[152:155], v19, s[20:23], s28 offen offset:2048 sc1
v_accvgpr_read_b32 v28, a184
v_accvgpr_read_b32 v29, a185
v_accvgpr_read_b32 v30, a186
v_accvgpr_read_b32 v31, a187
v_cvt_pk_bf16_f32 v220, v28, v29
v_cvt_pk_bf16_f32 v221, v30, v31
v_accvgpr_read_b32 v28, a188
v_accvgpr_read_b32 v29, a189
v_accvgpr_read_b32 v30, a190
v_accvgpr_read_b32 v31, a191
v_cvt_pk_bf16_f32 v222, v28, v29
v_cvt_pk_bf16_f32 v223, v30, v31
v_accvgpr_read_b32 v28, a192
v_accvgpr_read_b32 v29, a193
v_accvgpr_read_b32 v30, a194
v_accvgpr_read_b32 v31, a195
v_cvt_pk_bf16_f32 v224, v28, v29
v_cvt_pk_bf16_f32 v225, v30, v31
v_accvgpr_read_b32 v28, a196
v_accvgpr_read_b32 v29, a197
v_accvgpr_read_b32 v30, a198
v_accvgpr_read_b32 v31, a199
v_cvt_pk_bf16_f32 v226, v28, v29
v_cvt_pk_bf16_f32 v227, v30, v31
v_accvgpr_read_b32 v28, a200
v_accvgpr_read_b32 v29, a201
v_accvgpr_read_b32 v30, a202
v_accvgpr_read_b32 v31, a203
v_cvt_pk_bf16_f32 v228, v28, v29
v_cvt_pk_bf16_f32 v229, v30, v31
v_accvgpr_read_b32 v28, a204
v_accvgpr_read_b32 v29, a205
v_accvgpr_read_b32 v30, a206
v_accvgpr_read_b32 v31, a207
v_cvt_pk_bf16_f32 v230, v28, v29
v_cvt_pk_bf16_f32 v231, v30, v31
buffer_store_dwordx4 v[156:159], v19, s[20:23], s28 offen offset:3072 sc1
v_accvgpr_read_b32 v28, a208
v_accvgpr_read_b32 v29, a209
v_accvgpr_read_b32 v30, a210
v_accvgpr_read_b32 v31, a211
v_cvt_pk_bf16_f32 v232, v28, v29
v_cvt_pk_bf16_f32 v233, v30, v31
v_accvgpr_read_b32 v28, a212
v_accvgpr_read_b32 v29, a213
v_accvgpr_read_b32 v30, a214
v_accvgpr_read_b32 v31, a215
v_cvt_pk_bf16_f32 v234, v28, v29
v_cvt_pk_bf16_f32 v235, v30, v31
v_accvgpr_read_b32 v28, a216
v_accvgpr_read_b32 v29, a217
v_accvgpr_read_b32 v30, a218
v_accvgpr_read_b32 v31, a219
v_cvt_pk_bf16_f32 v236, v28, v29
v_cvt_pk_bf16_f32 v237, v30, v31
v_accvgpr_read_b32 v28, a220
v_accvgpr_read_b32 v29, a221
v_accvgpr_read_b32 v30, a222
v_accvgpr_read_b32 v31, a223
v_cvt_pk_bf16_f32 v238, v28, v29
v_cvt_pk_bf16_f32 v239, v30, v31
v_accvgpr_read_b32 v28, a224
v_accvgpr_read_b32 v29, a225
v_accvgpr_read_b32 v30, a226
v_accvgpr_read_b32 v31, a227
v_cvt_pk_bf16_f32 v240, v28, v29
v_cvt_pk_bf16_f32 v241, v30, v31
v_accvgpr_read_b32 v28, a228
v_accvgpr_read_b32 v29, a229
v_accvgpr_read_b32 v30, a230
v_accvgpr_read_b32 v31, a231
v_cvt_pk_bf16_f32 v242, v28, v29
v_cvt_pk_bf16_f32 v243, v30, v31
s_mov_b32 s28, 16384
buffer_store_dwordx4 v[160:163], v19, s[20:23], s28 offen offset:0 sc1
v_accvgpr_read_b32 v28, a232
v_accvgpr_read_b32 v29, a233
v_accvgpr_read_b32 v30, a234
v_accvgpr_read_b32 v31, a235
v_cvt_pk_bf16_f32 v244, v28, v29
v_cvt_pk_bf16_f32 v245, v30, v31
v_accvgpr_read_b32 v28, a236
v_accvgpr_read_b32 v29, a237
v_accvgpr_read_b32 v30, a238
v_accvgpr_read_b32 v31, a239
v_cvt_pk_bf16_f32 v246, v28, v29
v_cvt_pk_bf16_f32 v247, v30, v31
v_accvgpr_read_b32 v28, a240
v_accvgpr_read_b32 v29, a241
v_accvgpr_read_b32 v30, a242
v_accvgpr_read_b32 v31, a243
v_cvt_pk_bf16_f32 v248, v28, v29
v_cvt_pk_bf16_f32 v249, v30, v31
v_accvgpr_read_b32 v28, a244
v_accvgpr_read_b32 v29, a245
v_accvgpr_read_b32 v30, a246
v_accvgpr_read_b32 v31, a247
v_cvt_pk_bf16_f32 v250, v28, v29
v_cvt_pk_bf16_f32 v251, v30, v31
v_accvgpr_read_b32 v28, a248
v_accvgpr_read_b32 v29, a249
v_accvgpr_read_b32 v30, a250
v_accvgpr_read_b32 v31, a251
v_cvt_pk_bf16_f32 v252, v28, v29
v_cvt_pk_bf16_f32 v253, v30, v31
v_accvgpr_read_b32 v28, a252
v_accvgpr_read_b32 v29, a253
v_accvgpr_read_b32 v30, a254
v_accvgpr_read_b32 v31, a255
v_cvt_pk_bf16_f32 v254, v28, v29
v_cvt_pk_bf16_f32 v255, v30, v31
buffer_store_dwordx4 v[164:167], v19, s[20:23], s28 offen offset:1024 sc1
s_branch L_k1_p2
L_k1_v:
s_waitcnt lgkmcnt(0)
v_mfma_f32_16x16x32_bf16 a[0:3], v[32:35], v[64:67], 0
v_mfma_f32_16x16x32_bf16 a[4:7], v[32:35], v[68:71], 0
v_mfma_f32_16x16x32_bf16 a[8:11], v[32:35], v[72:75], 0
s_waitcnt vmcnt(12)
s_barrier
v_mfma_f32_16x16x32_bf16 a[12:15], v[32:35], v[76:79], 0
s_add_u32 m0, s58, 49152
ds_read_b128 v[128:131], v15
v_mfma_f32_16x16x32_bf16 a[16:19], v[32:35], v[80:83], 0
buffer_load_dwordx4 v10, s[16:19], s25 offen offset:0 lds
v_mfma_f32_16x16x32_bf16 a[20:23], v[32:35], v[84:87], 0
ds_read_b64_tr_b16 v[160:161], v20 offset:16384
v_mfma_f32_16x16x32_bf16 a[24:27], v[32:35], v[88:91], 0
v_mfma_f32_16x16x32_bf16 a[28:31], v[32:35], v[92:95], 0
ds_read_b64_tr_b16 v[162:163], v20 offset:18432
v_mfma_f32_16x16x32_bf16 a[32:35], v[36:39], v[64:67], 0
buffer_load_dwordx4 v11, s[16:19], s25 offen offset:1024 lds
v_mfma_f32_16x16x32_bf16 a[36:39], v[36:39], v[68:71], 0
ds_read_b64_tr_b16 v[164:165], v21 offset:16384
v_mfma_f32_16x16x32_bf16 a[40:43], v[36:39], v[72:75], 0
v_mfma_f32_16x16x32_bf16 a[44:47], v[36:39], v[76:79], 0
ds_read_b64_tr_b16 v[166:167], v21 offset:18432
v_mfma_f32_16x16x32_bf16 a[48:51], v[36:39], v[80:83], 0
buffer_load_dwordx4 v12, s[16:19], s25 offen offset:2048 lds
v_mfma_f32_16x16x32_bf16 a[52:55], v[36:39], v[84:87], 0
ds_read_b64_tr_b16 v[168:169], v22 offset:16384
v_mfma_f32_16x16x32_bf16 a[56:59], v[36:39], v[88:91], 0
v_mfma_f32_16x16x32_bf16 a[60:63], v[36:39], v[92:95], 0
ds_read_b64_tr_b16 v[170:171], v22 offset:18432
v_mfma_f32_16x16x32_bf16 a[64:67], v[40:43], v[64:67], 0
v_mfma_f32_16x16x32_bf16 a[68:71], v[40:43], v[68:71], 0
buffer_load_dwordx4 v13, s[16:19], s25 offen offset:3072 lds
v_mfma_f32_16x16x32_bf16 a[72:75], v[40:43], v[72:75], 0
s_add_u32 s25, s25, 262144
ds_read_b64_tr_b16 v[172:173], v23 offset:16384
v_mfma_f32_16x16x32_bf16 a[76:79], v[40:43], v[76:79], 0
ds_read_b64_tr_b16 v[174:175], v23 offset:18432
v_mfma_f32_16x16x32_bf16 a[80:83], v[40:43], v[80:83], 0
s_add_u32 m0, s30, 131072
v_mfma_f32_16x16x32_bf16 a[84:87], v[40:43], v[84:87], 0
buffer_load_dwordx4 v2, s[12:15], s24 offen offset:0 lds
v_mfma_f32_16x16x32_bf16 a[88:91], v[40:43], v[88:91], 0
ds_read_b64_tr_b16 v[176:177], v24 offset:16384
v_mfma_f32_16x16x32_bf16 a[92:95], v[40:43], v[92:95], 0
ds_read_b64_tr_b16 v[178:179], v24 offset:18432
v_mfma_f32_16x16x32_bf16 a[96:99], v[44:47], v[64:67], 0
v_mfma_f32_16x16x32_bf16 a[100:103], v[44:47], v[68:71], 0
ds_read_b64_tr_b16 v[180:181], v25 offset:16384
v_mfma_f32_16x16x32_bf16 a[104:107], v[44:47], v[72:75], 0
buffer_load_dwordx4 v3, s[12:15], s24 offen offset:1024 lds
v_mfma_f32_16x16x32_bf16 a[108:111], v[44:47], v[76:79], 0
ds_read_b64_tr_b16 v[182:183], v25 offset:18432
v_mfma_f32_16x16x32_bf16 a[112:115], v[44:47], v[80:83], 0
v_mfma_f32_16x16x32_bf16 a[116:119], v[44:47], v[84:87], 0
ds_read_b64_tr_b16 v[184:185], v26 offset:16384
v_mfma_f32_16x16x32_bf16 a[120:123], v[44:47], v[88:91], 0
buffer_load_dwordx4 v4, s[12:15], s24 offen offset:2048 lds
v_mfma_f32_16x16x32_bf16 a[124:127], v[44:47], v[92:95], 0
ds_read_b64_tr_b16 v[186:187], v26 offset:18432
v_mfma_f32_16x16x32_bf16 a[128:131], v[48:51], v[64:67], 0
v_mfma_f32_16x16x32_bf16 a[132:135], v[48:51], v[68:71], 0
ds_read_b64_tr_b16 v[188:189], v27 offset:16384
v_mfma_f32_16x16x32_bf16 a[136:139], v[48:51], v[72:75], 0
buffer_load_dwordx4 v5, s[12:15], s24 offen offset:3072 lds
v_mfma_f32_16x16x32_bf16 a[140:143], v[48:51], v[76:79], 0
s_add_u32 s24, s24, 128
ds_read_b64_tr_b16 v[190:191], v27 offset:18432
v_mfma_f32_16x16x32_bf16 a[144:147], v[48:51], v[80:83], 0
v_mfma_f32_16x16x32_bf16 a[148:151], v[48:51], v[84:87], 0
ds_read_b128 v[132:135], v15 offset:2048
v_mfma_f32_16x16x32_bf16 a[152:155], v[48:51], v[88:91], 0
s_add_u32 m0, s31, 131072
v_mfma_f32_16x16x32_bf16 a[156:159], v[48:51], v[92:95], 0
buffer_load_dwordx4 v6, s[44:47], s56 offen offset:0 lds
v_mfma_f32_16x16x32_bf16 a[160:163], v[52:55], v[64:67], 0
ds_read_b128 v[136:139], v15 offset:4096
v_mfma_f32_16x16x32_bf16 a[164:167], v[52:55], v[68:71], 0
ds_read_b128 v[140:143], v15 offset:6144
v_mfma_f32_16x16x32_bf16 a[168:171], v[52:55], v[72:75], 0
v_mfma_f32_16x16x32_bf16 a[172:175], v[52:55], v[76:79], 0
buffer_load_dwordx4 v7, s[44:47], s56 offen offset:1024 lds
v_mfma_f32_16x16x32_bf16 a[176:179], v[52:55], v[80:83], 0
ds_read_b128 v[144:147], v15 offset:8192
v_mfma_f32_16x16x32_bf16 a[180:183], v[52:55], v[84:87], 0
ds_read_b128 v[148:151], v15 offset:10240
v_mfma_f32_16x16x32_bf16 a[184:187], v[52:55], v[88:91], 0
v_mfma_f32_16x16x32_bf16 a[188:191], v[52:55], v[92:95], 0
ds_read_b128 v[152:155], v15 offset:12288
v_mfma_f32_16x16x32_bf16 a[192:195], v[56:59], v[64:67], 0
buffer_load_dwordx4 v8, s[44:47], s56 offen offset:2048 lds
v_mfma_f32_16x16x32_bf16 a[196:199], v[56:59], v[68:71], 0
ds_read_b128 v[156:159], v15 offset:14336
v_mfma_f32_16x16x32_bf16 a[200:203], v[56:59], v[72:75], 0
v_mfma_f32_16x16x32_bf16 a[204:207], v[56:59], v[76:79], 0
v_mfma_f32_16x16x32_bf16 a[208:211], v[56:59], v[80:83], 0
buffer_load_dwordx4 v9, s[44:47], s56 offen offset:3072 lds
v_mfma_f32_16x16x32_bf16 a[212:215], v[56:59], v[84:87], 0
s_add_u32 s56, s56, s57
v_mfma_f32_16x16x32_bf16 a[216:219], v[56:59], v[88:91], 0
v_mfma_f32_16x16x32_bf16 a[220:223], v[56:59], v[92:95], 0
v_mfma_f32_16x16x32_bf16 a[224:227], v[60:63], v[64:67], 0
v_mfma_f32_16x16x32_bf16 a[228:231], v[60:63], v[68:71], 0
v_mfma_f32_16x16x32_bf16 a[232:235], v[60:63], v[72:75], 0
v_mfma_f32_16x16x32_bf16 a[236:239], v[60:63], v[76:79], 0
s_add_u32 s74, s73, s30
s_add_u32 s75, s73, s31
v_mfma_f32_16x16x32_bf16 a[240:243], v[60:63], v[80:83], 0
s_add_u32 s73, s73, 32768
s_cmp_eq_u32 s73, 163840
v_mfma_f32_16x16x32_bf16 a[244:247], v[60:63], v[84:87], 0
s_cselect_b32 s73, 65536, s73
v_add_u32 v14, s73, v110
v_mfma_f32_16x16x32_bf16 a[248:251], v[60:63], v[88:91], 0
v_add_u32 v15, s73, v111
v_mfma_f32_16x16x32_bf16 a[252:255], v[60:63], v[92:95], 0
s_waitcnt lgkmcnt(0)
v_mfma_f32_16x16x32_bf16 a[0:3], v[128:131], v[160:163], a[0:3]
v_mfma_f32_16x16x32_bf16 a[4:7], v[128:131], v[164:167], a[4:7]
v_mfma_f32_16x16x32_bf16 a[8:11], v[128:131], v[168:171], a[8:11]
s_waitcnt vmcnt(12)
s_barrier
v_mfma_f32_16x16x32_bf16 a[12:15], v[128:131], v[172:175], a[12:15]
s_mov_b32 m0, s58
ds_read_b128 v[32:35], v14
v_mfma_f32_16x16x32_bf16 a[16:19], v[128:131], v[176:179], a[16:19]
buffer_load_dwordx4 v10, s[16:19], s25 offen offset:0 lds
v_mfma_f32_16x16x32_bf16 a[20:23], v[128:131], v[180:183], a[20:23]
ds_read_b64_tr_b16 v[64:65], v20 offset:32768
v_mfma_f32_16x16x32_bf16 a[24:27], v[128:131], v[184:187], a[24:27]
v_mfma_f32_16x16x32_bf16 a[28:31], v[128:131], v[188:191], a[28:31]
ds_read_b64_tr_b16 v[66:67], v20 offset:34816
v_mfma_f32_16x16x32_bf16 a[32:35], v[132:135], v[160:163], a[32:35]
buffer_load_dwordx4 v11, s[16:19], s25 offen offset:1024 lds
v_mfma_f32_16x16x32_bf16 a[36:39], v[132:135], v[164:167], a[36:39]
ds_read_b64_tr_b16 v[68:69], v21 offset:32768
v_mfma_f32_16x16x32_bf16 a[40:43], v[132:135], v[168:171], a[40:43]
v_mfma_f32_16x16x32_bf16 a[44:47], v[132:135], v[172:175], a[44:47]
ds_read_b64_tr_b16 v[70:71], v21 offset:34816
v_mfma_f32_16x16x32_bf16 a[48:51], v[132:135], v[176:179], a[48:51]
v_mfma_f32_16x16x32_bf16 a[52:55], v[132:135], v[180:183], a[52:55]
buffer_load_dwordx4 v12, s[16:19], s25 offen offset:2048 lds
v_mfma_f32_16x16x32_bf16 a[56:59], v[132:135], v[184:187], a[56:59]
ds_read_b64_tr_b16 v[72:73], v22 offset:32768
v_mfma_f32_16x16x32_bf16 a[60:63], v[132:135], v[188:191], a[60:63]
ds_read_b64_tr_b16 v[74:75], v22 offset:34816
v_mfma_f32_16x16x32_bf16 a[64:67], v[136:139], v[160:163], a[64:67]
v_mfma_f32_16x16x32_bf16 a[68:71], v[136:139], v[164:167], a[68:71]
ds_read_b64_tr_b16 v[76:77], v23 offset:32768
v_mfma_f32_16x16x32_bf16 a[72:75], v[136:139], v[168:171], a[72:75]
buffer_load_dwordx4 v13, s[16:19], s25 offen offset:3072 lds
v_mfma_f32_16x16x32_bf16 a[76:79], v[136:139], v[172:175], a[76:79]
s_add_u32 s25, s25, 262144
ds_read_b64_tr_b16 v[78:79], v23 offset:34816
v_mfma_f32_16x16x32_bf16 a[80:83], v[136:139], v[176:179], a[80:83]
v_mfma_f32_16x16x32_bf16 a[84:87], v[136:139], v[180:183], a[84:87]
ds_read_b64_tr_b16 v[80:81], v24 offset:32768
v_mfma_f32_16x16x32_bf16 a[88:91], v[136:139], v[184:187], a[88:91]
s_add_u32 m0, s58, 16384
v_mfma_f32_16x16x32_bf16 a[92:95], v[136:139], v[188:191], a[92:95]
buffer_load_dwordx4 v10, s[16:19], s25 offen offset:0 lds
v_mfma_f32_16x16x32_bf16 a[96:99], v[140:143], v[160:163], a[96:99]
ds_read_b64_tr_b16 v[82:83], v24 offset:34816
v_mfma_f32_16x16x32_bf16 a[100:103], v[140:143], v[164:167], a[100:103]
ds_read_b64_tr_b16 v[84:85], v25 offset:32768
v_mfma_f32_16x16x32_bf16 a[104:107], v[140:143], v[168:171], a[104:107]
v_mfma_f32_16x16x32_bf16 a[108:111], v[140:143], v[172:175], a[108:111]
buffer_load_dwordx4 v11, s[16:19], s25 offen offset:1024 lds
v_mfma_f32_16x16x32_bf16 a[112:115], v[140:143], v[176:179], a[112:115]
ds_read_b64_tr_b16 v[86:87], v25 offset:34816
v_mfma_f32_16x16x32_bf16 a[116:119], v[140:143], v[180:183], a[116:119]
ds_read_b64_tr_b16 v[88:89], v26 offset:32768
v_mfma_f32_16x16x32_bf16 a[120:123], v[140:143], v[184:187], a[120:123]
v_mfma_f32_16x16x32_bf16 a[124:127], v[140:143], v[188:191], a[124:127]
ds_read_b64_tr_b16 v[90:91], v26 offset:34816
v_mfma_f32_16x16x32_bf16 a[128:131], v[144:147], v[160:163], a[128:131]
buffer_load_dwordx4 v12, s[16:19], s25 offen offset:2048 lds
v_mfma_f32_16x16x32_bf16 a[132:135], v[144:147], v[164:167], a[132:135]
ds_read_b64_tr_b16 v[92:93], v27 offset:32768
v_mfma_f32_16x16x32_bf16 a[136:139], v[144:147], v[168:171], a[136:139]
v_mfma_f32_16x16x32_bf16 a[140:143], v[144:147], v[172:175], a[140:143]
ds_read_b64_tr_b16 v[94:95], v27 offset:34816
v_mfma_f32_16x16x32_bf16 a[144:147], v[144:147], v[176:179], a[144:147]
v_mfma_f32_16x16x32_bf16 a[148:151], v[144:147], v[180:183], a[148:151]
buffer_load_dwordx4 v13, s[16:19], s25 offen offset:3072 lds
v_mfma_f32_16x16x32_bf16 a[152:155], v[144:147], v[184:187], a[152:155]
s_add_u32 s25, s25, 262144
ds_read_b128 v[36:39], v14 offset:2048
v_mfma_f32_16x16x32_bf16 a[156:159], v[144:147], v[188:191], a[156:159]
ds_read_b128 v[40:43], v14 offset:4096
v_mfma_f32_16x16x32_bf16 a[160:163], v[148:151], v[160:163], a[160:163]
v_mfma_f32_16x16x32_bf16 a[164:167], v[148:151], v[164:167], a[164:167]
s_add_u32 m0, s30, 65536
ds_read_b128 v[44:47], v14 offset:6144
v_mfma_f32_16x16x32_bf16 a[168:171], v[148:151], v[168:171], a[168:171]
buffer_load_dwordx4 v2, s[12:15], s24 offen offset:0 lds
v_mfma_f32_16x16x32_bf16 a[172:175], v[148:151], v[172:175], a[172:175]
ds_read_b128 v[48:51], v14 offset:8192
v_mfma_f32_16x16x32_bf16 a[176:179], v[148:151], v[176:179], a[176:179]
v_mfma_f32_16x16x32_bf16 a[180:183], v[148:151], v[180:183], a[180:183]
ds_read_b128 v[52:55], v14 offset:10240
v_mfma_f32_16x16x32_bf16 a[184:187], v[148:151], v[184:187], a[184:187]
buffer_load_dwordx4 v3, s[12:15], s24 offen offset:1024 lds
v_mfma_f32_16x16x32_bf16 a[188:191], v[148:151], v[188:191], a[188:191]
ds_read_b128 v[56:59], v14 offset:12288
v_mfma_f32_16x16x32_bf16 a[192:195], v[152:155], v[160:163], a[192:195]
v_mfma_f32_16x16x32_bf16 a[196:199], v[152:155], v[164:167], a[196:199]
ds_read_b128 v[60:63], v14 offset:14336
v_mfma_f32_16x16x32_bf16 a[200:203], v[152:155], v[168:171], a[200:203]
v_mfma_f32_16x16x32_bf16 a[204:207], v[152:155], v[172:175], a[204:207]
buffer_load_dwordx4 v4, s[12:15], s24 offen offset:2048 lds
v_mfma_f32_16x16x32_bf16 a[208:211], v[152:155], v[176:179], a[208:211]
v_mfma_f32_16x16x32_bf16 a[212:215], v[152:155], v[180:183], a[212:215]
v_mfma_f32_16x16x32_bf16 a[216:219], v[152:155], v[184:187], a[216:219]
v_mfma_f32_16x16x32_bf16 a[220:223], v[152:155], v[188:191], a[220:223]
v_mfma_f32_16x16x32_bf16 a[224:227], v[156:159], v[160:163], a[224:227]
buffer_load_dwordx4 v5, s[12:15], s24 offen offset:3072 lds
v_mfma_f32_16x16x32_bf16 a[228:231], v[156:159], v[164:167], a[228:231]
s_add_u32 s24, s24, 128
v_mfma_f32_16x16x32_bf16 a[232:235], v[156:159], v[168:171], a[232:235]
v_mfma_f32_16x16x32_bf16 a[236:239], v[156:159], v[172:175], a[236:239]
v_mfma_f32_16x16x32_bf16 a[240:243], v[156:159], v[176:179], a[240:243]
v_mfma_f32_16x16x32_bf16 a[244:247], v[156:159], v[180:183], a[244:247]
v_mfma_f32_16x16x32_bf16 a[248:251], v[156:159], v[184:187], a[248:251]
v_mfma_f32_16x16x32_bf16 a[252:255], v[156:159], v[188:191], a[252:255]
s_waitcnt lgkmcnt(0)
v_mfma_f32_16x16x32_bf16 a[0:3], v[32:35], v[64:67], a[0:3]
v_mfma_f32_16x16x32_bf16 a[4:7], v[32:35], v[68:71], a[4:7]
v_mfma_f32_16x16x32_bf16 a[8:11], v[32:35], v[72:75], a[8:11]
s_waitcnt vmcnt(20)
s_barrier
v_mfma_f32_16x16x32_bf16 a[12:15], v[32:35], v[76:79], a[12:15]
s_add_u32 m0, s31, 65536
ds_read_b128 v[128:131], v15
v_mfma_f32_16x16x32_bf16 a[16:19], v[32:35], v[80:83], a[16:19]
buffer_load_dwordx4 v6, s[44:47], s56 offen offset:0 lds
v_mfma_f32_16x16x32_bf16 a[20:23], v[32:35], v[84:87], a[20:23]
ds_read_b64_tr_b16 v[160:161], v20 offset:49152
v_mfma_f32_16x16x32_bf16 a[24:27], v[32:35], v[88:91], a[24:27]
v_mfma_f32_16x16x32_bf16 a[28:31], v[32:35], v[92:95], a[28:31]
ds_read_b64_tr_b16 v[162:163], v20 offset:51200
v_mfma_f32_16x16x32_bf16 a[32:35], v[36:39], v[64:67], a[32:35]
v_mfma_f32_16x16x32_bf16 a[36:39], v[36:39], v[68:71], a[36:39]
ds_read_b64_tr_b16 v[164:165], v21 offset:49152
v_mfma_f32_16x16x32_bf16 a[40:43], v[36:39], v[72:75], a[40:43]
buffer_load_dwordx4 v7, s[44:47], s56 offen offset:1024 lds
v_mfma_f32_16x16x32_bf16 a[44:47], v[36:39], v[76:79], a[44:47]
ds_read_b64_tr_b16 v[166:167], v21 offset:51200
v_mfma_f32_16x16x32_bf16 a[48:51], v[36:39], v[80:83], a[48:51]
v_mfma_f32_16x16x32_bf16 a[52:55], v[36:39], v[84:87], a[52:55]
ds_read_b64_tr_b16 v[168:169], v22 offset:49152
v_mfma_f32_16x16x32_bf16 a[56:59], v[36:39], v[88:91], a[56:59]
v_mfma_f32_16x16x32_bf16 a[60:63], v[36:39], v[92:95], a[60:63]
ds_read_b64_tr_b16 v[170:171], v22 offset:51200
v_mfma_f32_16x16x32_bf16 a[64:67], v[40:43], v[64:67], a[64:67]
v_mfma_f32_16x16x32_bf16 a[68:71], v[40:43], v[68:71], a[68:71]
buffer_load_dwordx4 v8, s[44:47], s56 offen offset:2048 lds
v_mfma_f32_16x16x32_bf16 a[72:75], v[40:43], v[72:75], a[72:75]
ds_read_b64_tr_b16 v[172:173], v23 offset:49152
v_mfma_f32_16x16x32_bf16 a[76:79], v[40:43], v[76:79], a[76:79]
ds_read_b64_tr_b16 v[174:175], v23 offset:51200
v_mfma_f32_16x16x32_bf16 a[80:83], v[40:43], v[80:83], a[80:83]
v_mfma_f32_16x16x32_bf16 a[84:87], v[40:43], v[84:87], a[84:87]
ds_read_b64_tr_b16 v[176:177], v24 offset:49152
v_mfma_f32_16x16x32_bf16 a[88:91], v[40:43], v[88:91], a[88:91]
v_mfma_f32_16x16x32_bf16 a[92:95], v[40:43], v[92:95], a[92:95]
buffer_load_dwordx4 v9, s[44:47], s56 offen offset:3072 lds
v_mfma_f32_16x16x32_bf16 a[96:99], v[44:47], v[64:67], a[96:99]
s_add_u32 s56, s56, s57
ds_read_b64_tr_b16 v[178:179], v24 offset:51200
v_mfma_f32_16x16x32_bf16 a[100:103], v[44:47], v[68:71], a[100:103]
ds_read_b64_tr_b16 v[180:181], v25 offset:49152
v_mfma_f32_16x16x32_bf16 a[104:107], v[44:47], v[72:75], a[104:107]
v_mfma_f32_16x16x32_bf16 a[108:111], v[44:47], v[76:79], a[108:111]
ds_read_b64_tr_b16 v[182:183], v25 offset:51200
v_mfma_f32_16x16x32_bf16 a[112:115], v[44:47], v[80:83], a[112:115]
v_mfma_f32_16x16x32_bf16 a[116:119], v[44:47], v[84:87], a[116:119]
s_add_u32 m0, s58, 32768
ds_read_b64_tr_b16 v[184:185], v26 offset:49152
v_mfma_f32_16x16x32_bf16 a[120:123], v[44:47], v[88:91], a[120:123]
buffer_load_dwordx4 v10, s[16:19], s25 offen offset:0 lds
v_mfma_f32_16x16x32_bf16 a[124:127], v[44:47], v[92:95], a[124:127]
ds_read_b64_tr_b16 v[186:187], v26 offset:51200
v_mfma_f32_16x16x32_bf16 a[128:131], v[48:51], v[64:67], a[128:131]
v_mfma_f32_16x16x32_bf16 a[132:135], v[48:51], v[68:71], a[132:135]
ds_read_b64_tr_b16 v[188:189], v27 offset:49152
v_mfma_f32_16x16x32_bf16 a[136:139], v[48:51], v[72:75], a[136:139]
v_mfma_f32_16x16x32_bf16 a[140:143], v[48:51], v[76:79], a[140:143]
ds_read_b64_tr_b16 v[190:191], v27 offset:51200
v_mfma_f32_16x16x32_bf16 a[144:147], v[48:51], v[80:83], a[144:147]
v_mfma_f32_16x16x32_bf16 a[148:151], v[48:51], v[84:87], a[148:151]
buffer_load_dwordx4 v11, s[16:19], s25 offen offset:1024 lds
v_mfma_f32_16x16x32_bf16 a[152:155], v[48:51], v[88:91], a[152:155]
ds_read_b128 v[132:135], v15 offset:2048
v_mfma_f32_16x16x32_bf16 a[156:159], v[48:51], v[92:95], a[156:159]
ds_read_b128 v[136:139], v15 offset:4096
v_mfma_f32_16x16x32_bf16 a[160:163], v[52:55], v[64:67], a[160:163]
v_mfma_f32_16x16x32_bf16 a[164:167], v[52:55], v[68:71], a[164:167]
ds_read_b128 v[140:143], v15 offset:6144
v_mfma_f32_16x16x32_bf16 a[168:171], v[52:55], v[72:75], a[168:171]
v_mfma_f32_16x16x32_bf16 a[172:175], v[52:55], v[76:79], a[172:175]
buffer_load_dwordx4 v12, s[16:19], s25 offen offset:2048 lds
v_mfma_f32_16x16x32_bf16 a[176:179], v[52:55], v[80:83], a[176:179]
ds_read_b128 v[144:147], v15 offset:8192
v_mfma_f32_16x16x32_bf16 a[180:183], v[52:55], v[84:87], a[180:183]
ds_read_b128 v[148:151], v15 offset:10240
v_mfma_f32_16x16x32_bf16 a[184:187], v[52:55], v[88:91], a[184:187]
v_mfma_f32_16x16x32_bf16 a[188:191], v[52:55], v[92:95], a[188:191]
ds_read_b128 v[152:155], v15 offset:12288
v_mfma_f32_16x16x32_bf16 a[192:195], v[56:59], v[64:67], a[192:195]
v_mfma_f32_16x16x32_bf16 a[196:199], v[56:59], v[68:71], a[196:199]
ds_read_b128 v[156:159], v15 offset:14336
v_mfma_f32_16x16x32_bf16 a[200:203], v[56:59], v[72:75], a[200:203]
buffer_load_dwordx4 v13, s[16:19], s25 offen offset:3072 lds
v_mfma_f32_16x16x32_bf16 a[204:207], v[56:59], v[76:79], a[204:207]
s_add_u32 s25, s25, 262144
v_mfma_f32_16x16x32_bf16 a[208:211], v[56:59], v[80:83], a[208:211]
v_mfma_f32_16x16x32_bf16 a[212:215], v[56:59], v[84:87], a[212:215]
v_mfma_f32_16x16x32_bf16 a[216:219], v[56:59], v[88:91], a[216:219]
v_mfma_f32_16x16x32_bf16 a[220:223], v[56:59], v[92:95], a[220:223]
v_mfma_f32_16x16x32_bf16 a[224:227], v[60:63], v[64:67], a[224:227]
v_mfma_f32_16x16x32_bf16 a[228:231], v[60:63], v[68:71], a[228:231]
v_mfma_f32_16x16x32_bf16 a[232:235], v[60:63], v[72:75], a[232:235]
v_mfma_f32_16x16x32_bf16 a[236:239], v[60:63], v[76:79], a[236:239]
s_add_u32 s74, s73, s30
s_add_u32 s75, s73, s31
v_mfma_f32_16x16x32_bf16 a[240:243], v[60:63], v[80:83], a[240:243]
s_add_u32 s73, s73, 32768
s_cmp_eq_u32 s73, 163840
v_mfma_f32_16x16x32_bf16 a[244:247], v[60:63], v[84:87], a[244:247]
s_cselect_b32 s73, 65536, s73
v_add_u32 v14, s73, v110
v_mfma_f32_16x16x32_bf16 a[248:251], v[60:63], v[88:91], a[248:251]
v_add_u32 v15, s73, v111
v_mfma_f32_16x16x32_bf16 a[252:255], v[60:63], v[92:95], a[252:255]
s_waitcnt lgkmcnt(0)
v_mfma_f32_16x16x32_bf16 a[0:3], v[128:131], v[160:163], a[0:3]
v_mfma_f32_16x16x32_bf16 a[4:7], v[128:131], v[164:167], a[4:7]
v_mfma_f32_16x16x32_bf16 a[8:11], v[128:131], v[168:171], a[8:11]
s_waitcnt vmcnt(16)
s_barrier
v_mfma_f32_16x16x32_bf16 a[12:15], v[128:131], v[172:175], a[12:15]
s_add_u32 m0, s58, 49152
ds_read_b128 v[32:35], v14
v_mfma_f32_16x16x32_bf16 a[16:19], v[128:131], v[176:179], a[16:19]
buffer_load_dwordx4 v10, s[16:19], s25 offen offset:0 lds
v_mfma_f32_16x16x32_bf16 a[20:23], v[128:131], v[180:183], a[20:23]
ds_read_b64_tr_b16 v[64:65], v20 offset:0
v_mfma_f32_16x16x32_bf16 a[24:27], v[128:131], v[184:187], a[24:27]
v_mfma_f32_16x16x32_bf16 a[28:31], v[128:131], v[188:191], a[28:31]
ds_read_b64_tr_b16 v[66:67], v20 offset:2048
v_mfma_f32_16x16x32_bf16 a[32:35], v[132:135], v[160:163], a[32:35]
v_mfma_f32_16x16x32_bf16 a[36:39], v[132:135], v[164:167], a[36:39]
ds_read_b64_tr_b16 v[68:69], v21 offset:0
v_mfma_f32_16x16x32_bf16 a[40:43], v[132:135], v[168:171], a[40:43]
v_mfma_f32_16x16x32_bf16 a[44:47], v[132:135], v[172:175], a[44:47]
buffer_load_dwordx4 v11, s[16:19], s25 offen offset:1024 lds
v_mfma_f32_16x16x32_bf16 a[48:51], v[132:135], v[176:179], a[48:51]
ds_read_b64_tr_b16 v[70:71], v21 offset:2048
v_mfma_f32_16x16x32_bf16 a[52:55], v[132:135], v[180:183], a[52:55]
ds_read_b64_tr_b16 v[72:73], v22 offset:0
v_mfma_f32_16x16x32_bf16 a[56:59], v[132:135], v[184:187], a[56:59]
v_mfma_f32_16x16x32_bf16 a[60:63], v[132:135], v[188:191], a[60:63]
ds_read_b64_tr_b16 v[74:75], v22 offset:2048
v_mfma_f32_16x16x32_bf16 a[64:67], v[136:139], v[160:163], a[64:67]
v_mfma_f32_16x16x32_bf16 a[68:71], v[136:139], v[164:167], a[68:71]
ds_read_b64_tr_b16 v[76:77], v23 offset:0
v_mfma_f32_16x16x32_bf16 a[72:75], v[136:139], v[168:171], a[72:75]
buffer_load_dwordx4 v12, s[16:19], s25 offen offset:2048 lds
v_mfma_f32_16x16x32_bf16 a[76:79], v[136:139], v[172:175], a[76:79]
ds_read_b64_tr_b16 v[78:79], v23 offset:2048
v_mfma_f32_16x16x32_bf16 a[80:83], v[136:139], v[176:179], a[80:83]
v_mfma_f32_16x16x32_bf16 a[84:87], v[136:139], v[180:183], a[84:87]
ds_read_b64_tr_b16 v[80:81], v24 offset:0
v_mfma_f32_16x16x32_bf16 a[88:91], v[136:139], v[184:187], a[88:91]
v_mfma_f32_16x16x32_bf16 a[92:95], v[136:139], v[188:191], a[92:95]
ds_read_b64_tr_b16 v[82:83], v24 offset:2048
v_mfma_f32_16x16x32_bf16 a[96:99], v[140:143], v[160:163], a[96:99]
v_mfma_f32_16x16x32_bf16 a[100:103], v[140:143], v[164:167], a[100:103]
buffer_load_dwordx4 v13, s[16:19], s25 offen offset:3072 lds
v_mfma_f32_16x16x32_bf16 a[104:107], v[140:143], v[168:171], a[104:107]
s_add_u32 s25, s25, 262144
ds_read_b64_tr_b16 v[84:85], v25 offset:0
v_mfma_f32_16x16x32_bf16 a[108:111], v[140:143], v[172:175], a[108:111]
ds_read_b64_tr_b16 v[86:87], v25 offset:2048
v_mfma_f32_16x16x32_bf16 a[112:115], v[140:143], v[176:179], a[112:115]
v_mfma_f32_16x16x32_bf16 a[116:119], v[140:143], v[180:183], a[116:119]
ds_read_b64_tr_b16 v[88:89], v26 offset:0
v_mfma_f32_16x16x32_bf16 a[120:123], v[140:143], v[184:187], a[120:123]
v_mfma_f32_16x16x32_bf16 a[124:127], v[140:143], v[188:191], a[124:127]
s_mov_b32 m0, s74
ds_read_b64_tr_b16 v[90:91], v26 offset:2048
v_mfma_f32_16x16x32_bf16 a[128:131], v[144:147], v[160:163], a[128:131]
buffer_load_dwordx4 v2, s[12:15], s24 offen offset:0 lds
v_mfma_f32_16x16x32_bf16 a[132:135], v[144:147], v[164:167], a[132:135]
ds_read_b64_tr_b16 v[92:93], v27 offset:0
v_mfma_f32_16x16x32_bf16 a[136:139], v[144:147], v[168:171], a[136:139]
v_mfma_f32_16x16x32_bf16 a[140:143], v[144:147], v[172:175], a[140:143]
ds_read_b64_tr_b16 v[94:95], v27 offset:2048
v_mfma_f32_16x16x32_bf16 a[144:147], v[144:147], v[176:179], a[144:147]
v_mfma_f32_16x16x32_bf16 a[148:151], v[144:147], v[180:183], a[148:151]
ds_read_b128 v[36:39], v14 offset:2048
v_mfma_f32_16x16x32_bf16 a[152:155], v[144:147], v[184:187], a[152:155]
v_mfma_f32_16x16x32_bf16 a[156:159], v[144:147], v[188:191], a[156:159]
buffer_load_dwordx4 v3, s[12:15], s24 offen offset:1024 lds
v_mfma_f32_16x16x32_bf16 a[160:163], v[148:151], v[160:163], a[160:163]
ds_read_b128 v[40:43], v14 offset:4096
v_mfma_f32_16x16x32_bf16 a[164:167], v[148:151], v[164:167], a[164:167]
ds_read_b128 v[44:47], v14 offset:6144
v_mfma_f32_16x16x32_bf16 a[168:171], v[148:151], v[168:171], a[168:171]
v_mfma_f32_16x16x32_bf16 a[172:175], v[148:151], v[172:175], a[172:175]
ds_read_b128 v[48:51], v14 offset:8192
v_mfma_f32_16x16x32_bf16 a[176:179], v[148:151], v[176:179], a[176:179]
v_mfma_f32_16x16x32_bf16 a[180:183], v[148:151], v[180:183], a[180:183]
ds_read_b128 v[52:55], v14 offset:10240
v_mfma_f32_16x16x32_bf16 a[184:187], v[148:151], v[184:187], a[184:187]
buffer_load_dwordx4 v4, s[12:15], s24 offen offset:2048 lds
v_mfma_f32_16x16x32_bf16 a[188:191], v[148:151], v[188:191], a[188:191]
ds_read_b128 v[56:59], v14 offset:12288
v_mfma_f32_16x16x32_bf16 a[192:195], v[152:155], v[160:163], a[192:195]
v_mfma_f32_16x16x32_bf16 a[196:199], v[152:155], v[164:167], a[196:199]
ds_read_b128 v[60:63], v14 offset:14336
v_mfma_f32_16x16x32_bf16 a[200:203], v[152:155], v[168:171], a[200:203]
v_mfma_f32_16x16x32_bf16 a[204:207], v[152:155], v[172:175], a[204:207]
v_mfma_f32_16x16x32_bf16 a[208:211], v[152:155], v[176:179], a[208:211]
v_mfma_f32_16x16x32_bf16 a[212:215], v[152:155], v[180:183], a[212:215]
buffer_load_dwordx4 v5, s[12:15], s24 offen offset:3072 lds
v_mfma_f32_16x16x32_bf16 a[216:219], v[152:155], v[184:187], a[216:219]
s_add_u32 s24, s24, 128
v_mfma_f32_16x16x32_bf16 a[220:223], v[152:155], v[188:191], a[220:223]
v_mfma_f32_16x16x32_bf16 a[224:227], v[156:159], v[160:163], a[224:227]
v_mfma_f32_16x16x32_bf16 a[228:231], v[156:159], v[164:167], a[228:231]
v_mfma_f32_16x16x32_bf16 a[232:235], v[156:159], v[168:171], a[232:235]
v_mfma_f32_16x16x32_bf16 a[236:239], v[156:159], v[172:175], a[236:239]
v_mfma_f32_16x16x32_bf16 a[240:243], v[156:159], v[176:179], a[240:243]
v_mfma_f32_16x16x32_bf16 a[244:247], v[156:159], v[180:183], a[244:247]
v_mfma_f32_16x16x32_bf16 a[248:251], v[156:159], v[184:187], a[248:251]
s_add_u32 s36, s36, s40
v_mfma_f32_16x16x32_bf16 a[252:255], v[156:159], v[188:191], a[252:255]
L_kloop_5:
s_waitcnt lgkmcnt(0)
v_mfma_f32_16x16x32_bf16 a[0:3], v[32:35], v[64:67], a[0:3]
v_mfma_f32_16x16x32_bf16 a[4:7], v[32:35], v[68:71], a[4:7]
v_mfma_f32_16x16x32_bf16 a[8:11], v[32:35], v[72:75], a[8:11]
s_waitcnt vmcnt(17)
s_barrier
v_mfma_f32_16x16x32_bf16 a[12:15], v[32:35], v[76:79], a[12:15]
s_cmp_lt_u32 s26, 6
s_cselect_b32 s34, s34, 0
v_mfma_f32_16x16x32_bf16 a[16:19], v[32:35], v[80:83], a[16:19]
buffer_load_dword v127, v126, s[32:35], s36 offen
v_mfma_f32_16x16x32_bf16 a[20:23], v[32:35], v[84:87], a[20:23]
s_add_u32 s36, s36, s40
ds_read_b128 v[128:131], v15
v_mfma_f32_16x16x32_bf16 a[24:27], v[32:35], v[88:91], a[24:27]
ds_read_b64_tr_b16 v[160:161], v20 offset:16384
v_mfma_f32_16x16x32_bf16 a[28:31], v[32:35], v[92:95], a[28:31]
ds_read_b64_tr_b16 v[162:163], v20 offset:18432
v_mfma_f32_16x16x32_bf16 a[32:35], v[36:39], v[64:67], a[32:35]
s_mov_b32 m0, s58
v_mfma_f32_16x16x32_bf16 a[36:39], v[36:39], v[68:71], a[36:39]
buffer_load_dwordx4 v10, s[16:19], s25 offen offset:0 lds
v_mfma_f32_16x16x32_bf16 a[40:43], v[36:39], v[72:75], a[40:43]
ds_read_b64_tr_b16 v[164:165], v21 offset:16384
v_mfma_f32_16x16x32_bf16 a[44:47], v[36:39], v[76:79], a[44:47]
ds_read_b64_tr_b16 v[166:167], v21 offset:18432
v_mfma_f32_16x16x32_bf16 a[48:51], v[36:39], v[80:83], a[48:51]
v_mfma_f32_16x16x32_bf16 a[52:55], v[36:39], v[84:87], a[52:55]
ds_read_b64_tr_b16 v[168:169], v22 offset:16384
v_mfma_f32_16x16x32_bf16 a[56:59], v[36:39], v[88:91], a[56:59]
v_mfma_f32_16x16x32_bf16 a[60:63], v[36:39], v[92:95], a[60:63]
buffer_load_dwordx4 v11, s[16:19], s25 offen offset:1024 lds
v_mfma_f32_16x16x32_bf16 a[64:67], v[40:43], v[64:67], a[64:67]
ds_read_b64_tr_b16 v[170:171], v22 offset:18432
v_mfma_f32_16x16x32_bf16 a[68:71], v[40:43], v[68:71], a[68:71]
ds_read_b64_tr_b16 v[172:173], v23 offset:16384
v_mfma_f32_16x16x32_bf16 a[72:75], v[40:43], v[72:75], a[72:75]
v_mfma_f32_16x16x32_bf16 a[76:79], v[40:43], v[76:79], a[76:79]
ds_read_b64_tr_b16 v[174:175], v23 offset:18432
v_mfma_f32_16x16x32_bf16 a[80:83], v[40:43], v[80:83], a[80:83]
v_mfma_f32_16x16x32_bf16 a[84:87], v[40:43], v[84:87], a[84:87]
buffer_load_dwordx4 v12, s[16:19], s25 offen offset:2048 lds
v_mfma_f32_16x16x32_bf16 a[88:91], v[40:43], v[88:91], a[88:91]
ds_read_b64_tr_b16 v[176:177], v24 offset:16384
v_mfma_f32_16x16x32_bf16 a[92:95], v[40:43], v[92:95], a[92:95]
ds_read_b64_tr_b16 v[178:179], v24 offset:18432
v_mfma_f32_16x16x32_bf16 a[96:99], v[44:47], v[64:67], a[96:99]
v_mfma_f32_16x16x32_bf16 a[100:103], v[44:47], v[68:71], a[100:103]
ds_read_b64_tr_b16 v[180:181], v25 offset:16384
v_mfma_f32_16x16x32_bf16 a[104:107], v[44:47], v[72:75], a[104:107]
v_mfma_f32_16x16x32_bf16 a[108:111], v[44:47], v[76:79], a[108:111]
buffer_load_dwordx4 v13, s[16:19], s25 offen offset:3072 lds
v_mfma_f32_16x16x32_bf16 a[112:115], v[44:47], v[80:83], a[112:115]
s_add_u32 s25, s25, 262144
ds_read_b64_tr_b16 v[182:183], v25 offset:18432
v_mfma_f32_16x16x32_bf16 a[116:119], v[44:47], v[84:87], a[116:119]
ds_read_b64_tr_b16 v[184:185], v26 offset:16384
v_mfma_f32_16x16x32_bf16 a[120:123], v[44:47], v[88:91], a[120:123]
v_mfma_f32_16x16x32_bf16 a[124:127], v[44:47], v[92:95], a[124:127]
ds_read_b64_tr_b16 v[186:187], v26 offset:18432
v_mfma_f32_16x16x32_bf16 a[128:131], v[48:51], v[64:67], a[128:131]
s_mov_b32 m0, s75
v_mfma_f32_16x16x32_bf16 a[132:135], v[48:51], v[68:71], a[132:135]
buffer_load_dwordx4 v6, s[44:47], s56 offen offset:0 lds
v_mfma_f32_16x16x32_bf16 a[136:139], v[48:51], v[72:75], a[136:139]
ds_read_b64_tr_b16 v[188:189], v27 offset:16384
v_mfma_f32_16x16x32_bf16 a[140:143], v[48:51], v[76:79], a[140:143]
ds_read_b64_tr_b16 v[190:191], v27 offset:18432
v_mfma_f32_16x16x32_bf16 a[144:147], v[48:51], v[80:83], a[144:147]
v_mfma_f32_16x16x32_bf16 a[148:151], v[48:51], v[84:87], a[148:151]
ds_read_b128 v[132:135], v15 offset:2048
v_mfma_f32_16x16x32_bf16 a[152:155], v[48:51], v[88:91], a[152:155]
v_mfma_f32_16x16x32_bf16 a[156:159], v[48:51], v[92:95], a[156:159]
buffer_load_dwordx4 v7, s[44:47], s56 offen offset:1024 lds
v_mfma_f32_16x16x32_bf16 a[160:163], v[52:55], v[64:67], a[160:163]
ds_read_b128 v[136:139], v15 offset:4096
v_mfma_f32_16x16x32_bf16 a[164:167], v[52:55], v[68:71], a[164:167]
ds_read_b128 v[140:143], v15 offset:6144
v_mfma_f32_16x16x32_bf16 a[168:171], v[52:55], v[72:75], a[168:171]
v_mfma_f32_16x16x32_bf16 a[172:175], v[52:55], v[76:79], a[172:175]
ds_read_b128 v[144:147], v15 offset:8192
v_mfma_f32_16x16x32_bf16 a[176:179], v[52:55], v[80:83], a[176:179]
v_mfma_f32_16x16x32_bf16 a[180:183], v[52:55], v[84:87], a[180:183]
buffer_load_dwordx4 v8, s[44:47], s56 offen offset:2048 lds
v_mfma_f32_16x16x32_bf16 a[184:187], v[52:55], v[88:91], a[184:187]
ds_read_b128 v[148:151], v15 offset:10240
v_mfma_f32_16x16x32_bf16 a[188:191], v[52:55], v[92:95], a[188:191]
ds_read_b128 v[152:155], v15 offset:12288
v_mfma_f32_16x16x32_bf16 a[192:195], v[56:59], v[64:67], a[192:195]
v_mfma_f32_16x16x32_bf16 a[196:199], v[56:59], v[68:71], a[196:199]
ds_read_b128 v[156:159], v15 offset:14336
v_mfma_f32_16x16x32_bf16 a[200:203], v[56:59], v[72:75], a[200:203]
v_mfma_f32_16x16x32_bf16 a[204:207], v[56:59], v[76:79], a[204:207]
buffer_load_dwordx4 v9, s[44:47], s56 offen offset:3072 lds
v_mfma_f32_16x16x32_bf16 a[208:211], v[56:59], v[80:83], a[208:211]
s_add_u32 s56, s56, s57
v_mfma_f32_16x16x32_bf16 a[212:215], v[56:59], v[84:87], a[212:215]
v_mfma_f32_16x16x32_bf16 a[216:219], v[56:59], v[88:91], a[216:219]
v_mfma_f32_16x16x32_bf16 a[220:223], v[56:59], v[92:95], a[220:223]
v_mfma_f32_16x16x32_bf16 a[224:227], v[60:63], v[64:67], a[224:227]
v_mfma_f32_16x16x32_bf16 a[228:231], v[60:63], v[68:71], a[228:231]
v_mfma_f32_16x16x32_bf16 a[232:235], v[60:63], v[72:75], a[232:235]
v_mfma_f32_16x16x32_bf16 a[236:239], v[60:63], v[76:79], a[236:239]
s_add_u32 s74, s73, s30
s_add_u32 s75, s73, s31
v_mfma_f32_16x16x32_bf16 a[240:243], v[60:63], v[80:83], a[240:243]
s_add_u32 s73, s73, 32768
s_cmp_eq_u32 s73, 163840
v_mfma_f32_16x16x32_bf16 a[244:247], v[60:63], v[84:87], a[244:247]
s_cselect_b32 s73, 65536, s73
v_add_u32 v14, s73, v110
v_mfma_f32_16x16x32_bf16 a[248:251], v[60:63], v[88:91], a[248:251]
v_add_u32 v15, s73, v111
v_mfma_f32_16x16x32_bf16 a[252:255], v[60:63], v[92:95], a[252:255]
s_waitcnt lgkmcnt(0)
v_mfma_f32_16x16x32_bf16 a[0:3], v[128:131], v[160:163], a[0:3]
v_mfma_f32_16x16x32_bf16 a[4:7], v[128:131], v[164:167], a[4:7]
v_mfma_f32_16x16x32_bf16 a[8:11], v[128:131], v[168:171], a[8:11]
s_waitcnt vmcnt(17)
s_barrier
v_mfma_f32_16x16x32_bf16 a[12:15], v[128:131], v[172:175], a[12:15]
s_add_u32 m0, s58, 16384
ds_read_b128 v[32:35], v14
v_mfma_f32_16x16x32_bf16 a[16:19], v[128:131], v[176:179], a[16:19]
buffer_load_dwordx4 v10, s[16:19], s25 offen offset:0 lds
v_mfma_f32_16x16x32_bf16 a[20:23], v[128:131], v[180:183], a[20:23]
ds_read_b64_tr_b16 v[64:65], v20 offset:32768
v_mfma_f32_16x16x32_bf16 a[24:27], v[128:131], v[184:187], a[24:27]
v_mfma_f32_16x16x32_bf16 a[28:31], v[128:131], v[188:191], a[28:31]
ds_read_b64_tr_b16 v[66:67], v20 offset:34816
v_mfma_f32_16x16x32_bf16 a[32:35], v[132:135], v[160:163], a[32:35]
v_mfma_f32_16x16x32_bf16 a[36:39], v[132:135], v[164:167], a[36:39]
ds_read_b64_tr_b16 v[68:69], v21 offset:32768
v_mfma_f32_16x16x32_bf16 a[40:43], v[132:135], v[168:171], a[40:43]
v_mfma_f32_16x16x32_bf16 a[44:47], v[132:135], v[172:175], a[44:47]
buffer_load_dwordx4 v11, s[16:19], s25 offen offset:1024 lds
v_mfma_f32_16x16x32_bf16 a[48:51], v[132:135], v[176:179], a[48:51]
ds_read_b64_tr_b16 v[70:71], v21 offset:34816
v_mfma_f32_16x16x32_bf16 a[52:55], v[132:135], v[180:183], a[52:55]
ds_read_b64_tr_b16 v[72:73], v22 offset:32768
v_mfma_f32_16x16x32_bf16 a[56:59], v[132:135], v[184:187], a[56:59]
v_mfma_f32_16x16x32_bf16 a[60:63], v[132:135], v[188:191], a[60:63]
ds_read_b64_tr_b16 v[74:75], v22 offset:34816
v_mfma_f32_16x16x32_bf16 a[64:67], v[136:139], v[160:163], a[64:67]
v_mfma_f32_16x16x32_bf16 a[68:71], v[136:139], v[164:167], a[68:71]
ds_read_b64_tr_b16 v[76:77], v23 offset:32768
v_mfma_f32_16x16x32_bf16 a[72:75], v[136:139], v[168:171], a[72:75]
buffer_load_dwordx4 v12, s[16:19], s25 offen offset:2048 lds
v_mfma_f32_16x16x32_bf16 a[76:79], v[136:139], v[172:175], a[76:79]
ds_read_b64_tr_b16 v[78:79], v23 offset:34816
v_mfma_f32_16x16x32_bf16 a[80:83], v[136:139], v[176:179], a[80:83]
v_mfma_f32_16x16x32_bf16 a[84:87], v[136:139], v[180:183], a[84:87]
ds_read_b64_tr_b16 v[80:81], v24 offset:32768
v_mfma_f32_16x16x32_bf16 a[88:91], v[136:139], v[184:187], a[88:91]
v_mfma_f32_16x16x32_bf16 a[92:95], v[136:139], v[188:191], a[92:95]
ds_read_b64_tr_b16 v[82:83], v24 offset:34816
v_mfma_f32_16x16x32_bf16 a[96:99], v[140:143], v[160:163], a[96:99]
v_mfma_f32_16x16x32_bf16 a[100:103], v[140:143], v[164:167], a[100:103]
buffer_load_dwordx4 v13, s[16:19], s25 offen offset:3072 lds
v_mfma_f32_16x16x32_bf16 a[104:107], v[140:143], v[168:171], a[104:107]
s_add_u32 s25, s25, 262144
ds_read_b64_tr_b16 v[84:85], v25 offset:32768
v_mfma_f32_16x16x32_bf16 a[108:111], v[140:143], v[172:175], a[108:111]
ds_read_b64_tr_b16 v[86:87], v25 offset:34816
v_mfma_f32_16x16x32_bf16 a[112:115], v[140:143], v[176:179], a[112:115]
v_mfma_f32_16x16x32_bf16 a[116:119], v[140:143], v[180:183], a[116:119]
ds_read_b64_tr_b16 v[88:89], v26 offset:32768
v_mfma_f32_16x16x32_bf16 a[120:123], v[140:143], v[184:187], a[120:123]
v_mfma_f32_16x16x32_bf16 a[124:127], v[140:143], v[188:191], a[124:127]
s_mov_b32 m0, s74
ds_read_b64_tr_b16 v[90:91], v26 offset:34816
v_mfma_f32_16x16x32_bf16 a[128:131], v[144:147], v[160:163], a[128:131]
buffer_load_dwordx4 v2, s[12:15], s24 offen offset:0 lds
v_mfma_f32_16x16x32_bf16 a[132:135], v[144:147], v[164:167], a[132:135]
ds_read_b64_tr_b16 v[92:93], v27 offset:32768
v_mfma_f32_16x16x32_bf16 a[136:139], v[144:147], v[168:171], a[136:139]
v_mfma_f32_16x16x32_bf16 a[140:143], v[144:147], v[172:175], a[140:143]
ds_read_b64_tr_b16 v[94:95], v27 offset:34816
v_mfma_f32_16x16x32_bf16 a[144:147], v[144:147], v[176:179], a[144:147]
v_mfma_f32_16x16x32_bf16 a[148:151], v[144:147], v[180:183], a[148:151]
ds_read_b128 v[36:39], v14 offset:2048
v_mfma_f32_16x16x32_bf16 a[152:155], v[144:147], v[184:187], a[152:155]
v_mfma_f32_16x16x32_bf16 a[156:159], v[144:147], v[188:191], a[156:159]
buffer_load_dwordx4 v3, s[12:15], s24 offen offset:1024 lds
v_mfma_f32_16x16x32_bf16 a[160:163], v[148:151], v[160:163], a[160:163]
ds_read_b128 v[40:43], v14 offset:4096
v_mfma_f32_16x16x32_bf16 a[164:167], v[148:151], v[164:167], a[164:167]
ds_read_b128 v[44:47], v14 offset:6144
v_mfma_f32_16x16x32_bf16 a[168:171], v[148:151], v[168:171], a[168:171]
v_mfma_f32_16x16x32_bf16 a[172:175], v[148:151], v[172:175], a[172:175]
ds_read_b128 v[48:51], v14 offset:8192
v_mfma_f32_16x16x32_bf16 a[176:179], v[148:151], v[176:179], a[176:179]
v_mfma_f32_16x16x32_bf16 a[180:183], v[148:151], v[180:183], a[180:183]
ds_read_b128 v[52:55], v14 offset:10240
v_mfma_f32_16x16x32_bf16 a[184:187], v[148:151], v[184:187], a[184:187]
buffer_load_dwordx4 v4, s[12:15], s24 offen offset:2048 lds
v_mfma_f32_16x16x32_bf16 a[188:191], v[148:151], v[188:191], a[188:191]
ds_read_b128 v[56:59], v14 offset:12288
v_mfma_f32_16x16x32_bf16 a[192:195], v[152:155], v[160:163], a[192:195]
v_mfma_f32_16x16x32_bf16 a[196:199], v[152:155], v[164:167], a[196:199]
ds_read_b128 v[60:63], v14 offset:14336
v_mfma_f32_16x16x32_bf16 a[200:203], v[152:155], v[168:171], a[200:203]
v_mfma_f32_16x16x32_bf16 a[204:207], v[152:155], v[172:175], a[204:207]
v_mfma_f32_16x16x32_bf16 a[208:211], v[152:155], v[176:179], a[208:211]
v_mfma_f32_16x16x32_bf16 a[212:215], v[152:155], v[180:183], a[212:215]
buffer_load_dwordx4 v5, s[12:15], s24 offen offset:3072 lds
v_mfma_f32_16x16x32_bf16 a[216:219], v[152:155], v[184:187], a[216:219]
s_add_u32 s24, s24, 128
v_mfma_f32_16x16x32_bf16 a[220:223], v[152:155], v[188:191], a[220:223]
v_mfma_f32_16x16x32_bf16 a[224:227], v[156:159], v[160:163], a[224:227]
v_mfma_f32_16x16x32_bf16 a[228:231], v[156:159], v[164:167], a[228:231]
v_mfma_f32_16x16x32_bf16 a[232:235], v[156:159], v[168:171], a[232:235]
v_mfma_f32_16x16x32_bf16 a[236:239], v[156:159], v[172:175], a[236:239]
v_mfma_f32_16x16x32_bf16 a[240:243], v[156:159], v[176:179], a[240:243]
v_mfma_f32_16x16x32_bf16 a[244:247], v[156:159], v[180:183], a[244:247]
v_mfma_f32_16x16x32_bf16 a[248:251], v[156:159], v[184:187], a[248:251]
v_mfma_f32_16x16x32_bf16 a[252:255], v[156:159], v[188:191], a[252:255]
s_waitcnt lgkmcnt(0)
v_mfma_f32_16x16x32_bf16 a[0:3], v[32:35], v[64:67], a[0:3]
v_mfma_f32_16x16x32_bf16 a[4:7], v[32:35], v[68:71], a[4:7]
v_mfma_f32_16x16x32_bf16 a[8:11], v[32:35], v[72:75], a[8:11]
s_waitcnt vmcnt(17)
s_barrier
v_mfma_f32_16x16x32_bf16 a[12:15], v[32:35], v[76:79], a[12:15]
s_cmp_eq_u32 s26, 3
s_cselect_b32 s70, 0, s70
v_mfma_f32_16x16x32_bf16 a[16:19], v[32:35], v[80:83], a[16:19]
buffer_load_dword v113, v112, s[52:55], s70 offen
v_mfma_f32_16x16x32_bf16 a[20:23], v[32:35], v[84:87], a[20:23]
s_add_u32 s70, s70, 4096
ds_read_b128 v[128:131], v15
v_mfma_f32_16x16x32_bf16 a[24:27], v[32:35], v[88:91], a[24:27]
ds_read_b64_tr_b16 v[160:161], v20 offset:49152
v_mfma_f32_16x16x32_bf16 a[28:31], v[32:35], v[92:95], a[28:31]
ds_read_b64_tr_b16 v[162:163], v20 offset:51200
v_mfma_f32_16x16x32_bf16 a[32:35], v[36:39], v[64:67], a[32:35]
s_add_u32 m0, s58, 32768
v_mfma_f32_16x16x32_bf16 a[36:39], v[36:39], v[68:71], a[36:39]
buffer_load_dwordx4 v10, s[16:19], s25 offen offset:0 lds
v_mfma_f32_16x16x32_bf16 a[40:43], v[36:39], v[72:75], a[40:43]
ds_read_b64_tr_b16 v[164:165], v21 offset:49152
v_mfma_f32_16x16x32_bf16 a[44:47], v[36:39], v[76:79], a[44:47]
ds_read_b64_tr_b16 v[166:167], v21 offset:51200
v_mfma_f32_16x16x32_bf16 a[48:51], v[36:39], v[80:83], a[48:51]
v_mfma_f32_16x16x32_bf16 a[52:55], v[36:39], v[84:87], a[52:55]
ds_read_b64_tr_b16 v[168:169], v22 offset:49152
v_mfma_f32_16x16x32_bf16 a[56:59], v[36:39], v[88:91], a[56:59]
v_mfma_f32_16x16x32_bf16 a[60:63], v[36:39], v[92:95], a[60:63]
buffer_load_dwordx4 v11, s[16:19], s25 offen offset:1024 lds
v_mfma_f32_16x16x32_bf16 a[64:67], v[40:43], v[64:67], a[64:67]
ds_read_b64_tr_b16 v[170:171], v22 offset:51200
v_mfma_f32_16x16x32_bf16 a[68:71], v[40:43], v[68:71], a[68:71]
ds_read_b64_tr_b16 v[172:173], v23 offset:49152
v_mfma_f32_16x16x32_bf16 a[72:75], v[40:43], v[72:75], a[72:75]
v_mfma_f32_16x16x32_bf16 a[76:79], v[40:43], v[76:79], a[76:79]
ds_read_b64_tr_b16 v[174:175], v23 offset:51200
v_mfma_f32_16x16x32_bf16 a[80:83], v[40:43], v[80:83], a[80:83]
v_mfma_f32_16x16x32_bf16 a[84:87], v[40:43], v[84:87], a[84:87]
buffer_load_dwordx4 v12, s[16:19], s25 offen offset:2048 lds
v_mfma_f32_16x16x32_bf16 a[88:91], v[40:43], v[88:91], a[88:91]
ds_read_b64_tr_b16 v[176:177], v24 offset:49152
v_mfma_f32_16x16x32_bf16 a[92:95], v[40:43], v[92:95], a[92:95]
ds_read_b64_tr_b16 v[178:179], v24 offset:51200
v_mfma_f32_16x16x32_bf16 a[96:99], v[44:47], v[64:67], a[96:99]
v_mfma_f32_16x16x32_bf16 a[100:103], v[44:47], v[68:71], a[100:103]
ds_read_b64_tr_b16 v[180:181], v25 offset:49152
v_mfma_f32_16x16x32_bf16 a[104:107], v[44:47], v[72:75], a[104:107]
v_mfma_f32_16x16x32_bf16 a[108:111], v[44:47], v[76:79], a[108:111]
buffer_load_dwordx4 v13, s[16:19], s25 offen offset:3072 lds
v_mfma_f32_16x16x32_bf16 a[112:115], v[44:47], v[80:83], a[112:115]
s_add_u32 s25, s25, 262144
ds_read_b64_tr_b16 v[182:183], v25 offset:51200
v_mfma_f32_16x16x32_bf16 a[116:119], v[44:47], v[84:87], a[116:119]
ds_read_b64_tr_b16 v[184:185], v26 offset:49152
v_mfma_f32_16x16x32_bf16 a[120:123], v[44:47], v[88:91], a[120:123]
v_mfma_f32_16x16x32_bf16 a[124:127], v[44:47], v[92:95], a[124:127]
s_mov_b32 m0, s75
ds_read_b64_tr_b16 v[186:187], v26 offset:51200
v_mfma_f32_16x16x32_bf16 a[128:131], v[48:51], v[64:67], a[128:131]
buffer_load_dwordx4 v6, s[44:47], s56 offen offset:0 lds
v_mfma_f32_16x16x32_bf16 a[132:135], v[48:51], v[68:71], a[132:135]
ds_read_b64_tr_b16 v[188:189], v27 offset:49152
v_mfma_f32_16x16x32_bf16 a[136:139], v[48:51], v[72:75], a[136:139]
v_mfma_f32_16x16x32_bf16 a[140:143], v[48:51], v[76:79], a[140:143]
ds_read_b64_tr_b16 v[190:191], v27 offset:51200
v_mfma_f32_16x16x32_bf16 a[144:147], v[48:51], v[80:83], a[144:147]
v_mfma_f32_16x16x32_bf16 a[148:151], v[48:51], v[84:87], a[148:151]
ds_read_b128 v[132:135], v15 offset:2048
v_mfma_f32_16x16x32_bf16 a[152:155], v[48:51], v[88:91], a[152:155]
buffer_load_dwordx4 v7, s[44:47], s56 offen offset:1024 lds
v_mfma_f32_16x16x32_bf16 a[156:159], v[48:51], v[92:95], a[156:159]
ds_read_b128 v[136:139], v15 offset:4096
v_mfma_f32_16x16x32_bf16 a[160:163], v[52:55], v[64:67], a[160:163]
v_mfma_f32_16x16x32_bf16 a[164:167], v[52:55], v[68:71], a[164:167]
ds_read_b128 v[140:143], v15 offset:6144
v_mfma_f32_16x16x32_bf16 a[168:171], v[52:55], v[72:75], a[168:171]
v_mfma_f32_16x16x32_bf16 a[172:175], v[52:55], v[76:79], a[172:175]
ds_read_b128 v[144:147], v15 offset:8192
v_mfma_f32_16x16x32_bf16 a[176:179], v[52:55], v[80:83], a[176:179]
buffer_load_dwordx4 v8, s[44:47], s56 offen offset:2048 lds
v_mfma_f32_16x16x32_bf16 a[180:183], v[52:55], v[84:87], a[180:183]
ds_read_b128 v[148:151], v15 offset:10240
v_mfma_f32_16x16x32_bf16 a[184:187], v[52:55], v[88:91], a[184:187]
v_mfma_f32_16x16x32_bf16 a[188:191], v[52:55], v[92:95], a[188:191]
ds_read_b128 v[152:155], v15 offset:12288
v_mfma_f32_16x16x32_bf16 a[192:195], v[56:59], v[64:67], a[192:195]
v_mfma_f32_16x16x32_bf16 a[196:199], v[56:59], v[68:71], a[196:199]
ds_read_b128 v[156:159], v15 offset:14336
v_mfma_f32_16x16x32_bf16 a[200:203], v[56:59], v[72:75], a[200:203]
buffer_load_dwordx4 v9, s[44:47], s56 offen offset:3072 lds
v_mfma_f32_16x16x32_bf16 a[204:207], v[56:59], v[76:79], a[204:207]
s_add_u32 s56, s56, s57
v_mfma_f32_16x16x32_bf16 a[208:211], v[56:59], v[80:83], a[208:211]
v_mfma_f32_16x16x32_bf16 a[212:215], v[56:59], v[84:87], a[212:215]
v_mfma_f32_16x16x32_bf16 a[216:219], v[56:59], v[88:91], a[216:219]
v_mfma_f32_16x16x32_bf16 a[220:223], v[56:59], v[92:95], a[220:223]
v_mfma_f32_16x16x32_bf16 a[224:227], v[60:63], v[64:67], a[224:227]
v_mfma_f32_16x16x32_bf16 a[228:231], v[60:63], v[68:71], a[228:231]
v_mfma_f32_16x16x32_bf16 a[232:235], v[60:63], v[72:75], a[232:235]
s_cmp_eq_u32 s26, 6
s_cbranch_scc1 L_swA_6
L_swA_6_b:
v_mfma_f32_16x16x32_bf16 a[236:239], v[60:63], v[76:79], a[236:239]
s_add_u32 s74, s73, s30
s_add_u32 s75, s73, s31
v_mfma_f32_16x16x32_bf16 a[240:243], v[60:63], v[80:83], a[240:243]
s_add_u32 s73, s73, 32768
s_cmp_eq_u32 s73, 163840
v_mfma_f32_16x16x32_bf16 a[244:247], v[60:63], v[84:87], a[244:247]
s_cselect_b32 s73, 65536, s73
v_add_u32 v14, s73, v110
v_mfma_f32_16x16x32_bf16 a[248:251], v[60:63], v[88:91], a[248:251]
v_add_u32 v15, s73, v111
v_mfma_f32_16x16x32_bf16 a[252:255], v[60:63], v[92:95], a[252:255]
s_waitcnt lgkmcnt(0)
v_mfma_f32_16x16x32_bf16 a[0:3], v[128:131], v[160:163], a[0:3]
v_mfma_f32_16x16x32_bf16 a[4:7], v[128:131], v[164:167], a[4:7]
v_mfma_f32_16x16x32_bf16 a[8:11], v[128:131], v[168:171], a[8:11]
s_waitcnt vmcnt(17)
s_barrier
v_mfma_f32_16x16x32_bf16 a[12:15], v[128:131], v[172:175], a[12:15]
s_add_u32 m0, s58, 49152
ds_read_b128 v[32:35], v14
v_mfma_f32_16x16x32_bf16 a[16:19], v[128:131], v[176:179], a[16:19]
buffer_load_dwordx4 v10, s[16:19], s25 offen offset:0 lds
v_mfma_f32_16x16x32_bf16 a[20:23], v[128:131], v[180:183], a[20:23]
ds_read_b64_tr_b16 v[64:65], v20 offset:0
v_mfma_f32_16x16x32_bf16 a[24:27], v[128:131], v[184:187], a[24:27]
v_mfma_f32_16x16x32_bf16 a[28:31], v[128:131], v[188:191], a[28:31]
ds_read_b64_tr_b16 v[66:67], v20 offset:2048
v_mfma_f32_16x16x32_bf16 a[32:35], v[132:135], v[160:163], a[32:35]
v_mfma_f32_16x16x32_bf16 a[36:39], v[132:135], v[164:167], a[36:39]
ds_read_b64_tr_b16 v[68:69], v21 offset:0
v_mfma_f32_16x16x32_bf16 a[40:43], v[132:135], v[168:171], a[40:43]
buffer_load_dwordx4 v11, s[16:19], s25 offen offset:1024 lds
v_mfma_f32_16x16x32_bf16 a[44:47], v[132:135], v[172:175], a[44:47]
ds_read_b64_tr_b16 v[70:71], v21 offset:2048
v_mfma_f32_16x16x32_bf16 a[48:51], v[132:135], v[176:179], a[48:51]
v_mfma_f32_16x16x32_bf16 a[52:55], v[132:135], v[180:183], a[52:55]
ds_read_b64_tr_b16 v[72:73], v22 offset:0
v_mfma_f32_16x16x32_bf16 a[56:59], v[132:135], v[184:187], a[56:59]
v_mfma_f32_16x16x32_bf16 a[60:63], v[132:135], v[188:191], a[60:63]
ds_read_b64_tr_b16 v[74:75], v22 offset:2048
v_mfma_f32_16x16x32_bf16 a[64:67], v[136:139], v[160:163], a[64:67]
v_mfma_f32_16x16x32_bf16 a[68:71], v[136:139], v[164:167], a[68:71]
buffer_load_dwordx4 v12, s[16:19], s25 offen offset:2048 lds
v_mfma_f32_16x16x32_bf16 a[72:75], v[136:139], v[168:171], a[72:75]
ds_read_b64_tr_b16 v[76:77], v23 offset:0
v_mfma_f32_16x16x32_bf16 a[76:79], v[136:139], v[172:175], a[76:79]
ds_read_b64_tr_b16 v[78:79], v23 offset:2048
v_mfma_f32_16x16x32_bf16 a[80:83], v[136:139], v[176:179], a[80:83]
v_mfma_f32_16x16x32_bf16 a[84:87], v[136:139], v[180:183], a[84:87]
ds_read_b64_tr_b16 v[80:81], v24 offset:0
v_mfma_f32_16x16x32_bf16 a[88:91], v[136:139], v[184:187], a[88:91]
v_mfma_f32_16x16x32_bf16 a[92:95], v[136:139], v[188:191], a[92:95]
ds_read_b64_tr_b16 v[82:83], v24 offset:2048
v_mfma_f32_16x16x32_bf16 a[96:99], v[140:143], v[160:163], a[96:99]
buffer_load_dwordx4 v13, s[16:19], s25 offen offset:3072 lds
v_mfma_f32_16x16x32_bf16 a[100:103], v[140:143], v[164:167], a[100:103]
s_add_u32 s25, s25, 262144
ds_read_b64_tr_b16 v[84:85], v25 offset:0
v_mfma_f32_16x16x32_bf16 a[104:107], v[140:143], v[168:171], a[104:107]
v_mfma_f32_16x16x32_bf16 a[108:111], v[140:143], v[172:175], a[108:111]
ds_read_b64_tr_b16 v[86:87], v25 offset:2048
v_mfma_f32_16x16x32_bf16 a[112:115], v[140:143], v[176:179], a[112:115]
v_mfma_f32_16x16x32_bf16 a[116:119], v[140:143], v[180:183], a[116:119]
ds_read_b64_tr_b16 v[88:89], v26 offset:0
v_mfma_f32_16x16x32_bf16 a[120:123], v[140:143], v[184:187], a[120:123]
s_mov_b32 m0, s74
v_mfma_f32_16x16x32_bf16 a[124:127], v[140:143], v[188:191], a[124:127]
buffer_load_dwordx4 v2, s[12:15], s24 offen offset:0 lds
v_mfma_f32_16x16x32_bf16 a[128:131], v[144:147], v[160:163], a[128:131]
ds_read_b64_tr_b16 v[90:91], v26 offset:2048
v_mfma_f32_16x16x32_bf16 a[132:135], v[144:147], v[164:167], a[132:135]
ds_read_b64_tr_b16 v[92:93], v27 offset:0
v_mfma_f32_16x16x32_bf16 a[136:139], v[144:147], v[168:171], a[136:139]
v_mfma_f32_16x16x32_bf16 a[140:143], v[144:147], v[172:175], a[140:143]
ds_read_b64_tr_b16 v[94:95], v27 offset:2048
v_mfma_f32_16x16x32_bf16 a[144:147], v[144:147], v[176:179], a[144:147]
v_mfma_f32_16x16x32_bf16 a[148:151], v[144:147], v[180:183], a[148:151]
buffer_load_dwordx4 v3, s[12:15], s24 offen offset:1024 lds
v_mfma_f32_16x16x32_bf16 a[152:155], v[144:147], v[184:187], a[152:155]
ds_read_b128 v[36:39], v14 offset:2048
v_mfma_f32_16x16x32_bf16 a[156:159], v[144:147], v[188:191], a[156:159]
ds_read_b128 v[40:43], v14 offset:4096
v_mfma_f32_16x16x32_bf16 a[160:163], v[148:151], v[160:163], a[160:163]
v_mfma_f32_16x16x32_bf16 a[164:167], v[148:151], v[164:167], a[164:167]
ds_read_b128 v[44:47], v14 offset:6144
v_mfma_f32_16x16x32_bf16 a[168:171], v[148:151], v[168:171], a[168:171]
v_mfma_f32_16x16x32_bf16 a[172:175], v[148:151], v[172:175], a[172:175]
ds_read_b128 v[48:51], v14 offset:8192
v_mfma_f32_16x16x32_bf16 a[176:179], v[148:151], v[176:179], a[176:179]
buffer_load_dwordx4 v4, s[12:15], s24 offen offset:2048 lds
v_mfma_f32_16x16x32_bf16 a[180:183], v[148:151], v[180:183], a[180:183]
ds_read_b128 v[52:55], v14 offset:10240
v_mfma_f32_16x16x32_bf16 a[184:187], v[148:151], v[184:187], a[184:187]
v_mfma_f32_16x16x32_bf16 a[188:191], v[148:151], v[188:191], a[188:191]
ds_read_b128 v[56:59], v14 offset:12288
v_mfma_f32_16x16x32_bf16 a[192:195], v[152:155], v[160:163], a[192:195]
v_mfma_f32_16x16x32_bf16 a[196:199], v[152:155], v[164:167], a[196:199]
ds_read_b128 v[60:63], v14 offset:14336
v_mfma_f32_16x16x32_bf16 a[200:203], v[152:155], v[168:171], a[200:203]
v_mfma_f32_16x16x32_bf16 a[204:207], v[152:155], v[172:175], a[204:207]
buffer_load_dwordx4 v5, s[12:15], s24 offen offset:3072 lds
v_mfma_f32_16x16x32_bf16 a[208:211], v[152:155], v[176:179], a[208:211]
s_add_u32 s24, s24, 128
v_mfma_f32_16x16x32_bf16 a[212:215], v[152:155], v[180:183], a[212:215]
v_mfma_f32_16x16x32_bf16 a[216:219], v[152:155], v[184:187], a[216:219]
v_mfma_f32_16x16x32_bf16 a[220:223], v[152:155], v[188:191], a[220:223]
v_mfma_f32_16x16x32_bf16 a[224:227], v[156:159], v[160:163], a[224:227]
v_mfma_f32_16x16x32_bf16 a[228:231], v[156:159], v[164:167], a[228:231]
v_mfma_f32_16x16x32_bf16 a[232:235], v[156:159], v[168:171], a[232:235]
v_mfma_f32_16x16x32_bf16 a[236:239], v[156:159], v[172:175], a[236:239]
v_mfma_f32_16x16x32_bf16 a[240:243], v[156:159], v[176:179], a[240:243]
s_cmp_eq_u32 s26, 6
s_cbranch_scc1 L_swB_7
L_swB_7_b:
v_mfma_f32_16x16x32_bf16 a[244:247], v[156:159], v[180:183], a[244:247]
s_add_u32 s26, s26, 1
s_cmp_lt_u32 s26, 8
v_mfma_f32_16x16x32_bf16 a[248:251], v[156:159], v[184:187], a[248:251]
v_mfma_f32_16x16x32_bf16 a[252:255], v[156:159], v[188:191], a[252:255]
s_cbranch_scc1 L_kloop_5
buffer_load_dwordx4 v[114:117], v109, s[64:67], 0 offen offset:0
buffer_load_dwordx4 v[118:121], v109, s[64:67], 0 offen offset:64
buffer_load_dwordx4 v[122:125], v109, s[64:67], 0 offen offset:128
s_add_u32 s92, s8, 104857600
s_addc_u32 s93, s9, 0
s_mov_b32 s94, 65536
v_lshlrev_b32 v28, 16, v0
v_mov_b32 v29, 0
s_lshr_b32 s28, s37, 1
s_lshl_b32 s29, s38, 4
s_add_u32 s28, s28, s29
s_lshl_b32 s29, s28, 7
buffer_store_dword v29, v28, s[92:95], s29 offen sc1
s_lshl_b32 s29, s28, 4
s_add_u32 s29, s29, 32768
buffer_store_dword v29, v28, s[92:95], s29 offen sc1
s_lshl_b32 s28, s43, 2
s_add_u32 s28, s28, s27
s_lshl_b32 s28, s28, 4
s_add_u32 s28, s28, s38
s_lshl_b32 s29, s28, 4
s_add_u32 s29, s29, 36864
v_lshlrev_b32 v28, 16, v1
buffer_store_dword v29, v28, s[92:95], s29 offen sc1
s_lshl_b32 s29, s43, 7
s_add_u32 s29, s29, 57344
s_or_b32 s28, s38, s27
s_cmp_eq_u32 s28, 0
s_cselect_b32 s29, s29, 0x10000
buffer_store_dword v29, v28, s[92:95], s29 offen sc1
s_add_u32 s92, s8, 105906176
s_addc_u32 s93, s9, 0
s_mov_b32 s94, 8192
buffer_store_dword v197, v196, s[92:95], 0 offen sc1
s_waitcnt lgkmcnt(0)
v_add_u32 v14, s73, v104
v_add_u32 v15, s73, v105
v_add_u32 v16, s73, v106
v_add_u32 v17, s73, v107
v_add_u32 v18, s73, v108
ds_read_b128 v[32:35], v14
ds_read_b64_tr_b16 v[64:65], v20 offset:0
ds_read_b64_tr_b16 v[66:67], v20 offset:2048
ds_read_b64_tr_b16 v[68:69], v21 offset:0
ds_read_b64_tr_b16 v[70:71], v21 offset:2048
ds_read_b64_tr_b16 v[72:73], v22 offset:0
ds_read_b64_tr_b16 v[74:75], v22 offset:2048
ds_read_b64_tr_b16 v[76:77], v23 offset:0
ds_read_b64_tr_b16 v[78:79], v23 offset:2048
ds_read_b64_tr_b16 v[80:81], v24 offset:0
ds_read_b64_tr_b16 v[82:83], v24 offset:2048
ds_read_b64_tr_b16 v[84:85], v25 offset:0
ds_read_b64_tr_b16 v[86:87], v25 offset:2048
ds_read_b64_tr_b16 v[88:89], v26 offset:0
ds_read_b64_tr_b16 v[90:91], v26 offset:2048
ds_read_b64_tr_b16 v[92:93], v27 offset:0
ds_read_b64_tr_b16 v[94:95], v27 offset:2048
ds_read_b64_tr_b16 v[48:49], v16 offset:0
ds_read_b64_tr_b16 v[50:51], v16 offset:768
ds_read_b64_tr_b16 v[52:53], v17 offset:0
ds_read_b64_tr_b16 v[54:55], v17 offset:768
ds_read_b64_tr_b16 v[56:57], v18 offset:0
ds_read_b64_tr_b16 v[58:59], v18 offset:768
ds_read_b128 v[36:39], v14 offset:2048
ds_read_b128 v[40:43], v14 offset:4096
ds_read_b128 v[44:47], v14 offset:6144
s_lshr_b32 s29, 8192, s39
s_nop 7
v_accvgpr_read_b32 v28, a0
v_accvgpr_read_b32 v29, a1
v_accvgpr_read_b32 v30, a2
v_accvgpr_read_b32 v31, a3
v_cvt_pk_bf16_f32 v128, v28, v29
v_cvt_pk_bf16_f32 v129, v30, v31
v_accvgpr_read_b32 v28, a32
v_accvgpr_read_b32 v29, a33
v_accvgpr_read_b32 v30, a34
v_accvgpr_read_b32 v31, a35
v_cvt_pk_bf16_f32 v130, v28, v29
v_cvt_pk_bf16_f32 v131, v30, v31
v_accvgpr_read_b32 v28, a4
v_accvgpr_read_b32 v29, a5
v_accvgpr_read_b32 v30, a6
v_accvgpr_read_b32 v31, a7
v_cvt_pk_bf16_f32 v132, v28, v29
v_cvt_pk_bf16_f32 v133, v30, v31
v_accvgpr_read_b32 v28, a36
v_accvgpr_read_b32 v29, a37
v_accvgpr_read_b32 v30, a38
v_accvgpr_read_b32 v31, a39
v_cvt_pk_bf16_f32 v134, v28, v29
v_cvt_pk_bf16_f32 v135, v30, v31
v_accvgpr_read_b32 v28, a8
v_accvgpr_read_b32 v29, a9
v_accvgpr_read_b32 v30, a10
v_accvgpr_read_b32 v31, a11
v_cvt_pk_bf16_f32 v136, v28, v29
v_cvt_pk_bf16_f32 v137, v30, v31
v_accvgpr_read_b32 v28, a40
v_accvgpr_read_b32 v29, a41
v_accvgpr_read_b32 v30, a42
v_accvgpr_read_b32 v31, a43
v_cvt_pk_bf16_f32 v138, v28, v29
v_cvt_pk_bf16_f32 v139, v30, v31
v_accvgpr_read_b32 v28, a12
v_accvgpr_read_b32 v29, a13
v_accvgpr_read_b32 v30, a14
v_accvgpr_read_b32 v31, a15
v_cvt_pk_bf16_f32 v140, v28, v29
v_cvt_pk_bf16_f32 v141, v30, v31
v_accvgpr_read_b32 v28, a44
v_accvgpr_read_b32 v29, a45
v_accvgpr_read_b32 v30, a46
v_accvgpr_read_b32 v31, a47
v_cvt_pk_bf16_f32 v142, v28, v29
v_cvt_pk_bf16_f32 v143, v30, v31
s_mov_b32 s28, 0
buffer_store_dwordx4 v[128:131], v19, s[20:23], s28 offen offset:0 sc1
v_accvgpr_read_b32 v28, a16
v_accvgpr_read_b32 v29, a17
v_accvgpr_read_b32 v30, a18
v_accvgpr_read_b32 v31, a19
v_cvt_pk_bf16_f32 v144, v28, v29
v_cvt_pk_bf16_f32 v145, v30, v31
v_accvgpr_read_b32 v28, a48
v_accvgpr_read_b32 v29, a49
v_accvgpr_read_b32 v30, a50
v_accvgpr_read_b32 v31, a51
v_cvt_pk_bf16_f32 v146, v28, v29
v_cvt_pk_bf16_f32 v147, v30, v31
v_accvgpr_read_b32 v28, a20
v_accvgpr_read_b32 v29, a21
v_accvgpr_read_b32 v30, a22
v_accvgpr_read_b32 v31, a23
v_cvt_pk_bf16_f32 v148, v28, v29
v_cvt_pk_bf16_f32 v149, v30, v31
v_accvgpr_read_b32 v28, a52
v_accvgpr_read_b32 v29, a53
v_accvgpr_read_b32 v30, a54
v_accvgpr_read_b32 v31, a55
v_cvt_pk_bf16_f32 v150, v28, v29
v_cvt_pk_bf16_f32 v151, v30, v31
v_accvgpr_read_b32 v28, a24
v_accvgpr_read_b32 v29, a25
v_accvgpr_read_b32 v30, a26
v_accvgpr_read_b32 v31, a27
v_cvt_pk_bf16_f32 v152, v28, v29
v_cvt_pk_bf16_f32 v153, v30, v31
v_accvgpr_read_b32 v28, a56
v_accvgpr_read_b32 v29, a57
v_accvgpr_read_b32 v30, a58
v_accvgpr_read_b32 v31, a59
v_cvt_pk_bf16_f32 v154, v28, v29
v_cvt_pk_bf16_f32 v155, v30, v31
buffer_store_dwordx4 v[132:135], v19, s[20:23], s28 offen offset:1024 sc1
v_accvgpr_read_b32 v28, a28
v_accvgpr_read_b32 v29, a29
v_accvgpr_read_b32 v30, a30
v_accvgpr_read_b32 v31, a31
v_cvt_pk_bf16_f32 v156, v28, v29
v_cvt_pk_bf16_f32 v157, v30, v31
v_accvgpr_read_b32 v28, a60
v_accvgpr_read_b32 v29, a61
v_accvgpr_read_b32 v30, a62
v_accvgpr_read_b32 v31, a63
v_cvt_pk_bf16_f32 v158, v28, v29
v_cvt_pk_bf16_f32 v159, v30, v31
v_accvgpr_read_b32 v28, a64
v_accvgpr_read_b32 v29, a65
v_accvgpr_read_b32 v30, a66
v_accvgpr_read_b32 v31, a67
v_cvt_pk_bf16_f32 v160, v28, v29
v_cvt_pk_bf16_f32 v161, v30, v31
v_accvgpr_read_b32 v28, a96
v_accvgpr_read_b32 v29, a97
v_accvgpr_read_b32 v30, a98
v_accvgpr_read_b32 v31, a99
v_cvt_pk_bf16_f32 v162, v28, v29
v_cvt_pk_bf16_f32 v163, v30, v31
v_accvgpr_read_b32 v28, a68
v_accvgpr_read_b32 v29, a69
v_accvgpr_read_b32 v30, a70
v_accvgpr_read_b32 v31, a71
v_cvt_pk_bf16_f32 v164, v28, v29
v_cvt_pk_bf16_f32 v165, v30, v31
v_accvgpr_read_b32 v28, a100
v_accvgpr_read_b32 v29, a101
v_accvgpr_read_b32 v30, a102
v_accvgpr_read_b32 v31, a103
v_cvt_pk_bf16_f32 v166, v28, v29
v_cvt_pk_bf16_f32 v167, v30, v31
buffer_store_dwordx4 v[136:139], v19, s[20:23], s28 offen offset:2048 sc1
v_accvgpr_read_b32 v28, a72
v_accvgpr_read_b32 v29, a73
v_accvgpr_read_b32 v30, a74
v_accvgpr_read_b32 v31, a75
v_cvt_pk_bf16_f32 v168, v28, v29
v_cvt_pk_bf16_f32 v169, v30, v31
v_accvgpr_read_b32 v28, a104
v_accvgpr_read_b32 v29, a105
v_accvgpr_read_b32 v30, a106
v_accvgpr_read_b32 v31, a107
v_cvt_pk_bf16_f32 v170, v28, v29
v_cvt_pk_bf16_f32 v171, v30, v31
v_accvgpr_read_b32 v28, a76
v_accvgpr_read_b32 v29, a77
v_accvgpr_read_b32 v30, a78
v_accvgpr_read_b32 v31, a79
v_cvt_pk_bf16_f32 v172, v28, v29
v_cvt_pk_bf16_f32 v173, v30, v31
v_accvgpr_read_b32 v28, a108
v_accvgpr_read_b32 v29, a109
v_accvgpr_read_b32 v30, a110
v_accvgpr_read_b32 v31, a111
v_cvt_pk_bf16_f32 v174, v28, v29
v_cvt_pk_bf16_f32 v175, v30, v31
v_accvgpr_read_b32 v28, a80
v_accvgpr_read_b32 v29, a81
v_accvgpr_read_b32 v30, a82
v_accvgpr_read_b32 v31, a83
v_cvt_pk_bf16_f32 v176, v28, v29
v_cvt_pk_bf16_f32 v177, v30, v31
v_accvgpr_read_b32 v28, a112
v_accvgpr_read_b32 v29, a113
v_accvgpr_read_b32 v30, a114
v_accvgpr_read_b32 v31, a115
v_cvt_pk_bf16_f32 v178, v28, v29
v_cvt_pk_bf16_f32 v179, v30, v31
buffer_store_dwordx4 v[140:143], v19, s[20:23], s28 offen offset:3072 sc1
v_accvgpr_read_b32 v28, a84
v_accvgpr_read_b32 v29, a85
v_accvgpr_read_b32 v30, a86
v_accvgpr_read_b32 v31, a87
v_cvt_pk_bf16_f32 v180, v28, v29
v_cvt_pk_bf16_f32 v181, v30, v31
v_accvgpr_read_b32 v28, a116
v_accvgpr_read_b32 v29, a117
v_accvgpr_read_b32 v30, a118
v_accvgpr_read_b32 v31, a119
v_cvt_pk_bf16_f32 v182, v28, v29
v_cvt_pk_bf16_f32 v183, v30, v31
v_accvgpr_read_b32 v28, a88
v_accvgpr_read_b32 v29, a89
v_accvgpr_read_b32 v30, a90
v_accvgpr_read_b32 v31, a91
v_cvt_pk_bf16_f32 v184, v28, v29
v_cvt_pk_bf16_f32 v185, v30, v31
v_accvgpr_read_b32 v28, a120
v_accvgpr_read_b32 v29, a121
v_accvgpr_read_b32 v30, a122
v_accvgpr_read_b32 v31, a123
v_cvt_pk_bf16_f32 v186, v28, v29
v_cvt_pk_bf16_f32 v187, v30, v31
v_accvgpr_read_b32 v28, a92
v_accvgpr_read_b32 v29, a93
v_accvgpr_read_b32 v30, a94
v_accvgpr_read_b32 v31, a95
v_cvt_pk_bf16_f32 v188, v28, v29
v_cvt_pk_bf16_f32 v189, v30, v31
v_accvgpr_read_b32 v28, a124
v_accvgpr_read_b32 v29, a125
v_accvgpr_read_b32 v30, a126
v_accvgpr_read_b32 v31, a127
v_cvt_pk_bf16_f32 v190, v28, v29
v_cvt_pk_bf16_f32 v191, v30, v31
s_add_u32 s28, s29, 0
buffer_store_dwordx4 v[144:147], v19, s[20:23], s28 offen offset:0 sc1
v_accvgpr_read_b32 v28, a128
v_accvgpr_read_b32 v29, a129
v_accvgpr_read_b32 v30, a130
v_accvgpr_read_b32 v31, a131
v_cvt_pk_bf16_f32 v192, v28, v29
v_cvt_pk_bf16_f32 v193, v30, v31
v_accvgpr_read_b32 v28, a160
v_accvgpr_read_b32 v29, a161
v_accvgpr_read_b32 v30, a162
v_accvgpr_read_b32 v31, a163
v_cvt_pk_bf16_f32 v194, v28, v29
v_cvt_pk_bf16_f32 v195, v30, v31
v_accvgpr_read_b32 v28, a132
v_accvgpr_read_b32 v29, a133
v_accvgpr_read_b32 v30, a134
v_accvgpr_read_b32 v31, a135
v_cvt_pk_bf16_f32 v196, v28, v29
v_cvt_pk_bf16_f32 v197, v30, v31
v_accvgpr_read_b32 v28, a164
v_accvgpr_read_b32 v29, a165
v_accvgpr_read_b32 v30, a166
v_accvgpr_read_b32 v31, a167
v_cvt_pk_bf16_f32 v198, v28, v29
v_cvt_pk_bf16_f32 v199, v30, v31
v_accvgpr_read_b32 v28, a136
v_accvgpr_read_b32 v29, a137
v_accvgpr_read_b32 v30, a138
v_accvgpr_read_b32 v31, a139
v_cvt_pk_bf16_f32 v200, v28, v29
v_cvt_pk_bf16_f32 v201, v30, v31
v_accvgpr_read_b32 v28, a168
v_accvgpr_read_b32 v29, a169
v_accvgpr_read_b32 v30, a170
v_accvgpr_read_b32 v31, a171
v_cvt_pk_bf16_f32 v202, v28, v29
v_cvt_pk_bf16_f32 v203, v30, v31
v_accvgpr_read_b32 v28, a140
v_accvgpr_read_b32 v29, a141
v_accvgpr_read_b32 v30, a142
v_accvgpr_read_b32 v31, a143
v_cvt_pk_bf16_f32 v204, v28, v29
v_cvt_pk_bf16_f32 v205, v30, v31
v_accvgpr_read_b32 v28, a172
v_accvgpr_read_b32 v29, a173
v_accvgpr_read_b32 v30, a174
v_accvgpr_read_b32 v31, a175
v_cvt_pk_bf16_f32 v206, v28, v29
v_cvt_pk_bf16_f32 v207, v30, v31
buffer_store_dwordx4 v[148:151], v19, s[20:23], s28 offen offset:1024 sc1
v_accvgpr_read_b32 v28, a144
v_accvgpr_read_b32 v29, a145
v_accvgpr_read_b32 v30, a146
v_accvgpr_read_b32 v31, a147
v_cvt_pk_bf16_f32 v208, v28, v29
v_cvt_pk_bf16_f32 v209, v30, v31
v_accvgpr_read_b32 v28, a176
v_accvgpr_read_b32 v29, a177
v_accvgpr_read_b32 v30, a178
v_accvgpr_read_b32 v31, a179
v_cvt_pk_bf16_f32 v210, v28, v29
v_cvt_pk_bf16_f32 v211, v30, v31
v_accvgpr_read_b32 v28, a148
v_accvgpr_read_b32 v29, a149
v_accvgpr_read_b32 v30, a150
v_accvgpr_read_b32 v31, a151
v_cvt_pk_bf16_f32 v212, v28, v29
v_cvt_pk_bf16_f32 v213, v30, v31
v_accvgpr_read_b32 v28, a180
v_accvgpr_read_b32 v29, a181
v_accvgpr_read_b32 v30, a182
v_accvgpr_read_b32 v31, a183
v_cvt_pk_bf16_f32 v214, v28, v29
v_cvt_pk_bf16_f32 v215, v30, v31
v_accvgpr_read_b32 v28, a152
v_accvgpr_read_b32 v29, a153
v_accvgpr_read_b32 v30, a154
v_accvgpr_read_b32 v31, a155
v_cvt_pk_bf16_f32 v216, v28, v29
v_cvt_pk_bf16_f32 v217, v30, v31
v_accvgpr_read_b32 v28, a184
v_accvgpr_read_b32 v29, a185
v_accvgpr_read_b32 v30, a186
v_accvgpr_read_b32 v31, a187
v_cvt_pk_bf16_f32 v218, v28, v29
v_cvt_pk_bf16_f32 v219, v30, v31
buffer_store_dwordx4 v[152:155], v19, s[20:23], s28 offen offset:2048 sc1
v_accvgpr_read_b32 v28, a156
v_accvgpr_read_b32 v29, a157
v_accvgpr_read_b32 v30, a158
v_accvgpr_read_b32 v31, a159
v_cvt_pk_bf16_f32 v220, v28, v29
v_cvt_pk_bf16_f32 v221, v30, v31
v_accvgpr_read_b32 v28, a188
v_accvgpr_read_b32 v29, a189
v_accvgpr_read_b32 v30, a190
v_accvgpr_read_b32 v31, a191
v_cvt_pk_bf16_f32 v222, v28, v29
v_cvt_pk_bf16_f32 v223, v30, v31
v_accvgpr_read_b32 v28, a192
v_accvgpr_read_b32 v29, a193
v_accvgpr_read_b32 v30, a194
v_accvgpr_read_b32 v31, a195
v_cvt_pk_bf16_f32 v224, v28, v29
v_cvt_pk_bf16_f32 v225, v30, v31
v_accvgpr_read_b32 v28, a224
v_accvgpr_read_b32 v29, a225
v_accvgpr_read_b32 v30, a226
v_accvgpr_read_b32 v31, a227
v_cvt_pk_bf16_f32 v226, v28, v29
v_cvt_pk_bf16_f32 v227, v30, v31
v_accvgpr_read_b32 v28, a196
v_accvgpr_read_b32 v29, a197
v_accvgpr_read_b32 v30, a198
v_accvgpr_read_b32 v31, a199
v_cvt_pk_bf16_f32 v228, v28, v29
v_cvt_pk_bf16_f32 v229, v30, v31
v_accvgpr_read_b32 v28, a228
v_accvgpr_read_b32 v29, a229
v_accvgpr_read_b32 v30, a230
v_accvgpr_read_b32 v31, a231
v_cvt_pk_bf16_f32 v230, v28, v29
v_cvt_pk_bf16_f32 v231, v30, v31
buffer_store_dwordx4 v[156:159], v19, s[20:23], s28 offen offset:3072 sc1
v_accvgpr_read_b32 v28, a200
v_accvgpr_read_b32 v29, a201
v_accvgpr_read_b32 v30, a202
v_accvgpr_read_b32 v31, a203
v_cvt_pk_bf16_f32 v232, v28, v29
v_cvt_pk_bf16_f32 v233, v30, v31
v_accvgpr_read_b32 v28, a232
v_accvgpr_read_b32 v29, a233
v_accvgpr_read_b32 v30, a234
v_accvgpr_read_b32 v31, a235
v_cvt_pk_bf16_f32 v234, v28, v29
v_cvt_pk_bf16_f32 v235, v30, v31
v_accvgpr_read_b32 v28, a204
v_accvgpr_read_b32 v29, a205
v_accvgpr_read_b32 v30, a206
v_accvgpr_read_b32 v31, a207
v_cvt_pk_bf16_f32 v236, v28, v29
v_cvt_pk_bf16_f32 v237, v30, v31
v_accvgpr_read_b32 v28, a236
v_accvgpr_read_b32 v29, a237
v_accvgpr_read_b32 v30, a238
v_accvgpr_read_b32 v31, a239
v_cvt_pk_bf16_f32 v238, v28, v29
v_cvt_pk_bf16_f32 v239, v30, v31
v_accvgpr_read_b32 v28, a208
v_accvgpr_read_b32 v29, a209
v_accvgpr_read_b32 v30, a210
v_accvgpr_read_b32 v31, a211
v_cvt_pk_bf16_f32 v240, v28, v29
v_cvt_pk_bf16_f32 v241, v30, v31
v_accvgpr_read_b32 v28, a240
v_accvgpr_read_b32 v29, a241
v_accvgpr_read_b32 v30, a242
v_accvgpr_read_b32 v31, a243
v_cvt_pk_bf16_f32 v242, v28, v29
v_cvt_pk_bf16_f32 v243, v30, v31
s_mov_b32 s28, 16384
buffer_store_dwordx4 v[160:163], v19, s[20:23], s28 offen offset:0 sc1
v_accvgpr_read_b32 v28, a212
v_accvgpr_read_b32 v29, a213
v_accvgpr_read_b32 v30, a214
v_accvgpr_read_b32 v31, a215
v_cvt_pk_bf16_f32 v244, v28, v29
v_cvt_pk_bf16_f32 v245, v30, v31
v_accvgpr_read_b32 v28, a244
v_accvgpr_read_b32 v29, a245
v_accvgpr_read_b32 v30, a246
v_accvgpr_read_b32 v31, a247
v_cvt_pk_bf16_f32 v246, v28, v29
v_cvt_pk_bf16_f32 v247, v30, v31
v_accvgpr_read_b32 v28, a216
v_accvgpr_read_b32 v29, a217
v_accvgpr_read_b32 v30, a218
v_accvgpr_read_b32 v31, a219
v_cvt_pk_bf16_f32 v248, v28, v29
v_cvt_pk_bf16_f32 v249, v30, v31
v_accvgpr_read_b32 v28, a248
v_accvgpr_read_b32 v29, a249
v_accvgpr_read_b32 v30, a250
v_accvgpr_read_b32 v31, a251
v_cvt_pk_bf16_f32 v250, v28, v29
v_cvt_pk_bf16_f32 v251, v30, v31
v_accvgpr_read_b32 v28, a220
v_accvgpr_read_b32 v29, a221
v_accvgpr_read_b32 v30, a222
v_accvgpr_read_b32 v31, a223
v_cvt_pk_bf16_f32 v252, v28, v29
v_cvt_pk_bf16_f32 v253, v30, v31
v_accvgpr_read_b32 v28, a252
v_accvgpr_read_b32 v29, a253
v_accvgpr_read_b32 v30, a254
v_accvgpr_read_b32 v31, a255
v_cvt_pk_bf16_f32 v254, v28, v29
v_cvt_pk_bf16_f32 v255, v30, v31
buffer_store_dwordx4 v[164:167], v19, s[20:23], s28 offen offset:1024 sc1
L_k1_p2:
s_lshr_b32 s29, 8192, s39
s_waitcnt vmcnt(15)
v_lshlrev_b32 v112, 8, v0
v_mov_b32 v113, 1
s_lshr_b32 s28, s2, 4
s_lshl_b32 s28, s28, 4
s_add_u32 s28, s28, 8
s_add_u32 s92, s100, s28
s_addc_u32 s93, s101, 0
s_mov_b32 s94, 4
s_waitcnt lgkmcnt(0)
v_mfma_f32_16x16x32_bf16 a[0:3], v[64:67], v[32:35], 0
v_mfma_f32_16x16x32_bf16 a[4:7], v[68:71], v[32:35], 0
v_mfma_f32_16x16x32_bf16 a[8:11], v[72:75], v[32:35], 0
s_waitcnt vmcnt(33)
s_barrier
v_mfma_f32_16x16x32_bf16 a[176:179], v[52:55], v[114:117], 0
s_mov_b32 m0, s58
ds_read_b128 a[180:183], v15
v_mfma_f32_16x16x32_bf16 a[12:15], v[76:79], v[32:35], 0
buffer_load_dwordx4 v10, s[16:19], s25 offen offset:0 lds
v_mfma_f32_16x16x32_bf16 a[16:19], v[80:83], v[32:35], 0
ds_read_b64_tr_b16 a[212:213], v20 offset:16384
ds_read_b64_tr_b16 a[214:215], v20 offset:18432
v_mfma_f32_16x16x32_bf16 a[20:23], v[84:87], v[32:35], 0
ds_read_b64_tr_b16 a[216:217], v21 offset:16384
v_mfma_f32_16x16x32_bf16 a[24:27], v[88:91], v[32:35], 0
buffer_load_dwordx4 v11, s[16:19], s25 offen offset:1024 lds
v_mfma_f32_16x16x32_bf16 a[28:31], v[92:95], v[32:35], 0
ds_read_b64_tr_b16 a[218:219], v21 offset:18432
v_mfma_f32_16x16x32_bf16 a[128:131], v[48:51], v[32:35], 0
ds_read_b64_tr_b16 a[220:221], v22 offset:16384
v_mfma_f32_16x16x32_bf16 a[132:135], v[52:55], v[32:35], 0
ds_read_b64_tr_b16 a[222:223], v22 offset:18432
v_mfma_f32_16x16x32_bf16 a[136:139], v[56:59], v[32:35], 0
buffer_load_dwordx4 v12, s[16:19], s25 offen offset:2048 lds
v_mfma_f32_16x16x32_bf16 a[32:35], v[64:67], v[36:39], 0
ds_read_b64_tr_b16 a[224:225], v23 offset:16384
ds_read_b64_tr_b16 a[226:227], v23 offset:18432
v_mfma_f32_16x16x32_bf16 a[36:39], v[68:71], v[36:39], 0
v_mfma_f32_16x16x32_bf16 a[40:43], v[72:75], v[36:39], 0
ds_read_b64_tr_b16 a[228:229], v24 offset:16384
v_mfma_f32_16x16x32_bf16 a[44:47], v[76:79], v[36:39], 0
buffer_load_dwordx4 v13, s[16:19], s25 offen offset:3072 lds
v_mfma_f32_16x16x32_bf16 a[48:51], v[80:83], v[36:39], 0
s_add_u32 s25, s25, 262144
ds_read_b64_tr_b16 a[230:231], v24 offset:18432
v_mfma_f32_16x16x32_bf16 a[52:55], v[84:87], v[36:39], 0
s_mov_b32 m0, s75
ds_read_b64_tr_b16 a[232:233], v25 offset:16384
v_mfma_f32_16x16x32_bf16 a[56:59], v[88:91], v[36:39], 0
buffer_load_dwordx4 v6, s[44:47], s56 offen offset:0 lds
v_mfma_f32_16x16x32_bf16 a[60:63], v[92:95], v[36:39], 0
ds_read_b64_tr_b16 a[234:235], v25 offset:18432
ds_read_b64_tr_b16 a[236:237], v26 offset:16384
v_mfma_f32_16x16x32_bf16 a[140:143], v[48:51], v[36:39], 0
ds_read_b64_tr_b16 a[238:239], v26 offset:18432
v_mfma_f32_16x16x32_bf16 a[144:147], v[52:55], v[36:39], 0
ds_read_b64_tr_b16 a[240:241], v27 offset:16384
v_mfma_f32_16x16x32_bf16 a[148:151], v[56:59], v[36:39], 0
buffer_load_dwordx4 v7, s[44:47], s56 offen offset:1024 lds
v_mfma_f32_16x16x32_bf16 a[64:67], v[64:67], v[40:43], 0
ds_read_b64_tr_b16 a[242:243], v27 offset:18432
ds_read_b64_tr_b16 a[196:197], v16 offset:8192
v_mfma_f32_16x16x32_bf16 a[68:71], v[68:71], v[40:43], 0
v_mfma_f32_16x16x32_bf16 a[72:75], v[72:75], v[40:43], 0
ds_read_b64_tr_b16 a[198:199], v16 offset:8960
v_mfma_f32_16x16x32_bf16 a[76:79], v[76:79], v[40:43], 0
buffer_load_dwordx4 v8, s[44:47], s56 offen offset:2048 lds
v_mfma_f32_16x16x32_bf16 a[80:83], v[80:83], v[40:43], 0
s_add_u32 s56, s56, s57
ds_read_b64_tr_b16 a[200:201], v17 offset:8192
v_mfma_f32_16x16x32_bf16 a[84:87], v[84:87], v[40:43], 0
s_mov_b32 s28, 16384
ds_read_b64_tr_b16 a[202:203], v17 offset:8960
v_mfma_f32_16x16x32_bf16 a[88:91], v[88:91], v[40:43], 0
buffer_store_dwordx4 v[168:171], v19, s[20:23], s28 offen offset:2048 sc1
v_mfma_f32_16x16x32_bf16 a[92:95], v[92:95], v[40:43], 0
ds_read_b64_tr_b16 a[204:205], v18 offset:8192
ds_read_b64_tr_b16 a[206:207], v18 offset:8960
v_mfma_f32_16x16x32_bf16 a[152:155], v[48:51], v[40:43], 0
ds_read_b128 a[184:187], v15 offset:2048
v_mfma_f32_16x16x32_bf16 a[156:159], v[52:55], v[40:43], 0
ds_read_b128 a[188:191], v15 offset:4096
v_mfma_f32_16x16x32_bf16 a[160:163], v[56:59], v[40:43], 0
buffer_load_dwordx4 v[114:117], v109, s[64:67], 0 offen offset:192
v_mfma_f32_16x16x32_bf16 a[96:99], v[64:67], v[44:47], 0
ds_read_b128 a[192:195], v15 offset:6144
v_mfma_f32_16x16x32_bf16 a[100:103], v[68:71], v[44:47], 0
v_mfma_f32_16x16x32_bf16 a[104:107], v[72:75], v[44:47], 0
v_mfma_f32_16x16x32_bf16 a[108:111], v[76:79], v[44:47], 0
v_mfma_f32_16x16x32_bf16 a[112:115], v[80:83], v[44:47], 0
v_mfma_f32_16x16x32_bf16 a[116:119], v[84:87], v[44:47], 0
s_add_u32 s74, s73, s30
s_add_u32 s75, s73, s31
v_mfma_f32_16x16x32_bf16 a[120:123], v[88:91], v[44:47], 0
s_add_u32 s73, s73, 32768
s_cmp_eq_u32 s73, 163840
v_mfma_f32_16x16x32_bf16 a[124:127], v[92:95], v[44:47], 0
s_cselect_b32 s73, 65536, s73
v_add_u32 v14, s73, v104
v_mfma_f32_16x16x32_bf16 a[164:167], v[48:51], v[44:47], 0
v_add_u32 v15, s73, v105
v_add_u32 v16, s73, v106
v_mfma_f32_16x16x32_bf16 a[168:171], v[52:55], v[44:47], 0
v_add_u32 v17, s73, v107
v_add_u32 v18, s73, v108
v_mfma_f32_16x16x32_bf16 a[172:175], v[56:59], v[44:47], 0
s_waitcnt lgkmcnt(0)
v_mfma_f32_16x16x32_bf16 a[0:3], a[212:215], a[180:183], a[0:3]
v_mfma_f32_16x16x32_bf16 a[4:7], a[216:219], a[180:183], a[4:7]
v_mfma_f32_16x16x32_bf16 a[8:11], a[220:223], a[180:183], a[8:11]
s_waitcnt vmcnt(33)
s_barrier
v_mfma_f32_16x16x32_bf16 a[176:179], a[200:203], v[118:121], a[176:179]
s_add_u32 m0, s58, 16384
ds_read_b128 v[32:35], v14
v_mfma_f32_16x16x32_bf16 a[12:15], a[224:227], a[180:183], a[12:15]
buffer_load_dwordx4 v10, s[16:19], s25 offen offset:0 lds
v_mfma_f32_16x16x32_bf16 a[16:19], a[228:231], a[180:183], a[16:19]
ds_read_b64_tr_b16 v[64:65], v20 offset:32768
ds_read_b64_tr_b16 v[66:67], v20 offset:34816
v_mfma_f32_16x16x32_bf16 a[20:23], a[232:235], a[180:183], a[20:23]
v_mfma_f32_16x16x32_bf16 a[24:27], a[236:239], a[180:183], a[24:27]
buffer_load_dwordx4 v11, s[16:19], s25 offen offset:1024 lds
v_mfma_f32_16x16x32_bf16 a[28:31], a[240:243], a[180:183], a[28:31]
ds_read_b64_tr_b16 v[68:69], v21 offset:32768
ds_read_b64_tr_b16 v[70:71], v21 offset:34816
v_mfma_f32_16x16x32_bf16 a[128:131], a[196:199], a[180:183], a[128:131]
v_mfma_f32_16x16x32_bf16 a[132:135], a[200:203], a[180:183], a[132:135]
ds_read_b64_tr_b16 v[72:73], v22 offset:32768
v_mfma_f32_16x16x32_bf16 a[136:139], a[204:207], a[180:183], a[136:139]
buffer_load_dwordx4 v12, s[16:19], s25 offen offset:2048 lds
v_mfma_f32_16x16x32_bf16 a[32:35], a[212:215], a[184:187], a[32:35]
ds_read_b64_tr_b16 v[74:75], v22 offset:34816
ds_read_b64_tr_b16 v[76:77], v23 offset:32768
v_mfma_f32_16x16x32_bf16 a[36:39], a[216:219], a[184:187], a[36:39]
v_mfma_f32_16x16x32_bf16 a[40:43], a[220:223], a[184:187], a[40:43]
ds_read_b64_tr_b16 v[78:79], v23 offset:34816
v_mfma_f32_16x16x32_bf16 a[44:47], a[224:227], a[184:187], a[44:47]
buffer_load_dwordx4 v13, s[16:19], s25 offen offset:3072 lds
v_mfma_f32_16x16x32_bf16 a[48:51], a[228:231], a[184:187], a[48:51]
s_add_u32 s25, s25, 262144
ds_read_b64_tr_b16 v[80:81], v24 offset:32768
v_mfma_f32_16x16x32_bf16 a[52:55], a[232:235], a[184:187], a[52:55]
ds_read_b64_tr_b16 v[82:83], v24 offset:34816
v_mfma_f32_16x16x32_bf16 a[56:59], a[236:239], a[184:187], a[56:59]
s_mov_b32 m0, s74
ds_read_b64_tr_b16 v[84:85], v25 offset:32768
v_mfma_f32_16x16x32_bf16 a[60:63], a[240:243], a[184:187], a[60:63]
buffer_load_dwordx4 v2, s[12:15], s24 offen offset:0 lds
v_mfma_f32_16x16x32_bf16 a[140:143], a[196:199], a[184:187], a[140:143]
ds_read_b64_tr_b16 v[86:87], v25 offset:34816
v_mfma_f32_16x16x32_bf16 a[144:147], a[200:203], a[184:187], a[144:147]
ds_read_b64_tr_b16 v[88:89], v26 offset:32768
v_mfma_f32_16x16x32_bf16 a[148:151], a[204:207], a[184:187], a[148:151]
ds_read_b64_tr_b16 v[90:91], v26 offset:34816
v_mfma_f32_16x16x32_bf16 a[64:67], a[212:215], a[188:191], a[64:67]
buffer_load_dwordx4 v3, s[12:15], s24 offen offset:1024 lds
v_mfma_f32_16x16x32_bf16 a[68:71], a[216:219], a[188:191], a[68:71]
ds_read_b64_tr_b16 v[92:93], v27 offset:32768
v_mfma_f32_16x16x32_bf16 a[72:75], a[220:223], a[188:191], a[72:75]
ds_read_b64_tr_b16 v[94:95], v27 offset:34816
v_mfma_f32_16x16x32_bf16 a[76:79], a[224:227], a[188:191], a[76:79]
buffer_load_dwordx4 v4, s[12:15], s24 offen offset:2048 lds
v_mfma_f32_16x16x32_bf16 a[80:83], a[228:231], a[188:191], a[80:83]
ds_read_b64_tr_b16 v[48:49], v16 offset:0
v_mfma_f32_16x16x32_bf16 a[84:87], a[232:235], a[188:191], a[84:87]
ds_read_b64_tr_b16 v[50:51], v16 offset:768
v_mfma_f32_16x16x32_bf16 a[88:91], a[236:239], a[188:191], a[88:91]
v_mfma_f32_16x16x32_bf16 a[92:95], a[240:243], a[188:191], a[92:95]
buffer_load_dwordx4 v5, s[12:15], s24 offen offset:3072 lds
v_mfma_f32_16x16x32_bf16 a[152:155], a[196:199], a[188:191], a[152:155]
s_add_u32 s24, s24, 128
ds_read_b64_tr_b16 v[52:53], v17 offset:0
v_mfma_f32_16x16x32_bf16 a[156:159], a[200:203], a[188:191], a[156:159]
ds_read_b64_tr_b16 v[54:55], v17 offset:768
ds_read_b64_tr_b16 v[56:57], v18 offset:0
v_mfma_f32_16x16x32_bf16 a[160:163], a[204:207], a[188:191], a[160:163]
v_mfma_f32_16x16x32_bf16 a[96:99], a[212:215], a[192:195], a[96:99]
buffer_store_dwordx4 v[172:175], v19, s[20:23], s28 offen offset:3072 sc1
v_mfma_f32_16x16x32_bf16 a[100:103], a[216:219], a[192:195], a[100:103]
ds_read_b64_tr_b16 v[58:59], v18 offset:768
ds_read_b128 v[36:39], v14 offset:2048
v_mfma_f32_16x16x32_bf16 a[104:107], a[220:223], a[192:195], a[104:107]
v_mfma_f32_16x16x32_bf16 a[108:111], a[224:227], a[192:195], a[108:111]
ds_read_b128 v[40:43], v14 offset:4096
v_mfma_f32_16x16x32_bf16 a[112:115], a[228:231], a[192:195], a[112:115]
buffer_load_dwordx4 v[118:121], v109, s[64:67], 0 offen offset:256
v_mfma_f32_16x16x32_bf16 a[116:119], a[232:235], a[192:195], a[116:119]
ds_read_b128 v[44:47], v14 offset:6144
v_mfma_f32_16x16x32_bf16 a[120:123], a[236:239], a[192:195], a[120:123]
v_mfma_f32_16x16x32_bf16 a[124:127], a[240:243], a[192:195], a[124:127]
v_mfma_f32_16x16x32_bf16 a[164:167], a[196:199], a[192:195], a[164:167]
v_mfma_f32_16x16x32_bf16 a[168:171], a[200:203], a[192:195], a[168:171]
v_mfma_f32_16x16x32_bf16 a[172:175], a[204:207], a[192:195], a[172:175]
s_waitcnt lgkmcnt(0)
v_mfma_f32_16x16x32_bf16 a[0:3], v[64:67], v[32:35], a[0:3]
v_mfma_f32_16x16x32_bf16 a[4:7], v[68:71], v[32:35], a[4:7]
v_mfma_f32_16x16x32_bf16 a[8:11], v[72:75], v[32:35], a[8:11]
s_waitcnt vmcnt(19)
s_barrier
v_mfma_f32_16x16x32_bf16 a[176:179], v[52:55], v[122:125], a[176:179]
s_add_u32 m0, s58, 32768
ds_read_b128 a[180:183], v15
v_mfma_f32_16x16x32_bf16 a[12:15], v[76:79], v[32:35], a[12:15]
buffer_load_dwordx4 v10, s[16:19], s25 offen offset:0 lds
v_mfma_f32_16x16x32_bf16 a[16:19], v[80:83], v[32:35], a[16:19]
ds_read_b64_tr_b16 a[212:213], v20 offset:49152
ds_read_b64_tr_b16 a[214:215], v20 offset:51200
v_mfma_f32_16x16x32_bf16 a[20:23], v[84:87], v[32:35], a[20:23]
ds_read_b64_tr_b16 a[216:217], v21 offset:49152
v_mfma_f32_16x16x32_bf16 a[24:27], v[88:91], v[32:35], a[24:27]
buffer_load_dwordx4 v11, s[16:19], s25 offen offset:1024 lds
v_mfma_f32_16x16x32_bf16 a[28:31], v[92:95], v[32:35], a[28:31]
ds_read_b64_tr_b16 a[218:219], v21 offset:51200
v_mfma_f32_16x16x32_bf16 a[128:131], v[48:51], v[32:35], a[128:131]
ds_read_b64_tr_b16 a[220:221], v22 offset:49152
v_mfma_f32_16x16x32_bf16 a[132:135], v[52:55], v[32:35], a[132:135]
buffer_load_dwordx4 v12, s[16:19], s25 offen offset:2048 lds
v_mfma_f32_16x16x32_bf16 a[136:139], v[56:59], v[32:35], a[136:139]
ds_read_b64_tr_b16 a[222:223], v22 offset:51200
ds_read_b64_tr_b16 a[224:225], v23 offset:49152
v_mfma_f32_16x16x32_bf16 a[32:35], v[64:67], v[36:39], a[32:35]
ds_read_b64_tr_b16 a[226:227], v23 offset:51200
v_mfma_f32_16x16x32_bf16 a[36:39], v[68:71], v[36:39], a[36:39]
buffer_load_dwordx4 v13, s[16:19], s25 offen offset:3072 lds
v_mfma_f32_16x16x32_bf16 a[40:43], v[72:75], v[36:39], a[40:43]
s_add_u32 s25, s25, 262144
ds_read_b64_tr_b16 a[228:229], v24 offset:49152
v_mfma_f32_16x16x32_bf16 a[44:47], v[76:79], v[36:39], a[44:47]
ds_read_b64_tr_b16 a[230:231], v24 offset:51200
v_mfma_f32_16x16x32_bf16 a[48:51], v[80:83], v[36:39], a[48:51]
s_mov_b32 m0, s75
ds_read_b64_tr_b16 a[232:233], v25 offset:49152
v_mfma_f32_16x16x32_bf16 a[52:55], v[84:87], v[36:39], a[52:55]
buffer_load_dwordx4 v6, s[44:47], s56 offen offset:0 lds
v_mfma_f32_16x16x32_bf16 a[56:59], v[88:91], v[36:39], a[56:59]
ds_read_b64_tr_b16 a[234:235], v25 offset:51200
v_mfma_f32_16x16x32_bf16 a[60:63], v[92:95], v[36:39], a[60:63]
ds_read_b64_tr_b16 a[236:237], v26 offset:49152
v_mfma_f32_16x16x32_bf16 a[140:143], v[48:51], v[36:39], a[140:143]
buffer_load_dwordx4 v7, s[44:47], s56 offen offset:1024 lds
v_mfma_f32_16x16x32_bf16 a[144:147], v[52:55], v[36:39], a[144:147]
ds_read_b64_tr_b16 a[238:239], v26 offset:51200
ds_read_b64_tr_b16 a[240:241], v27 offset:49152
v_mfma_f32_16x16x32_bf16 a[148:151], v[56:59], v[36:39], a[148:151]
ds_read_b64_tr_b16 a[242:243], v27 offset:51200
v_mfma_f32_16x16x32_bf16 a[64:67], v[64:67], v[40:43], a[64:67]
buffer_load_dwordx4 v8, s[44:47], s56 offen offset:2048 lds
v_mfma_f32_16x16x32_bf16 a[68:71], v[68:71], v[40:43], a[68:71]
s_add_u32 s56, s56, s57
ds_read_b64_tr_b16 a[196:197], v16 offset:8192
v_mfma_f32_16x16x32_bf16 a[72:75], v[72:75], v[40:43], a[72:75]
ds_read_b64_tr_b16 a[198:199], v16 offset:8960
v_mfma_f32_16x16x32_bf16 a[76:79], v[76:79], v[40:43], a[76:79]
s_add_u32 s28, s29, 16384
ds_read_b64_tr_b16 a[200:201], v17 offset:8192
v_mfma_f32_16x16x32_bf16 a[80:83], v[80:83], v[40:43], a[80:83]
buffer_store_dwordx4 v[176:179], v19, s[20:23], s28 offen offset:0 sc1
v_mfma_f32_16x16x32_bf16 a[84:87], v[84:87], v[40:43], a[84:87]
ds_read_b64_tr_b16 a[202:203], v17 offset:8960
ds_read_b64_tr_b16 a[204:205], v18 offset:8192
v_mfma_f32_16x16x32_bf16 a[88:91], v[88:91], v[40:43], a[88:91]
v_mfma_f32_16x16x32_bf16 a[92:95], v[92:95], v[40:43], a[92:95]
buffer_load_dwordx4 v[122:125], v109, s[64:67], 0 offen offset:320
v_mfma_f32_16x16x32_bf16 a[152:155], v[48:51], v[40:43], a[152:155]
ds_read_b64_tr_b16 a[206:207], v18 offset:8960
ds_read_b128 a[184:187], v15 offset:2048
v_mfma_f32_16x16x32_bf16 a[156:159], v[52:55], v[40:43], a[156:159]
ds_read_b128 a[188:191], v15 offset:4096
v_mfma_f32_16x16x32_bf16 a[160:163], v[56:59], v[40:43], a[160:163]
buffer_atomic_add v113, v112, s[92:95], 0 offen sc1
v_mfma_f32_16x16x32_bf16 a[96:99], v[64:67], v[44:47], a[96:99]
ds_read_b128 a[192:195], v15 offset:6144
v_mfma_f32_16x16x32_bf16 a[100:103], v[68:71], v[44:47], a[100:103]
v_mfma_f32_16x16x32_bf16 a[104:107], v[72:75], v[44:47], a[104:107]
v_mfma_f32_16x16x32_bf16 a[108:111], v[76:79], v[44:47], a[108:111]
v_mfma_f32_16x16x32_bf16 a[112:115], v[80:83], v[44:47], a[112:115]
v_mfma_f32_16x16x32_bf16 a[116:119], v[84:87], v[44:47], a[116:119]
s_add_u32 s74, s73, s30
s_add_u32 s75, s73, s31
v_mfma_f32_16x16x32_bf16 a[120:123], v[88:91], v[44:47], a[120:123]
s_add_u32 s73, s73, 32768
s_cmp_eq_u32 s73, 163840
v_mfma_f32_16x16x32_bf16 a[124:127], v[92:95], v[44:47], a[124:127]
s_cselect_b32 s73, 65536, s73
v_add_u32 v14, s73, v104
v_mfma_f32_16x16x32_bf16 a[164:167], v[48:51], v[44:47], a[164:167]
v_add_u32 v15, s73, v105
v_add_u32 v16, s73, v106
v_mfma_f32_16x16x32_bf16 a[168:171], v[52:55], v[44:47], a[168:171]
v_add_u32 v17, s73, v107
v_add_u32 v18, s73, v108
v_mfma_f32_16x16x32_bf16 a[172:175], v[56:59], v[44:47], a[172:175]
s_waitcnt lgkmcnt(0)
v_mfma_f32_16x16x32_bf16 a[0:3], a[212:215], a[180:183], a[0:3]
v_mfma_f32_16x16x32_bf16 a[4:7], a[216:219], a[180:183], a[4:7]
v_mfma_f32_16x16x32_bf16 a[8:11], a[220:223], a[180:183], a[8:11]
s_waitcnt vmcnt(20)
s_barrier
v_mfma_f32_16x16x32_bf16 a[176:179], a[200:203], v[114:117], a[176:179]
s_add_u32 m0, s58, 49152
ds_read_b128 v[32:35], v14
v_mfma_f32_16x16x32_bf16 a[12:15], a[224:227], a[180:183], a[12:15]
buffer_load_dwordx4 v10, s[16:19], s25 offen offset:0 lds
v_mfma_f32_16x16x32_bf16 a[16:19], a[228:231], a[180:183], a[16:19]
ds_read_b64_tr_b16 v[64:65], v20 offset:0
ds_read_b64_tr_b16 v[66:67], v20 offset:2048
v_mfma_f32_16x16x32_bf16 a[20:23], a[232:235], a[180:183], a[20:23]
v_mfma_f32_16x16x32_bf16 a[24:27], a[236:239], a[180:183], a[24:27]
buffer_load_dwordx4 v11, s[16:19], s25 offen offset:1024 lds
v_mfma_f32_16x16x32_bf16 a[28:31], a[240:243], a[180:183], a[28:31]
ds_read_b64_tr_b16 v[68:69], v21 offset:0
ds_read_b64_tr_b16 v[70:71], v21 offset:2048
v_mfma_f32_16x16x32_bf16 a[128:131], a[196:199], a[180:183], a[128:131]
v_mfma_f32_16x16x32_bf16 a[132:135], a[200:203], a[180:183], a[132:135]
ds_read_b64_tr_b16 v[72:73], v22 offset:0
v_mfma_f32_16x16x32_bf16 a[136:139], a[204:207], a[180:183], a[136:139]
buffer_load_dwordx4 v12, s[16:19], s25 offen offset:2048 lds
v_mfma_f32_16x16x32_bf16 a[32:35], a[212:215], a[184:187], a[32:35]
ds_read_b64_tr_b16 v[74:75], v22 offset:2048
ds_read_b64_tr_b16 v[76:77], v23 offset:0
v_mfma_f32_16x16x32_bf16 a[36:39], a[216:219], a[184:187], a[36:39]
v_mfma_f32_16x16x32_bf16 a[40:43], a[220:223], a[184:187], a[40:43]
ds_read_b64_tr_b16 v[78:79], v23 offset:2048
v_mfma_f32_16x16x32_bf16 a[44:47], a[224:227], a[184:187], a[44:47]
buffer_load_dwordx4 v13, s[16:19], s25 offen offset:3072 lds
v_mfma_f32_16x16x32_bf16 a[48:51], a[228:231], a[184:187], a[48:51]
s_add_u32 s25, s25, 262144
ds_read_b64_tr_b16 v[80:81], v24 offset:0
v_mfma_f32_16x16x32_bf16 a[52:55], a[232:235], a[184:187], a[52:55]
ds_read_b64_tr_b16 v[82:83], v24 offset:2048
v_mfma_f32_16x16x32_bf16 a[56:59], a[236:239], a[184:187], a[56:59]
s_mov_b32 m0, s74
ds_read_b64_tr_b16 v[84:85], v25 offset:0
v_mfma_f32_16x16x32_bf16 a[60:63], a[240:243], a[184:187], a[60:63]
buffer_load_dwordx4 v2, s[12:15], s24 offen offset:0 lds
v_mfma_f32_16x16x32_bf16 a[140:143], a[196:199], a[184:187], a[140:143]
ds_read_b64_tr_b16 v[86:87], v25 offset:2048
v_mfma_f32_16x16x32_bf16 a[144:147], a[200:203], a[184:187], a[144:147]
ds_read_b64_tr_b16 v[88:89], v26 offset:0
v_mfma_f32_16x16x32_bf16 a[148:151], a[204:207], a[184:187], a[148:151]
ds_read_b64_tr_b16 v[90:91], v26 offset:2048
v_mfma_f32_16x16x32_bf16 a[64:67], a[212:215], a[188:191], a[64:67]
buffer_load_dwordx4 v3, s[12:15], s24 offen offset:1024 lds
v_mfma_f32_16x16x32_bf16 a[68:71], a[216:219], a[188:191], a[68:71]
ds_read_b64_tr_b16 v[92:93], v27 offset:0
v_mfma_f32_16x16x32_bf16 a[72:75], a[220:223], a[188:191], a[72:75]
ds_read_b64_tr_b16 v[94:95], v27 offset:2048
v_mfma_f32_16x16x32_bf16 a[76:79], a[224:227], a[188:191], a[76:79]
buffer_load_dwordx4 v4, s[12:15], s24 offen offset:2048 lds
v_mfma_f32_16x16x32_bf16 a[80:83], a[228:231], a[188:191], a[80:83]
ds_read_b64_tr_b16 v[48:49], v16 offset:0
v_mfma_f32_16x16x32_bf16 a[84:87], a[232:235], a[188:191], a[84:87]
ds_read_b64_tr_b16 v[50:51], v16 offset:768
v_mfma_f32_16x16x32_bf16 a[88:91], a[236:239], a[188:191], a[88:91]
v_mfma_f32_16x16x32_bf16 a[92:95], a[240:243], a[188:191], a[92:95]
buffer_load_dwordx4 v5, s[12:15], s24 offen offset:3072 lds
v_mfma_f32_16x16x32_bf16 a[152:155], a[196:199], a[188:191], a[152:155]
s_add_u32 s24, s24, 128
ds_read_b64_tr_b16 v[52:53], v17 offset:0
v_mfma_f32_16x16x32_bf16 a[156:159], a[200:203], a[188:191], a[156:159]
ds_read_b64_tr_b16 v[54:55], v17 offset:768
ds_read_b64_tr_b16 v[56:57], v18 offset:0
v_mfma_f32_16x16x32_bf16 a[160:163], a[204:207], a[188:191], a[160:163]
v_mfma_f32_16x16x32_bf16 a[96:99], a[212:215], a[192:195], a[96:99]
buffer_store_dwordx4 v[180:183], v19, s[20:23], s28 offen offset:1024 sc1
v_mfma_f32_16x16x32_bf16 a[100:103], a[216:219], a[192:195], a[100:103]
ds_read_b64_tr_b16 v[58:59], v18 offset:768
ds_read_b128 v[36:39], v14 offset:2048
v_mfma_f32_16x16x32_bf16 a[104:107], a[220:223], a[192:195], a[104:107]
v_mfma_f32_16x16x32_bf16 a[108:111], a[224:227], a[192:195], a[108:111]
ds_read_b128 v[40:43], v14 offset:4096
v_mfma_f32_16x16x32_bf16 a[112:115], a[228:231], a[192:195], a[112:115]
buffer_load_dwordx4 v[114:117], v109, s[64:67], 0 offen offset:384
v_mfma_f32_16x16x32_bf16 a[116:119], a[232:235], a[192:195], a[116:119]
ds_read_b128 v[44:47], v14 offset:6144
v_mfma_f32_16x16x32_bf16 a[120:123], a[236:239], a[192:195], a[120:123]
v_mfma_f32_16x16x32_bf16 a[124:127], a[240:243], a[192:195], a[124:127]
v_mfma_f32_16x16x32_bf16 a[164:167], a[196:199], a[192:195], a[164:167]
v_mfma_f32_16x16x32_bf16 a[168:171], a[200:203], a[192:195], a[168:171]
v_mfma_f32_16x16x32_bf16 a[172:175], a[204:207], a[192:195], a[172:175]
s_waitcnt lgkmcnt(0)
v_mfma_f32_16x16x32_bf16 a[0:3], v[64:67], v[32:35], a[0:3]
v_mfma_f32_16x16x32_bf16 a[4:7], v[68:71], v[32:35], a[4:7]
v_mfma_f32_16x16x32_bf16 a[8:11], v[72:75], v[32:35], a[8:11]
s_waitcnt vmcnt(20)
s_barrier
v_mfma_f32_16x16x32_bf16 a[176:179], v[52:55], v[118:121], a[176:179]
s_mov_b32 m0, s58
ds_read_b128 a[180:183], v15
v_mfma_f32_16x16x32_bf16 a[12:15], v[76:79], v[32:35], a[12:15]
buffer_load_dwordx4 v10, s[16:19], s25 offen offset:0 lds
v_mfma_f32_16x16x32_bf16 a[16:19], v[80:83], v[32:35], a[16:19]
ds_read_b64_tr_b16 a[212:213], v20 offset:16384
ds_read_b64_tr_b16 a[214:215], v20 offset:18432
v_mfma_f32_16x16x32_bf16 a[20:23], v[84:87], v[32:35], a[20:23]
ds_read_b64_tr_b16 a[216:217], v21 offset:16384
v_mfma_f32_16x16x32_bf16 a[24:27], v[88:91], v[32:35], a[24:27]
buffer_load_dwordx4 v11, s[16:19], s25 offen offset:1024 lds
v_mfma_f32_16x16x32_bf16 a[28:31], v[92:95], v[32:35], a[28:31]
ds_read_b64_tr_b16 a[218:219], v21 offset:18432
v_mfma_f32_16x16x32_bf16 a[128:131], v[48:51], v[32:35], a[128:131]
ds_read_b64_tr_b16 a[220:221], v22 offset:16384
v_mfma_f32_16x16x32_bf16 a[132:135], v[52:55], v[32:35], a[132:135]
ds_read_b64_tr_b16 a[222:223], v22 offset:18432
v_mfma_f32_16x16x32_bf16 a[136:139], v[56:59], v[32:35], a[136:139]
buffer_load_dwordx4 v12, s[16:19], s25 offen offset:2048 lds
v_mfma_f32_16x16x32_bf16 a[32:35], v[64:67], v[36:39], a[32:35]
ds_read_b64_tr_b16 a[224:225], v23 offset:16384
ds_read_b64_tr_b16 a[226:227], v23 offset:18432
v_mfma_f32_16x16x32_bf16 a[36:39], v[68:71], v[36:39], a[36:39]
v_mfma_f32_16x16x32_bf16 a[40:43], v[72:75], v[36:39], a[40:43]
ds_read_b64_tr_b16 a[228:229], v24 offset:16384
v_mfma_f32_16x16x32_bf16 a[44:47], v[76:79], v[36:39], a[44:47]
buffer_load_dwordx4 v13, s[16:19], s25 offen offset:3072 lds
v_mfma_f32_16x16x32_bf16 a[48:51], v[80:83], v[36:39], a[48:51]
s_add_u32 s25, s25, 262144
ds_read_b64_tr_b16 a[230:231], v24 offset:18432
v_mfma_f32_16x16x32_bf16 a[52:55], v[84:87], v[36:39], a[52:55]
s_mov_b32 m0, s75
ds_read_b64_tr_b16 a[232:233], v25 offset:16384
v_mfma_f32_16x16x32_bf16 a[56:59], v[88:91], v[36:39], a[56:59]
buffer_load_dwordx4 v6, s[44:47], s56 offen offset:0 lds
v_mfma_f32_16x16x32_bf16 a[60:63], v[92:95], v[36:39], a[60:63]
ds_read_b64_tr_b16 a[234:235], v25 offset:18432
ds_read_b64_tr_b16 a[236:237], v26 offset:16384
v_mfma_f32_16x16x32_bf16 a[140:143], v[48:51], v[36:39], a[140:143]
ds_read_b64_tr_b16 a[238:239], v26 offset:18432
v_mfma_f32_16x16x32_bf16 a[144:147], v[52:55], v[36:39], a[144:147]
ds_read_b64_tr_b16 a[240:241], v27 offset:16384
v_mfma_f32_16x16x32_bf16 a[148:151], v[56:59], v[36:39], a[148:151]
buffer_load_dwordx4 v7, s[44:47], s56 offen offset:1024 lds
v_mfma_f32_16x16x32_bf16 a[64:67], v[64:67], v[40:43], a[64:67]
ds_read_b64_tr_b16 a[242:243], v27 offset:18432
ds_read_b64_tr_b16 a[196:197], v16 offset:8192
v_mfma_f32_16x16x32_bf16 a[68:71], v[68:71], v[40:43], a[68:71]
v_mfma_f32_16x16x32_bf16 a[72:75], v[72:75], v[40:43], a[72:75]
ds_read_b64_tr_b16 a[198:199], v16 offset:8960
v_mfma_f32_16x16x32_bf16 a[76:79], v[76:79], v[40:43], a[76:79]
buffer_load_dwordx4 v8, s[44:47], s56 offen offset:2048 lds
v_mfma_f32_16x16x32_bf16 a[80:83], v[80:83], v[40:43], a[80:83]
s_add_u32 s56, s56, s57
ds_read_b64_tr_b16 a[200:201], v17 offset:8192
v_mfma_f32_16x16x32_bf16 a[84:87], v[84:87], v[40:43], a[84:87]
ds_read_b64_tr_b16 a[202:203], v17 offset:8960
ds_read_b64_tr_b16 a[204:205], v18 offset:8192
v_mfma_f32_16x16x32_bf16 a[88:91], v[88:91], v[40:43], a[88:91]
buffer_store_dwordx4 v[184:187], v19, s[20:23], s28 offen offset:2048 sc1
v_mfma_f32_16x16x32_bf16 a[92:95], v[92:95], v[40:43], a[92:95]
ds_read_b64_tr_b16 a[206:207], v18 offset:8960
v_mfma_f32_16x16x32_bf16 a[152:155], v[48:51], v[40:43], a[152:155]
ds_read_b128 a[184:187], v15 offset:2048
v_mfma_f32_16x16x32_bf16 a[156:159], v[52:55], v[40:43], a[156:159]
ds_read_b128 a[188:191], v15 offset:4096
v_mfma_f32_16x16x32_bf16 a[160:163], v[56:59], v[40:43], a[160:163]
buffer_load_dwordx4 v[118:121], v109, s[64:67], 0 offen offset:448
v_mfma_f32_16x16x32_bf16 a[96:99], v[64:67], v[44:47], a[96:99]
ds_read_b128 a[192:195], v15 offset:6144
v_mfma_f32_16x16x32_bf16 a[100:103], v[68:71], v[44:47], a[100:103]
v_mfma_f32_16x16x32_bf16 a[104:107], v[72:75], v[44:47], a[104:107]
v_mfma_f32_16x16x32_bf16 a[108:111], v[76:79], v[44:47], a[108:111]
v_mfma_f32_16x16x32_bf16 a[112:115], v[80:83], v[44:47], a[112:115]
v_mfma_f32_16x16x32_bf16 a[116:119], v[84:87], v[44:47], a[116:119]
s_add_u32 s74, s73, s30
s_add_u32 s75, s73, s31
v_mfma_f32_16x16x32_bf16 a[120:123], v[88:91], v[44:47], a[120:123]
s_add_u32 s73, s73, 32768
s_cmp_eq_u32 s73, 163840
v_mfma_f32_16x16x32_bf16 a[124:127], v[92:95], v[44:47], a[124:127]
s_cselect_b32 s73, 65536, s73
v_add_u32 v14, s73, v104
v_mfma_f32_16x16x32_bf16 a[164:167], v[48:51], v[44:47], a[164:167]
v_add_u32 v15, s73, v105
v_add_u32 v16, s73, v106
v_mfma_f32_16x16x32_bf16 a[168:171], v[52:55], v[44:47], a[168:171]
v_add_u32 v17, s73, v107
v_add_u32 v18, s73, v108
v_mfma_f32_16x16x32_bf16 a[172:175], v[56:59], v[44:47], a[172:175]
s_waitcnt lgkmcnt(0)
v_mfma_f32_16x16x32_bf16 a[0:3], a[212:215], a[180:183], a[0:3]
v_mfma_f32_16x16x32_bf16 a[4:7], a[216:219], a[180:183], a[4:7]
v_mfma_f32_16x16x32_bf16 a[8:11], a[220:223], a[180:183], a[8:11]
s_waitcnt vmcnt(19)
s_barrier
v_mfma_f32_16x16x32_bf16 a[176:179], a[200:203], v[122:125], a[176:179]
s_add_u32 m0, s58, 16384
ds_read_b128 v[32:35], v14
v_mfma_f32_16x16x32_bf16 a[12:15], a[224:227], a[180:183], a[12:15]
buffer_load_dwordx4 v10, s[16:19], s25 offen offset:0 lds
v_mfma_f32_16x16x32_bf16 a[16:19], a[228:231], a[180:183], a[16:19]
ds_read_b64_tr_b16 v[64:65], v20 offset:32768
ds_read_b64_tr_b16 v[66:67], v20 offset:34816
v_mfma_f32_16x16x32_bf16 a[20:23], a[232:235], a[180:183], a[20:23]
v_mfma_f32_16x16x32_bf16 a[24:27], a[236:239], a[180:183], a[24:27]
buffer_load_dwordx4 v11, s[16:19], s25 offen offset:1024 lds
v_mfma_f32_16x16x32_bf16 a[28:31], a[240:243], a[180:183], a[28:31]
ds_read_b64_tr_b16 v[68:69], v21 offset:32768
ds_read_b64_tr_b16 v[70:71], v21 offset:34816
v_mfma_f32_16x16x32_bf16 a[128:131], a[196:199], a[180:183], a[128:131]
v_mfma_f32_16x16x32_bf16 a[132:135], a[200:203], a[180:183], a[132:135]
ds_read_b64_tr_b16 v[72:73], v22 offset:32768
v_mfma_f32_16x16x32_bf16 a[136:139], a[204:207], a[180:183], a[136:139]
buffer_load_dwordx4 v12, s[16:19], s25 offen offset:2048 lds
v_mfma_f32_16x16x32_bf16 a[32:35], a[212:215], a[184:187], a[32:35]
ds_read_b64_tr_b16 v[74:75], v22 offset:34816
ds_read_b64_tr_b16 v[76:77], v23 offset:32768
v_mfma_f32_16x16x32_bf16 a[36:39], a[216:219], a[184:187], a[36:39]
v_mfma_f32_16x16x32_bf16 a[40:43], a[220:223], a[184:187], a[40:43]
ds_read_b64_tr_b16 v[78:79], v23 offset:34816
v_mfma_f32_16x16x32_bf16 a[44:47], a[224:227], a[184:187], a[44:47]
buffer_load_dwordx4 v13, s[16:19], s25 offen offset:3072 lds
v_mfma_f32_16x16x32_bf16 a[48:51], a[228:231], a[184:187], a[48:51]
s_add_u32 s25, s25, 262144
ds_read_b64_tr_b16 v[80:81], v24 offset:32768
v_mfma_f32_16x16x32_bf16 a[52:55], a[232:235], a[184:187], a[52:55]
ds_read_b64_tr_b16 v[82:83], v24 offset:34816
v_mfma_f32_16x16x32_bf16 a[56:59], a[236:239], a[184:187], a[56:59]
s_mov_b32 m0, s74
ds_read_b64_tr_b16 v[84:85], v25 offset:32768
v_mfma_f32_16x16x32_bf16 a[60:63], a[240:243], a[184:187], a[60:63]
buffer_load_dwordx4 v2, s[12:15], s24 offen offset:0 lds
v_mfma_f32_16x16x32_bf16 a[140:143], a[196:199], a[184:187], a[140:143]
ds_read_b64_tr_b16 v[86:87], v25 offset:34816
v_mfma_f32_16x16x32_bf16 a[144:147], a[200:203], a[184:187], a[144:147]
ds_read_b64_tr_b16 v[88:89], v26 offset:32768
v_mfma_f32_16x16x32_bf16 a[148:151], a[204:207], a[184:187], a[148:151]
ds_read_b64_tr_b16 v[90:91], v26 offset:34816
v_mfma_f32_16x16x32_bf16 a[64:67], a[212:215], a[188:191], a[64:67]
buffer_load_dwordx4 v3, s[12:15], s24 offen offset:1024 lds
v_mfma_f32_16x16x32_bf16 a[68:71], a[216:219], a[188:191], a[68:71]
ds_read_b64_tr_b16 v[92:93], v27 offset:32768
v_mfma_f32_16x16x32_bf16 a[72:75], a[220:223], a[188:191], a[72:75]
ds_read_b64_tr_b16 v[94:95], v27 offset:34816
v_mfma_f32_16x16x32_bf16 a[76:79], a[224:227], a[188:191], a[76:79]
buffer_load_dwordx4 v4, s[12:15], s24 offen offset:2048 lds
v_mfma_f32_16x16x32_bf16 a[80:83], a[228:231], a[188:191], a[80:83]
ds_read_b64_tr_b16 v[48:49], v16 offset:0
v_mfma_f32_16x16x32_bf16 a[84:87], a[232:235], a[188:191], a[84:87]
ds_read_b64_tr_b16 v[50:51], v16 offset:768
v_mfma_f32_16x16x32_bf16 a[88:91], a[236:239], a[188:191], a[88:91]
v_mfma_f32_16x16x32_bf16 a[92:95], a[240:243], a[188:191], a[92:95]
buffer_load_dwordx4 v5, s[12:15], s24 offen offset:3072 lds
v_mfma_f32_16x16x32_bf16 a[152:155], a[196:199], a[188:191], a[152:155]
s_add_u32 s24, s24, 128
ds_read_b64_tr_b16 v[52:53], v17 offset:0
v_mfma_f32_16x16x32_bf16 a[156:159], a[200:203], a[188:191], a[156:159]
ds_read_b64_tr_b16 v[54:55], v17 offset:768
ds_read_b64_tr_b16 v[56:57], v18 offset:0
v_mfma_f32_16x16x32_bf16 a[160:163], a[204:207], a[188:191], a[160:163]
v_mfma_f32_16x16x32_bf16 a[96:99], a[212:215], a[192:195], a[96:99]
buffer_store_dwordx4 v[188:191], v19, s[20:23], s28 offen offset:3072 sc1
v_mfma_f32_16x16x32_bf16 a[100:103], a[216:219], a[192:195], a[100:103]
ds_read_b64_tr_b16 v[58:59], v18 offset:768
ds_read_b128 v[36:39], v14 offset:2048
v_mfma_f32_16x16x32_bf16 a[104:107], a[220:223], a[192:195], a[104:107]
v_mfma_f32_16x16x32_bf16 a[108:111], a[224:227], a[192:195], a[108:111]
ds_read_b128 v[40:43], v14 offset:4096
v_mfma_f32_16x16x32_bf16 a[112:115], a[228:231], a[192:195], a[112:115]
buffer_load_dwordx4 v[122:125], v109, s[64:67], 0 offen offset:512
v_mfma_f32_16x16x32_bf16 a[116:119], a[232:235], a[192:195], a[116:119]
ds_read_b128 v[44:47], v14 offset:6144
v_mfma_f32_16x16x32_bf16 a[120:123], a[236:239], a[192:195], a[120:123]
v_mfma_f32_16x16x32_bf16 a[124:127], a[240:243], a[192:195], a[124:127]
v_mfma_f32_16x16x32_bf16 a[164:167], a[196:199], a[192:195], a[164:167]
v_mfma_f32_16x16x32_bf16 a[168:171], a[200:203], a[192:195], a[168:171]
v_mfma_f32_16x16x32_bf16 a[172:175], a[204:207], a[192:195], a[172:175]
s_waitcnt lgkmcnt(0)
v_mfma_f32_16x16x32_bf16 a[0:3], v[64:67], v[32:35], a[0:3]
v_mfma_f32_16x16x32_bf16 a[4:7], v[68:71], v[32:35], a[4:7]
v_mfma_f32_16x16x32_bf16 a[8:11], v[72:75], v[32:35], a[8:11]
s_waitcnt vmcnt(19)
s_barrier
v_mfma_f32_16x16x32_bf16 a[176:179], v[52:55], v[114:117], a[176:179]
s_add_u32 m0, s58, 32768
ds_read_b128 a[180:183], v15
v_mfma_f32_16x16x32_bf16 a[12:15], v[76:79], v[32:35], a[12:15]
buffer_load_dwordx4 v10, s[16:19], s25 offen offset:0 lds
v_mfma_f32_16x16x32_bf16 a[16:19], v[80:83], v[32:35], a[16:19]
ds_read_b64_tr_b16 a[212:213], v20 offset:49152
ds_read_b64_tr_b16 a[214:215], v20 offset:51200
v_mfma_f32_16x16x32_bf16 a[20:23], v[84:87], v[32:35], a[20:23]
ds_read_b64_tr_b16 a[216:217], v21 offset:49152
v_mfma_f32_16x16x32_bf16 a[24:27], v[88:91], v[32:35], a[24:27]
buffer_load_dwordx4 v11, s[16:19], s25 offen offset:1024 lds
v_mfma_f32_16x16x32_bf16 a[28:31], v[92:95], v[32:35], a[28:31]
ds_read_b64_tr_b16 a[218:219], v21 offset:51200
v_mfma_f32_16x16x32_bf16 a[128:131], v[48:51], v[32:35], a[128:131]
ds_read_b64_tr_b16 a[220:221], v22 offset:49152
v_mfma_f32_16x16x32_bf16 a[132:135], v[52:55], v[32:35], a[132:135]
ds_read_b64_tr_b16 a[222:223], v22 offset:51200
v_mfma_f32_16x16x32_bf16 a[136:139], v[56:59], v[32:35], a[136:139]
buffer_load_dwordx4 v12, s[16:19], s25 offen offset:2048 lds
v_mfma_f32_16x16x32_bf16 a[32:35], v[64:67], v[36:39], a[32:35]
ds_read_b64_tr_b16 a[224:225], v23 offset:49152
ds_read_b64_tr_b16 a[226:227], v23 offset:51200
v_mfma_f32_16x16x32_bf16 a[36:39], v[68:71], v[36:39], a[36:39]
v_mfma_f32_16x16x32_bf16 a[40:43], v[72:75], v[36:39], a[40:43]
ds_read_b64_tr_b16 a[228:229], v24 offset:49152
v_mfma_f32_16x16x32_bf16 a[44:47], v[76:79], v[36:39], a[44:47]
buffer_load_dwordx4 v13, s[16:19], s25 offen offset:3072 lds
v_mfma_f32_16x16x32_bf16 a[48:51], v[80:83], v[36:39], a[48:51]
s_add_u32 s25, s25, 262144
ds_read_b64_tr_b16 a[230:231], v24 offset:51200
v_mfma_f32_16x16x32_bf16 a[52:55], v[84:87], v[36:39], a[52:55]
s_mov_b32 m0, s75
ds_read_b64_tr_b16 a[232:233], v25 offset:49152
v_mfma_f32_16x16x32_bf16 a[56:59], v[88:91], v[36:39], a[56:59]
buffer_load_dwordx4 v6, s[44:47], s56 offen offset:0 lds
v_mfma_f32_16x16x32_bf16 a[60:63], v[92:95], v[36:39], a[60:63]
ds_read_b64_tr_b16 a[234:235], v25 offset:51200
ds_read_b64_tr_b16 a[236:237], v26 offset:49152
v_mfma_f32_16x16x32_bf16 a[140:143], v[48:51], v[36:39], a[140:143]
ds_read_b64_tr_b16 a[238:239], v26 offset:51200
v_mfma_f32_16x16x32_bf16 a[144:147], v[52:55], v[36:39], a[144:147]
ds_read_b64_tr_b16 a[240:241], v27 offset:49152
v_mfma_f32_16x16x32_bf16 a[148:151], v[56:59], v[36:39], a[148:151]
buffer_load_dwordx4 v7, s[44:47], s56 offen offset:1024 lds
v_mfma_f32_16x16x32_bf16 a[64:67], v[64:67], v[40:43], a[64:67]
ds_read_b64_tr_b16 a[242:243], v27 offset:51200
ds_read_b64_tr_b16 a[196:197], v16 offset:8192
v_mfma_f32_16x16x32_bf16 a[68:71], v[68:71], v[40:43], a[68:71]
v_mfma_f32_16x16x32_bf16 a[72:75], v[72:75], v[40:43], a[72:75]
ds_read_b64_tr_b16 a[198:199], v16 offset:8960
v_mfma_f32_16x16x32_bf16 a[76:79], v[76:79], v[40:43], a[76:79]
buffer_load_dwordx4 v8, s[44:47], s56 offen offset:2048 lds
v_mfma_f32_16x16x32_bf16 a[80:83], v[80:83], v[40:43], a[80:83]
s_add_u32 s56, s56, s57
ds_read_b64_tr_b16 a[200:201], v17 offset:8192
v_mfma_f32_16x16x32_bf16 a[84:87], v[84:87], v[40:43], a[84:87]
s_mov_b32 s28, 32768
ds_read_b64_tr_b16 a[202:203], v17 offset:8960
v_mfma_f32_16x16x32_bf16 a[88:91], v[88:91], v[40:43], a[88:91]
buffer_store_dwordx4 v[192:195], v19, s[20:23], s28 offen offset:0 sc1
v_mfma_f32_16x16x32_bf16 a[92:95], v[92:95], v[40:43], a[92:95]
ds_read_b64_tr_b16 a[204:205], v18 offset:8192
ds_read_b64_tr_b16 a[206:207], v18 offset:8960
v_mfma_f32_16x16x32_bf16 a[152:155], v[48:51], v[40:43], a[152:155]
ds_read_b128 a[184:187], v15 offset:2048
v_mfma_f32_16x16x32_bf16 a[156:159], v[52:55], v[40:43], a[156:159]
ds_read_b128 a[188:191], v15 offset:4096
v_mfma_f32_16x16x32_bf16 a[160:163], v[56:59], v[40:43], a[160:163]
buffer_load_dwordx4 v[114:117], v109, s[64:67], 0 offen offset:576
v_mfma_f32_16x16x32_bf16 a[96:99], v[64:67], v[44:47], a[96:99]
ds_read_b128 a[192:195], v15 offset:6144
v_mfma_f32_16x16x32_bf16 a[100:103], v[68:71], v[44:47], a[100:103]
v_mfma_f32_16x16x32_bf16 a[104:107], v[72:75], v[44:47], a[104:107]
v_mfma_f32_16x16x32_bf16 a[108:111], v[76:79], v[44:47], a[108:111]
v_mfma_f32_16x16x32_bf16 a[112:115], v[80:83], v[44:47], a[112:115]
v_mfma_f32_16x16x32_bf16 a[116:119], v[84:87], v[44:47], a[116:119]
s_add_u32 s74, s73, s30
s_add_u32 s75, s73, s31
v_mfma_f32_16x16x32_bf16 a[120:123], v[88:91], v[44:47], a[120:123]
s_add_u32 s73, s73, 32768
s_cmp_eq_u32 s73, 163840
v_mfma_f32_16x16x32_bf16 a[124:127], v[92:95], v[44:47], a[124:127]
s_cselect_b32 s73, 65536, s73
v_add_u32 v14, s73, v104
v_mfma_f32_16x16x32_bf16 a[164:167], v[48:51], v[44:47], a[164:167]
v_add_u32 v15, s73, v105
v_add_u32 v16, s73, v106
v_mfma_f32_16x16x32_bf16 a[168:171], v[52:55], v[44:47], a[168:171]
v_add_u32 v17, s73, v107
v_add_u32 v18, s73, v108
v_mfma_f32_16x16x32_bf16 a[172:175], v[56:59], v[44:47], a[172:175]
s_waitcnt lgkmcnt(0)
v_mfma_f32_16x16x32_bf16 a[0:3], a[212:215], a[180:183], a[0:3]
v_mfma_f32_16x16x32_bf16 a[4:7], a[216:219], a[180:183], a[4:7]
v_mfma_f32_16x16x32_bf16 a[8:11], a[220:223], a[180:183], a[8:11]
s_waitcnt vmcnt(19)
s_barrier
v_mfma_f32_16x16x32_bf16 a[176:179], a[200:203], v[118:121], a[176:179]
s_add_u32 m0, s58, 49152
ds_read_b128 v[32:35], v14
v_mfma_f32_16x16x32_bf16 a[12:15], a[224:227], a[180:183], a[12:15]
buffer_load_dwordx4 v10, s[16:19], s25 offen offset:0 lds
v_mfma_f32_16x16x32_bf16 a[16:19], a[228:231], a[180:183], a[16:19]
ds_read_b64_tr_b16 v[64:65], v20 offset:0
ds_read_b64_tr_b16 v[66:67], v20 offset:2048
v_mfma_f32_16x16x32_bf16 a[20:23], a[232:235], a[180:183], a[20:23]
v_mfma_f32_16x16x32_bf16 a[24:27], a[236:239], a[180:183], a[24:27]
buffer_load_dwordx4 v11, s[16:19], s25 offen offset:1024 lds
v_mfma_f32_16x16x32_bf16 a[28:31], a[240:243], a[180:183], a[28:31]
ds_read_b64_tr_b16 v[68:69], v21 offset:0
ds_read_b64_tr_b16 v[70:71], v21 offset:2048
v_mfma_f32_16x16x32_bf16 a[128:131], a[196:199], a[180:183], a[128:131]
v_mfma_f32_16x16x32_bf16 a[132:135], a[200:203], a[180:183], a[132:135]
ds_read_b64_tr_b16 v[72:73], v22 offset:0
v_mfma_f32_16x16x32_bf16 a[136:139], a[204:207], a[180:183], a[136:139]
buffer_load_dwordx4 v12, s[16:19], s25 offen offset:2048 lds
v_mfma_f32_16x16x32_bf16 a[32:35], a[212:215], a[184:187], a[32:35]
ds_read_b64_tr_b16 v[74:75], v22 offset:2048
ds_read_b64_tr_b16 v[76:77], v23 offset:0
v_mfma_f32_16x16x32_bf16 a[36:39], a[216:219], a[184:187], a[36:39]
v_mfma_f32_16x16x32_bf16 a[40:43], a[220:223], a[184:187], a[40:43]
ds_read_b64_tr_b16 v[78:79], v23 offset:2048
v_mfma_f32_16x16x32_bf16 a[44:47], a[224:227], a[184:187], a[44:47]
buffer_load_dwordx4 v13, s[16:19], s25 offen offset:3072 lds
v_mfma_f32_16x16x32_bf16 a[48:51], a[228:231], a[184:187], a[48:51]
s_add_u32 s25, s25, 262144
ds_read_b64_tr_b16 v[80:81], v24 offset:0
v_mfma_f32_16x16x32_bf16 a[52:55], a[232:235], a[184:187], a[52:55]
ds_read_b64_tr_b16 v[82:83], v24 offset:2048
v_mfma_f32_16x16x32_bf16 a[56:59], a[236:239], a[184:187], a[56:59]
s_mov_b32 m0, s74
ds_read_b64_tr_b16 v[84:85], v25 offset:0
v_mfma_f32_16x16x32_bf16 a[60:63], a[240:243], a[184:187], a[60:63]
buffer_load_dwordx4 v2, s[12:15], s24 offen offset:0 lds
v_mfma_f32_16x16x32_bf16 a[140:143], a[196:199], a[184:187], a[140:143]
ds_read_b64_tr_b16 v[86:87], v25 offset:2048
v_mfma_f32_16x16x32_bf16 a[144:147], a[200:203], a[184:187], a[144:147]
ds_read_b64_tr_b16 v[88:89], v26 offset:0
v_mfma_f32_16x16x32_bf16 a[148:151], a[204:207], a[184:187], a[148:151]
ds_read_b64_tr_b16 v[90:91], v26 offset:2048
v_mfma_f32_16x16x32_bf16 a[64:67], a[212:215], a[188:191], a[64:67]
buffer_load_dwordx4 v3, s[12:15], s24 offen offset:1024 lds
v_mfma_f32_16x16x32_bf16 a[68:71], a[216:219], a[188:191], a[68:71]
ds_read_b64_tr_b16 v[92:93], v27 offset:0
v_mfma_f32_16x16x32_bf16 a[72:75], a[220:223], a[188:191], a[72:75]
ds_read_b64_tr_b16 v[94:95], v27 offset:2048
v_mfma_f32_16x16x32_bf16 a[76:79], a[224:227], a[188:191], a[76:79]
buffer_load_dwordx4 v4, s[12:15], s24 offen offset:2048 lds
v_mfma_f32_16x16x32_bf16 a[80:83], a[228:231], a[188:191], a[80:83]
ds_read_b64_tr_b16 v[48:49], v16 offset:0
v_mfma_f32_16x16x32_bf16 a[84:87], a[232:235], a[188:191], a[84:87]
ds_read_b64_tr_b16 v[50:51], v16 offset:768
v_mfma_f32_16x16x32_bf16 a[88:91], a[236:239], a[188:191], a[88:91]
v_mfma_f32_16x16x32_bf16 a[92:95], a[240:243], a[188:191], a[92:95]
buffer_load_dwordx4 v5, s[12:15], s24 offen offset:3072 lds
v_mfma_f32_16x16x32_bf16 a[152:155], a[196:199], a[188:191], a[152:155]
s_add_u32 s24, s24, 128
ds_read_b64_tr_b16 v[52:53], v17 offset:0
v_mfma_f32_16x16x32_bf16 a[156:159], a[200:203], a[188:191], a[156:159]
ds_read_b64_tr_b16 v[54:55], v17 offset:768
ds_read_b64_tr_b16 v[56:57], v18 offset:0
v_mfma_f32_16x16x32_bf16 a[160:163], a[204:207], a[188:191], a[160:163]
v_mfma_f32_16x16x32_bf16 a[96:99], a[212:215], a[192:195], a[96:99]
buffer_store_dwordx4 v[196:199], v19, s[20:23], s28 offen offset:1024 sc1
v_mfma_f32_16x16x32_bf16 a[100:103], a[216:219], a[192:195], a[100:103]
ds_read_b64_tr_b16 v[58:59], v18 offset:768
ds_read_b128 v[36:39], v14 offset:2048
v_mfma_f32_16x16x32_bf16 a[104:107], a[220:223], a[192:195], a[104:107]
v_mfma_f32_16x16x32_bf16 a[108:111], a[224:227], a[192:195], a[108:111]
ds_read_b128 v[40:43], v14 offset:4096
v_mfma_f32_16x16x32_bf16 a[112:115], a[228:231], a[192:195], a[112:115]
buffer_load_dwordx4 v[118:121], v109, s[64:67], 0 offen offset:640
v_mfma_f32_16x16x32_bf16 a[116:119], a[232:235], a[192:195], a[116:119]
ds_read_b128 v[44:47], v14 offset:6144
v_mfma_f32_16x16x32_bf16 a[120:123], a[236:239], a[192:195], a[120:123]
v_mfma_f32_16x16x32_bf16 a[124:127], a[240:243], a[192:195], a[124:127]
v_mfma_f32_16x16x32_bf16 a[164:167], a[196:199], a[192:195], a[164:167]
v_mfma_f32_16x16x32_bf16 a[168:171], a[200:203], a[192:195], a[168:171]
v_mfma_f32_16x16x32_bf16 a[172:175], a[204:207], a[192:195], a[172:175]
s_waitcnt lgkmcnt(0)
v_mfma_f32_16x16x32_bf16 a[0:3], v[64:67], v[32:35], a[0:3]
v_mfma_f32_16x16x32_bf16 a[4:7], v[68:71], v[32:35], a[4:7]
v_mfma_f32_16x16x32_bf16 a[8:11], v[72:75], v[32:35], a[8:11]
s_waitcnt vmcnt(19)
s_barrier
v_mfma_f32_16x16x32_bf16 a[176:179], v[52:55], v[122:125], a[176:179]
s_mov_b32 m0, s58
ds_read_b128 a[180:183], v15
v_mfma_f32_16x16x32_bf16 a[12:15], v[76:79], v[32:35], a[12:15]
buffer_load_dwordx4 v10, s[16:19], s25 offen offset:0 lds
v_mfma_f32_16x16x32_bf16 a[16:19], v[80:83], v[32:35], a[16:19]
ds_read_b64_tr_b16 a[212:213], v20 offset:16384
ds_read_b64_tr_b16 a[214:215], v20 offset:18432
v_mfma_f32_16x16x32_bf16 a[20:23], v[84:87], v[32:35], a[20:23]
ds_read_b64_tr_b16 a[216:217], v21 offset:16384
v_mfma_f32_16x16x32_bf16 a[24:27], v[88:91], v[32:35], a[24:27]
buffer_load_dwordx4 v11, s[16:19], s25 offen offset:1024 lds
v_mfma_f32_16x16x32_bf16 a[28:31], v[92:95], v[32:35], a[28:31]
ds_read_b64_tr_b16 a[218:219], v21 offset:18432
v_mfma_f32_16x16x32_bf16 a[128:131], v[48:51], v[32:35], a[128:131]
ds_read_b64_tr_b16 a[220:221], v22 offset:16384
v_mfma_f32_16x16x32_bf16 a[132:135], v[52:55], v[32:35], a[132:135]
buffer_load_dwordx4 v12, s[16:19], s25 offen offset:2048 lds
v_mfma_f32_16x16x32_bf16 a[136:139], v[56:59], v[32:35], a[136:139]
ds_read_b64_tr_b16 a[222:223], v22 offset:18432
ds_read_b64_tr_b16 a[224:225], v23 offset:16384
v_mfma_f32_16x16x32_bf16 a[32:35], v[64:67], v[36:39], a[32:35]
ds_read_b64_tr_b16 a[226:227], v23 offset:18432
v_mfma_f32_16x16x32_bf16 a[36:39], v[68:71], v[36:39], a[36:39]
buffer_load_dwordx4 v13, s[16:19], s25 offen offset:3072 lds
v_mfma_f32_16x16x32_bf16 a[40:43], v[72:75], v[36:39], a[40:43]
s_add_u32 s25, s25, 262144
ds_read_b64_tr_b16 a[228:229], v24 offset:16384
v_mfma_f32_16x16x32_bf16 a[44:47], v[76:79], v[36:39], a[44:47]
s_mov_b32 m0, s75
ds_read_b64_tr_b16 a[230:231], v24 offset:18432
v_mfma_f32_16x16x32_bf16 a[48:51], v[80:83], v[36:39], a[48:51]
buffer_load_dwordx4 v6, s[44:47], s56 offen offset:0 lds
v_mfma_f32_16x16x32_bf16 a[52:55], v[84:87], v[36:39], a[52:55]
ds_read_b64_tr_b16 a[232:233], v25 offset:16384
ds_read_b64_tr_b16 a[234:235], v25 offset:18432
v_mfma_f32_16x16x32_bf16 a[56:59], v[88:91], v[36:39], a[56:59]
v_mfma_f32_16x16x32_bf16 a[60:63], v[92:95], v[36:39], a[60:63]
buffer_load_dwordx4 v7, s[44:47], s56 offen offset:1024 lds
v_mfma_f32_16x16x32_bf16 a[140:143], v[48:51], v[36:39], a[140:143]
ds_read_b64_tr_b16 a[236:237], v26 offset:16384
ds_read_b64_tr_b16 a[238:239], v26 offset:18432
v_mfma_f32_16x16x32_bf16 a[144:147], v[52:55], v[36:39], a[144:147]
ds_read_b64_tr_b16 a[240:241], v27 offset:16384
v_mfma_f32_16x16x32_bf16 a[148:151], v[56:59], v[36:39], a[148:151]
buffer_load_dwordx4 v8, s[44:47], s56 offen offset:2048 lds
v_mfma_f32_16x16x32_bf16 a[64:67], v[64:67], v[40:43], a[64:67]
s_add_u32 s56, s56, s57
ds_read_b64_tr_b16 a[242:243], v27 offset:18432
v_mfma_f32_16x16x32_bf16 a[68:71], v[68:71], v[40:43], a[68:71]
ds_read_b64_tr_b16 a[196:197], v16 offset:8192
v_mfma_f32_16x16x32_bf16 a[72:75], v[72:75], v[40:43], a[72:75]
buffer_store_dwordx4 v[200:203], v19, s[20:23], s28 offen offset:2048 sc1
v_mfma_f32_16x16x32_bf16 a[76:79], v[76:79], v[40:43], a[76:79]
ds_read_b64_tr_b16 a[198:199], v16 offset:8960
ds_read_b64_tr_b16 a[200:201], v17 offset:8192
v_mfma_f32_16x16x32_bf16 a[80:83], v[80:83], v[40:43], a[80:83]
ds_read_b64_tr_b16 a[202:203], v17 offset:8960
v_mfma_f32_16x16x32_bf16 a[84:87], v[84:87], v[40:43], a[84:87]
buffer_store_dwordx4 v[204:207], v19, s[20:23], s28 offen offset:3072 sc1
v_mfma_f32_16x16x32_bf16 a[88:91], v[88:91], v[40:43], a[88:91]
ds_read_b64_tr_b16 a[204:205], v18 offset:8192
v_mfma_f32_16x16x32_bf16 a[92:95], v[92:95], v[40:43], a[92:95]
s_add_u32 s28, s29, 32768
ds_read_b64_tr_b16 a[206:207], v18 offset:8960
v_mfma_f32_16x16x32_bf16 a[152:155], v[48:51], v[40:43], a[152:155]
buffer_store_dwordx4 v[208:211], v19, s[20:23], s28 offen offset:0 sc1
v_mfma_f32_16x16x32_bf16 a[156:159], v[52:55], v[40:43], a[156:159]
ds_read_b128 a[184:187], v15 offset:2048
ds_read_b128 a[188:191], v15 offset:4096
v_mfma_f32_16x16x32_bf16 a[160:163], v[56:59], v[40:43], a[160:163]
ds_read_b128 a[192:195], v15 offset:6144
v_mfma_f32_16x16x32_bf16 a[96:99], v[64:67], v[44:47], a[96:99]
buffer_load_dwordx4 v[122:125], v109, s[64:67], 0 offen offset:704
v_mfma_f32_16x16x32_bf16 a[100:103], v[68:71], v[44:47], a[100:103]
v_mfma_f32_16x16x32_bf16 a[104:107], v[72:75], v[44:47], a[104:107]
v_mfma_f32_16x16x32_bf16 a[108:111], v[76:79], v[44:47], a[108:111]
v_mfma_f32_16x16x32_bf16 a[112:115], v[80:83], v[44:47], a[112:115]
v_mfma_f32_16x16x32_bf16 a[116:119], v[84:87], v[44:47], a[116:119]
s_add_u32 s74, s73, s30
s_add_u32 s75, s73, s31
v_mfma_f32_16x16x32_bf16 a[120:123], v[88:91], v[44:47], a[120:123]
s_add_u32 s73, s73, 32768
s_cmp_eq_u32 s73, 163840
v_mfma_f32_16x16x32_bf16 a[124:127], v[92:95], v[44:47], a[124:127]
s_cselect_b32 s73, 65536, s73
v_add_u32 v14, s73, v104
v_mfma_f32_16x16x32_bf16 a[164:167], v[48:51], v[44:47], a[164:167]
v_add_u32 v15, s73, v105
v_add_u32 v16, s73, v106
v_mfma_f32_16x16x32_bf16 a[168:171], v[52:55], v[44:47], a[168:171]
v_add_u32 v17, s73, v107
v_add_u32 v18, s73, v108
v_mfma_f32_16x16x32_bf16 a[172:175], v[56:59], v[44:47], a[172:175]
s_waitcnt lgkmcnt(0)
v_mfma_f32_16x16x32_bf16 a[0:3], a[212:215], a[180:183], a[0:3]
v_mfma_f32_16x16x32_bf16 a[4:7], a[216:219], a[180:183], a[4:7]
v_mfma_f32_16x16x32_bf16 a[8:11], a[220:223], a[180:183], a[8:11]
s_waitcnt vmcnt(21)
s_barrier
v_mfma_f32_16x16x32_bf16 a[176:179], a[200:203], v[114:117], a[176:179]
s_add_u32 m0, s58, 16384
ds_read_b128 v[32:35], v14
v_mfma_f32_16x16x32_bf16 a[12:15], a[224:227], a[180:183], a[12:15]
buffer_load_dwordx4 v10, s[16:19], s25 offen offset:0 lds
v_mfma_f32_16x16x32_bf16 a[16:19], a[228:231], a[180:183], a[16:19]
ds_read_b64_tr_b16 v[64:65], v20 offset:32768
ds_read_b64_tr_b16 v[66:67], v20 offset:34816
v_mfma_f32_16x16x32_bf16 a[20:23], a[232:235], a[180:183], a[20:23]
v_mfma_f32_16x16x32_bf16 a[24:27], a[236:239], a[180:183], a[24:27]
buffer_load_dwordx4 v11, s[16:19], s25 offen offset:1024 lds
v_mfma_f32_16x16x32_bf16 a[28:31], a[240:243], a[180:183], a[28:31]
ds_read_b64_tr_b16 v[68:69], v21 offset:32768
ds_read_b64_tr_b16 v[70:71], v21 offset:34816
v_mfma_f32_16x16x32_bf16 a[128:131], a[196:199], a[180:183], a[128:131]
v_mfma_f32_16x16x32_bf16 a[132:135], a[200:203], a[180:183], a[132:135]
ds_read_b64_tr_b16 v[72:73], v22 offset:32768
v_mfma_f32_16x16x32_bf16 a[136:139], a[204:207], a[180:183], a[136:139]
buffer_load_dwordx4 v12, s[16:19], s25 offen offset:2048 lds
v_mfma_f32_16x16x32_bf16 a[32:35], a[212:215], a[184:187], a[32:35]
ds_read_b64_tr_b16 v[74:75], v22 offset:34816
ds_read_b64_tr_b16 v[76:77], v23 offset:32768
v_mfma_f32_16x16x32_bf16 a[36:39], a[216:219], a[184:187], a[36:39]
v_mfma_f32_16x16x32_bf16 a[40:43], a[220:223], a[184:187], a[40:43]
ds_read_b64_tr_b16 v[78:79], v23 offset:34816
v_mfma_f32_16x16x32_bf16 a[44:47], a[224:227], a[184:187], a[44:47]
buffer_load_dwordx4 v13, s[16:19], s25 offen offset:3072 lds
v_mfma_f32_16x16x32_bf16 a[48:51], a[228:231], a[184:187], a[48:51]
s_add_u32 s25, s25, 262144
ds_read_b64_tr_b16 v[80:81], v24 offset:32768
v_mfma_f32_16x16x32_bf16 a[52:55], a[232:235], a[184:187], a[52:55]
ds_read_b64_tr_b16 v[82:83], v24 offset:34816
v_mfma_f32_16x16x32_bf16 a[56:59], a[236:239], a[184:187], a[56:59]
ds_read_b64_tr_b16 v[84:85], v25 offset:32768
v_mfma_f32_16x16x32_bf16 a[60:63], a[240:243], a[184:187], a[60:63]
buffer_store_dwordx4 v[212:215], v19, s[20:23], s28 offen offset:1024 sc1
v_mfma_f32_16x16x32_bf16 a[140:143], a[196:199], a[184:187], a[140:143]
ds_read_b64_tr_b16 v[86:87], v25 offset:34816
v_mfma_f32_16x16x32_bf16 a[144:147], a[200:203], a[184:187], a[144:147]
ds_read_b64_tr_b16 v[88:89], v26 offset:32768
v_mfma_f32_16x16x32_bf16 a[148:151], a[204:207], a[184:187], a[148:151]
ds_read_b64_tr_b16 v[90:91], v26 offset:34816
v_mfma_f32_16x16x32_bf16 a[64:67], a[212:215], a[188:191], a[64:67]
buffer_store_dwordx4 v[216:219], v19, s[20:23], s28 offen offset:2048 sc1
v_mfma_f32_16x16x32_bf16 a[68:71], a[216:219], a[188:191], a[68:71]
ds_read_b64_tr_b16 v[92:93], v27 offset:32768
v_mfma_f32_16x16x32_bf16 a[72:75], a[220:223], a[188:191], a[72:75]
ds_read_b64_tr_b16 v[94:95], v27 offset:34816
v_mfma_f32_16x16x32_bf16 a[76:79], a[224:227], a[188:191], a[76:79]
buffer_store_dwordx4 v[220:223], v19, s[20:23], s28 offen offset:3072 sc1
v_mfma_f32_16x16x32_bf16 a[80:83], a[228:231], a[188:191], a[80:83]
ds_read_b64_tr_b16 v[48:49], v16 offset:0
v_mfma_f32_16x16x32_bf16 a[84:87], a[232:235], a[188:191], a[84:87]
ds_read_b64_tr_b16 v[50:51], v16 offset:768
v_mfma_f32_16x16x32_bf16 a[88:91], a[236:239], a[188:191], a[88:91]
s_mov_b32 s28, 49152
v_mfma_f32_16x16x32_bf16 a[92:95], a[240:243], a[188:191], a[92:95]
buffer_store_dwordx4 v[224:227], v19, s[20:23], s28 offen offset:0 sc1
v_mfma_f32_16x16x32_bf16 a[152:155], a[196:199], a[188:191], a[152:155]
ds_read_b64_tr_b16 v[52:53], v17 offset:0
ds_read_b64_tr_b16 v[54:55], v17 offset:768
v_mfma_f32_16x16x32_bf16 a[156:159], a[200:203], a[188:191], a[156:159]
ds_read_b64_tr_b16 v[56:57], v18 offset:0
v_mfma_f32_16x16x32_bf16 a[160:163], a[204:207], a[188:191], a[160:163]
v_mfma_f32_16x16x32_bf16 a[96:99], a[212:215], a[192:195], a[96:99]
buffer_store_dwordx4 v[228:231], v19, s[20:23], s28 offen offset:1024 sc1
v_mfma_f32_16x16x32_bf16 a[100:103], a[216:219], a[192:195], a[100:103]
ds_read_b64_tr_b16 v[58:59], v18 offset:768
ds_read_b128 v[36:39], v14 offset:2048
v_mfma_f32_16x16x32_bf16 a[104:107], a[220:223], a[192:195], a[104:107]
v_mfma_f32_16x16x32_bf16 a[108:111], a[224:227], a[192:195], a[108:111]
ds_read_b128 v[40:43], v14 offset:4096
v_mfma_f32_16x16x32_bf16 a[112:115], a[228:231], a[192:195], a[112:115]
buffer_load_dwordx4 v[114:117], v109, s[64:67], 0 offen offset:768
v_mfma_f32_16x16x32_bf16 a[116:119], a[232:235], a[192:195], a[116:119]
ds_read_b128 v[44:47], v14 offset:6144
v_mfma_f32_16x16x32_bf16 a[120:123], a[236:239], a[192:195], a[120:123]
v_mfma_f32_16x16x32_bf16 a[124:127], a[240:243], a[192:195], a[124:127]
v_mfma_f32_16x16x32_bf16 a[164:167], a[196:199], a[192:195], a[164:167]
v_mfma_f32_16x16x32_bf16 a[168:171], a[200:203], a[192:195], a[168:171]
v_mfma_f32_16x16x32_bf16 a[172:175], a[204:207], a[192:195], a[172:175]
s_waitcnt lgkmcnt(0)
v_mfma_f32_16x16x32_bf16 a[0:3], v[64:67], v[32:35], a[0:3]
v_mfma_f32_16x16x32_bf16 a[4:7], v[68:71], v[32:35], a[4:7]
v_mfma_f32_16x16x32_bf16 a[8:11], v[72:75], v[32:35], a[8:11]
s_waitcnt vmcnt(21)
s_barrier
v_mfma_f32_16x16x32_bf16 a[176:179], v[52:55], v[118:121], a[176:179]
ds_read_b128 a[180:183], v15
v_mfma_f32_16x16x32_bf16 a[12:15], v[76:79], v[32:35], a[12:15]
buffer_store_dwordx4 v[232:235], v19, s[20:23], s28 offen offset:2048 sc1
v_mfma_f32_16x16x32_bf16 a[16:19], v[80:83], v[32:35], a[16:19]
ds_read_b64_tr_b16 a[212:213], v20 offset:49152
ds_read_b64_tr_b16 a[214:215], v20 offset:51200
v_mfma_f32_16x16x32_bf16 a[20:23], v[84:87], v[32:35], a[20:23]
ds_read_b64_tr_b16 a[216:217], v21 offset:49152
v_mfma_f32_16x16x32_bf16 a[24:27], v[88:91], v[32:35], a[24:27]
ds_read_b64_tr_b16 a[218:219], v21 offset:51200
v_mfma_f32_16x16x32_bf16 a[28:31], v[92:95], v[32:35], a[28:31]
buffer_store_dwordx4 v[236:239], v19, s[20:23], s28 offen offset:3072 sc1
v_mfma_f32_16x16x32_bf16 a[128:131], v[48:51], v[32:35], a[128:131]
ds_read_b64_tr_b16 a[220:221], v22 offset:49152
v_mfma_f32_16x16x32_bf16 a[132:135], v[52:55], v[32:35], a[132:135]
ds_read_b64_tr_b16 a[222:223], v22 offset:51200
v_mfma_f32_16x16x32_bf16 a[136:139], v[56:59], v[32:35], a[136:139]
s_add_u32 s28, s29, 49152
ds_read_b64_tr_b16 a[224:225], v23 offset:49152
v_mfma_f32_16x16x32_bf16 a[32:35], v[64:67], v[36:39], a[32:35]
buffer_store_dwordx4 v[240:243], v19, s[20:23], s28 offen offset:0 sc1
v_mfma_f32_16x16x32_bf16 a[36:39], v[68:71], v[36:39], a[36:39]
ds_read_b64_tr_b16 a[226:227], v23 offset:51200
v_mfma_f32_16x16x32_bf16 a[40:43], v[72:75], v[36:39], a[40:43]
ds_read_b64_tr_b16 a[228:229], v24 offset:49152
v_mfma_f32_16x16x32_bf16 a[44:47], v[76:79], v[36:39], a[44:47]
ds_read_b64_tr_b16 a[230:231], v24 offset:51200
v_mfma_f32_16x16x32_bf16 a[48:51], v[80:83], v[36:39], a[48:51]
buffer_store_dwordx4 v[244:247], v19, s[20:23], s28 offen offset:1024 sc1
v_mfma_f32_16x16x32_bf16 a[52:55], v[84:87], v[36:39], a[52:55]
ds_read_b64_tr_b16 a[232:233], v25 offset:49152
ds_read_b64_tr_b16 a[234:235], v25 offset:51200
v_mfma_f32_16x16x32_bf16 a[56:59], v[88:91], v[36:39], a[56:59]
v_mfma_f32_16x16x32_bf16 a[60:63], v[92:95], v[36:39], a[60:63]
ds_read_b64_tr_b16 a[236:237], v26 offset:49152
v_mfma_f32_16x16x32_bf16 a[140:143], v[48:51], v[36:39], a[140:143]
buffer_store_dwordx4 v[248:251], v19, s[20:23], s28 offen offset:2048 sc1
v_mfma_f32_16x16x32_bf16 a[144:147], v[52:55], v[36:39], a[144:147]
ds_read_b64_tr_b16 a[238:239], v26 offset:51200
ds_read_b64_tr_b16 a[240:241], v27 offset:49152
v_mfma_f32_16x16x32_bf16 a[148:151], v[56:59], v[36:39], a[148:151]
ds_read_b64_tr_b16 a[242:243], v27 offset:51200
v_mfma_f32_16x16x32_bf16 a[64:67], v[64:67], v[40:43], a[64:67]
ds_read_b64_tr_b16 a[196:197], v16 offset:8192
v_mfma_f32_16x16x32_bf16 a[68:71], v[68:71], v[40:43], a[68:71]
buffer_store_dwordx4 v[252:255], v19, s[20:23], s28 offen offset:3072 sc1
v_mfma_f32_16x16x32_bf16 a[72:75], v[72:75], v[40:43], a[72:75]
ds_read_b64_tr_b16 a[198:199], v16 offset:8960
v_mfma_f32_16x16x32_bf16 a[76:79], v[76:79], v[40:43], a[76:79]
ds_read_b64_tr_b16 a[200:201], v17 offset:8192
v_mfma_f32_16x16x32_bf16 a[80:83], v[80:83], v[40:43], a[80:83]
ds_read_b64_tr_b16 a[202:203], v17 offset:8960
v_mfma_f32_16x16x32_bf16 a[84:87], v[84:87], v[40:43], a[84:87]
buffer_load_dwordx4 v[118:121], v109, s[64:67], 0 offen offset:832
v_mfma_f32_16x16x32_bf16 a[88:91], v[88:91], v[40:43], a[88:91]
ds_read_b64_tr_b16 a[204:205], v18 offset:8192
v_mfma_f32_16x16x32_bf16 a[92:95], v[92:95], v[40:43], a[92:95]
ds_read_b64_tr_b16 a[206:207], v18 offset:8960
v_mfma_f32_16x16x32_bf16 a[152:155], v[48:51], v[40:43], a[152:155]
s_add_u32 s92, s100, 8
s_addc_u32 s93, s101, 0
v_mfma_f32_16x16x32_bf16 a[156:159], v[52:55], v[40:43], a[156:159]
s_mov_b32 s94, 248
ds_read_b128 a[184:187], v15 offset:2048
v_mfma_f32_16x16x32_bf16 a[160:163], v[56:59], v[40:43], a[160:163]
buffer_load_dword v12, v19, s[92:95], 0 offen sc1
v_mfma_f32_16x16x32_bf16 a[96:99], v[64:67], v[44:47], a[96:99]
ds_read_b128 a[188:191], v15 offset:4096
ds_read_b128 a[192:195], v15 offset:6144
v_mfma_f32_16x16x32_bf16 a[100:103], v[68:71], v[44:47], a[100:103]
v_mfma_f32_16x16x32_bf16 a[104:107], v[72:75], v[44:47], a[104:107]
v_mfma_f32_16x16x32_bf16 a[108:111], v[76:79], v[44:47], a[108:111]
v_mfma_f32_16x16x32_bf16 a[112:115], v[80:83], v[44:47], a[112:115]
v_mfma_f32_16x16x32_bf16 a[116:119], v[84:87], v[44:47], a[116:119]
s_add_u32 s74, s73, s30
s_add_u32 s75, s73, s31
v_mfma_f32_16x16x32_bf16 a[120:123], v[88:91], v[44:47], a[120:123]
s_add_u32 s73, s73, 32768
s_cmp_eq_u32 s73, 163840
v_mfma_f32_16x16x32_bf16 a[124:127], v[92:95], v[44:47], a[124:127]
s_cselect_b32 s73, 65536, s73
v_add_u32 v14, s73, v104
v_mfma_f32_16x16x32_bf16 a[164:167], v[48:51], v[44:47], a[164:167]
v_add_u32 v15, s73, v105
v_add_u32 v16, s73, v106
v_mfma_f32_16x16x32_bf16 a[168:171], v[52:55], v[44:47], a[168:171]
v_add_u32 v17, s73, v107
v_add_u32 v18, s73, v108
v_mfma_f32_16x16x32_bf16 a[172:175], v[56:59], v[44:47], a[172:175]
s_waitcnt lgkmcnt(0)
v_mfma_f32_16x16x32_bf16 a[0:3], a[212:215], a[180:183], a[0:3]
v_mfma_f32_16x16x32_bf16 a[4:7], a[216:219], a[180:183], a[4:7]
v_mfma_f32_16x16x32_bf16 a[8:11], a[220:223], a[180:183], a[8:11]
s_waitcnt vmcnt(18)
s_barrier
v_mfma_f32_16x16x32_bf16 a[176:179], a[200:203], v[122:125], a[176:179]
ds_read_b128 v[32:35], v14
s_mov_b32 s4, s8
v_mfma_f32_16x16x32_bf16 a[12:15], a[224:227], a[180:183], a[12:15]
ds_read_b64_tr_b16 v[64:65], v20 offset:0
s_mov_b32 s5, s9
v_mfma_f32_16x16x32_bf16 a[16:19], a[228:231], a[180:183], a[16:19]
ds_read_b64_tr_b16 v[66:67], v20 offset:2048
s_mov_b32 s32, s50
v_mfma_f32_16x16x32_bf16 a[20:23], a[232:235], a[180:183], a[20:23]
s_mov_b32 s33, s51
s_load_dwordx2 s[56:57], s[0:1], 40
v_mfma_f32_16x16x32_bf16 a[24:27], a[236:239], a[180:183], a[24:27]
ds_read_b64_tr_b16 v[68:69], v21 offset:0
s_load_dwordx2 s[6:7], s[0:1], 80
v_mfma_f32_16x16x32_bf16 a[28:31], a[240:243], a[180:183], a[28:31]
ds_read_b64_tr_b16 v[70:71], v21 offset:2048
s_mov_b32 s22, s27
v_mfma_f32_16x16x32_bf16 a[128:131], a[196:199], a[180:183], a[128:131]
s_mov_b32 s24, s38
s_lshr_b32 s25, s37, 1
v_mfma_f32_16x16x32_bf16 a[132:135], a[200:203], a[180:183], a[132:135]
ds_read_b64_tr_b16 v[72:73], v22 offset:0
s_lshl_b32 s23, s22, 13
v_mfma_f32_16x16x32_bf16 a[136:139], a[204:207], a[180:183], a[136:139]
ds_read_b64_tr_b16 v[74:75], v22 offset:2048
s_mov_b32 s37, 0
v_mfma_f32_16x16x32_bf16 a[32:35], a[212:215], a[184:187], a[32:35]
ds_read_b64_tr_b16 v[76:77], v23 offset:0
s_and_b32 s58, s25, 7
v_mfma_f32_16x16x32_bf16 a[36:39], a[216:219], a[184:187], a[36:39]
s_add_u32 s26, s58, 8
s_lshl_b32 s34, s26, 1
v_mfma_f32_16x16x32_bf16 a[40:43], a[220:223], a[184:187], a[40:43]
ds_read_b64_tr_b16 v[78:79], v23 offset:2048
s_add_u32 s34, s34, 2
v_mfma_f32_16x16x32_bf16 a[44:47], a[224:227], a[184:187], a[44:47]
ds_read_b64_tr_b16 v[80:81], v24 offset:0
s_cmp_lt_u32 s25, 8
v_mfma_f32_16x16x32_bf16 a[48:51], a[228:231], a[184:187], a[48:51]
s_cselect_b32 s31, 2, 1
s_cselect_b32 s36, 0, 18
v_mfma_f32_16x16x32_bf16 a[52:55], a[232:235], a[184:187], a[52:55]
ds_read_b64_tr_b16 v[82:83], v24 offset:2048
s_cselect_b32 s28, 18, s34
v_mfma_f32_16x16x32_bf16 a[56:59], a[236:239], a[184:187], a[56:59]
ds_read_b64_tr_b16 v[84:85], v25 offset:0
s_sub_u32 s35, 15, s25
v_mfma_f32_16x16x32_bf16 a[60:63], a[240:243], a[184:187], a[60:63]
s_cmp_lt_u32 s25, 8
s_cselect_b32 s35, s26, s35
v_mfma_f32_16x16x32_bf16 a[140:143], a[196:199], a[184:187], a[140:143]
ds_read_b64_tr_b16 v[86:87], v25 offset:2048
s_cmp_le_u32 s34, 18
v_mfma_f32_16x16x32_bf16 a[144:147], a[200:203], a[184:187], a[144:147]
ds_read_b64_tr_b16 v[88:89], v26 offset:0
s_cselect_b32 s31, 0, s31
v_mfma_f32_16x16x32_bf16 a[148:151], a[204:207], a[184:187], a[148:151]
ds_read_b64_tr_b16 v[90:91], v26 offset:2048
s_cselect_b32 s36, 0, s36
v_mfma_f32_16x16x32_bf16 a[64:67], a[212:215], a[188:191], a[64:67]
s_cselect_b32 s26, s35, s26
s_lshl_b32 s35, s35, 1
v_mfma_f32_16x16x32_bf16 a[68:71], a[216:219], a[188:191], a[68:71]
ds_read_b64_tr_b16 v[92:93], v27 offset:0
s_add_u32 s35, s35, 2
v_mfma_f32_16x16x32_bf16 a[72:75], a[220:223], a[188:191], a[72:75]
ds_read_b64_tr_b16 v[94:95], v27 offset:2048
s_cmp_eq_u32 s31, 0
v_mfma_f32_16x16x32_bf16 a[76:79], a[224:227], a[188:191], a[76:79]
s_cselect_b32 s28, s35, s28
s_lshl_b32 s34, s24, 20
v_mfma_f32_16x16x32_bf16 a[80:83], a[228:231], a[188:191], a[80:83]
ds_read_b64_tr_b16 v[48:49], v16 offset:0
s_add_u32 s8, s4, s34
v_mfma_f32_16x16x32_bf16 a[84:87], a[232:235], a[188:191], a[84:87]
ds_read_b64_tr_b16 v[50:51], v16 offset:768
s_addc_u32 s9, s5, 0
v_mfma_f32_16x16x32_bf16 a[88:91], a[236:239], a[188:191], a[88:91]
s_mov_b32 s11, 0x20000
s_add_u32 s12, s8, 16777216
v_mfma_f32_16x16x32_bf16 a[92:95], a[240:243], a[188:191], a[92:95]
ds_read_b64_tr_b16 v[52:53], v17 offset:0
s_addc_u32 s13, s9, 0
v_mfma_f32_16x16x32_bf16 a[152:155], a[196:199], a[188:191], a[152:155]
ds_read_b64_tr_b16 v[54:55], v17 offset:768
s_mov_b32 s15, 0x20000
v_mfma_f32_16x16x32_bf16 a[156:159], a[200:203], a[188:191], a[156:159]
ds_read_b64_tr_b16 v[56:57], v18 offset:0
s_mov_b32 s19, 0x20000
v_mfma_f32_16x16x32_bf16 a[160:163], a[204:207], a[188:191], a[160:163]
s_lshl_b32 s10, s28, 15
s_mov_b32 s14, s10
v_mfma_f32_16x16x32_bf16 a[96:99], a[212:215], a[192:195], a[96:99]
ds_read_b64_tr_b16 v[58:59], v18 offset:768
s_lshl_b32 s20, s36, 15
v_mfma_f32_16x16x32_bf16 a[100:103], a[216:219], a[192:195], a[100:103]
ds_read_b128 v[36:39], v14 offset:2048
s_mov_b32 s21, s20
v_mfma_f32_16x16x32_bf16 a[104:107], a[220:223], a[192:195], a[104:107]
s_lshl_b32 s34, s26, 2
s_add_u32 s34, s34, s22
v_mfma_f32_16x16x32_bf16 a[108:111], a[224:227], a[192:195], a[108:111]
ds_read_b128 v[40:43], v14 offset:4096
s_lshl_b32 s34, s34, 14
v_mfma_f32_16x16x32_bf16 a[112:115], a[228:231], a[192:195], a[112:115]
ds_read_b128 v[44:47], v14 offset:6144
s_add_u32 s34, s34, 33554432
v_mfma_f32_16x16x32_bf16 a[116:119], a[232:235], a[192:195], a[116:119]
s_add_u32 s16, s8, s34
s_addc_u32 s17, s9, 0
v_mfma_f32_16x16x32_bf16 a[120:123], a[236:239], a[192:195], a[120:123]
s_mov_b32 s18, 16384
s_xor_b32 s34, s25, 0
v_mfma_f32_16x16x32_bf16 a[124:127], a[240:243], a[192:195], a[124:127]
s_lshl_b32 s35, s24, 4
s_add_u32 s34, s34, s35
v_mfma_f32_16x16x32_bf16 a[164:167], a[196:199], a[192:195], a[164:167]
s_lshl_b32 s34, s34, 7
s_add_u32 s34, s34, 104857600
v_mfma_f32_16x16x32_bf16 a[168:171], a[200:203], a[192:195], a[168:171]
s_add_u32 s76, s4, s34
s_addc_u32 s77, s5, 0
v_mfma_f32_16x16x32_bf16 a[172:175], a[204:207], a[192:195], a[172:175]
s_mov_b32 s78, 4
s_mov_b32 s79, 0x20000
s_xor_b32 s34, s25, 8
s_lshl_b32 s35, s24, 4
s_add_u32 s34, s34, s35
s_lshl_b32 s34, s34, 7
s_waitcnt lgkmcnt(0)
v_mfma_f32_16x16x32_bf16 a[0:3], v[64:67], v[32:35], a[0:3]
v_mfma_f32_16x16x32_bf16 a[4:7], v[68:71], v[32:35], a[4:7]
v_mfma_f32_16x16x32_bf16 a[8:11], v[72:75], v[32:35], a[8:11]
s_waitcnt vmcnt(8)
s_barrier
v_mfma_f32_16x16x32_bf16 a[176:179], v[52:55], v[114:117], a[176:179]
ds_read_b128 a[180:183], v15
s_add_u32 s34, s34, 104857600
v_mfma_f32_16x16x32_bf16 a[12:15], v[76:79], v[32:35], a[12:15]
ds_read_b64_tr_b16 a[212:213], v20 offset:16384
s_add_u32 s52, s4, s34
v_mfma_f32_16x16x32_bf16 a[16:19], v[80:83], v[32:35], a[16:19]
ds_read_b64_tr_b16 a[214:215], v20 offset:18432
s_addc_u32 s53, s5, 0
v_mfma_f32_16x16x32_bf16 a[20:23], v[84:87], v[32:35], a[20:23]
s_mov_b32 s54, 4
s_mov_b32 s55, 0x20000
v_mfma_f32_16x16x32_bf16 a[24:27], v[88:91], v[32:35], a[24:27]
ds_read_b64_tr_b16 a[216:217], v21 offset:16384
s_lshl_b32 s34, s24, 3
v_mfma_f32_16x16x32_bf16 a[28:31], v[92:95], v[32:35], a[28:31]
ds_read_b64_tr_b16 a[218:219], v21 offset:18432
s_add_u32 s34, s34, s58
v_mfma_f32_16x16x32_bf16 a[128:131], v[48:51], v[32:35], a[128:131]
s_lshl_b32 s34, s34, 2
s_add_u32 s34, s34, s22
v_mfma_f32_16x16x32_bf16 a[132:135], v[52:55], v[32:35], a[132:135]
ds_read_b64_tr_b16 a[220:221], v22 offset:16384
s_lshl_b32 s50, s34, 15
v_mfma_f32_16x16x32_bf16 a[136:139], v[56:59], v[32:35], a[136:139]
ds_read_b64_tr_b16 a[222:223], v22 offset:18432
s_add_u32 s50, s50, 83886080
v_mfma_f32_16x16x32_bf16 a[32:35], v[64:67], v[36:39], a[32:35]
ds_read_b64_tr_b16 a[224:225], v23 offset:16384
v_add_u32 v10, s23, v19
v_mfma_f32_16x16x32_bf16 a[36:39], v[68:71], v[36:39], a[36:39]
v_add_u32 v11, 0x1000, v10
s_cmp_eq_u32 s31, 2
v_mfma_f32_16x16x32_bf16 a[40:43], v[72:75], v[36:39], a[40:43]
ds_read_b64_tr_b16 a[226:227], v23 offset:18432
s_cselect_b32 s62, 0x8000, 0
v_mfma_f32_16x16x32_bf16 a[44:47], v[76:79], v[36:39], a[44:47]
ds_read_b64_tr_b16 a[228:229], v24 offset:16384
s_lshr_b32 s68, s27, 1
v_mfma_f32_16x16x32_bf16 a[48:51], v[80:83], v[36:39], a[48:51]
s_lshl_b32 s68, s68, 15
s_and_b32 s69, s27, 1
v_mfma_f32_16x16x32_bf16 a[52:55], v[84:87], v[36:39], a[52:55]
ds_read_b64_tr_b16 a[230:231], v24 offset:18432
s_lshl_b32 s69, s69, 12
v_mfma_f32_16x16x32_bf16 a[56:59], v[88:91], v[36:39], a[56:59]
ds_read_b64_tr_b16 a[232:233], v25 offset:16384
s_add_u32 s68, s68, s69
v_mfma_f32_16x16x32_bf16 a[60:63], v[92:95], v[36:39], a[60:63]
s_add_u32 s68, s68, 32768
v_add_u32 v13, s68, v19
v_mfma_f32_16x16x32_bf16 a[140:143], v[48:51], v[36:39], a[140:143]
ds_read_b64_tr_b16 a[234:235], v25 offset:18432
v_and_b32 v28, 15, v1
v_mfma_f32_16x16x32_bf16 a[144:147], v[52:55], v[36:39], a[144:147]
ds_read_b64_tr_b16 a[236:237], v26 offset:16384
v_lshrrev_b32 v29, 4, v1
v_mfma_f32_16x16x32_bf16 a[148:151], v[56:59], v[36:39], a[148:151]
ds_read_b64_tr_b16 a[238:239], v26 offset:18432
v_mul_u32_u24 v28, 400, v28
v_mfma_f32_16x16x32_bf16 a[64:67], v[64:67], v[40:43], a[64:67]
v_lshl_add_u32 v28, v29, 4, v28
s_and_b32 s68, s27, 1
v_mfma_f32_16x16x32_bf16 a[68:71], v[68:71], v[40:43], a[68:71]
ds_read_b64_tr_b16 a[240:241], v27 offset:16384
s_lshl_b32 s68, s68, 6
v_mfma_f32_16x16x32_bf16 a[72:75], v[72:75], v[40:43], a[72:75]
ds_read_b64_tr_b16 a[242:243], v27 offset:18432
s_add_u32 s68, s68, 98304
v_mfma_f32_16x16x32_bf16 a[76:79], v[76:79], v[40:43], a[76:79]
s_lshr_b32 s69, s27, 1
s_lshl_b32 s42, s69, 7
v_mfma_f32_16x16x32_bf16 a[80:83], v[80:83], v[40:43], a[80:83]
ds_read_b64_tr_b16 a[196:197], v16 offset:8192
s_add_u32 s71, s68, s42
v_mfma_f32_16x16x32_bf16 a[84:87], v[84:87], v[40:43], a[84:87]
ds_read_b64_tr_b16 a[198:199], v16 offset:8960
s_add_u32 s71, s71, 128
v_mfma_f32_16x16x32_bf16 a[88:91], v[88:91], v[40:43], a[88:91]
v_add_u32 v5, s71, v28
s_mul_i32 s69, s69, 25600
v_mfma_f32_16x16x32_bf16 a[92:95], v[92:95], v[40:43], a[92:95]
ds_read_b64_tr_b16 a[200:201], v17 offset:8192
s_add_u32 s69, s69, 6400
v_mfma_f32_16x16x32_bf16 a[152:155], v[48:51], v[40:43], a[152:155]
ds_read_b64_tr_b16 a[202:203], v17 offset:8960
v_add_u32 v3, s69, v5
v_mfma_f32_16x16x32_bf16 a[156:159], v[52:55], v[40:43], a[156:159]
ds_read_b64_tr_b16 a[204:205], v18 offset:8192
s_add_u32 s68, s68, s69
v_mfma_f32_16x16x32_bf16 a[160:163], v[56:59], v[40:43], a[160:163]
v_add_u32 v2, s68, v28
s_sub_u32 s68, s68, s42
v_mfma_f32_16x16x32_bf16 a[96:99], v[64:67], v[44:47], a[96:99]
ds_read_b64_tr_b16 a[206:207], v18 offset:8960
s_add_u32 s68, s68, 256
v_mfma_f32_16x16x32_bf16 a[100:103], v[68:71], v[44:47], a[100:103]
ds_read_b128 a[184:187], v15 offset:2048
v_add_u32 v4, s68, v28
v_mfma_f32_16x16x32_bf16 a[104:107], v[72:75], v[44:47], a[104:107]
v_and_b32 v28, 31, v1
s_lshl_b32 s68, s27, 5
v_mfma_f32_16x16x32_bf16 a[108:111], v[76:79], v[44:47], a[108:111]
ds_read_b128 a[188:191], v15 offset:4096
v_add_u32 v7, s68, v28
v_mfma_f32_16x16x32_bf16 a[112:115], v[80:83], v[44:47], a[112:115]
ds_read_b128 a[192:195], v15 offset:6144
v_mul_u32_u24 v6, 400, v7
v_mfma_f32_16x16x32_bf16 a[116:119], v[84:87], v[44:47], a[116:119]
v_lshrrev_b32 v29, 5, v1
v_lshl_add_u32 v6, v29, 6, v6
v_mfma_f32_16x16x32_bf16 a[120:123], v[88:91], v[44:47], a[120:123]
v_add_u32 v6, 99104, v6
s_lshl_b32 s68, s43, 7
v_mfma_f32_16x16x32_bf16 a[124:127], v[92:95], v[44:47], a[124:127]
v_add_u32 v7, s68, v7
v_mov_b32 v8, 1049335798
v_mfma_f32_16x16x32_bf16 a[164:167], v[48:51], v[44:47], a[164:167]
v_cmp_eq_u32 vcc, 0, v29
s_add_u32 s64, s4, 105906176
v_mfma_f32_16x16x32_bf16 a[168:171], v[52:55], v[44:47], a[168:171]
s_addc_u32 s65, s5, 0
s_mov_b32 s66, 8192
v_mfma_f32_16x16x32_bf16 a[172:175], v[56:59], v[44:47], a[172:175]
v_cndmask_b32 v9, 0, v8, vcc
s_lshl_b32 s68, s38, 8
s_add_u32 s68, s68, 104890368
s_add_u32 s44, s4, s68
s_addc_u32 s45, s5, 0
s_mov_b32 s46, 256
s_lshl_b32 s68, s25, 4
s_waitcnt lgkmcnt(0)
v_mfma_f32_16x16x32_bf16 a[0:3], a[212:215], a[180:183], a[0:3]
v_mfma_f32_16x16x32_bf16 a[4:7], a[216:219], a[180:183], a[4:7]
v_mfma_f32_16x16x32_bf16 a[8:11], a[220:223], a[180:183], a[8:11]
s_waitcnt vmcnt(0)
s_cmp_eq_u32 s27, 0
s_cbranch_scc1 L_p16_8
L_p16_8_b:
s_barrier
v_mfma_f32_16x16x32_bf16 a[176:179], a[200:203], v[118:121], a[176:179]
buffer_store_dword v113, v112, s[44:47], s68 offen sc1
v_lshlrev_b32 v14, 2, v7
buffer_load_dword v14, v14, s[64:67], 0 offen sc1
s_mul_i32 s68, s38, 25088
s_add_u32 s92, s32, s68
s_addc_u32 s93, s33, 0
s_sub_u32 s94, 401408, s68
v_mfma_f32_16x16x32_bf16 a[12:15], a[224:227], a[180:183], a[12:15]
v_mfma_f32_16x16x32_bf16 a[16:19], a[228:231], a[180:183], a[16:19]
v_mfma_f32_16x16x32_bf16 a[20:23], a[232:235], a[180:183], a[20:23]
v_mfma_f32_16x16x32_bf16 a[24:27], a[236:239], a[180:183], a[24:27]
v_mfma_f32_16x16x32_bf16 a[28:31], a[240:243], a[180:183], a[28:31]
ds_write_b128 v5, a[176:179]
v_mfma_f32_16x16x32_bf16 a[128:131], a[196:199], a[180:183], a[128:131]
v_mfma_f32_16x16x32_bf16 a[132:135], a[200:203], a[180:183], a[132:135]
v_mfma_f32_16x16x32_bf16 a[136:139], a[204:207], a[180:183], a[136:139]
v_mfma_f32_16x16x32_bf16 a[32:35], a[212:215], a[184:187], a[32:35]
s_mov_b32 s70, 0
v_accvgpr_read_b32 v32, a0
v_accvgpr_read_b32 v33, a1
v_accvgpr_read_b32 v34, a2
v_accvgpr_read_b32 v35, a3
v_accvgpr_read_b32 v36, a4
v_accvgpr_read_b32 v37, a5
v_mfma_f32_16x16x32_bf16 a[36:39], a[216:219], a[184:187], a[36:39]
v_accvgpr_read_b32 v38, a6
v_accvgpr_read_b32 v39, a7
v_mul_f32 v32, s59, v32
v_mul_f32 v33, s59, v33
v_mul_f32 v34, s59, v34
v_mul_f32 v35, s59, v35
v_mul_f32 v36, s59, v36
v_mfma_f32_16x16x32_bf16 a[40:43], a[220:223], a[184:187], a[40:43]
v_mul_f32 v37, s59, v37
v_mul_f32 v38, s59, v38
v_mul_f32 v39, s59, v39
v_cvt_pk_bf16_f32 v40, v32, v33
v_cvt_pk_bf16_f32 v41, v34, v35
v_cvt_pk_bf16_f32 v42, v36, v37
v_cvt_pk_bf16_f32 v43, v38, v39
v_mfma_f32_16x16x32_bf16 a[44:47], a[224:227], a[184:187], a[44:47]
ds_write_b128 v13, v[40:43] offset:0
buffer_store_dwordx4 v[40:43], v19, s[60:63], s70 offen offset:0 sc1
v_accvgpr_read_b32 v44, a8
v_accvgpr_read_b32 v45, a9
v_accvgpr_read_b32 v46, a10
v_accvgpr_read_b32 v47, a11
v_accvgpr_read_b32 v48, a12
v_mfma_f32_16x16x32_bf16 a[48:51], a[228:231], a[184:187], a[48:51]
v_accvgpr_read_b32 v49, a13
v_accvgpr_read_b32 v50, a14
v_accvgpr_read_b32 v51, a15
v_mul_f32 v44, s59, v44
v_mul_f32 v45, s59, v45
v_mul_f32 v46, s59, v46
v_mul_f32 v47, s59, v47
v_mfma_f32_16x16x32_bf16 a[52:55], a[232:235], a[184:187], a[52:55]
v_mul_f32 v48, s59, v48
v_mul_f32 v49, s59, v49
v_mul_f32 v50, s59, v50
v_mul_f32 v51, s59, v51
v_cvt_pk_bf16_f32 v52, v44, v45
v_cvt_pk_bf16_f32 v53, v46, v47
v_cvt_pk_bf16_f32 v54, v48, v49
v_mfma_f32_16x16x32_bf16 a[56:59], a[236:239], a[184:187], a[56:59]
v_cvt_pk_bf16_f32 v55, v50, v51
ds_write_b128 v13, v[52:55] offset:1024
buffer_store_dwordx4 v[52:55], v19, s[60:63], s70 offen offset:1024 sc1
v_accvgpr_read_b32 v56, a16
v_accvgpr_read_b32 v57, a17
v_accvgpr_read_b32 v58, a18
v_accvgpr_read_b32 v59, a19
v_mfma_f32_16x16x32_bf16 a[60:63], a[240:243], a[184:187], a[60:63]
v_accvgpr_read_b32 v60, a20
v_accvgpr_read_b32 v61, a21
v_accvgpr_read_b32 v62, a22
v_accvgpr_read_b32 v63, a23
v_mul_f32 v56, s59, v56
v_mul_f32 v57, s59, v57
v_mul_f32 v58, s59, v58
v_mfma_f32_16x16x32_bf16 a[140:143], a[196:199], a[184:187], a[140:143]
v_mul_f32 v59, s59, v59
v_mul_f32 v60, s59, v60
v_mul_f32 v61, s59, v61
v_mul_f32 v62, s59, v62
v_mul_f32 v63, s59, v63
v_cvt_pk_bf16_f32 v64, v56, v57
v_cvt_pk_bf16_f32 v65, v58, v59
v_mfma_f32_16x16x32_bf16 a[144:147], a[200:203], a[184:187], a[144:147]
v_cvt_pk_bf16_f32 v66, v60, v61
v_cvt_pk_bf16_f32 v67, v62, v63
ds_write_b128 v13, v[64:67] offset:2048
buffer_store_dwordx4 v[64:67], v19, s[60:63], s70 offen offset:2048 sc1
v_accvgpr_read_b32 v68, a24
v_accvgpr_read_b32 v69, a25
v_accvgpr_read_b32 v70, a26
v_mfma_f32_16x16x32_bf16 a[148:151], a[204:207], a[184:187], a[148:151]
v_accvgpr_read_b32 v71, a27
v_accvgpr_read_b32 v72, a28
v_accvgpr_read_b32 v73, a29
v_accvgpr_read_b32 v74, a30
v_accvgpr_read_b32 v75, a31
v_mul_f32 v68, s59, v68
v_mul_f32 v69, s59, v69
v_mfma_f32_16x16x32_bf16 a[64:67], a[212:215], a[188:191], a[64:67]
v_mul_f32 v70, s59, v70
v_mul_f32 v71, s59, v71
v_mul_f32 v72, s59, v72
v_mul_f32 v73, s59, v73
v_mul_f32 v74, s59, v74
v_mul_f32 v75, s59, v75
v_cvt_pk_bf16_f32 v76, v68, v69
v_mfma_f32_16x16x32_bf16 a[68:71], a[216:219], a[188:191], a[68:71]
v_cvt_pk_bf16_f32 v77, v70, v71
v_cvt_pk_bf16_f32 v78, v72, v73
v_cvt_pk_bf16_f32 v79, v74, v75
ds_write_b128 v13, v[76:79] offset:3072
buffer_store_dwordx4 v[76:79], v19, s[60:63], s70 offen offset:3072 sc1
ds_write_b128 v2, a[128:131] offset:0
ds_write_b128 v3, a[132:135] offset:0
v_mfma_f32_16x16x32_bf16 a[72:75], a[220:223], a[188:191], a[72:75]
ds_write_b128 v4, a[136:139] offset:0
s_mov_b32 s70, 8192
v_accvgpr_read_b32 v32, a32
v_accvgpr_read_b32 v33, a33
v_accvgpr_read_b32 v34, a34
v_accvgpr_read_b32 v35, a35
v_accvgpr_read_b32 v36, a36
v_mfma_f32_16x16x32_bf16 a[76:79], a[224:227], a[188:191], a[76:79]
v_accvgpr_read_b32 v37, a37
v_accvgpr_read_b32 v38, a38
v_accvgpr_read_b32 v39, a39
v_mul_f32 v32, s59, v32
v_mul_f32 v33, s59, v33
v_mul_f32 v34, s59, v34
v_mul_f32 v35, s59, v35
v_mfma_f32_16x16x32_bf16 a[80:83], a[228:231], a[188:191], a[80:83]
v_mul_f32 v36, s59, v36
v_mul_f32 v37, s59, v37
v_mul_f32 v38, s59, v38
v_mul_f32 v39, s59, v39
v_cvt_pk_bf16_f32 v40, v32, v33
v_cvt_pk_bf16_f32 v41, v34, v35
v_cvt_pk_bf16_f32 v42, v36, v37
v_mfma_f32_16x16x32_bf16 a[84:87], a[232:235], a[188:191], a[84:87]
v_cvt_pk_bf16_f32 v43, v38, v39
ds_write_b128 v13, v[40:43] offset:8192
buffer_store_dwordx4 v[40:43], v19, s[60:63], s70 offen offset:0 sc1
v_accvgpr_read_b32 v44, a40
v_accvgpr_read_b32 v45, a41
v_accvgpr_read_b32 v46, a42
v_accvgpr_read_b32 v47, a43
v_mfma_f32_16x16x32_bf16 a[88:91], a[236:239], a[188:191], a[88:91]
v_accvgpr_read_b32 v48, a44
v_accvgpr_read_b32 v49, a45
v_accvgpr_read_b32 v50, a46
v_accvgpr_read_b32 v51, a47
v_mul_f32 v44, s59, v44
v_mul_f32 v45, s59, v45
v_mul_f32 v46, s59, v46
v_mfma_f32_16x16x32_bf16 a[92:95], a[240:243], a[188:191], a[92:95]
v_mul_f32 v47, s59, v47
v_mul_f32 v48, s59, v48
v_mul_f32 v49, s59, v49
v_mul_f32 v50, s59, v50
v_mul_f32 v51, s59, v51
v_cvt_pk_bf16_f32 v52, v44, v45
v_cvt_pk_bf16_f32 v53, v46, v47
v_mfma_f32_16x16x32_bf16 a[152:155], a[196:199], a[188:191], a[152:155]
v_cvt_pk_bf16_f32 v54, v48, v49
v_cvt_pk_bf16_f32 v55, v50, v51
ds_write_b128 v13, v[52:55] offset:9216
buffer_store_dwordx4 v[52:55], v19, s[60:63], s70 offen offset:1024 sc1
v_accvgpr_read_b32 v56, a48
v_accvgpr_read_b32 v57, a49
v_accvgpr_read_b32 v58, a50
v_mfma_f32_16x16x32_bf16 a[156:159], a[200:203], a[188:191], a[156:159]
v_accvgpr_read_b32 v59, a51
v_accvgpr_read_b32 v60, a52
v_accvgpr_read_b32 v61, a53
v_accvgpr_read_b32 v62, a54
v_accvgpr_read_b32 v63, a55
v_mul_f32 v56, s59, v56
v_mul_f32 v57, s59, v57
v_mfma_f32_16x16x32_bf16 a[160:163], a[204:207], a[188:191], a[160:163]
v_mul_f32 v58, s59, v58
v_mul_f32 v59, s59, v59
v_mul_f32 v60, s59, v60
v_mul_f32 v61, s59, v61
v_mul_f32 v62, s59, v62
v_mul_f32 v63, s59, v63
v_cvt_pk_bf16_f32 v64, v56, v57
v_mfma_f32_16x16x32_bf16 a[96:99], a[212:215], a[192:195], a[96:99]
v_cvt_pk_bf16_f32 v65, v58, v59
v_cvt_pk_bf16_f32 v66, v60, v61
v_cvt_pk_bf16_f32 v67, v62, v63
ds_write_b128 v13, v[64:67] offset:10240
buffer_store_dwordx4 v[64:67], v19, s[60:63], s70 offen offset:2048 sc1
v_accvgpr_read_b32 v68, a56
v_accvgpr_read_b32 v69, a57
v_mfma_f32_16x16x32_bf16 a[100:103], a[216:219], a[192:195], a[100:103]
v_accvgpr_read_b32 v70, a58
v_accvgpr_read_b32 v71, a59
v_accvgpr_read_b32 v72, a60
v_accvgpr_read_b32 v73, a61
v_accvgpr_read_b32 v74, a62
v_accvgpr_read_b32 v75, a63
v_mul_f32 v68, s59, v68
v_mfma_f32_16x16x32_bf16 a[104:107], a[220:223], a[192:195], a[104:107]
v_mul_f32 v69, s59, v69
v_mul_f32 v70, s59, v70
v_mul_f32 v71, s59, v71
v_mul_f32 v72, s59, v72
v_mul_f32 v73, s59, v73
v_mul_f32 v74, s59, v74
v_mul_f32 v75, s59, v75
v_mfma_f32_16x16x32_bf16 a[108:111], a[224:227], a[192:195], a[108:111]
v_cvt_pk_bf16_f32 v76, v68, v69
v_cvt_pk_bf16_f32 v77, v70, v71
v_cvt_pk_bf16_f32 v78, v72, v73
v_cvt_pk_bf16_f32 v79, v74, v75
ds_write_b128 v13, v[76:79] offset:11264
buffer_store_dwordx4 v[76:79], v19, s[60:63], s70 offen offset:3072 sc1
ds_write_b128 v2, a[140:143] offset:6400
v_mfma_f32_16x16x32_bf16 a[112:115], a[228:231], a[192:195], a[112:115]
ds_write_b128 v3, a[144:147] offset:6400
ds_write_b128 v4, a[148:151] offset:6400
s_mov_b32 s70, 16384
v_accvgpr_read_b32 v32, a64
v_accvgpr_read_b32 v33, a65
v_accvgpr_read_b32 v34, a66
v_accvgpr_read_b32 v35, a67
v_mfma_f32_16x16x32_bf16 a[116:119], a[232:235], a[192:195], a[116:119]
v_accvgpr_read_b32 v36, a68
v_accvgpr_read_b32 v37, a69
v_accvgpr_read_b32 v38, a70
v_accvgpr_read_b32 v39, a71
v_mul_f32 v32, s59, v32
v_mul_f32 v33, s59, v33
v_mul_f32 v34, s59, v34
v_mfma_f32_16x16x32_bf16 a[120:123], a[236:239], a[192:195], a[120:123]
v_mul_f32 v35, s59, v35
v_mul_f32 v36, s59, v36
v_mul_f32 v37, s59, v37
v_mul_f32 v38, s59, v38
v_mul_f32 v39, s59, v39
v_cvt_pk_bf16_f32 v40, v32, v33
v_cvt_pk_bf16_f32 v41, v34, v35
v_mfma_f32_16x16x32_bf16 a[124:127], a[240:243], a[192:195], a[124:127]
v_cvt_pk_bf16_f32 v42, v36, v37
v_cvt_pk_bf16_f32 v43, v38, v39
ds_write_b128 v13, v[40:43] offset:16384
buffer_store_dwordx4 v[40:43], v19, s[60:63], s70 offen offset:0 sc1
v_accvgpr_read_b32 v44, a72
v_accvgpr_read_b32 v45, a73
v_accvgpr_read_b32 v46, a74
v_mfma_f32_16x16x32_bf16 a[164:167], a[196:199], a[192:195], a[164:167]
v_accvgpr_read_b32 v47, a75
v_accvgpr_read_b32 v48, a76
v_accvgpr_read_b32 v49, a77
v_accvgpr_read_b32 v50, a78
v_accvgpr_read_b32 v51, a79
v_mul_f32 v44, s59, v44
v_mul_f32 v45, s59, v45
v_mfma_f32_16x16x32_bf16 a[168:171], a[200:203], a[192:195], a[168:171]
v_mul_f32 v46, s59, v46
v_mul_f32 v47, s59, v47
v_mul_f32 v48, s59, v48
v_mul_f32 v49, s59, v49
v_mul_f32 v50, s59, v50
v_mul_f32 v51, s59, v51
v_cvt_pk_bf16_f32 v52, v44, v45
v_mfma_f32_16x16x32_bf16 a[172:175], a[204:207], a[192:195], a[172:175]
v_cvt_pk_bf16_f32 v53, v46, v47
v_cvt_pk_bf16_f32 v54, v48, v49
v_cvt_pk_bf16_f32 v55, v50, v51
ds_write_b128 v13, v[52:55] offset:17408
buffer_store_dwordx4 v[52:55], v19, s[60:63], s70 offen offset:1024 sc1
v_accvgpr_read_b32 v56, a80
v_accvgpr_read_b32 v57, a81
v_accvgpr_read_b32 v58, a82
v_accvgpr_read_b32 v59, a83
v_accvgpr_read_b32 v60, a84
v_accvgpr_read_b32 v61, a85
v_accvgpr_read_b32 v62, a86
v_accvgpr_read_b32 v63, a87
v_mul_f32 v56, s59, v56
v_mul_f32 v57, s59, v57
v_mul_f32 v58, s59, v58
v_mul_f32 v59, s59, v59
v_mul_f32 v60, s59, v60
v_mul_f32 v61, s59, v61
v_mul_f32 v62, s59, v62
v_mul_f32 v63, s59, v63
v_cvt_pk_bf16_f32 v64, v56, v57
v_cvt_pk_bf16_f32 v65, v58, v59
v_cvt_pk_bf16_f32 v66, v60, v61
v_cvt_pk_bf16_f32 v67, v62, v63
ds_write_b128 v13, v[64:67] offset:18432
buffer_store_dwordx4 v[64:67], v19, s[60:63], s70 offen offset:2048 sc1
v_accvgpr_read_b32 v68, a88
v_accvgpr_read_b32 v69, a89
v_accvgpr_read_b32 v70, a90
v_accvgpr_read_b32 v71, a91
v_accvgpr_read_b32 v72, a92
v_accvgpr_read_b32 v73, a93
v_accvgpr_read_b32 v74, a94
v_accvgpr_read_b32 v75, a95
v_mul_f32 v68, s59, v68
v_mul_f32 v69, s59, v69
v_mul_f32 v70, s59, v70
v_mul_f32 v71, s59, v71
v_mul_f32 v72, s59, v72
v_mul_f32 v73, s59, v73
v_mul_f32 v74, s59, v74
v_mul_f32 v75, s59, v75
v_cvt_pk_bf16_f32 v76, v68, v69
v_cvt_pk_bf16_f32 v77, v70, v71
v_cvt_pk_bf16_f32 v78, v72, v73
v_cvt_pk_bf16_f32 v79, v74, v75
ds_write_b128 v13, v[76:79] offset:19456
buffer_store_dwordx4 v[76:79], v19, s[60:63], s70 offen offset:3072 sc1
ds_write_b128 v2, a[152:155] offset:12800
ds_write_b128 v3, a[156:159] offset:12800
ds_write_b128 v4, a[160:163] offset:12800
s_nop 3
s_mov_b32 s70, 24576
v_accvgpr_read_b32 v32, a96
v_accvgpr_read_b32 v33, a97
v_accvgpr_read_b32 v34, a98
v_accvgpr_read_b32 v35, a99
v_accvgpr_read_b32 v36, a100
v_accvgpr_read_b32 v37, a101
v_accvgpr_read_b32 v38, a102
v_accvgpr_read_b32 v39, a103
v_mul_f32 v32, s59, v32
v_mul_f32 v33, s59, v33
v_mul_f32 v34, s59, v34
v_mul_f32 v35, s59, v35
v_mul_f32 v36, s59, v36
v_mul_f32 v37, s59, v37
v_mul_f32 v38, s59, v38
v_mul_f32 v39, s59, v39
v_cvt_pk_bf16_f32 v40, v32, v33
v_cvt_pk_bf16_f32 v41, v34, v35
v_cvt_pk_bf16_f32 v42, v36, v37
v_cvt_pk_bf16_f32 v43, v38, v39
ds_write_b128 v13, v[40:43] offset:24576
buffer_store_dwordx4 v[40:43], v19, s[60:63], s70 offen offset:0 sc1
v_accvgpr_read_b32 v44, a104
v_accvgpr_read_b32 v45, a105
v_accvgpr_read_b32 v46, a106
v_accvgpr_read_b32 v47, a107
v_accvgpr_read_b32 v48, a108
v_accvgpr_read_b32 v49, a109
v_accvgpr_read_b32 v50, a110
v_accvgpr_read_b32 v51, a111
v_mul_f32 v44, s59, v44
v_mul_f32 v45, s59, v45
v_mul_f32 v46, s59, v46
v_mul_f32 v47, s59, v47
v_mul_f32 v48, s59, v48
v_mul_f32 v49, s59, v49
v_mul_f32 v50, s59, v50
v_mul_f32 v51, s59, v51
v_cvt_pk_bf16_f32 v52, v44, v45
v_cvt_pk_bf16_f32 v53, v46, v47
v_cvt_pk_bf16_f32 v54, v48, v49
v_cvt_pk_bf16_f32 v55, v50, v51
ds_write_b128 v13, v[52:55] offset:25600
buffer_store_dwordx4 v[52:55], v19, s[60:63], s70 offen offset:1024 sc1
v_accvgpr_read_b32 v56, a112
v_accvgpr_read_b32 v57, a113
v_accvgpr_read_b32 v58, a114
v_accvgpr_read_b32 v59, a115
v_accvgpr_read_b32 v60, a116
v_accvgpr_read_b32 v61, a117
v_accvgpr_read_b32 v62, a118
v_accvgpr_read_b32 v63, a119
v_mul_f32 v56, s59, v56
v_mul_f32 v57, s59, v57
v_mul_f32 v58, s59, v58
v_mul_f32 v59, s59, v59
v_mul_f32 v60, s59, v60
v_mul_f32 v61, s59, v61
v_mul_f32 v62, s59, v62
v_mul_f32 v63, s59, v63
v_cvt_pk_bf16_f32 v64, v56, v57
v_cvt_pk_bf16_f32 v65, v58, v59
v_cvt_pk_bf16_f32 v66, v60, v61
v_cvt_pk_bf16_f32 v67, v62, v63
ds_write_b128 v13, v[64:67] offset:26624
buffer_store_dwordx4 v[64:67], v19, s[60:63], s70 offen offset:2048 sc1
v_accvgpr_read_b32 v68, a120
v_accvgpr_read_b32 v69, a121
v_accvgpr_read_b32 v70, a122
v_accvgpr_read_b32 v71, a123
v_accvgpr_read_b32 v72, a124
v_accvgpr_read_b32 v73, a125
v_accvgpr_read_b32 v74, a126
v_accvgpr_read_b32 v75, a127
v_mul_f32 v68, s59, v68
v_mul_f32 v69, s59, v69
v_mul_f32 v70, s59, v70
v_mul_f32 v71, s59, v71
v_mul_f32 v72, s59, v72
v_mul_f32 v73, s59, v73
v_mul_f32 v74, s59, v74
v_mul_f32 v75, s59, v75
v_cvt_pk_bf16_f32 v76, v68, v69
v_cvt_pk_bf16_f32 v77, v70, v71
v_cvt_pk_bf16_f32 v78, v72, v73
v_cvt_pk_bf16_f32 v79, v74, v75
ds_write_b128 v13, v[76:79] offset:27648
buffer_store_dwordx4 v[76:79], v19, s[60:63], s70 offen offset:3072 sc1
ds_write_b128 v2, a[164:167] offset:19200
ds_write_b128 v3, a[168:171] offset:19200
ds_write_b128 v4, a[172:175] offset:19200
s_waitcnt lgkmcnt(0)
s_barrier
buffer_load_dword v12, v19, s[44:47], 0 offen sc1
s_lshl_b32 s68, s27, 14
s_add_u32 s68, s68, 32768
v_add_u32 v13, s68, v19
s_cmp_eq_u32 s31, 1
s_cbranch_scc1 L_f_park
ds_read_b128 a[0:3], v13 offset:0
ds_read_b128 a[4:7], v13 offset:1024
ds_read_b128 a[8:11], v13 offset:2048
ds_read_b128 a[12:15], v13 offset:3072
ds_read_b128 a[16:19], v13 offset:4096
ds_read_b128 a[20:23], v13 offset:5120
ds_read_b128 a[24:27], v13 offset:6144
ds_read_b128 a[28:31], v13 offset:7168
ds_read_b128 a[32:35], v13 offset:8192
ds_read_b128 a[36:39], v13 offset:9216
ds_read_b128 a[40:43], v13 offset:10240
ds_read_b128 a[44:47], v13 offset:11264
ds_read_b128 a[48:51], v13 offset:12288
ds_read_b128 a[52:55], v13 offset:13312
ds_read_b128 a[56:59], v13 offset:14336
ds_read_b128 a[60:63], v13 offset:15360
s_branch L_f_parked
L_f_park:
ds_read_b128 a[192:195], v13 offset:0
ds_read_b128 a[196:199], v13 offset:1024
ds_read_b128 a[200:203], v13 offset:2048
ds_read_b128 a[204:207], v13 offset:3072
ds_read_b128 a[208:211], v13 offset:4096
ds_read_b128 a[212:215], v13 offset:5120
ds_read_b128 a[216:219], v13 offset:6144
ds_read_b128 a[220:223], v13 offset:7168
ds_read_b128 a[224:227], v13 offset:8192
ds_read_b128 a[228:231], v13 offset:9216
ds_read_b128 a[232:235], v13 offset:10240
ds_read_b128 a[236:239], v13 offset:11264
ds_read_b128 a[240:243], v13 offset:12288
ds_read_b128 a[244:247], v13 offset:13312
ds_read_b128 a[248:251], v13 offset:14336
ds_read_b128 a[252:255], v13 offset:15360
L_f_parked:
ds_read_b128 v[80:83], v6 offset:5600
ds_read_b128 v[84:87], v6 offset:5616
ds_read_b128 v[88:91], v6 offset:5632
ds_read_b128 v[92:95], v6 offset:5648
ds_read_b128 v[128:131], v6 offset:5728
ds_read_b128 v[132:135], v6 offset:5744
ds_read_b128 v[136:139], v6 offset:5760
ds_read_b128 v[140:143], v6 offset:5776
ds_read_b128 v[144:147], v6 offset:4928
ds_read_b128 v[148:151], v6 offset:4944
ds_read_b128 v[152:155], v6 offset:4960
ds_read_b128 v[156:159], v6 offset:4976
ds_read_b128 v[160:163], v6 offset:4128
ds_read_b128 v[164:167], v6 offset:4144
ds_read_b128 v[168:171], v6 offset:4160
ds_read_b128 v[172:175], v6 offset:4176
ds_read_b128 v[176:179], v6 offset:3328
ds_read_b128 v[180:183], v6 offset:3344
ds_read_b128 v[184:187], v6 offset:3360
ds_read_b128 v[188:191], v6 offset:3376
ds_read_b128 v[192:195], v6 offset:2528
ds_read_b128 v[196:199], v6 offset:2544
ds_read_b128 v[200:203], v6 offset:2560
ds_read_b128 v[204:207], v6 offset:2576
ds_read_b128 v[208:211], v6 offset:1728
ds_read_b128 v[212:215], v6 offset:1744
ds_read_b128 v[216:219], v6 offset:1760
ds_read_b128 v[220:223], v6 offset:1776
ds_read_b128 v[224:227], v6 offset:928
ds_read_b128 v[228:231], v6 offset:944
ds_read_b128 v[232:235], v6 offset:960
ds_read_b128 v[236:239], v6 offset:976
ds_read_b128 v[240:243], v6 offset:128
ds_read_b128 v[244:247], v6 offset:144
ds_read_b128 v[248:251], v6 offset:160
ds_read_b128 v[252:255], v6 offset:176
s_waitcnt vmcnt(0) lgkmcnt(15)
s_barrier
s_cmp_eq_u32 s31, 2
s_cselect_b32 s68, 0, 64
buffer_store_dword v113, v112, s[76:79], s68 offen sc1
s_cmp_eq_u32 s27, 0
s_cbranch_scc1 L_p16_9
L_p16_9_b:
s_barrier
s_add_u32 m0, s23, 0
s_nop 0
buffer_load_dwordx4 v10, s[8:11], s20 offen offset:0 sc1 lds
buffer_load_dwordx4 v10, s[8:11], s20 offen offset:1024 sc1 lds
buffer_load_dwordx4 v10, s[8:11], s20 offen offset:2048 sc1 lds
buffer_load_dwordx4 v10, s[8:11], s20 offen offset:3072 sc1 lds
s_waitcnt lgkmcnt(0)
v_mul_f32 v80, v80, v8
v_mul_f32 v81, v81, v8
v_mul_f32 v82, v82, v8
v_mul_f32 v83, v83, v8
s_add_u32 m0, s23, 4096
s_nop 0
buffer_load_dwordx4 v11, s[8:11], s20 offen offset:0 sc1 lds
v_mul_f32 v84, v84, v8
v_mul_f32 v85, v85, v8
v_mul_f32 v86, v86, v8
v_mul_f32 v87, v87, v8
buffer_load_dwordx4 v11, s[8:11], s20 offen offset:1024 sc1 lds
v_mul_f32 v88, v88, v8
v_mul_f32 v89, v89, v8
v_mul_f32 v90, v90, v8
v_mul_f32 v91, v91, v8
buffer_load_dwordx4 v11, s[8:11], s20 offen offset:2048 sc1 lds
v_mul_f32 v92, v92, v9
v_mul_f32 v93, v93, v9
v_mul_f32 v94, v94, v9
v_mul_f32 v95, v95, v9
buffer_load_dwordx4 v11, s[8:11], s20 offen offset:3072 sc1 lds
s_add_u32 s20, s20, 32768
v_pk_mul_f32 v[96:97], v[80:81], v[128:129]
v_pk_fma_f32 v[96:97], v[82:83], v[130:131], v[96:97]
v_pk_fma_f32 v[96:97], v[84:85], v[132:133], v[96:97]
v_pk_fma_f32 v[96:97], v[86:87], v[134:135], v[96:97]
s_add_u32 m0, s23, 32768
s_nop 0
buffer_load_dwordx4 v10, s[8:11], s20 offen offset:0 sc1 lds
v_pk_fma_f32 v[96:97], v[88:89], v[136:137], v[96:97]
v_pk_fma_f32 v[96:97], v[90:91], v[138:139], v[96:97]
v_pk_fma_f32 v[96:97], v[92:93], v[140:141], v[96:97]
v_pk_fma_f32 v[96:97], v[94:95], v[142:143], v[96:97]
buffer_load_dwordx4 v10, s[8:11], s20 offen offset:1024 sc1 lds
ds_read_b128 v[128:131], v6 offset:5856
ds_read_b128 v[132:135], v6 offset:5872
ds_read_b128 v[136:139], v6 offset:5888
ds_read_b128 v[140:143], v6 offset:5904
v_add_f32 v96, v96, v97
v_pk_mul_f32 v[98:99], v[80:81], v[144:145]
v_pk_fma_f32 v[98:99], v[82:83], v[146:147], v[98:99]
v_pk_fma_f32 v[98:99], v[84:85], v[148:149], v[98:99]
v_pk_fma_f32 v[98:99], v[86:87], v[150:151], v[98:99]
buffer_load_dwordx4 v10, s[8:11], s20 offen offset:2048 sc1 lds
v_pk_fma_f32 v[98:99], v[88:89], v[152:153], v[98:99]
v_pk_fma_f32 v[98:99], v[90:91], v[154:155], v[98:99]
v_pk_fma_f32 v[98:99], v[92:93], v[156:157], v[98:99]
v_pk_fma_f32 v[98:99], v[94:95], v[158:159], v[98:99]
buffer_load_dwordx4 v10, s[8:11], s20 offen offset:3072 sc1 lds
ds_read_b128 v[144:147], v6 offset:5056
ds_read_b128 v[148:151], v6 offset:5072
ds_read_b128 v[152:155], v6 offset:5088
ds_read_b128 v[156:159], v6 offset:5104
v_add_f32 v98, v98, v99
v_pk_mul_f32 v[100:101], v[80:81], v[160:161]
v_pk_fma_f32 v[100:101], v[82:83], v[162:163], v[100:101]
v_pk_fma_f32 v[100:101], v[84:85], v[164:165], v[100:101]
v_pk_fma_f32 v[100:101], v[86:87], v[166:167], v[100:101]
s_add_u32 m0, s23, 36864
s_nop 0
buffer_load_dwordx4 v11, s[8:11], s20 offen offset:0 sc1 lds
v_pk_fma_f32 v[100:101], v[88:89], v[168:169], v[100:101]
v_pk_fma_f32 v[100:101], v[90:91], v[170:171], v[100:101]
v_pk_fma_f32 v[100:101], v[92:93], v[172:173], v[100:101]
v_pk_fma_f32 v[100:101], v[94:95], v[174:175], v[100:101]
buffer_load_dwordx4 v11, s[8:11], s20 offen offset:1024 sc1 lds
ds_read_b128 v[160:163], v6 offset:4256
ds_read_b128 v[164:167], v6 offset:4272
ds_read_b128 v[168:171], v6 offset:4288
ds_read_b128 v[172:175], v6 offset:4304
v_add_f32 v100, v100, v101
v_pk_mul_f32 v[102:103], v[80:81], v[176:177]
v_pk_fma_f32 v[102:103], v[82:83], v[178:179], v[102:103]
v_pk_fma_f32 v[102:103], v[84:85], v[180:181], v[102:103]
v_pk_fma_f32 v[102:103], v[86:87], v[182:183], v[102:103]
buffer_load_dwordx4 v11, s[8:11], s20 offen offset:2048 sc1 lds
v_pk_fma_f32 v[102:103], v[88:89], v[184:185], v[102:103]
v_pk_fma_f32 v[102:103], v[90:91], v[186:187], v[102:103]
v_pk_fma_f32 v[102:103], v[92:93], v[188:189], v[102:103]
v_pk_fma_f32 v[102:103], v[94:95], v[190:191], v[102:103]
buffer_load_dwordx4 v11, s[8:11], s20 offen offset:3072 sc1 lds
s_add_u32 s20, s20, 32768
ds_read_b128 v[176:179], v6 offset:3456
ds_read_b128 v[180:183], v6 offset:3472
ds_read_b128 v[184:187], v6 offset:3488
ds_read_b128 v[188:191], v6 offset:3504
v_add_f32 v102, v102, v103
v_pk_mul_f32 v[104:105], v[80:81], v[192:193]
v_pk_fma_f32 v[104:105], v[82:83], v[194:195], v[104:105]
v_pk_fma_f32 v[104:105], v[84:85], v[196:197], v[104:105]
v_pk_fma_f32 v[104:105], v[86:87], v[198:199], v[104:105]
s_add_u32 m0, s23, 65536
s_nop 0
buffer_load_dwordx4 v10, s[12:15], s21 offen offset:0 sc1 lds
v_pk_fma_f32 v[104:105], v[88:89], v[200:201], v[104:105]
v_pk_fma_f32 v[104:105], v[90:91], v[202:203], v[104:105]
v_pk_fma_f32 v[104:105], v[92:93], v[204:205], v[104:105]
v_pk_fma_f32 v[104:105], v[94:95], v[206:207], v[104:105]
buffer_load_dwordx4 v10, s[12:15], s21 offen offset:1024 sc1 lds
ds_read_b128 v[192:195], v6 offset:2656
ds_read_b128 v[196:199], v6 offset:2672
ds_read_b128 v[200:203], v6 offset:2688
ds_read_b128 v[204:207], v6 offset:2704
v_add_f32 v104, v104, v105
v_pk_mul_f32 v[106:107], v[80:81], v[208:209]
v_pk_fma_f32 v[106:107], v[82:83], v[210:211], v[106:107]
v_pk_fma_f32 v[106:107], v[84:85], v[212:213], v[106:107]
v_pk_fma_f32 v[106:107], v[86:87], v[214:215], v[106:107]
buffer_load_dwordx4 v10, s[12:15], s21 offen offset:2048 sc1 lds
v_pk_fma_f32 v[106:107], v[88:89], v[216:217], v[106:107]
v_pk_fma_f32 v[106:107], v[90:91], v[218:219], v[106:107]
v_pk_fma_f32 v[106:107], v[92:93], v[220:221], v[106:107]
v_pk_fma_f32 v[106:107], v[94:95], v[222:223], v[106:107]
buffer_load_dwordx4 v10, s[12:15], s21 offen offset:3072 sc1 lds
ds_read_b128 v[208:211], v6 offset:1856
ds_read_b128 v[212:215], v6 offset:1872
ds_read_b128 v[216:219], v6 offset:1888
ds_read_b128 v[220:223], v6 offset:1904
v_add_f32 v106, v106, v107
v_pk_mul_f32 v[108:109], v[80:81], v[224:225]
v_pk_fma_f32 v[108:109], v[82:83], v[226:227], v[108:109]
v_pk_fma_f32 v[108:109], v[84:85], v[228:229], v[108:109]
v_pk_fma_f32 v[108:109], v[86:87], v[230:231], v[108:109]
s_add_u32 m0, s23, 69632
s_nop 0
buffer_load_dwordx4 v11, s[12:15], s21 offen offset:0 sc1 lds
v_pk_fma_f32 v[108:109], v[88:89], v[232:233], v[108:109]
v_pk_fma_f32 v[108:109], v[90:91], v[234:235], v[108:109]
v_pk_fma_f32 v[108:109], v[92:93], v[236:237], v[108:109]
v_pk_fma_f32 v[108:109], v[94:95], v[238:239], v[108:109]
buffer_load_dwordx4 v11, s[12:15], s21 offen offset:1024 sc1 lds
ds_read_b128 v[224:227], v6 offset:1056
ds_read_b128 v[228:231], v6 offset:1072
ds_read_b128 v[232:235], v6 offset:1088
ds_read_b128 v[236:239], v6 offset:1104
v_add_f32 v108, v108, v109
v_pk_mul_f32 v[110:111], v[80:81], v[240:241]
v_pk_fma_f32 v[110:111], v[82:83], v[242:243], v[110:111]
v_pk_fma_f32 v[110:111], v[84:85], v[244:245], v[110:111]
v_pk_fma_f32 v[110:111], v[86:87], v[246:247], v[110:111]
buffer_load_dwordx4 v11, s[12:15], s21 offen offset:2048 sc1 lds
v_pk_fma_f32 v[110:111], v[88:89], v[248:249], v[110:111]
v_pk_fma_f32 v[110:111], v[90:91], v[250:251], v[110:111]
v_pk_fma_f32 v[110:111], v[92:93], v[252:253], v[110:111]
v_pk_fma_f32 v[110:111], v[94:95], v[254:255], v[110:111]
buffer_load_dwordx4 v11, s[12:15], s21 offen offset:3072 sc1 lds
s_add_u32 s21, s21, 32768
ds_read_b128 v[240:243], v6 offset:256
ds_read_b128 v[244:247], v6 offset:272
ds_read_b128 v[248:251], v6 offset:288
ds_read_b128 v[252:255], v6 offset:304
v_add_f32 v110, v110, v111
v_mov_b32 v97, v96
v_mov_b32 v99, v98
v_mov_b32 v101, v100
v_mov_b32 v103, v102
v_mov_b32 v105, v104
v_mov_b32 v107, v106
v_mov_b32 v109, v108
v_mov_b32 v111, v110
s_nop 0
v_permlane32_swap_b32 v97, v96
v_permlane32_swap_b32 v99, v98
v_permlane32_swap_b32 v101, v100
v_permlane32_swap_b32 v103, v102
v_permlane32_swap_b32 v105, v104
v_permlane32_swap_b32 v107, v106
v_permlane32_swap_b32 v109, v108
v_permlane32_swap_b32 v111, v110
v_mov_b32 v31, 4048155338
v_add_f32 v96, v96, v97
v_add_f32 v98, v98, v99
v_add_f32 v100, v100, v101
v_add_f32 v102, v102, v103
v_add_f32 v104, v104, v105
v_add_f32 v106, v106, v107
v_add_f32 v108, v108, v109
v_add_f32 v110, v110, v111
v_cmp_gt_u32 vcc, 2, v7
s_nop 1
v_cndmask_b32 v98, v98, v31, vcc
v_cmp_gt_u32 vcc, 4, v7
s_nop 1
v_cndmask_b32 v100, v100, v31, vcc
v_cmp_gt_u32 vcc, 6, v7
s_nop 1
v_cndmask_b32 v102, v102, v31, vcc
v_cmp_gt_u32 vcc, 8, v7
s_nop 1
v_cndmask_b32 v104, v104, v31, vcc
v_cmp_gt_u32 vcc, 10, v7
s_nop 1
v_cndmask_b32 v106, v106, v31, vcc
v_cmp_gt_u32 vcc, 12, v7
s_nop 1
v_cndmask_b32 v108, v108, v31, vcc
v_cmp_gt_u32 vcc, 14, v7
s_nop 1
v_cndmask_b32 v110, v110, v31, vcc
v_max3_f32 v28, v96, v98, v100
v_max3_f32 v28, v28, v102, v104
v_max3_f32 v28, v28, v106, v108
v_max_f32 v28, v28, v110
v_sub_f32 v96, v96, v28
v_sub_f32 v98, v98, v28
v_sub_f32 v100, v100, v28
v_sub_f32 v102, v102, v28
v_sub_f32 v104, v104, v28
v_sub_f32 v106, v106, v28
v_sub_f32 v108, v108, v28
v_sub_f32 v110, v110, v28
v_exp_f32 v96, v96
v_exp_f32 v98, v98
v_exp_f32 v100, v100
v_exp_f32 v102, v102
v_exp_f32 v104, v104
v_exp_f32 v106, v106
v_exp_f32 v108, v108
v_exp_f32 v110, v110
s_nop 0
v_add_f32 v28, v96, v98
v_add_f32 v28, v28, v100
v_add_f32 v28, v28, v102
v_add_f32 v28, v28, v104
v_add_f32 v28, v28, v106
v_add_f32 v28, v28, v108
v_add_f32 v28, v28, v110
v_rcp_f32 v28, v28
buffer_load_dword v12, v19, s[52:55], 0 offen sc1
s_waitcnt lgkmcnt(0)
v_pk_mul_f32 v[112:113], v[128:129], v[96:97] op_sel_hi:[1,0]
v_pk_mul_f32 v[114:115], v[130:131], v[96:97] op_sel_hi:[1,0]
v_pk_mul_f32 v[116:117], v[132:133], v[96:97] op_sel_hi:[1,0]
v_pk_mul_f32 v[118:119], v[134:135], v[96:97] op_sel_hi:[1,0]
v_pk_mul_f32 v[120:121], v[136:137], v[96:97] op_sel_hi:[1,0]
v_pk_mul_f32 v[122:123], v[138:139], v[96:97] op_sel_hi:[1,0]
v_pk_mul_f32 v[124:125], v[140:141], v[96:97] op_sel_hi:[1,0]
v_pk_mul_f32 v[126:127], v[142:143], v[96:97] op_sel_hi:[1,0]
v_pk_fma_f32 v[112:113], v[144:145], v[98:99], v[112:113] op_sel_hi:[1,0,1]
v_pk_fma_f32 v[114:115], v[146:147], v[98:99], v[114:115] op_sel_hi:[1,0,1]
v_pk_fma_f32 v[116:117], v[148:149], v[98:99], v[116:117] op_sel_hi:[1,0,1]
v_pk_fma_f32 v[118:119], v[150:151], v[98:99], v[118:119] op_sel_hi:[1,0,1]
v_pk_fma_f32 v[120:121], v[152:153], v[98:99], v[120:121] op_sel_hi:[1,0,1]
v_pk_fma_f32 v[122:123], v[154:155], v[98:99], v[122:123] op_sel_hi:[1,0,1]
v_pk_fma_f32 v[124:125], v[156:157], v[98:99], v[124:125] op_sel_hi:[1,0,1]
v_pk_fma_f32 v[126:127], v[158:159], v[98:99], v[126:127] op_sel_hi:[1,0,1]
v_pk_fma_f32 v[112:113], v[160:161], v[100:101], v[112:113] op_sel_hi:[1,0,1]
v_pk_fma_f32 v[114:115], v[162:163], v[100:101], v[114:115] op_sel_hi:[1,0,1]
v_pk_fma_f32 v[116:117], v[164:165], v[100:101], v[116:117] op_sel_hi:[1,0,1]
v_pk_fma_f32 v[118:119], v[166:167], v[100:101], v[118:119] op_sel_hi:[1,0,1]
v_pk_fma_f32 v[120:121], v[168:169], v[100:101], v[120:121] op_sel_hi:[1,0,1]
v_pk_fma_f32 v[122:123], v[170:171], v[100:101], v[122:123] op_sel_hi:[1,0,1]
v_pk_fma_f32 v[124:125], v[172:173], v[100:101], v[124:125] op_sel_hi:[1,0,1]
v_pk_fma_f32 v[126:127], v[174:175], v[100:101], v[126:127] op_sel_hi:[1,0,1]
v_pk_fma_f32 v[112:113], v[176:177], v[102:103], v[112:113] op_sel_hi:[1,0,1]
v_pk_fma_f32 v[114:115], v[178:179], v[102:103], v[114:115] op_sel_hi:[1,0,1]
v_pk_fma_f32 v[116:117], v[180:181], v[102:103], v[116:117] op_sel_hi:[1,0,1]
v_pk_fma_f32 v[118:119], v[182:183], v[102:103], v[118:119] op_sel_hi:[1,0,1]
v_pk_fma_f32 v[120:121], v[184:185], v[102:103], v[120:121] op_sel_hi:[1,0,1]
v_pk_fma_f32 v[122:123], v[186:187], v[102:103], v[122:123] op_sel_hi:[1,0,1]
v_pk_fma_f32 v[124:125], v[188:189], v[102:103], v[124:125] op_sel_hi:[1,0,1]
v_pk_fma_f32 v[126:127], v[190:191], v[102:103], v[126:127] op_sel_hi:[1,0,1]
v_pk_fma_f32 v[112:113], v[192:193], v[104:105], v[112:113] op_sel_hi:[1,0,1]
v_pk_fma_f32 v[114:115], v[194:195], v[104:105], v[114:115] op_sel_hi:[1,0,1]
v_pk_fma_f32 v[116:117], v[196:197], v[104:105], v[116:117] op_sel_hi:[1,0,1]
v_pk_fma_f32 v[118:119], v[198:199], v[104:105], v[118:119] op_sel_hi:[1,0,1]
v_pk_fma_f32 v[120:121], v[200:201], v[104:105], v[120:121] op_sel_hi:[1,0,1]
v_pk_fma_f32 v[122:123], v[202:203], v[104:105], v[122:123] op_sel_hi:[1,0,1]
v_pk_fma_f32 v[124:125], v[204:205], v[104:105], v[124:125] op_sel_hi:[1,0,1]
v_pk_fma_f32 v[126:127], v[206:207], v[104:105], v[126:127] op_sel_hi:[1,0,1]
v_pk_fma_f32 v[112:113], v[208:209], v[106:107], v[112:113] op_sel_hi:[1,0,1]
v_pk_fma_f32 v[114:115], v[210:211], v[106:107], v[114:115] op_sel_hi:[1,0,1]
v_pk_fma_f32 v[116:117], v[212:213], v[106:107], v[116:117] op_sel_hi:[1,0,1]
v_pk_fma_f32 v[118:119], v[214:215], v[106:107], v[118:119] op_sel_hi:[1,0,1]
v_pk_fma_f32 v[120:121], v[216:217], v[106:107], v[120:121] op_sel_hi:[1,0,1]
v_pk_fma_f32 v[122:123], v[218:219], v[106:107], v[122:123] op_sel_hi:[1,0,1]
v_pk_fma_f32 v[124:125], v[220:221], v[106:107], v[124:125] op_sel_hi:[1,0,1]
v_pk_fma_f32 v[126:127], v[222:223], v[106:107], v[126:127] op_sel_hi:[1,0,1]
v_pk_fma_f32 v[112:113], v[224:225], v[108:109], v[112:113] op_sel_hi:[1,0,1]
v_pk_fma_f32 v[114:115], v[226:227], v[108:109], v[114:115] op_sel_hi:[1,0,1]
v_pk_fma_f32 v[116:117], v[228:229], v[108:109], v[116:117] op_sel_hi:[1,0,1]
v_pk_fma_f32 v[118:119], v[230:231], v[108:109], v[118:119] op_sel_hi:[1,0,1]
v_pk_fma_f32 v[120:121], v[232:233], v[108:109], v[120:121] op_sel_hi:[1,0,1]
v_pk_fma_f32 v[122:123], v[234:235], v[108:109], v[122:123] op_sel_hi:[1,0,1]
v_pk_fma_f32 v[124:125], v[236:237], v[108:109], v[124:125] op_sel_hi:[1,0,1]
v_pk_fma_f32 v[126:127], v[238:239], v[108:109], v[126:127] op_sel_hi:[1,0,1]
v_pk_fma_f32 v[112:113], v[240:241], v[110:111], v[112:113] op_sel_hi:[1,0,1]
v_pk_fma_f32 v[114:115], v[242:243], v[110:111], v[114:115] op_sel_hi:[1,0,1]
v_pk_fma_f32 v[116:117], v[244:245], v[110:111], v[116:117] op_sel_hi:[1,0,1]
v_pk_fma_f32 v[118:119], v[246:247], v[110:111], v[118:119] op_sel_hi:[1,0,1]
v_pk_fma_f32 v[120:121], v[248:249], v[110:111], v[120:121] op_sel_hi:[1,0,1]
v_pk_fma_f32 v[122:123], v[250:251], v[110:111], v[122:123] op_sel_hi:[1,0,1]
v_pk_fma_f32 v[124:125], v[252:253], v[110:111], v[124:125] op_sel_hi:[1,0,1]
v_pk_fma_f32 v[126:127], v[254:255], v[110:111], v[126:127] op_sel_hi:[1,0,1]
v_sub_f32 v14, 1.0, v14
v_mul_f32 v28, v28, v14
v_cmp_eq_u32 vcc, 0, v29
s_add_u32 s64, s4, 106954752
s_addc_u32 s65, s5, 0
s_mov_b32 s66, 2097152
v_cndmask_b32 v30, 0, v28, vcc
v_mul_f32 v112, v112, v28
v_mul_f32 v113, v113, v28
v_mul_f32 v114, v114, v28
v_mul_f32 v115, v115, v28
v_mul_f32 v116, v116, v28
v_mul_f32 v117, v117, v28
v_mul_f32 v118, v118, v28
v_mul_f32 v119, v119, v28
v_mul_f32 v120, v120, v28
v_mul_f32 v121, v121, v28
v_mul_f32 v122, v122, v28
v_mul_f32 v123, v123, v28
v_mul_f32 v124, v124, v30
v_mul_f32 v125, v125, v30
v_mul_f32 v126, v126, v30
v_mul_f32 v127, v127, v30
v_lshrrev_b32 v28, 4, v7
v_lshlrev_b32 v28, 14, v28
v_and_b32 v30, 15, v7
v_lshl_add_u32 v28, v30, 4, v28
v_lshl_add_u32 v28, v29, 3, v28
s_lshl_b32 s68, s38, 10
v_cvt_pk_bf16_f32 v96, v112, v113
v_cvt_pk_bf16_f32 v97, v114, v115
buffer_store_dwordx2 v[96:97], v28, s[64:67], s68 offen offset:0
v_cvt_pk_bf16_f32 v98, v116, v117
v_cvt_pk_bf16_f32 v99, v118, v119
buffer_store_dwordx2 v[98:99], v28, s[64:67], s68 offen offset:256
v_cvt_pk_bf16_f32 v100, v120, v121
v_cvt_pk_bf16_f32 v101, v122, v123
buffer_store_dwordx2 v[100:101], v28, s[64:67], s68 offen offset:512
v_cvt_pk_bf16_f32 v102, v124, v125
v_cvt_pk_bf16_f32 v103, v126, v127
buffer_store_dwordx2 v[102:103], v28, s[64:67], s68 offen offset:768
s_cmp_eq_u32 s31, 1
s_cbranch_scc0 L_f_go
s_waitcnt vmcnt(4)
s_branch L_qpoll_10
L_qpoll_10_b:
s_mov_b32 s49, 0
s_nop 0
buffer_load_dwordx4 a[0:3], v19, s[16:19], s49 offen offset:0 sc1
buffer_load_dwordx4 a[4:7], v19, s[16:19], s49 offen offset:1024 sc1
buffer_load_dwordx4 a[8:11], v19, s[16:19], s49 offen offset:2048 sc1
buffer_load_dwordx4 a[12:15], v19, s[16:19], s49 offen offset:3072 sc1
s_mov_b32 s49, 4096
s_nop 0
buffer_load_dwordx4 a[16:19], v19, s[16:19], s49 offen offset:0 sc1
buffer_load_dwordx4 a[20:23], v19, s[16:19], s49 offen offset:1024 sc1
buffer_load_dwordx4 a[24:27], v19, s[16:19], s49 offen offset:2048 sc1
buffer_load_dwordx4 a[28:31], v19, s[16:19], s49 offen offset:3072 sc1
s_mov_b32 s49, 8192
s_nop 0
buffer_load_dwordx4 a[32:35], v19, s[16:19], s49 offen offset:0 sc1
buffer_load_dwordx4 a[36:39], v19, s[16:19], s49 offen offset:1024 sc1
buffer_load_dwordx4 a[40:43], v19, s[16:19], s49 offen offset:2048 sc1
buffer_load_dwordx4 a[44:47], v19, s[16:19], s49 offen offset:3072 sc1
s_mov_b32 s49, 12288
s_nop 0
buffer_load_dwordx4 a[48:51], v19, s[16:19], s49 offen offset:0 sc1
buffer_load_dwordx4 a[52:55], v19, s[16:19], s49 offen offset:1024 sc1
buffer_load_dwordx4 a[56:59], v19, s[16:19], s49 offen offset:2048 sc1
buffer_load_dwordx4 a[60:63], v19, s[16:19], s49 offen offset:3072 sc1
s_waitcnt vmcnt(0)
L_f_go:
s_waitcnt vmcnt(21)
v_add_u32 v13, 0x10000, v19
s_mov_b32 s33, 1132462080
v_mov_b32 v1, 4048155338
s_mov_b32 s63, 0x20000
v_and_b32 v28, 15, v0
v_bfe_u32 v29, v0, 4, 2
v_lshlrev_b32 v29, 2, v29
v_sub_u32 v28, v28, v29
s_lshl_b32 s35, s22, 5
v_add_u32 v18, s35, v28
L_k2_job:
s_lshl_b32 s34, s26, 1
s_add_u32 s34, s34, 2
s_cmp_eq_u32 s34, s28
s_cselect_b32 s27, 1, 0x7fffffff
s_sub_u32 s29, s28, s36
s_lshr_b32 s29, s29, 1
v_mov_b32 v14, 0
v_mov_b32 v15, 0
v_mov_b32 v20, 0
v_mov_b32 v21, 0
v_mov_b32 v22, 0
v_mov_b32 v23, 0
v_mov_b32 v24, 0
v_mov_b32 v25, 0
v_mov_b32 v26, 0
v_mov_b32 v27, 0
s_barrier
ds_read_b128 a[64:67], v19 offset:0
ds_read_b128 a[68:71], v19 offset:1024
ds_read_b128 a[72:75], v19 offset:2048
ds_read_b128 a[76:79], v19 offset:3072
ds_read_b128 a[80:83], v19 offset:4096
ds_read_b128 a[84:87], v19 offset:5120
ds_read_b128 a[88:91], v19 offset:6144
ds_read_b128 a[92:95], v19 offset:7168
ds_read_b128 a[96:99], v19 offset:8192
ds_read_b128 a[100:103], v19 offset:9216
ds_read_b128 a[104:107], v19 offset:10240
ds_read_b128 a[108:111], v19 offset:11264
ds_read_b128 a[112:115], v19 offset:12288
ds_read_b128 a[116:119], v19 offset:13312
ds_read_b128 a[120:123], v19 offset:14336
ds_read_b128 a[124:127], v19 offset:15360
v_mov_b64 v[128:129], 0
v_mov_b64 v[130:131], 0
v_mov_b64 v[132:133], 0
v_mov_b64 v[134:135], 0
v_mov_b64 v[136:137], 0
v_mov_b64 v[138:139], 0
v_mov_b64 v[140:141], 0
v_mov_b64 v[142:143], 0
v_mov_b64 v[144:145], 0
v_mov_b64 v[146:147], 0
v_mov_b64 v[148:149], 0
v_mov_b64 v[150:151], 0
v_mov_b64 v[152:153], 0
v_mov_b64 v[154:155], 0
v_mov_b64 v[156:157], 0
v_mov_b64 v[158:159], 0
v_mov_b64 v[160:161], 0
v_mov_b64 v[162:163], 0
v_mov_b64 v[164:165], 0
v_mov_b64 v[166:167], 0
v_mov_b64 v[168:169], 0
v_mov_b64 v[170:171], 0
v_mov_b64 v[172:173], 0
v_mov_b64 v[174:175], 0
s_waitcnt lgkmcnt(8)
v_mfma_f32_16x16x32_bf16 v[32:35], a[64:67], a[0:3], v[20:23]
ds_read_b128 a[128:131], v19 offset:16384
v_mov_b64 v[176:177], 0
v_mov_b64 v[178:179], 0
v_mfma_f32_16x16x32_bf16 v[32:35], a[68:71], a[4:7], v[32:35]
ds_read_b128 a[132:135], v19 offset:17408
v_mov_b64 v[180:181], 0
v_mov_b64 v[182:183], 0
v_mfma_f32_16x16x32_bf16 v[32:35], a[72:75], a[8:11], v[32:35]
v_mov_b64 v[184:185], 0
v_mov_b64 v[186:187], 0
v_mov_b64 v[188:189], 0
v_mfma_f32_16x16x32_bf16 v[32:35], a[76:79], a[12:15], v[32:35]
ds_read_b128 a[136:139], v19 offset:18432
v_mov_b64 v[190:191], 0
v_mov_b64 v[192:193], 0
v_mfma_f32_16x16x32_bf16 v[32:35], a[80:83], a[16:19], v[32:35]
ds_read_b128 a[140:143], v19 offset:19456
v_mov_b64 v[194:195], 0
v_mov_b64 v[196:197], 0
v_mfma_f32_16x16x32_bf16 v[32:35], a[84:87], a[20:23], v[32:35]
v_mov_b64 v[198:199], 0
v_mov_b64 v[200:201], 0
v_mov_b64 v[202:203], 0
v_mfma_f32_16x16x32_bf16 v[32:35], a[88:91], a[24:27], v[32:35]
ds_read_b128 a[144:147], v19 offset:20480
v_mov_b64 v[204:205], 0
v_mov_b64 v[206:207], 0
v_mfma_f32_16x16x32_bf16 v[32:35], a[92:95], a[28:31], v[32:35]
v_mov_b64 v[208:209], 0
v_mov_b64 v[210:211], 0
v_mov_b64 v[212:213], 0
v_mfma_f32_16x16x32_bf16 v[36:39], a[64:67], a[32:35], v[24:27]
ds_read_b128 a[148:151], v19 offset:21504
v_mov_b64 v[214:215], 0
v_mov_b64 v[216:217], 0
v_mfma_f32_16x16x32_bf16 v[36:39], a[68:71], a[36:39], v[36:39]
ds_read_b128 a[152:155], v19 offset:22528
v_mov_b64 v[218:219], 0
v_mov_b64 v[220:221], 0
v_mfma_f32_16x16x32_bf16 v[36:39], a[72:75], a[40:43], v[36:39]
v_mov_b64 v[222:223], 0
v_mov_b64 v[224:225], 0
v_mov_b64 v[226:227], 0
v_mfma_f32_16x16x32_bf16 v[36:39], a[76:79], a[44:47], v[36:39]
ds_read_b128 a[156:159], v19 offset:23552
v_mov_b64 v[228:229], 0
v_mov_b64 v[230:231], 0
v_mfma_f32_16x16x32_bf16 v[36:39], a[80:83], a[48:51], v[36:39]
v_mov_b64 v[232:233], 0
v_mov_b64 v[234:235], 0
v_max3_f32 v28, v32, v33, v34
v_mfma_f32_16x16x32_bf16 v[36:39], a[84:87], a[52:55], v[36:39]
ds_read_b128 a[160:163], v19 offset:24576
v_max_f32 v28, v28, v35
v_mov_b32 v30, v28
v_mfma_f32_16x16x32_bf16 v[36:39], a[88:91], a[56:59], v[36:39]
s_nop 1
ds_read_b128 a[164:167], v19 offset:25600
v_mfma_f32_16x16x32_bf16 v[36:39], a[92:95], a[60:63], v[36:39]
v_permlane32_swap_b32 v30, v28
v_max_f32 v28, v28, v30
s_waitcnt lgkmcnt(10)
v_mfma_f32_16x16x32_bf16 v[40:43], a[96:99], a[0:3], v[20:23]
ds_read_b128 a[168:171], v19 offset:26624
v_mov_b32 v30, v28
v_mfma_f32_16x16x32_bf16 v[40:43], a[100:103], a[4:7], v[40:43]
s_nop 1
ds_read_b128 a[172:175], v19 offset:27648
v_mfma_f32_16x16x32_bf16 v[40:43], a[104:107], a[8:11], v[40:43]
v_permlane16_swap_b32 v30, v28
v_max_f32 v28, v28, v30
v_mfma_f32_16x16x32_bf16 v[40:43], a[108:111], a[12:15], v[40:43]
ds_read_b128 a[176:179], v19 offset:28672
v_sub_f32 v20, 0, v28
v_sub_f32 v21, 0, v28
v_mfma_f32_16x16x32_bf16 v[40:43], a[112:115], a[16:19], v[40:43]
v_sub_f32 v22, 0, v28
v_sub_f32 v23, 0, v28
v_sub_f32 v32, v32, v28
v_mfma_f32_16x16x32_bf16 v[40:43], a[116:119], a[20:23], v[40:43]
ds_read_b128 a[180:183], v19 offset:29696
v_sub_f32 v33, v33, v28
v_sub_f32 v34, v34, v28
v_mfma_f32_16x16x32_bf16 v[40:43], a[120:123], a[24:27], v[40:43]
ds_read_b128 a[184:187], v19 offset:30720
v_sub_f32 v35, v35, v28
v_max3_f32 v29, v36, v37, v38
v_mfma_f32_16x16x32_bf16 v[40:43], a[124:127], a[28:31], v[40:43]
v_max_f32 v29, v29, v39
v_mov_b32 v30, v29
v_mfma_f32_16x16x32_bf16 v[44:47], a[96:99], a[32:35], v[24:27]
s_nop 1
ds_read_b128 a[188:191], v19 offset:31744
v_mfma_f32_16x16x32_bf16 v[44:47], a[100:103], a[36:39], v[44:47]
v_permlane32_swap_b32 v30, v29
v_max_f32 v29, v29, v30
v_mov_b32 v30, v29
v_mfma_f32_16x16x32_bf16 v[44:47], a[104:107], a[40:43], v[44:47]
s_nop 1
v_permlane16_swap_b32 v30, v29
v_mfma_f32_16x16x32_bf16 v[44:47], a[108:111], a[44:47], v[44:47]
v_max_f32 v29, v29, v30
v_sub_f32 v24, 0, v29
v_sub_f32 v25, 0, v29
v_mfma_f32_16x16x32_bf16 v[44:47], a[112:115], a[48:51], v[44:47]
v_sub_f32 v26, 0, v29
v_sub_f32 v27, 0, v29
v_sub_f32 v36, v36, v29
v_mfma_f32_16x16x32_bf16 v[44:47], a[116:119], a[52:55], v[44:47]
v_sub_f32 v37, v37, v29
v_sub_f32 v38, v38, v29
v_sub_f32 v39, v39, v29
v_mfma_f32_16x16x32_bf16 v[44:47], a[120:123], a[56:59], v[44:47]
v_sub_f32 v40, v40, v28
v_sub_f32 v41, v41, v28
v_sub_f32 v42, v42, v28
v_mfma_f32_16x16x32_bf16 v[44:47], a[124:127], a[60:63], v[44:47]
s_waitcnt vmcnt(0) lgkmcnt(0)
s_barrier
v_sub_f32 v43, v43, v28
v_mfma_f32_16x16x32_bf16 v[48:51], a[128:131], a[0:3], v[20:23]
v_exp_f32 v2, v32
ds_read_b128 a[64:67], v19 offset:32768
v_mfma_f32_16x16x32_bf16 v[48:51], a[132:135], a[4:7], v[48:51]
v_exp_f32 v3, v33
ds_read_b128 a[68:71], v19 offset:33792
v_mfma_f32_16x16x32_bf16 v[48:51], a[136:139], a[8:11], v[48:51]
v_exp_f32 v4, v34
s_add_u32 m0, s23, 0
v_mfma_f32_16x16x32_bf16 v[48:51], a[140:143], a[12:15], v[48:51]
buffer_load_dwordx4 v10, s[8:11], s20 offen offset:0 sc1 lds
ds_read_b128 a[72:75], v19 offset:34816
v_mfma_f32_16x16x32_bf16 v[48:51], a[144:147], a[16:19], v[48:51]
v_add_f32 v16, v2, v3
v_cvt_pk_bf16_f32 v96, v2, v3
v_mfma_f32_16x16x32_bf16 v[48:51], a[148:151], a[20:23], v[48:51]
v_exp_f32 v5, v35
v_mfma_f32_16x16x32_bf16 v[48:51], a[152:155], a[24:27], v[48:51]
v_exp_f32 v6, v36
v_add_f32 v16, v16, v4
v_mfma_f32_16x16x32_bf16 v[48:51], a[156:159], a[28:31], v[48:51]
buffer_load_dwordx4 v10, s[8:11], s20 offen offset:1024 sc1 lds
ds_read_b128 a[76:79], v19 offset:35840
v_mfma_f32_16x16x32_bf16 v[52:55], a[128:131], a[32:35], v[24:27]
buffer_load_dwordx4 v10, s[8:11], s20 offen offset:2048 sc1 lds
ds_read_b128 a[80:83], v19 offset:36864
v_mfma_f32_16x16x32_bf16 v[52:55], a[132:135], a[36:39], v[52:55]
ds_read_b128 a[84:87], v19 offset:37888
buffer_load_dwordx4 v10, s[8:11], s20 offen offset:3072 sc1 lds
v_mfma_f32_16x16x32_bf16 v[52:55], a[136:139], a[40:43], v[52:55]
s_add_u32 m0, s23, 4096
ds_read_b128 a[88:91], v19 offset:38912
v_add_f32 v16, v16, v5
v_mfma_f32_16x16x32_bf16 v[52:55], a[140:143], a[44:47], v[52:55]
v_exp_f32 v7, v37
v_cvt_pk_bf16_f32 v97, v4, v5
v_mfma_f32_16x16x32_bf16 v[52:55], a[144:147], a[48:51], v[52:55]
v_exp_f32 v8, v38
v_add_f32 v17, v6, v7
v_mfma_f32_16x16x32_bf16 v[52:55], a[148:151], a[52:55], v[52:55]
buffer_load_dwordx4 v11, s[8:11], s20 offen offset:0 sc1 lds
ds_read_b128 a[92:95], v19 offset:39936
v_mfma_f32_16x16x32_bf16 v[52:55], a[152:155], a[56:59], v[52:55]
buffer_load_dwordx4 v11, s[8:11], s20 offen offset:1024 sc1 lds
ds_read_b128 a[96:99], v19 offset:40960
v_mfma_f32_16x16x32_bf16 v[52:55], a[156:159], a[60:63], v[52:55]
ds_read_b128 a[100:103], v19 offset:41984
v_cvt_pk_bf16_f32 v100, v6, v7
v_mfma_f32_16x16x32_bf16 v[56:59], a[160:163], a[0:3], v[20:23]
v_exp_f32 v9, v39
v_mfma_f32_16x16x32_bf16 v[56:59], a[164:167], a[4:7], v[56:59]
v_exp_f32 v2, v40
v_add_f32 v17, v17, v8
v_mfma_f32_16x16x32_bf16 v[56:59], a[168:171], a[8:11], v[56:59]
buffer_load_dwordx4 v11, s[8:11], s20 offen offset:2048 sc1 lds
ds_read_b128 a[104:107], v19 offset:43008
v_mfma_f32_16x16x32_bf16 v[56:59], a[172:175], a[12:15], v[56:59]
buffer_load_dwordx4 v11, s[8:11], s20 offen offset:3072 sc1 lds
s_add_u32 s20, s20, 32768
v_mfma_f32_16x16x32_bf16 v[56:59], a[176:179], a[16:19], v[56:59]
s_add_u32 m0, s23, 98304
ds_read_b128 a[108:111], v19 offset:44032
v_add_f32 v17, v17, v9
v_mfma_f32_16x16x32_bf16 v[56:59], a[180:183], a[20:23], v[56:59]
v_exp_f32 v3, v41
v_cvt_pk_bf16_f32 v101, v8, v9
v_mfma_f32_16x16x32_bf16 v[56:59], a[184:187], a[24:27], v[56:59]
buffer_load_dwordx4 v10, s[12:15], s21 offen offset:0 sc1 lds
ds_read_b128 a[112:115], v19 offset:45056
v_mfma_f32_16x16x32_bf16 v[56:59], a[188:191], a[28:31], v[56:59]
v_exp_f32 v4, v42
v_add_f32 v16, v16, v2
v_mfma_f32_16x16x32_bf16 v[60:63], a[160:163], a[32:35], v[24:27]
buffer_load_dwordx4 v10, s[12:15], s21 offen offset:1024 sc1 lds
ds_read_b128 a[116:119], v19 offset:46080
v_mfma_f32_16x16x32_bf16 v[60:63], a[164:167], a[36:39], v[60:63]
buffer_load_dwordx4 v10, s[12:15], s21 offen offset:2048 sc1 lds
ds_read_b128 a[120:123], v19 offset:47104
v_mfma_f32_16x16x32_bf16 v[60:63], a[168:171], a[40:43], v[60:63]
buffer_load_dwordx4 v10, s[12:15], s21 offen offset:3072 sc1 lds
ds_read_b128 a[124:127], v19 offset:48128
v_mfma_f32_16x16x32_bf16 v[60:63], a[172:175], a[44:47], v[60:63]
v_add_f32 v16, v16, v3
v_exp_f32 v5, v43
v_mfma_f32_16x16x32_bf16 v[60:63], a[176:179], a[48:51], v[60:63]
v_cvt_pk_bf16_f32 v98, v2, v3
v_sub_f32 v44, v44, v29
v_sub_f32 v45, v45, v29
v_mfma_f32_16x16x32_bf16 v[60:63], a[180:183], a[52:55], v[60:63]
v_sub_f32 v46, v46, v29
v_sub_f32 v47, v47, v29
v_mfma_f32_16x16x32_bf16 v[60:63], a[184:187], a[56:59], v[60:63]
v_exp_f32 v6, v44
v_add_f32 v16, v16, v4
v_mfma_f32_16x16x32_bf16 v[60:63], a[188:191], a[60:63], v[60:63]
v_add_f32 v16, v16, v5
v_exp_f32 v7, v45
v_cvt_pk_bf16_f32 v99, v4, v5
v_exp_f32 v8, v46
v_add_f32 v17, v17, v6
v_add_f32 v17, v17, v7
v_exp_f32 v9, v47
v_cvt_pk_bf16_f32 v102, v6, v7
s_nop 0
v_add_f32 v17, v17, v8
v_add_f32 v17, v17, v9
v_cvt_pk_bf16_f32 v103, v8, v9
v_mov_b64 v[236:237], 0
v_mov_b64 v[238:239], 0
v_mov_b64 v[240:241], 0
v_mov_b64 v[242:243], 0
v_mov_b64 v[244:245], 0
v_mov_b64 v[246:247], 0
v_mov_b64 v[248:249], 0
v_mov_b64 v[250:251], 0
v_mov_b64 v[252:253], 0
v_mov_b64 v[254:255], 0
s_cmp_lg_u32 s37, 0
s_cbranch_scc1 L_flag_11
L_flag_11_b:
s_cmp_eq_u32 s29, s27
s_cbranch_scc1 L_mask_12
L_mask_12_b:
s_sub_u32 s29, s29, 1
s_cmp_eq_u32 s29, 0
s_cbranch_scc1 L_k2_tail
L_k2_loop:
s_waitcnt lgkmcnt(8)
v_mfma_f32_16x16x32_bf16 v[64:67], a[64:67], a[0:3], v[20:23]
v_exp_f32 v2, v48
v_mfma_f32_16x16x32_bf16 v[64:67], a[68:71], a[4:7], v[64:67]
v_exp_f32 v3, v49
v_mfma_f32_16x16x32_bf16 v[64:67], a[72:75], a[8:11], v[64:67]
ds_read_b128 a[128:131], v19 offset:49152
s_add_u32 m0, s23, 102400
v_mfma_f32_16x16x32_bf16 v[64:67], a[76:79], a[12:15], v[64:67]
ds_read_b128 a[132:135], v19 offset:50176
v_mfma_f32_16x16x32_bf16 v[64:67], a[80:83], a[16:19], v[64:67]
buffer_load_dwordx4 v11, s[12:15], s21 offen offset:0 sc1 lds
v_mfma_f32_16x16x32_bf16 v[64:67], a[84:87], a[20:23], v[64:67]
ds_read_b128 a[136:139], v19 offset:51200
ds_read_b128 a[140:143], v19 offset:52224
v_mfma_f32_16x16x32_bf16 v[64:67], a[88:91], a[24:27], v[64:67]
v_exp_f32 v4, v50
v_mfma_f32_16x16x32_bf16 v[64:67], a[92:95], a[28:31], v[64:67]
ds_read_b128 a[144:147], v19 offset:53248
v_add_f32 v16, v16, v2
v_mfma_f32_16x16x32_bf16 v[68:71], a[64:67], a[32:35], v[24:27]
ds_read_b128 a[148:151], v19 offset:54272
v_add_f32 v16, v16, v3
v_mfma_f32_16x16x32_bf16 v[68:71], a[68:71], a[36:39], v[68:71]
v_exp_f32 v5, v51
v_mfma_f32_16x16x32_bf16 v[68:71], a[72:75], a[40:43], v[68:71]
buffer_load_dwordx4 v11, s[12:15], s21 offen offset:1024 sc1 lds
v_mfma_f32_16x16x32_bf16 v[68:71], a[76:79], a[44:47], v[68:71]
ds_read_b128 a[152:155], v19 offset:55296
ds_read_b128 a[156:159], v19 offset:56320
v_mfma_f32_16x16x32_bf16 v[68:71], a[80:83], a[48:51], v[68:71]
v_cvt_pk_bf16_f32 v104, v2, v3
v_mfma_f32_16x16x32_bf16 v[68:71], a[84:87], a[52:55], v[68:71]
v_exp_f32 v6, v52
v_mfma_f32_16x16x32_bf16 v[68:71], a[88:91], a[56:59], v[68:71]
ds_read_b128 a[160:163], v19 offset:57344
ds_read_b128 a[164:167], v19 offset:58368
v_mfma_f32_16x16x32_bf16 v[68:71], a[92:95], a[60:63], v[68:71]
v_add_f32 v16, v16, v4
s_waitcnt lgkmcnt(10)
v_mfma_f32_16x16x32_bf16 v[72:75], a[96:99], a[0:3], v[20:23]
buffer_load_dwordx4 v11, s[12:15], s21 offen offset:2048 sc1 lds
v_mfma_f32_16x16x32_bf16 v[72:75], a[100:103], a[4:7], v[72:75]
ds_read_b128 a[168:171], v19 offset:59392
ds_read_b128 a[172:175], v19 offset:60416
v_mfma_f32_16x16x32_bf16 v[72:75], a[104:107], a[8:11], v[72:75]
v_add_f32 v16, v16, v5
v_mfma_f32_16x16x32_bf16 v[72:75], a[108:111], a[12:15], v[72:75]
v_exp_f32 v7, v53
v_mfma_f32_16x16x32_bf16 v[72:75], a[112:115], a[16:19], v[72:75]
ds_read_b128 a[176:179], v19 offset:61440
v_cvt_pk_bf16_f32 v105, v4, v5
v_mfma_f32_16x16x32_bf16 v[72:75], a[116:119], a[20:23], v[72:75]
v_exp_f32 v8, v54
v_mfma_f32_16x16x32_bf16 v[72:75], a[120:123], a[24:27], v[72:75]
ds_read_b128 a[180:183], v19 offset:62464
v_add_f32 v17, v17, v6
v_mfma_f32_16x16x32_bf16 v[72:75], a[124:127], a[28:31], v[72:75]
buffer_load_dwordx4 v11, s[12:15], s21 offen offset:3072 sc1 lds
v_mfma_f32_16x16x32_bf16 v[76:79], a[96:99], a[32:35], v[24:27]
s_add_u32 s21, s21, 32768
ds_read_b128 a[184:187], v19 offset:63488
v_mfma_f32_16x16x32_bf16 v[76:79], a[100:103], a[36:39], v[76:79]
ds_read_b128 a[188:191], v19 offset:64512
v_add_f32 v17, v17, v7
v_mfma_f32_16x16x32_bf16 v[76:79], a[104:107], a[40:43], v[76:79]
v_exp_f32 v9, v55
v_mfma_f32_16x16x32_bf16 v[76:79], a[108:111], a[44:47], v[76:79]
v_cvt_pk_bf16_f32 v108, v6, v7
v_mfma_f32_16x16x32_bf16 v[76:79], a[112:115], a[48:51], v[76:79]
v_exp_f32 v2, v56
v_mfma_f32_16x16x32_bf16 v[76:79], a[116:119], a[52:55], v[76:79]
v_add_f32 v17, v17, v8
v_add_f32 v17, v17, v9
v_mfma_f32_16x16x32_bf16 v[76:79], a[120:123], a[56:59], v[76:79]
v_exp_f32 v3, v57
v_mfma_f32_16x16x32_bf16 v[76:79], a[124:127], a[60:63], v[76:79]
s_waitcnt vmcnt(16) lgkmcnt(0)
s_barrier
v_mfma_f32_16x16x32_bf16 v[80:83], a[128:131], a[0:3], v[20:23]
ds_read_b128 a[64:67], v13 offset:0
v_cvt_pk_bf16_f32 v109, v8, v9
v_mfma_f32_16x16x32_bf16 v[80:83], a[132:135], a[4:7], v[80:83]
v_exp_f32 v4, v58
v_mfma_f32_16x16x32_bf16 v[80:83], a[136:139], a[8:11], v[80:83]
ds_read_b128 a[68:71], v13 offset:16384
s_add_u32 m0, s23, 32768
v_mfma_f32_16x16x32_bf16 v[80:83], a[140:143], a[12:15], v[80:83]
buffer_load_dwordx4 v10, s[8:11], s20 offen offset:0 sc1 lds
v_mfma_f32_16x16x32_bf16 v[80:83], a[144:147], a[16:19], v[80:83]
ds_read_b128 a[72:75], v13 offset:1024
v_add_f32 v16, v16, v2
v_mfma_f32_16x16x32_bf16 v[80:83], a[148:151], a[20:23], v[80:83]
ds_read_b128 a[76:79], v13 offset:17408
v_add_f32 v16, v16, v3
v_mfma_f32_16x16x32_bf16 v[80:83], a[152:155], a[24:27], v[80:83]
v_exp_f32 v5, v59
v_mfma_f32_16x16x32_bf16 v[80:83], a[156:159], a[28:31], v[80:83]
ds_read_b128 a[80:83], v13 offset:2048
v_cvt_pk_bf16_f32 v106, v2, v3
v_mfma_f32_16x16x32_bf16 v[84:87], a[128:131], a[32:35], v[24:27]
v_exp_f32 v6, v60
v_mfma_f32_16x16x32_bf16 v[84:87], a[132:135], a[36:39], v[84:87]
ds_read_b128 a[84:87], v13 offset:18432
v_add_f32 v16, v16, v4
v_mfma_f32_16x16x32_bf16 v[84:87], a[136:139], a[40:43], v[84:87]
buffer_load_dwordx4 v10, s[8:11], s20 offen offset:1024 sc1 lds
v_mfma_f32_16x16x32_bf16 v[84:87], a[140:143], a[44:47], v[84:87]
ds_read_b128 a[88:91], v13 offset:3072
v_add_f32 v16, v16, v5
v_mfma_f32_16x16x32_bf16 v[84:87], a[144:147], a[48:51], v[84:87]
v_exp_f32 v7, v61
v_mfma_f32_16x16x32_bf16 v[84:87], a[148:151], a[52:55], v[84:87]
ds_read_b128 a[92:95], v13 offset:19456
v_cvt_pk_bf16_f32 v107, v4, v5
v_mfma_f32_16x16x32_bf16 v[84:87], a[152:155], a[56:59], v[84:87]
v_exp_f32 v8, v62
v_mfma_f32_16x16x32_bf16 v[84:87], a[156:159], a[60:63], v[84:87]
ds_read_b128 a[96:99], v13 offset:4096
ds_read_b128 a[100:103], v13 offset:20480
v_mfma_f32_16x16x32_bf16 v[88:91], a[160:163], a[0:3], v[20:23]
buffer_load_dwordx4 v10, s[8:11], s20 offen offset:2048 sc1 lds
v_mfma_f32_16x16x32_bf16 v[88:91], a[164:167], a[4:7], v[88:91]
ds_read_b128 a[104:107], v13 offset:5120
v_add_f32 v17, v17, v6
v_mfma_f32_16x16x32_bf16 v[88:91], a[168:171], a[8:11], v[88:91]
v_add_f32 v17, v17, v7
v_mfma_f32_16x16x32_bf16 v[88:91], a[172:175], a[12:15], v[88:91]
v_exp_f32 v9, v63
v_mfma_f32_16x16x32_bf16 v[88:91], a[176:179], a[16:19], v[88:91]
ds_read_b128 a[108:111], v13 offset:21504
v_cvt_pk_bf16_f32 v110, v6, v7
v_mfma_f32_16x16x32_bf16 v[88:91], a[180:183], a[20:23], v[88:91]
ds_read_b128 a[112:115], v13 offset:6144
s_nop 0
v_mfma_f32_16x16x32_bf16 v[88:91], a[184:187], a[24:27], v[88:91]
buffer_load_dwordx4 v10, s[8:11], s20 offen offset:3072 sc1 lds
v_mfma_f32_16x16x32_bf16 v[88:91], a[188:191], a[28:31], v[88:91]
ds_read_b128 a[116:119], v13 offset:22528
v_add_f32 v17, v17, v8
v_mfma_f32_16x16x32_bf16 v[92:95], a[160:163], a[32:35], v[24:27]
ds_read_b128 a[120:123], v13 offset:7168
v_add_f32 v17, v17, v9
v_mfma_f32_16x16x32_bf16 v[92:95], a[164:167], a[36:39], v[92:95]
v_cvt_pk_bf16_f32 v111, v8, v9
v_max_f32 v28, v16, v17
v_mfma_f32_16x16x32_bf16 v[92:95], a[168:171], a[40:43], v[92:95]
ds_read_b128 a[124:127], v13 offset:23552
v_cmp_nge_f32 vcc, s33, v28
v_mfma_f32_16x16x32_bf16 v[92:95], a[172:175], a[44:47], v[92:95]
v_mfma_f32_16x16x32_bf16 v[92:95], a[176:179], a[48:51], v[92:95]
v_mfma_f32_16x16x32_bf16 v[92:95], a[180:183], a[52:55], v[92:95]
v_mfma_f32_16x16x32_bf16 v[92:95], a[184:187], a[56:59], v[92:95]
v_mfma_f32_16x16x32_bf16 v[92:95], a[188:191], a[60:63], v[92:95]
s_cbranch_vccnz L_resc_13
L_resc_13_b:
s_waitcnt lgkmcnt(8)
v_mfma_f32_16x16x32_bf16 v[128:131], a[64:67], v[96:99], v[128:131]
ds_read_b128 a[128:131], v13 offset:8192
v_add_f32 v14, v14, v16
v_mfma_f32_16x16x32_bf16 v[128:131], a[68:71], v[104:107], v[128:131]
s_add_u32 m0, s23, 36864
ds_read_b128 a[132:135], v13 offset:24576
v_mfma_f32_16x16x32_bf16 v[132:135], a[64:67], v[100:103], v[132:135]
buffer_load_dwordx4 v11, s[8:11], s20 offen offset:0 sc1 lds
v_mfma_f32_16x16x32_bf16 v[132:135], a[68:71], v[108:111], v[132:135]
ds_read_b128 a[136:139], v13 offset:9216
v_add_f32 v15, v15, v17
v_mfma_f32_16x16x32_bf16 v[136:139], a[72:75], v[96:99], v[136:139]
v_exp_f32 v2, v64
v_mfma_f32_16x16x32_bf16 v[136:139], a[76:79], v[104:107], v[136:139]
v_exp_f32 v3, v65
v_mfma_f32_16x16x32_bf16 v[140:143], a[72:75], v[100:103], v[140:143]
ds_read_b128 a[140:143], v13 offset:25600
ds_read_b128 a[144:147], v13 offset:10240
v_mfma_f32_16x16x32_bf16 v[140:143], a[76:79], v[108:111], v[140:143]
v_exp_f32 v4, v66
v_mfma_f32_16x16x32_bf16 v[144:147], a[80:83], v[96:99], v[144:147]
ds_read_b128 a[148:151], v13 offset:26624
v_add_f32 v16, v2, v3
v_mfma_f32_16x16x32_bf16 v[144:147], a[84:87], v[104:107], v[144:147]
buffer_load_dwordx4 v11, s[8:11], s20 offen offset:1024 sc1 lds
v_mfma_f32_16x16x32_bf16 v[148:151], a[80:83], v[100:103], v[148:151]
ds_read_b128 a[152:155], v13 offset:11264
v_cvt_pk_bf16_f32 v112, v2, v3
v_mfma_f32_16x16x32_bf16 v[148:151], a[84:87], v[108:111], v[148:151]
v_exp_f32 v5, v67
v_mfma_f32_16x16x32_bf16 v[152:155], a[88:91], v[96:99], v[152:155]
v_exp_f32 v6, v68
v_mfma_f32_16x16x32_bf16 v[152:155], a[92:95], v[104:107], v[152:155]
ds_read_b128 a[156:159], v13 offset:27648
ds_read_b128 a[160:163], v13 offset:12288
v_mfma_f32_16x16x32_bf16 v[156:159], a[88:91], v[100:103], v[156:159]
ds_read_b128 a[164:167], v13 offset:28672
v_add_f32 v16, v16, v4
v_mfma_f32_16x16x32_bf16 v[156:159], a[92:95], v[108:111], v[156:159]
v_add_f32 v16, v16, v5
s_waitcnt lgkmcnt(10)
v_mfma_f32_16x16x32_bf16 v[160:163], a[96:99], v[96:99], v[160:163]
v_exp_f32 v7, v69
v_mfma_f32_16x16x32_bf16 v[160:163], a[100:103], v[104:107], v[160:163]
buffer_load_dwordx4 v11, s[8:11], s20 offen offset:2048 sc1 lds
v_mfma_f32_16x16x32_bf16 v[164:167], a[96:99], v[100:103], v[164:167]
ds_read_b128 a[168:171], v13 offset:13312
ds_read_b128 a[172:175], v13 offset:29696
v_mfma_f32_16x16x32_bf16 v[164:167], a[100:103], v[108:111], v[164:167]
ds_read_b128 a[176:179], v13 offset:14336
v_cvt_pk_bf16_f32 v113, v4, v5
v_mfma_f32_16x16x32_bf16 v[168:171], a[104:107], v[96:99], v[168:171]
v_exp_f32 v8, v70
v_mfma_f32_16x16x32_bf16 v[168:171], a[108:111], v[104:107], v[168:171]
ds_read_b128 a[180:183], v13 offset:30720
v_add_f32 v17, v6, v7
v_mfma_f32_16x16x32_bf16 v[172:175], a[104:107], v[100:103], v[172:175]
buffer_load_dwordx4 v11, s[8:11], s20 offen offset:3072 sc1 lds
v_mfma_f32_16x16x32_bf16 v[172:175], a[108:111], v[108:111], v[172:175]
s_add_u32 s20, s20, 32768
ds_read_b128 a[184:187], v13 offset:15360
v_mfma_f32_16x16x32_bf16 v[176:179], a[112:115], v[96:99], v[176:179]
ds_read_b128 a[188:191], v13 offset:31744
v_cvt_pk_bf16_f32 v116, v6, v7
v_mfma_f32_16x16x32_bf16 v[176:179], a[116:119], v[104:107], v[176:179]
v_exp_f32 v9, v71
v_mfma_f32_16x16x32_bf16 v[180:183], a[112:115], v[100:103], v[180:183]
v_exp_f32 v2, v72
v_mfma_f32_16x16x32_bf16 v[180:183], a[116:119], v[108:111], v[180:183]
v_add_f32 v17, v17, v8
v_mfma_f32_16x16x32_bf16 v[184:187], a[120:123], v[96:99], v[184:187]
v_add_f32 v17, v17, v9
v_mfma_f32_16x16x32_bf16 v[184:187], a[124:127], v[104:107], v[184:187]
v_exp_f32 v3, v73
v_mfma_f32_16x16x32_bf16 v[188:191], a[120:123], v[100:103], v[188:191]
v_mfma_f32_16x16x32_bf16 v[188:191], a[124:127], v[108:111], v[188:191]
s_waitcnt vmcnt(16) lgkmcnt(0)
s_barrier
v_mfma_f32_16x16x32_bf16 v[192:195], a[128:131], v[96:99], v[192:195]
ds_read_b128 a[64:67], v19 offset:0
v_cvt_pk_bf16_f32 v117, v8, v9
v_mfma_f32_16x16x32_bf16 v[192:195], a[132:135], v[104:107], v[192:195]
v_exp_f32 v4, v74
v_mfma_f32_16x16x32_bf16 v[196:199], a[128:131], v[100:103], v[196:199]
ds_read_b128 a[68:71], v19 offset:1024
s_add_u32 m0, s23, 65536
v_mfma_f32_16x16x32_bf16 v[196:199], a[132:135], v[108:111], v[196:199]
buffer_load_dwordx4 v10, s[12:15], s21 offen offset:0 sc1 lds
v_mfma_f32_16x16x32_bf16 v[200:203], a[136:139], v[96:99], v[200:203]
ds_read_b128 a[72:75], v19 offset:2048
v_add_f32 v16, v16, v2
v_mfma_f32_16x16x32_bf16 v[200:203], a[140:143], v[104:107], v[200:203]
ds_read_b128 a[76:79], v19 offset:3072
v_add_f32 v16, v16, v3
v_mfma_f32_16x16x32_bf16 v[204:207], a[136:139], v[100:103], v[204:207]
v_exp_f32 v5, v75
v_mfma_f32_16x16x32_bf16 v[204:207], a[140:143], v[108:111], v[204:207]
ds_read_b128 a[80:83], v19 offset:4096
v_cvt_pk_bf16_f32 v114, v2, v3
v_mfma_f32_16x16x32_bf16 v[208:211], a[144:147], v[96:99], v[208:211]
v_exp_f32 v6, v76
v_mfma_f32_16x16x32_bf16 v[208:211], a[148:151], v[104:107], v[208:211]
ds_read_b128 a[84:87], v19 offset:5120
v_add_f32 v16, v16, v4
v_mfma_f32_16x16x32_bf16 v[212:215], a[144:147], v[100:103], v[212:215]
buffer_load_dwordx4 v10, s[12:15], s21 offen offset:1024 sc1 lds
v_mfma_f32_16x16x32_bf16 v[212:215], a[148:151], v[108:111], v[212:215]
ds_read_b128 a[88:91], v19 offset:6144
v_add_f32 v16, v16, v5
v_mfma_f32_16x16x32_bf16 v[216:219], a[152:155], v[96:99], v[216:219]
v_exp_f32 v7, v77
v_mfma_f32_16x16x32_bf16 v[216:219], a[156:159], v[104:107], v[216:219]
ds_read_b128 a[92:95], v19 offset:7168
v_cvt_pk_bf16_f32 v115, v4, v5
v_mfma_f32_16x16x32_bf16 v[220:223], a[152:155], v[100:103], v[220:223]
v_exp_f32 v8, v78
v_mfma_f32_16x16x32_bf16 v[220:223], a[156:159], v[108:111], v[220:223]
ds_read_b128 a[96:99], v19 offset:8192
ds_read_b128 a[100:103], v19 offset:9216
v_mfma_f32_16x16x32_bf16 v[224:227], a[160:163], v[96:99], v[224:227]
buffer_load_dwordx4 v10, s[12:15], s21 offen offset:2048 sc1 lds
v_mfma_f32_16x16x32_bf16 v[224:227], a[164:167], v[104:107], v[224:227]
ds_read_b128 a[104:107], v19 offset:10240
v_add_f32 v17, v17, v6
v_mfma_f32_16x16x32_bf16 v[228:231], a[160:163], v[100:103], v[228:231]
v_add_f32 v17, v17, v7
v_mfma_f32_16x16x32_bf16 v[228:231], a[164:167], v[108:111], v[228:231]
v_exp_f32 v9, v79
v_mfma_f32_16x16x32_bf16 v[232:235], a[168:171], v[96:99], v[232:235]
ds_read_b128 a[108:111], v19 offset:11264
v_cvt_pk_bf16_f32 v118, v6, v7
v_mfma_f32_16x16x32_bf16 v[232:235], a[172:175], v[104:107], v[232:235]
ds_read_b128 a[112:115], v19 offset:12288
s_nop 0
v_mfma_f32_16x16x32_bf16 v[236:239], a[168:171], v[100:103], v[236:239]
buffer_load_dwordx4 v10, s[12:15], s21 offen offset:3072 sc1 lds
v_mfma_f32_16x16x32_bf16 v[236:239], a[172:175], v[108:111], v[236:239]
ds_read_b128 a[116:119], v19 offset:13312
v_add_f32 v17, v17, v8
v_mfma_f32_16x16x32_bf16 v[240:243], a[176:179], v[96:99], v[240:243]
ds_read_b128 a[120:123], v19 offset:14336
v_add_f32 v17, v17, v9
v_mfma_f32_16x16x32_bf16 v[240:243], a[180:183], v[104:107], v[240:243]
v_cvt_pk_bf16_f32 v119, v8, v9
v_mfma_f32_16x16x32_bf16 v[244:247], a[176:179], v[100:103], v[244:247]
ds_read_b128 a[124:127], v19 offset:15360
v_mfma_f32_16x16x32_bf16 v[244:247], a[180:183], v[108:111], v[244:247]
v_mfma_f32_16x16x32_bf16 v[248:251], a[184:187], v[96:99], v[248:251]
v_mfma_f32_16x16x32_bf16 v[248:251], a[188:191], v[104:107], v[248:251]
v_mfma_f32_16x16x32_bf16 v[252:255], a[184:187], v[100:103], v[252:255]
v_mfma_f32_16x16x32_bf16 v[252:255], a[188:191], v[108:111], v[252:255]
s_waitcnt lgkmcnt(8)
v_mfma_f32_16x16x32_bf16 v[32:35], a[64:67], a[0:3], v[20:23]
v_exp_f32 v2, v80
v_mfma_f32_16x16x32_bf16 v[32:35], a[68:71], a[4:7], v[32:35]
v_exp_f32 v3, v81
v_mfma_f32_16x16x32_bf16 v[32:35], a[72:75], a[8:11], v[32:35]
ds_read_b128 a[128:131], v19 offset:16384
s_add_u32 m0, s23, 69632
v_mfma_f32_16x16x32_bf16 v[32:35], a[76:79], a[12:15], v[32:35]
ds_read_b128 a[132:135], v19 offset:17408
v_mfma_f32_16x16x32_bf16 v[32:35], a[80:83], a[16:19], v[32:35]
buffer_load_dwordx4 v11, s[12:15], s21 offen offset:0 sc1 lds
v_mfma_f32_16x16x32_bf16 v[32:35], a[84:87], a[20:23], v[32:35]
ds_read_b128 a[136:139], v19 offset:18432
ds_read_b128 a[140:143], v19 offset:19456
v_mfma_f32_16x16x32_bf16 v[32:35], a[88:91], a[24:27], v[32:35]
v_exp_f32 v4, v82
v_mfma_f32_16x16x32_bf16 v[32:35], a[92:95], a[28:31], v[32:35]
ds_read_b128 a[144:147], v19 offset:20480
v_add_f32 v16, v16, v2
v_mfma_f32_16x16x32_bf16 v[36:39], a[64:67], a[32:35], v[24:27]
ds_read_b128 a[148:151], v19 offset:21504
v_add_f32 v16, v16, v3
v_mfma_f32_16x16x32_bf16 v[36:39], a[68:71], a[36:39], v[36:39]
v_exp_f32 v5, v83
v_mfma_f32_16x16x32_bf16 v[36:39], a[72:75], a[40:43], v[36:39]
buffer_load_dwordx4 v11, s[12:15], s21 offen offset:1024 sc1 lds
v_mfma_f32_16x16x32_bf16 v[36:39], a[76:79], a[44:47], v[36:39]
ds_read_b128 a[152:155], v19 offset:22528
ds_read_b128 a[156:159], v19 offset:23552
v_mfma_f32_16x16x32_bf16 v[36:39], a[80:83], a[48:51], v[36:39]
v_cvt_pk_bf16_f32 v120, v2, v3
v_mfma_f32_16x16x32_bf16 v[36:39], a[84:87], a[52:55], v[36:39]
v_exp_f32 v6, v84
v_mfma_f32_16x16x32_bf16 v[36:39], a[88:91], a[56:59], v[36:39]
ds_read_b128 a[160:163], v19 offset:24576
ds_read_b128 a[164:167], v19 offset:25600
v_mfma_f32_16x16x32_bf16 v[36:39], a[92:95], a[60:63], v[36:39]
v_add_f32 v16, v16, v4
s_waitcnt lgkmcnt(10)
v_mfma_f32_16x16x32_bf16 v[40:43], a[96:99], a[0:3], v[20:23]
buffer_load_dwordx4 v11, s[12:15], s21 offen offset:2048 sc1 lds
v_mfma_f32_16x16x32_bf16 v[40:43], a[100:103], a[4:7], v[40:43]
ds_read_b128 a[168:171], v19 offset:26624
ds_read_b128 a[172:175], v19 offset:27648
v_mfma_f32_16x16x32_bf16 v[40:43], a[104:107], a[8:11], v[40:43]
v_add_f32 v16, v16, v5
v_mfma_f32_16x16x32_bf16 v[40:43], a[108:111], a[12:15], v[40:43]
v_exp_f32 v7, v85
v_mfma_f32_16x16x32_bf16 v[40:43], a[112:115], a[16:19], v[40:43]
ds_read_b128 a[176:179], v19 offset:28672
v_cvt_pk_bf16_f32 v121, v4, v5
v_mfma_f32_16x16x32_bf16 v[40:43], a[116:119], a[20:23], v[40:43]
v_exp_f32 v8, v86
v_mfma_f32_16x16x32_bf16 v[40:43], a[120:123], a[24:27], v[40:43]
ds_read_b128 a[180:183], v19 offset:29696
v_add_f32 v17, v17, v6
v_mfma_f32_16x16x32_bf16 v[40:43], a[124:127], a[28:31], v[40:43]
buffer_load_dwordx4 v11, s[12:15], s21 offen offset:3072 sc1 lds
v_mfma_f32_16x16x32_bf16 v[44:47], a[96:99], a[32:35], v[24:27]
s_add_u32 s21, s21, 32768
ds_read_b128 a[184:187], v19 offset:30720
v_mfma_f32_16x16x32_bf16 v[44:47], a[100:103], a[36:39], v[44:47]
ds_read_b128 a[188:191], v19 offset:31744
v_add_f32 v17, v17, v7
v_mfma_f32_16x16x32_bf16 v[44:47], a[104:107], a[40:43], v[44:47]
v_exp_f32 v9, v87
v_mfma_f32_16x16x32_bf16 v[44:47], a[108:111], a[44:47], v[44:47]
v_cvt_pk_bf16_f32 v124, v6, v7
v_mfma_f32_16x16x32_bf16 v[44:47], a[112:115], a[48:51], v[44:47]
v_exp_f32 v2, v88
v_mfma_f32_16x16x32_bf16 v[44:47], a[116:119], a[52:55], v[44:47]
v_add_f32 v17, v17, v8
v_add_f32 v17, v17, v9
v_mfma_f32_16x16x32_bf16 v[44:47], a[120:123], a[56:59], v[44:47]
v_exp_f32 v3, v89
v_mfma_f32_16x16x32_bf16 v[44:47], a[124:127], a[60:63], v[44:47]
s_waitcnt vmcnt(16) lgkmcnt(0)
s_barrier
v_mfma_f32_16x16x32_bf16 v[48:51], a[128:131], a[0:3], v[20:23]
ds_read_b128 a[64:67], v13 offset:32768
v_cvt_pk_bf16_f32 v125, v8, v9
v_mfma_f32_16x16x32_bf16 v[48:51], a[132:135], a[4:7], v[48:51]
v_exp_f32 v4, v90
v_mfma_f32_16x16x32_bf16 v[48:51], a[136:139], a[8:11], v[48:51]
ds_read_b128 a[68:71], v13 offset:49152
s_add_u32 m0, s23, 0
v_mfma_f32_16x16x32_bf16 v[48:51], a[140:143], a[12:15], v[48:51]
buffer_load_dwordx4 v10, s[8:11], s20 offen offset:0 sc1 lds
v_mfma_f32_16x16x32_bf16 v[48:51], a[144:147], a[16:19], v[48:51]
ds_read_b128 a[72:75], v13 offset:33792
v_add_f32 v16, v16, v2
v_mfma_f32_16x16x32_bf16 v[48:51], a[148:151], a[20:23], v[48:51]
ds_read_b128 a[76:79], v13 offset:50176
v_add_f32 v16, v16, v3
v_mfma_f32_16x16x32_bf16 v[48:51], a[152:155], a[24:27], v[48:51]
v_exp_f32 v5, v91
v_mfma_f32_16x16x32_bf16 v[48:51], a[156:159], a[28:31], v[48:51]
ds_read_b128 a[80:83], v13 offset:34816
v_cvt_pk_bf16_f32 v122, v2, v3
v_mfma_f32_16x16x32_bf16 v[52:55], a[128:131], a[32:35], v[24:27]
v_exp_f32 v6, v92
v_mfma_f32_16x16x32_bf16 v[52:55], a[132:135], a[36:39], v[52:55]
ds_read_b128 a[84:87], v13 offset:51200
v_add_f32 v16, v16, v4
v_mfma_f32_16x16x32_bf16 v[52:55], a[136:139], a[40:43], v[52:55]
buffer_load_dwordx4 v10, s[8:11], s20 offen offset:1024 sc1 lds
v_mfma_f32_16x16x32_bf16 v[52:55], a[140:143], a[44:47], v[52:55]
ds_read_b128 a[88:91], v13 offset:35840
v_add_f32 v16, v16, v5
v_mfma_f32_16x16x32_bf16 v[52:55], a[144:147], a[48:51], v[52:55]
v_exp_f32 v7, v93
v_mfma_f32_16x16x32_bf16 v[52:55], a[148:151], a[52:55], v[52:55]
ds_read_b128 a[92:95], v13 offset:52224
v_cvt_pk_bf16_f32 v123, v4, v5
v_mfma_f32_16x16x32_bf16 v[52:55], a[152:155], a[56:59], v[52:55]
v_exp_f32 v8, v94
v_mfma_f32_16x16x32_bf16 v[52:55], a[156:159], a[60:63], v[52:55]
ds_read_b128 a[96:99], v13 offset:36864
ds_read_b128 a[100:103], v13 offset:53248
v_mfma_f32_16x16x32_bf16 v[56:59], a[160:163], a[0:3], v[20:23]
buffer_load_dwordx4 v10, s[8:11], s20 offen offset:2048 sc1 lds
v_mfma_f32_16x16x32_bf16 v[56:59], a[164:167], a[4:7], v[56:59]
ds_read_b128 a[104:107], v13 offset:37888
v_add_f32 v17, v17, v6
v_mfma_f32_16x16x32_bf16 v[56:59], a[168:171], a[8:11], v[56:59]
v_add_f32 v17, v17, v7
v_mfma_f32_16x16x32_bf16 v[56:59], a[172:175], a[12:15], v[56:59]
v_exp_f32 v9, v95
v_mfma_f32_16x16x32_bf16 v[56:59], a[176:179], a[16:19], v[56:59]
ds_read_b128 a[108:111], v13 offset:54272
v_cvt_pk_bf16_f32 v126, v6, v7
v_mfma_f32_16x16x32_bf16 v[56:59], a[180:183], a[20:23], v[56:59]
ds_read_b128 a[112:115], v13 offset:38912
s_nop 0
v_mfma_f32_16x16x32_bf16 v[56:59], a[184:187], a[24:27], v[56:59]
buffer_load_dwordx4 v10, s[8:11], s20 offen offset:3072 sc1 lds
v_mfma_f32_16x16x32_bf16 v[56:59], a[188:191], a[28:31], v[56:59]
ds_read_b128 a[116:119], v13 offset:55296
v_add_f32 v17, v17, v8
v_mfma_f32_16x16x32_bf16 v[60:63], a[160:163], a[32:35], v[24:27]
ds_read_b128 a[120:123], v13 offset:39936
v_add_f32 v17, v17, v9
v_mfma_f32_16x16x32_bf16 v[60:63], a[164:167], a[36:39], v[60:63]
v_cvt_pk_bf16_f32 v127, v8, v9
v_max_f32 v28, v16, v17
v_mfma_f32_16x16x32_bf16 v[60:63], a[168:171], a[40:43], v[60:63]
ds_read_b128 a[124:127], v13 offset:56320
v_cmp_nge_f32 vcc, s33, v28
v_mfma_f32_16x16x32_bf16 v[60:63], a[172:175], a[44:47], v[60:63]
v_mfma_f32_16x16x32_bf16 v[60:63], a[176:179], a[48:51], v[60:63]
v_mfma_f32_16x16x32_bf16 v[60:63], a[180:183], a[52:55], v[60:63]
v_mfma_f32_16x16x32_bf16 v[60:63], a[184:187], a[56:59], v[60:63]
s_cmp_eq_u32 s29, s27
v_mfma_f32_16x16x32_bf16 v[60:63], a[188:191], a[60:63], v[60:63]
s_cbranch_vccnz L_resc_14
L_resc_14_b:
s_cbranch_scc1 L_mask_15
L_mask_15_b:
s_waitcnt lgkmcnt(8)
v_mfma_f32_16x16x32_bf16 v[128:131], a[64:67], v[112:115], v[128:131]
ds_read_b128 a[128:131], v13 offset:40960
v_add_f32 v14, v14, v16
v_mfma_f32_16x16x32_bf16 v[128:131], a[68:71], v[120:123], v[128:131]
s_add_u32 m0, s23, 4096
ds_read_b128 a[132:135], v13 offset:57344
v_mfma_f32_16x16x32_bf16 v[132:135], a[64:67], v[116:119], v[132:135]
buffer_load_dwordx4 v11, s[8:11], s20 offen offset:0 sc1 lds
v_mfma_f32_16x16x32_bf16 v[132:135], a[68:71], v[124:127], v[132:135]
ds_read_b128 a[136:139], v13 offset:41984
v_add_f32 v15, v15, v17
v_mfma_f32_16x16x32_bf16 v[136:139], a[72:75], v[112:115], v[136:139]
v_exp_f32 v2, v32
v_mfma_f32_16x16x32_bf16 v[136:139], a[76:79], v[120:123], v[136:139]
v_exp_f32 v3, v33
v_mfma_f32_16x16x32_bf16 v[140:143], a[72:75], v[116:119], v[140:143]
ds_read_b128 a[140:143], v13 offset:58368
ds_read_b128 a[144:147], v13 offset:43008
v_mfma_f32_16x16x32_bf16 v[140:143], a[76:79], v[124:127], v[140:143]
v_exp_f32 v4, v34
v_mfma_f32_16x16x32_bf16 v[144:147], a[80:83], v[112:115], v[144:147]
ds_read_b128 a[148:151], v13 offset:59392
v_add_f32 v16, v2, v3
v_mfma_f32_16x16x32_bf16 v[144:147], a[84:87], v[120:123], v[144:147]
buffer_load_dwordx4 v11, s[8:11], s20 offen offset:1024 sc1 lds
v_mfma_f32_16x16x32_bf16 v[148:151], a[80:83], v[116:119], v[148:151]
ds_read_b128 a[152:155], v13 offset:44032
v_cvt_pk_bf16_f32 v96, v2, v3
v_mfma_f32_16x16x32_bf16 v[148:151], a[84:87], v[124:127], v[148:151]
v_exp_f32 v5, v35
v_mfma_f32_16x16x32_bf16 v[152:155], a[88:91], v[112:115], v[152:155]
v_exp_f32 v6, v36
v_mfma_f32_16x16x32_bf16 v[152:155], a[92:95], v[120:123], v[152:155]
ds_read_b128 a[156:159], v13 offset:60416
ds_read_b128 a[160:163], v13 offset:45056
v_mfma_f32_16x16x32_bf16 v[156:159], a[88:91], v[116:119], v[156:159]
ds_read_b128 a[164:167], v13 offset:61440
v_add_f32 v16, v16, v4
v_mfma_f32_16x16x32_bf16 v[156:159], a[92:95], v[124:127], v[156:159]
v_add_f32 v16, v16, v5
s_waitcnt lgkmcnt(10)
v_mfma_f32_16x16x32_bf16 v[160:163], a[96:99], v[112:115], v[160:163]
v_exp_f32 v7, v37
v_mfma_f32_16x16x32_bf16 v[160:163], a[100:103], v[120:123], v[160:163]
buffer_load_dwordx4 v11, s[8:11], s20 offen offset:2048 sc1 lds
v_mfma_f32_16x16x32_bf16 v[164:167], a[96:99], v[116:119], v[164:167]
ds_read_b128 a[168:171], v13 offset:46080
ds_read_b128 a[172:175], v13 offset:62464
v_mfma_f32_16x16x32_bf16 v[164:167], a[100:103], v[124:127], v[164:167]
ds_read_b128 a[176:179], v13 offset:47104
v_cvt_pk_bf16_f32 v97, v4, v5
v_mfma_f32_16x16x32_bf16 v[168:171], a[104:107], v[112:115], v[168:171]
v_exp_f32 v8, v38
v_mfma_f32_16x16x32_bf16 v[168:171], a[108:111], v[120:123], v[168:171]
ds_read_b128 a[180:183], v13 offset:63488
v_add_f32 v17, v6, v7
v_mfma_f32_16x16x32_bf16 v[172:175], a[104:107], v[116:119], v[172:175]
buffer_load_dwordx4 v11, s[8:11], s20 offen offset:3072 sc1 lds
v_mfma_f32_16x16x32_bf16 v[172:175], a[108:111], v[124:127], v[172:175]
s_add_u32 s20, s20, 32768
ds_read_b128 a[184:187], v13 offset:48128
v_mfma_f32_16x16x32_bf16 v[176:179], a[112:115], v[112:115], v[176:179]
ds_read_b128 a[188:191], v13 offset:64512
v_cvt_pk_bf16_f32 v100, v6, v7
v_mfma_f32_16x16x32_bf16 v[176:179], a[116:119], v[120:123], v[176:179]
v_exp_f32 v9, v39
v_mfma_f32_16x16x32_bf16 v[180:183], a[112:115], v[116:119], v[180:183]
v_exp_f32 v2, v40
v_mfma_f32_16x16x32_bf16 v[180:183], a[116:119], v[124:127], v[180:183]
v_add_f32 v17, v17, v8
v_mfma_f32_16x16x32_bf16 v[184:187], a[120:123], v[112:115], v[184:187]
v_add_f32 v17, v17, v9
v_mfma_f32_16x16x32_bf16 v[184:187], a[124:127], v[120:123], v[184:187]
v_exp_f32 v3, v41
v_mfma_f32_16x16x32_bf16 v[188:191], a[120:123], v[116:119], v[188:191]
v_mfma_f32_16x16x32_bf16 v[188:191], a[124:127], v[124:127], v[188:191]
s_waitcnt vmcnt(16) lgkmcnt(0)
s_barrier
v_mfma_f32_16x16x32_bf16 v[192:195], a[128:131], v[112:115], v[192:195]
ds_read_b128 a[64:67], v19 offset:32768
v_cvt_pk_bf16_f32 v101, v8, v9
v_mfma_f32_16x16x32_bf16 v[192:195], a[132:135], v[120:123], v[192:195]
v_exp_f32 v4, v42
v_mfma_f32_16x16x32_bf16 v[196:199], a[128:131], v[116:119], v[196:199]
ds_read_b128 a[68:71], v19 offset:33792
s_add_u32 m0, s23, 98304
v_mfma_f32_16x16x32_bf16 v[196:199], a[132:135], v[124:127], v[196:199]
buffer_load_dwordx4 v10, s[12:15], s21 offen offset:0 sc1 lds
v_mfma_f32_16x16x32_bf16 v[200:203], a[136:139], v[112:115], v[200:203]
ds_read_b128 a[72:75], v19 offset:34816
v_add_f32 v16, v16, v2
v_mfma_f32_16x16x32_bf16 v[200:203], a[140:143], v[120:123], v[200:203]
ds_read_b128 a[76:79], v19 offset:35840
v_add_f32 v16, v16, v3
v_mfma_f32_16x16x32_bf16 v[204:207], a[136:139], v[116:119], v[204:207]
v_exp_f32 v5, v43
v_mfma_f32_16x16x32_bf16 v[204:207], a[140:143], v[124:127], v[204:207]
ds_read_b128 a[80:83], v19 offset:36864
v_cvt_pk_bf16_f32 v98, v2, v3
v_mfma_f32_16x16x32_bf16 v[208:211], a[144:147], v[112:115], v[208:211]
v_exp_f32 v6, v44
v_mfma_f32_16x16x32_bf16 v[208:211], a[148:151], v[120:123], v[208:211]
ds_read_b128 a[84:87], v19 offset:37888
v_add_f32 v16, v16, v4
v_mfma_f32_16x16x32_bf16 v[212:215], a[144:147], v[116:119], v[212:215]
buffer_load_dwordx4 v10, s[12:15], s21 offen offset:1024 sc1 lds
v_mfma_f32_16x16x32_bf16 v[212:215], a[148:151], v[124:127], v[212:215]
ds_read_b128 a[88:91], v19 offset:38912
v_add_f32 v16, v16, v5
v_mfma_f32_16x16x32_bf16 v[216:219], a[152:155], v[112:115], v[216:219]
v_exp_f32 v7, v45
v_mfma_f32_16x16x32_bf16 v[216:219], a[156:159], v[120:123], v[216:219]
ds_read_b128 a[92:95], v19 offset:39936
v_cvt_pk_bf16_f32 v99, v4, v5
v_mfma_f32_16x16x32_bf16 v[220:223], a[152:155], v[116:119], v[220:223]
v_exp_f32 v8, v46
v_mfma_f32_16x16x32_bf16 v[220:223], a[156:159], v[124:127], v[220:223]
ds_read_b128 a[96:99], v19 offset:40960
ds_read_b128 a[100:103], v19 offset:41984
v_mfma_f32_16x16x32_bf16 v[224:227], a[160:163], v[112:115], v[224:227]
buffer_load_dwordx4 v10, s[12:15], s21 offen offset:2048 sc1 lds
v_mfma_f32_16x16x32_bf16 v[224:227], a[164:167], v[120:123], v[224:227]
ds_read_b128 a[104:107], v19 offset:43008
v_add_f32 v17, v17, v6
v_mfma_f32_16x16x32_bf16 v[228:231], a[160:163], v[116:119], v[228:231]
v_add_f32 v17, v17, v7
v_mfma_f32_16x16x32_bf16 v[228:231], a[164:167], v[124:127], v[228:231]
v_exp_f32 v9, v47
v_mfma_f32_16x16x32_bf16 v[232:235], a[168:171], v[112:115], v[232:235]
ds_read_b128 a[108:111], v19 offset:44032
v_cvt_pk_bf16_f32 v102, v6, v7
v_mfma_f32_16x16x32_bf16 v[232:235], a[172:175], v[120:123], v[232:235]
ds_read_b128 a[112:115], v19 offset:45056
s_nop 0
v_mfma_f32_16x16x32_bf16 v[236:239], a[168:171], v[116:119], v[236:239]
buffer_load_dwordx4 v10, s[12:15], s21 offen offset:3072 sc1 lds
v_mfma_f32_16x16x32_bf16 v[236:239], a[172:175], v[124:127], v[236:239]
ds_read_b128 a[116:119], v19 offset:46080
v_add_f32 v17, v17, v8
v_mfma_f32_16x16x32_bf16 v[240:243], a[176:179], v[112:115], v[240:243]
ds_read_b128 a[120:123], v19 offset:47104
v_add_f32 v17, v17, v9
v_mfma_f32_16x16x32_bf16 v[240:243], a[180:183], v[120:123], v[240:243]
v_cvt_pk_bf16_f32 v103, v8, v9
v_mfma_f32_16x16x32_bf16 v[244:247], a[176:179], v[116:119], v[244:247]
ds_read_b128 a[124:127], v19 offset:48128
v_mfma_f32_16x16x32_bf16 v[244:247], a[180:183], v[124:127], v[244:247]
v_mfma_f32_16x16x32_bf16 v[248:251], a[184:187], v[112:115], v[248:251]
v_mfma_f32_16x16x32_bf16 v[248:251], a[188:191], v[120:123], v[248:251]
s_sub_u32 s29, s29, 1
v_mfma_f32_16x16x32_bf16 v[252:255], a[184:187], v[116:119], v[252:255]
s_cmp_lg_u32 s29, 0
v_mfma_f32_16x16x32_bf16 v[252:255], a[188:191], v[124:127], v[252:255]
s_cbranch_scc1 L_k2_loop
L_k2_tail:
s_cmp_eq_u32 s31, 1
s_cbranch_scc0 L_k2_fin
s_sub_u32 s48, 15, s25
s_lshl_b32 s10, s48, 16
s_add_u32 s10, s10, 65536
s_mov_b32 s20, 0
s_add_u32 s60, s4, s50
s_addc_u32 s61, s5, 0
s_mov_b32 s62, 32768
s_waitcnt lgkmcnt(8)
v_mfma_f32_16x16x32_bf16 v[64:67], a[64:67], a[0:3], v[20:23]
v_exp_f32 v2, v48
v_mfma_f32_16x16x32_bf16 v[64:67], a[68:71], a[4:7], v[64:67]
v_exp_f32 v3, v49
v_mfma_f32_16x16x32_bf16 v[64:67], a[72:75], a[8:11], v[64:67]
ds_read_b128 a[128:131], v19 offset:49152
s_add_u32 m0, s23, 102400
v_mfma_f32_16x16x32_bf16 v[64:67], a[76:79], a[12:15], v[64:67]
ds_read_b128 a[132:135], v19 offset:50176
v_mfma_f32_16x16x32_bf16 v[64:67], a[80:83], a[16:19], v[64:67]
buffer_load_dwordx4 v11, s[12:15], s21 offen offset:0 sc1 lds
v_mfma_f32_16x16x32_bf16 v[64:67], a[84:87], a[20:23], v[64:67]
ds_read_b128 a[136:139], v19 offset:51200
ds_read_b128 a[140:143], v19 offset:52224
v_mfma_f32_16x16x32_bf16 v[64:67], a[88:91], a[24:27], v[64:67]
v_exp_f32 v4, v50
v_mfma_f32_16x16x32_bf16 v[64:67], a[92:95], a[28:31], v[64:67]
ds_read_b128 a[144:147], v19 offset:53248
v_add_f32 v16, v16, v2
v_mfma_f32_16x16x32_bf16 v[68:71], a[64:67], a[32:35], v[24:27]
ds_read_b128 a[148:151], v19 offset:54272
v_add_f32 v16, v16, v3
v_mfma_f32_16x16x32_bf16 v[68:71], a[68:71], a[36:39], v[68:71]
v_exp_f32 v5, v51
v_mfma_f32_16x16x32_bf16 v[68:71], a[72:75], a[40:43], v[68:71]
buffer_load_dwordx4 v11, s[12:15], s21 offen offset:1024 sc1 lds
v_mfma_f32_16x16x32_bf16 v[68:71], a[76:79], a[44:47], v[68:71]
ds_read_b128 a[152:155], v19 offset:55296
ds_read_b128 a[156:159], v19 offset:56320
v_mfma_f32_16x16x32_bf16 v[68:71], a[80:83], a[48:51], v[68:71]
v_cvt_pk_bf16_f32 v104, v2, v3
v_mfma_f32_16x16x32_bf16 v[68:71], a[84:87], a[52:55], v[68:71]
v_exp_f32 v6, v52
v_mfma_f32_16x16x32_bf16 v[68:71], a[88:91], a[56:59], v[68:71]
ds_read_b128 a[160:163], v19 offset:57344
ds_read_b128 a[164:167], v19 offset:58368
v_mfma_f32_16x16x32_bf16 v[68:71], a[92:95], a[60:63], v[68:71]
v_add_f32 v16, v16, v4
s_waitcnt lgkmcnt(10)
v_mfma_f32_16x16x32_bf16 v[72:75], a[96:99], a[0:3], v[20:23]
buffer_load_dwordx4 v11, s[12:15], s21 offen offset:2048 sc1 lds
v_mfma_f32_16x16x32_bf16 v[72:75], a[100:103], a[4:7], v[72:75]
ds_read_b128 a[168:171], v19 offset:59392
ds_read_b128 a[172:175], v19 offset:60416
v_mfma_f32_16x16x32_bf16 v[72:75], a[104:107], a[8:11], v[72:75]
v_add_f32 v16, v16, v5
v_mfma_f32_16x16x32_bf16 v[72:75], a[108:111], a[12:15], v[72:75]
v_exp_f32 v7, v53
v_mfma_f32_16x16x32_bf16 v[72:75], a[112:115], a[16:19], v[72:75]
ds_read_b128 a[176:179], v19 offset:61440
v_cvt_pk_bf16_f32 v105, v4, v5
v_mfma_f32_16x16x32_bf16 v[72:75], a[116:119], a[20:23], v[72:75]
v_exp_f32 v8, v54
v_mfma_f32_16x16x32_bf16 v[72:75], a[120:123], a[24:27], v[72:75]
ds_read_b128 a[180:183], v19 offset:62464
v_add_f32 v17, v17, v6
v_mfma_f32_16x16x32_bf16 v[72:75], a[124:127], a[28:31], v[72:75]
buffer_load_dwordx4 v11, s[12:15], s21 offen offset:3072 sc1 lds
v_mfma_f32_16x16x32_bf16 v[76:79], a[96:99], a[32:35], v[24:27]
s_add_u32 s21, s21, 32768
ds_read_b128 a[184:187], v19 offset:63488
v_mfma_f32_16x16x32_bf16 v[76:79], a[100:103], a[36:39], v[76:79]
ds_read_b128 a[188:191], v19 offset:64512
v_add_f32 v17, v17, v7
v_mfma_f32_16x16x32_bf16 v[76:79], a[104:107], a[40:43], v[76:79]
v_exp_f32 v9, v55
v_mfma_f32_16x16x32_bf16 v[76:79], a[108:111], a[44:47], v[76:79]
v_cvt_pk_bf16_f32 v108, v6, v7
v_mfma_f32_16x16x32_bf16 v[76:79], a[112:115], a[48:51], v[76:79]
v_exp_f32 v2, v56
v_mfma_f32_16x16x32_bf16 v[76:79], a[116:119], a[52:55], v[76:79]
v_add_f32 v17, v17, v8
v_add_f32 v17, v17, v9
v_mfma_f32_16x16x32_bf16 v[76:79], a[120:123], a[56:59], v[76:79]
v_exp_f32 v3, v57
v_mfma_f32_16x16x32_bf16 v[76:79], a[124:127], a[60:63], v[76:79]
s_waitcnt vmcnt(16) lgkmcnt(0)
s_barrier
v_mfma_f32_16x16x32_bf16 v[80:83], a[128:131], a[0:3], v[20:23]
ds_read_b128 a[64:67], v13 offset:0
v_cvt_pk_bf16_f32 v109, v8, v9
v_mfma_f32_16x16x32_bf16 v[80:83], a[132:135], a[4:7], v[80:83]
v_exp_f32 v4, v58
v_mfma_f32_16x16x32_bf16 v[80:83], a[136:139], a[8:11], v[80:83]
ds_read_b128 a[68:71], v13 offset:16384
s_add_u32 m0, s23, 0
v_mfma_f32_16x16x32_bf16 v[80:83], a[140:143], a[12:15], v[80:83]
buffer_load_dwordx4 v10, s[8:11], s20 offen offset:0 sc1 lds
v_mfma_f32_16x16x32_bf16 v[80:83], a[144:147], a[16:19], v[80:83]
ds_read_b128 a[72:75], v13 offset:1024
v_add_f32 v16, v16, v2
v_mfma_f32_16x16x32_bf16 v[80:83], a[148:151], a[20:23], v[80:83]
ds_read_b128 a[76:79], v13 offset:17408
v_add_f32 v16, v16, v3
v_mfma_f32_16x16x32_bf16 v[80:83], a[152:155], a[24:27], v[80:83]
v_exp_f32 v5, v59
v_mfma_f32_16x16x32_bf16 v[80:83], a[156:159], a[28:31], v[80:83]
buffer_load_dwordx4 v10, s[8:11], s20 offen offset:1024 sc1 lds
v_mfma_f32_16x16x32_bf16 v[84:87], a[128:131], a[32:35], v[24:27]
ds_read_b128 a[80:83], v13 offset:2048
ds_read_b128 a[84:87], v13 offset:18432
v_mfma_f32_16x16x32_bf16 v[84:87], a[132:135], a[36:39], v[84:87]
buffer_load_dwordx4 v10, s[8:11], s20 offen offset:2048 sc1 lds
v_mfma_f32_16x16x32_bf16 v[84:87], a[136:139], a[40:43], v[84:87]
ds_read_b128 a[88:91], v13 offset:3072
v_cvt_pk_bf16_f32 v106, v2, v3
v_mfma_f32_16x16x32_bf16 v[84:87], a[140:143], a[44:47], v[84:87]
v_exp_f32 v6, v60
v_mfma_f32_16x16x32_bf16 v[84:87], a[144:147], a[48:51], v[84:87]
buffer_load_dwordx4 v10, s[8:11], s20 offen offset:3072 sc1 lds
v_mfma_f32_16x16x32_bf16 v[84:87], a[148:151], a[52:55], v[84:87]
ds_read_b128 a[92:95], v13 offset:19456
v_add_f32 v16, v16, v4
v_mfma_f32_16x16x32_bf16 v[84:87], a[152:155], a[56:59], v[84:87]
s_add_u32 m0, s23, 4096
ds_read_b128 a[96:99], v13 offset:4096
v_mfma_f32_16x16x32_bf16 v[84:87], a[156:159], a[60:63], v[84:87]
ds_read_b128 a[100:103], v13 offset:20480
v_add_f32 v16, v16, v5
v_mfma_f32_16x16x32_bf16 v[88:91], a[160:163], a[0:3], v[20:23]
v_exp_f32 v7, v61
v_mfma_f32_16x16x32_bf16 v[88:91], a[164:167], a[4:7], v[88:91]
buffer_load_dwordx4 v11, s[8:11], s20 offen offset:0 sc1 lds
v_mfma_f32_16x16x32_bf16 v[88:91], a[168:171], a[8:11], v[88:91]
ds_read_b128 a[104:107], v13 offset:5120
v_cvt_pk_bf16_f32 v107, v4, v5
v_mfma_f32_16x16x32_bf16 v[88:91], a[172:175], a[12:15], v[88:91]
v_exp_f32 v8, v62
v_mfma_f32_16x16x32_bf16 v[88:91], a[176:179], a[16:19], v[88:91]
buffer_load_dwordx4 v11, s[8:11], s20 offen offset:1024 sc1 lds
v_mfma_f32_16x16x32_bf16 v[88:91], a[180:183], a[20:23], v[88:91]
ds_read_b128 a[108:111], v13 offset:21504
ds_read_b128 a[112:115], v13 offset:6144
v_mfma_f32_16x16x32_bf16 v[88:91], a[184:187], a[24:27], v[88:91]
buffer_load_dwordx4 v11, s[8:11], s20 offen offset:2048 sc1 lds
v_mfma_f32_16x16x32_bf16 v[88:91], a[188:191], a[28:31], v[88:91]
ds_read_b128 a[116:119], v13 offset:22528
v_add_f32 v17, v17, v6
v_mfma_f32_16x16x32_bf16 v[92:95], a[160:163], a[32:35], v[24:27]
ds_read_b128 a[120:123], v13 offset:7168
v_add_f32 v17, v17, v7
v_mfma_f32_16x16x32_bf16 v[92:95], a[164:167], a[36:39], v[92:95]
v_exp_f32 v9, v63
v_mfma_f32_16x16x32_bf16 v[92:95], a[168:171], a[40:43], v[92:95]
buffer_load_dwordx4 v11, s[8:11], s20 offen offset:3072 sc1 lds
v_mfma_f32_16x16x32_bf16 v[92:95], a[172:175], a[44:47], v[92:95]
s_add_u32 s20, s20, 32768
ds_read_b128 a[124:127], v13 offset:23552
v_mfma_f32_16x16x32_bf16 v[92:95], a[176:179], a[48:51], v[92:95]
v_cvt_pk_bf16_f32 v110, v6, v7
s_nop 0
v_mfma_f32_16x16x32_bf16 v[92:95], a[180:183], a[52:55], v[92:95]
v_add_f32 v17, v17, v8
v_add_f32 v17, v17, v9
v_mfma_f32_16x16x32_bf16 v[92:95], a[184:187], a[56:59], v[92:95]
v_cvt_pk_bf16_f32 v111, v8, v9
v_max_f32 v28, v16, v17
v_mfma_f32_16x16x32_bf16 v[92:95], a[188:191], a[60:63], v[92:95]
v_cmp_nge_f32 vcc, s33, v28
s_cbranch_vccnz L_resc_17
L_resc_17_b:
s_cmp_eq_u32 s27, 1
s_cbranch_scc1 L_mask_18
L_mask_18_b:
s_mov_b32 s14, s10
s_mov_b32 s21, 0
s_waitcnt lgkmcnt(8)
v_mfma_f32_16x16x32_bf16 v[128:131], a[64:67], v[96:99], v[128:131]
ds_read_b128 a[128:131], v13 offset:8192
v_add_f32 v14, v14, v16
v_mfma_f32_16x16x32_bf16 v[128:131], a[68:71], v[104:107], v[128:131]
s_add_u32 m0, s23, 32768
ds_read_b128 a[132:135], v13 offset:24576
v_mfma_f32_16x16x32_bf16 v[132:135], a[64:67], v[100:103], v[132:135]
buffer_load_dwordx4 v10, s[8:11], s20 offen offset:0 sc1 lds
v_mfma_f32_16x16x32_bf16 v[132:135], a[68:71], v[108:111], v[132:135]
ds_read_b128 a[136:139], v13 offset:9216
v_add_f32 v15, v15, v17
v_mfma_f32_16x16x32_bf16 v[136:139], a[72:75], v[96:99], v[136:139]
v_exp_f32 v2, v64
v_mfma_f32_16x16x32_bf16 v[136:139], a[76:79], v[104:107], v[136:139]
v_exp_f32 v3, v65
v_mfma_f32_16x16x32_bf16 v[140:143], a[72:75], v[100:103], v[140:143]
ds_read_b128 a[140:143], v13 offset:25600
v_mfma_f32_16x16x32_bf16 v[140:143], a[76:79], v[108:111], v[140:143]
buffer_load_dwordx4 v10, s[8:11], s20 offen offset:1024 sc1 lds
v_mfma_f32_16x16x32_bf16 v[144:147], a[80:83], v[96:99], v[144:147]
ds_read_b128 a[144:147], v13 offset:10240
ds_read_b128 a[148:151], v13 offset:26624
v_mfma_f32_16x16x32_bf16 v[144:147], a[84:87], v[104:107], v[144:147]
v_exp_f32 v4, v66
v_mfma_f32_16x16x32_bf16 v[148:151], a[80:83], v[100:103], v[148:151]
buffer_load_dwordx4 v10, s[8:11], s20 offen offset:2048 sc1 lds
v_mfma_f32_16x16x32_bf16 v[148:151], a[84:87], v[108:111], v[148:151]
ds_read_b128 a[152:155], v13 offset:11264
ds_read_b128 a[156:159], v13 offset:27648
v_mfma_f32_16x16x32_bf16 v[152:155], a[88:91], v[96:99], v[152:155]
buffer_load_dwordx4 v10, s[8:11], s20 offen offset:3072 sc1 lds
v_mfma_f32_16x16x32_bf16 v[152:155], a[92:95], v[104:107], v[152:155]
ds_read_b128 a[160:163], v13 offset:12288
s_add_u32 m0, s23, 36864
v_mfma_f32_16x16x32_bf16 v[156:159], a[88:91], v[100:103], v[156:159]
ds_read_b128 a[164:167], v13 offset:28672
v_add_f32 v16, v2, v3
v_mfma_f32_16x16x32_bf16 v[156:159], a[92:95], v[108:111], v[156:159]
v_cvt_pk_bf16_f32 v112, v2, v3
s_waitcnt lgkmcnt(10)
v_mfma_f32_16x16x32_bf16 v[160:163], a[96:99], v[96:99], v[160:163]
v_exp_f32 v5, v67
v_mfma_f32_16x16x32_bf16 v[160:163], a[100:103], v[104:107], v[160:163]
buffer_load_dwordx4 v11, s[8:11], s20 offen offset:0 sc1 lds
v_mfma_f32_16x16x32_bf16 v[164:167], a[96:99], v[100:103], v[164:167]
ds_read_b128 a[168:171], v13 offset:13312
ds_read_b128 a[172:175], v13 offset:29696
v_mfma_f32_16x16x32_bf16 v[164:167], a[100:103], v[108:111], v[164:167]
v_exp_f32 v6, v68
v_mfma_f32_16x16x32_bf16 v[168:171], a[104:107], v[96:99], v[168:171]
buffer_load_dwordx4 v11, s[8:11], s20 offen offset:1024 sc1 lds
v_mfma_f32_16x16x32_bf16 v[168:171], a[108:111], v[104:107], v[168:171]
ds_read_b128 a[176:179], v13 offset:14336
ds_read_b128 a[180:183], v13 offset:30720
v_mfma_f32_16x16x32_bf16 v[172:175], a[104:107], v[100:103], v[172:175]
buffer_load_dwordx4 v11, s[8:11], s20 offen offset:2048 sc1 lds
v_mfma_f32_16x16x32_bf16 v[172:175], a[108:111], v[108:111], v[172:175]
ds_read_b128 a[184:187], v13 offset:15360
v_add_f32 v16, v16, v4
v_mfma_f32_16x16x32_bf16 v[176:179], a[112:115], v[96:99], v[176:179]
ds_read_b128 a[188:191], v13 offset:31744
v_add_f32 v16, v16, v5
v_mfma_f32_16x16x32_bf16 v[176:179], a[116:119], v[104:107], v[176:179]
v_exp_f32 v7, v69
v_mfma_f32_16x16x32_bf16 v[180:183], a[112:115], v[100:103], v[180:183]
buffer_load_dwordx4 v11, s[8:11], s20 offen offset:3072 sc1 lds
v_mfma_f32_16x16x32_bf16 v[180:183], a[116:119], v[108:111], v[180:183]
s_add_u32 s20, s20, 32768
v_cvt_pk_bf16_f32 v113, v4, v5
v_mfma_f32_16x16x32_bf16 v[184:187], a[120:123], v[96:99], v[184:187]
v_exp_f32 v8, v70
v_mfma_f32_16x16x32_bf16 v[184:187], a[124:127], v[104:107], v[184:187]
v_add_f32 v17, v6, v7
v_cvt_pk_bf16_f32 v116, v6, v7
v_mfma_f32_16x16x32_bf16 v[188:191], a[120:123], v[100:103], v[188:191]
v_exp_f32 v9, v71
v_mfma_f32_16x16x32_bf16 v[188:191], a[124:127], v[108:111], v[188:191]
s_waitcnt vmcnt(16) lgkmcnt(0)
s_barrier
v_mfma_f32_16x16x32_bf16 v[192:195], a[128:131], v[96:99], v[192:195]
v_exp_f32 v2, v72
v_mfma_f32_16x16x32_bf16 v[192:195], a[132:135], v[104:107], v[192:195]
ds_read_b128 a[64:67], v13 offset:32768
ds_read_b128 a[68:71], v13 offset:49152
v_mfma_f32_16x16x32_bf16 v[196:199], a[128:131], v[100:103], v[196:199]
s_add_u32 m0, s23, 65536
v_add_f32 v17, v17, v8
v_mfma_f32_16x16x32_bf16 v[196:199], a[132:135], v[108:111], v[196:199]
buffer_load_dwordx4 v10, s[12:15], s21 offen offset:0 sc1 lds
v_mfma_f32_16x16x32_bf16 v[200:203], a[136:139], v[96:99], v[200:203]
ds_read_b128 a[72:75], v13 offset:33792
v_add_f32 v17, v17, v9
v_mfma_f32_16x16x32_bf16 v[200:203], a[140:143], v[104:107], v[200:203]
v_exp_f32 v3, v73
v_mfma_f32_16x16x32_bf16 v[204:207], a[136:139], v[100:103], v[204:207]
ds_read_b128 a[76:79], v13 offset:50176
v_cvt_pk_bf16_f32 v117, v8, v9
v_mfma_f32_16x16x32_bf16 v[204:207], a[140:143], v[108:111], v[204:207]
v_exp_f32 v4, v74
v_mfma_f32_16x16x32_bf16 v[208:211], a[144:147], v[96:99], v[208:211]
buffer_load_dwordx4 v10, s[12:15], s21 offen offset:1024 sc1 lds
v_mfma_f32_16x16x32_bf16 v[208:211], a[148:151], v[104:107], v[208:211]
ds_read_b128 a[80:83], v13 offset:34816
ds_read_b128 a[84:87], v13 offset:51200
v_mfma_f32_16x16x32_bf16 v[212:215], a[144:147], v[100:103], v[212:215]
buffer_load_dwordx4 v10, s[12:15], s21 offen offset:2048 sc1 lds
v_mfma_f32_16x16x32_bf16 v[212:215], a[148:151], v[108:111], v[212:215]
ds_read_b128 a[88:91], v13 offset:35840
v_add_f32 v16, v16, v2
v_mfma_f32_16x16x32_bf16 v[216:219], a[152:155], v[96:99], v[216:219]
buffer_load_dwordx4 v10, s[12:15], s21 offen offset:3072 sc1 lds
v_mfma_f32_16x16x32_bf16 v[216:219], a[156:159], v[104:107], v[216:219]
ds_read_b128 a[92:95], v13 offset:52224
v_add_f32 v16, v16, v3
v_mfma_f32_16x16x32_bf16 v[220:223], a[152:155], v[100:103], v[220:223]
v_exp_f32 v5, v75
v_mfma_f32_16x16x32_bf16 v[220:223], a[156:159], v[108:111], v[220:223]
s_add_u32 m0, s23, 69632
ds_read_b128 a[96:99], v13 offset:36864
v_mfma_f32_16x16x32_bf16 v[224:227], a[160:163], v[96:99], v[224:227]
ds_read_b128 a[100:103], v13 offset:53248
v_cvt_pk_bf16_f32 v114, v2, v3
v_mfma_f32_16x16x32_bf16 v[224:227], a[164:167], v[104:107], v[224:227]
v_exp_f32 v6, v76
v_mfma_f32_16x16x32_bf16 v[228:231], a[160:163], v[100:103], v[228:231]
buffer_load_dwordx4 v11, s[12:15], s21 offen offset:0 sc1 lds
v_mfma_f32_16x16x32_bf16 v[228:231], a[164:167], v[108:111], v[228:231]
ds_read_b128 a[104:107], v13 offset:37888
v_add_f32 v16, v16, v4
v_mfma_f32_16x16x32_bf16 v[232:235], a[168:171], v[96:99], v[232:235]
buffer_load_dwordx4 v11, s[12:15], s21 offen offset:1024 sc1 lds
v_mfma_f32_16x16x32_bf16 v[232:235], a[172:175], v[104:107], v[232:235]
ds_read_b128 a[108:111], v13 offset:54272
ds_read_b128 a[112:115], v13 offset:38912
v_mfma_f32_16x16x32_bf16 v[236:239], a[168:171], v[100:103], v[236:239]
buffer_load_dwordx4 v11, s[12:15], s21 offen offset:2048 sc1 lds
v_mfma_f32_16x16x32_bf16 v[236:239], a[172:175], v[108:111], v[236:239]
ds_read_b128 a[116:119], v13 offset:55296
v_add_f32 v16, v16, v5
v_mfma_f32_16x16x32_bf16 v[240:243], a[176:179], v[96:99], v[240:243]
v_exp_f32 v7, v77
v_mfma_f32_16x16x32_bf16 v[240:243], a[180:183], v[104:107], v[240:243]
ds_read_b128 a[120:123], v13 offset:39936
v_cvt_pk_bf16_f32 v115, v4, v5
v_mfma_f32_16x16x32_bf16 v[244:247], a[176:179], v[100:103], v[244:247]
v_exp_f32 v8, v78
v_mfma_f32_16x16x32_bf16 v[244:247], a[180:183], v[108:111], v[244:247]
buffer_load_dwordx4 v11, s[12:15], s21 offen offset:3072 sc1 lds
v_mfma_f32_16x16x32_bf16 v[248:251], a[184:187], v[96:99], v[248:251]
s_add_u32 s21, s21, 32768
ds_read_b128 a[124:127], v13 offset:56320
v_mfma_f32_16x16x32_bf16 v[248:251], a[188:191], v[104:107], v[248:251]
v_add_f32 v17, v17, v6
v_add_f32 v17, v17, v7
v_mfma_f32_16x16x32_bf16 v[252:255], a[184:187], v[100:103], v[252:255]
v_exp_f32 v9, v79
v_mfma_f32_16x16x32_bf16 v[252:255], a[188:191], v[108:111], v[252:255]
v_cvt_pk_bf16_f32 v118, v6, v7
s_nop 0
v_add_f32 v17, v17, v8
v_add_f32 v17, v17, v9
v_cvt_pk_bf16_f32 v119, v8, v9
v_exp_f32 v2, v80
v_exp_f32 v3, v81
v_exp_f32 v4, v82
v_add_f32 v16, v16, v2
v_add_f32 v16, v16, v3
v_exp_f32 v5, v83
v_cvt_pk_bf16_f32 v120, v2, v3
v_exp_f32 v6, v84
v_add_f32 v16, v16, v4
v_add_f32 v16, v16, v5
v_exp_f32 v7, v85
v_cvt_pk_bf16_f32 v121, v4, v5
v_exp_f32 v8, v86
v_add_f32 v17, v17, v6
v_add_f32 v17, v17, v7
v_exp_f32 v9, v87
v_cvt_pk_bf16_f32 v124, v6, v7
v_exp_f32 v2, v88
v_add_f32 v17, v17, v8
v_add_f32 v17, v17, v9
v_exp_f32 v3, v89
v_cvt_pk_bf16_f32 v125, v8, v9
v_exp_f32 v4, v90
v_add_f32 v16, v16, v2
v_add_f32 v16, v16, v3
v_exp_f32 v5, v91
v_cvt_pk_bf16_f32 v122, v2, v3
v_exp_f32 v6, v92
v_add_f32 v16, v16, v4
v_add_f32 v16, v16, v5
v_exp_f32 v7, v93
v_cvt_pk_bf16_f32 v123, v4, v5
v_exp_f32 v8, v94
v_add_f32 v17, v17, v6
v_add_f32 v17, v17, v7
v_exp_f32 v9, v95
v_cvt_pk_bf16_f32 v126, v6, v7
s_nop 0
v_add_f32 v17, v17, v8
v_add_f32 v17, v17, v9
v_cvt_pk_bf16_f32 v127, v8, v9
v_max_f32 v28, v16, v17
v_cmp_nge_f32 vcc, s33, v28
s_nop 1
s_cbranch_vccnz L_resc_19
L_resc_19_b:
v_add_f32 v14, v14, v16
v_add_f32 v15, v15, v17
s_waitcnt lgkmcnt(8)
v_mfma_f32_16x16x32_bf16 v[128:131], a[64:67], v[112:115], v[128:131]
ds_read_b128 a[128:131], v13 offset:40960
v_mov_b32 v28, v14
s_nop 1
v_mfma_f32_16x16x32_bf16 v[128:131], a[68:71], v[120:123], v[128:131]
ds_read_b128 a[132:135], v13 offset:57344
v_permlane32_swap_b32 v28, v14
v_add_f32 v14, v14, v28
v_mov_b32 v28, v14
v_mfma_f32_16x16x32_bf16 v[132:135], a[64:67], v[116:119], v[132:135]
s_nop 1
v_permlane16_swap_b32 v28, v14
v_add_f32 v14, v14, v28
v_mfma_f32_16x16x32_bf16 v[132:135], a[68:71], v[124:127], v[132:135]
ds_read_b128 a[136:139], v13 offset:41984
v_mov_b32 v28, v15
s_nop 1
v_mfma_f32_16x16x32_bf16 v[136:139], a[72:75], v[112:115], v[136:139]
ds_read_b128 a[140:143], v13 offset:58368
v_permlane32_swap_b32 v28, v15
v_add_f32 v15, v15, v28
v_mov_b32 v28, v15
v_mfma_f32_16x16x32_bf16 v[136:139], a[76:79], v[120:123], v[136:139]
s_nop 1
v_permlane16_swap_b32 v28, v15
v_add_f32 v15, v15, v28
v_mfma_f32_16x16x32_bf16 v[140:143], a[72:75], v[116:119], v[140:143]
ds_read_b128 a[144:147], v13 offset:43008
v_mov_b32 v2, v20
v_mov_b32 v3, v24
v_mov_b32 v4, v14
v_mfma_f32_16x16x32_bf16 v[140:143], a[76:79], v[124:127], v[140:143]
v_mov_b32 v5, v15
s_mov_b32 s34, 16384
buffer_store_dwordx4 v[2:5], v19, s[60:63], s34 offen sc1
v_accvgpr_mov_b32 a0, a192
v_mfma_f32_16x16x32_bf16 v[144:147], a[80:83], v[112:115], v[144:147]
ds_read_b128 a[148:151], v13 offset:59392
v_accvgpr_mov_b32 a1, a193
v_accvgpr_mov_b32 a2, a194
v_accvgpr_mov_b32 a3, a195
v_mfma_f32_16x16x32_bf16 v[144:147], a[84:87], v[120:123], v[144:147]
ds_read_b128 a[152:155], v13 offset:44032
v_mfma_f32_16x16x32_bf16 v[148:151], a[80:83], v[116:119], v[148:151]
v_mfma_f32_16x16x32_bf16 v[148:151], a[84:87], v[124:127], v[148:151]
ds_read_b128 a[156:159], v13 offset:60416
v_cvt_pk_bf16_f32 v32, v128, v129
v_cvt_pk_bf16_f32 v33, v130, v131
v_cvt_pk_bf16_f32 v34, v136, v137
v_mfma_f32_16x16x32_bf16 v[152:155], a[88:91], v[112:115], v[152:155]
v_cvt_pk_bf16_f32 v35, v138, v139
s_mov_b32 s34, 0
buffer_store_dwordx4 v[32:35], v19, s[60:63], s34 offen offset:0 sc1
v_accvgpr_mov_b32 a32, a224
v_mfma_f32_16x16x32_bf16 v[152:155], a[92:95], v[120:123], v[152:155]
ds_read_b128 a[160:163], v13 offset:45056
v_accvgpr_mov_b32 a33, a225
v_accvgpr_mov_b32 a34, a226
v_accvgpr_mov_b32 a35, a227
v_mfma_f32_16x16x32_bf16 v[156:159], a[88:91], v[116:119], v[156:159]
ds_read_b128 a[164:167], v13 offset:61440
v_cvt_pk_bf16_f32 v64, v132, v133
v_cvt_pk_bf16_f32 v65, v134, v135
v_cvt_pk_bf16_f32 v66, v140, v141
v_mfma_f32_16x16x32_bf16 v[156:159], a[92:95], v[124:127], v[156:159]
v_cvt_pk_bf16_f32 v67, v142, v143
s_mov_b32 s34, 8192
buffer_store_dwordx4 v[64:67], v19, s[60:63], s34 offen offset:0 sc1
s_waitcnt lgkmcnt(10)
v_mfma_f32_16x16x32_bf16 v[160:163], a[96:99], v[112:115], v[160:163]
ds_read_b128 a[168:171], v13 offset:46080
v_accvgpr_mov_b32 a4, a196
v_accvgpr_mov_b32 a5, a197
v_accvgpr_mov_b32 a6, a198
v_mfma_f32_16x16x32_bf16 v[160:163], a[100:103], v[120:123], v[160:163]
ds_read_b128 a[172:175], v13 offset:62464
v_accvgpr_mov_b32 a7, a199
v_mfma_f32_16x16x32_bf16 v[164:167], a[96:99], v[116:119], v[164:167]
v_mfma_f32_16x16x32_bf16 v[164:167], a[100:103], v[124:127], v[164:167]
ds_read_b128 a[176:179], v13 offset:47104
v_cvt_pk_bf16_f32 v36, v144, v145
v_cvt_pk_bf16_f32 v37, v146, v147
v_cvt_pk_bf16_f32 v38, v152, v153
v_mfma_f32_16x16x32_bf16 v[168:171], a[104:107], v[112:115], v[168:171]
v_cvt_pk_bf16_f32 v39, v154, v155
s_mov_b32 s34, 0
buffer_store_dwordx4 v[36:39], v19, s[60:63], s34 offen offset:1024 sc1
v_accvgpr_mov_b32 a36, a228
v_mfma_f32_16x16x32_bf16 v[168:171], a[108:111], v[120:123], v[168:171]
ds_read_b128 a[180:183], v13 offset:63488
v_accvgpr_mov_b32 a37, a229
v_accvgpr_mov_b32 a38, a230
v_accvgpr_mov_b32 a39, a231
v_mfma_f32_16x16x32_bf16 v[172:175], a[104:107], v[116:119], v[172:175]
ds_read_b128 a[184:187], v13 offset:48128
v_cvt_pk_bf16_f32 v68, v148, v149
v_cvt_pk_bf16_f32 v69, v150, v151
v_cvt_pk_bf16_f32 v70, v156, v157
v_mfma_f32_16x16x32_bf16 v[172:175], a[108:111], v[124:127], v[172:175]
v_cvt_pk_bf16_f32 v71, v158, v159
s_mov_b32 s34, 8192
buffer_store_dwordx4 v[68:71], v19, s[60:63], s34 offen offset:1024 sc1
v_accvgpr_mov_b32 a8, a200
v_mfma_f32_16x16x32_bf16 v[176:179], a[112:115], v[112:115], v[176:179]
ds_read_b128 a[188:191], v13 offset:64512
v_accvgpr_mov_b32 a9, a201
v_accvgpr_mov_b32 a10, a202
v_accvgpr_mov_b32 a11, a203
v_mfma_f32_16x16x32_bf16 v[176:179], a[116:119], v[120:123], v[176:179]
v_mfma_f32_16x16x32_bf16 v[180:183], a[112:115], v[116:119], v[180:183]
v_mfma_f32_16x16x32_bf16 v[180:183], a[116:119], v[124:127], v[180:183]
v_cvt_pk_bf16_f32 v40, v160, v161
v_cvt_pk_bf16_f32 v41, v162, v163
v_cvt_pk_bf16_f32 v42, v168, v169
v_cvt_pk_bf16_f32 v43, v170, v171
v_mfma_f32_16x16x32_bf16 v[184:187], a[120:123], v[112:115], v[184:187]
s_mov_b32 s34, 0
buffer_store_dwordx4 v[40:43], v19, s[60:63], s34 offen offset:2048 sc1
v_accvgpr_mov_b32 a40, a232
v_accvgpr_mov_b32 a41, a233
v_mfma_f32_16x16x32_bf16 v[184:187], a[124:127], v[120:123], v[184:187]
v_accvgpr_mov_b32 a42, a234
v_accvgpr_mov_b32 a43, a235
v_cvt_pk_bf16_f32 v72, v164, v165
v_cvt_pk_bf16_f32 v73, v166, v167
v_mfma_f32_16x16x32_bf16 v[188:191], a[120:123], v[116:119], v[188:191]
v_cvt_pk_bf16_f32 v74, v172, v173
v_cvt_pk_bf16_f32 v75, v174, v175
s_mov_b32 s34, 8192
buffer_store_dwordx4 v[72:75], v19, s[60:63], s34 offen offset:2048 sc1
v_mfma_f32_16x16x32_bf16 v[188:191], a[124:127], v[124:127], v[188:191]
v_accvgpr_mov_b32 a12, a204
v_accvgpr_mov_b32 a13, a205
v_accvgpr_mov_b32 a14, a206
v_accvgpr_mov_b32 a15, a207
s_waitcnt lgkmcnt(8)
v_mfma_f32_16x16x32_bf16 v[192:195], a[128:131], v[112:115], v[192:195]
v_mfma_f32_16x16x32_bf16 v[192:195], a[132:135], v[120:123], v[192:195]
v_mfma_f32_16x16x32_bf16 v[196:199], a[128:131], v[116:119], v[196:199]
v_mfma_f32_16x16x32_bf16 v[196:199], a[132:135], v[124:127], v[196:199]
v_cvt_pk_bf16_f32 v44, v176, v177
v_cvt_pk_bf16_f32 v45, v178, v179
v_cvt_pk_bf16_f32 v46, v184, v185
v_cvt_pk_bf16_f32 v47, v186, v187
v_mfma_f32_16x16x32_bf16 v[200:203], a[136:139], v[112:115], v[200:203]
s_mov_b32 s34, 0
buffer_store_dwordx4 v[44:47], v19, s[60:63], s34 offen offset:3072 sc1
v_accvgpr_mov_b32 a44, a236
v_accvgpr_mov_b32 a45, a237
v_mfma_f32_16x16x32_bf16 v[200:203], a[140:143], v[120:123], v[200:203]
v_accvgpr_mov_b32 a46, a238
v_accvgpr_mov_b32 a47, a239
v_cvt_pk_bf16_f32 v76, v180, v181
v_cvt_pk_bf16_f32 v77, v182, v183
v_mfma_f32_16x16x32_bf16 v[204:207], a[136:139], v[116:119], v[204:207]
v_cvt_pk_bf16_f32 v78, v188, v189
v_cvt_pk_bf16_f32 v79, v190, v191
s_mov_b32 s34, 8192
buffer_store_dwordx4 v[76:79], v19, s[60:63], s34 offen offset:3072 sc1
v_mfma_f32_16x16x32_bf16 v[204:207], a[140:143], v[124:127], v[204:207]
v_accvgpr_mov_b32 a16, a208
v_accvgpr_mov_b32 a17, a209
v_accvgpr_mov_b32 a18, a210
v_accvgpr_mov_b32 a19, a211
v_mfma_f32_16x16x32_bf16 v[208:211], a[144:147], v[112:115], v[208:211]
v_mfma_f32_16x16x32_bf16 v[208:211], a[148:151], v[120:123], v[208:211]
v_mfma_f32_16x16x32_bf16 v[212:215], a[144:147], v[116:119], v[212:215]
v_mfma_f32_16x16x32_bf16 v[212:215], a[148:151], v[124:127], v[212:215]
v_cvt_pk_bf16_f32 v48, v192, v193
v_cvt_pk_bf16_f32 v49, v194, v195
v_cvt_pk_bf16_f32 v50, v200, v201
v_cvt_pk_bf16_f32 v51, v202, v203
v_mfma_f32_16x16x32_bf16 v[216:219], a[152:155], v[112:115], v[216:219]
s_mov_b32 s34, 4096
buffer_store_dwordx4 v[48:51], v19, s[60:63], s34 offen offset:0 sc1
v_accvgpr_mov_b32 a48, a240
v_accvgpr_mov_b32 a49, a241
v_mfma_f32_16x16x32_bf16 v[216:219], a[156:159], v[120:123], v[216:219]
v_accvgpr_mov_b32 a50, a242
v_accvgpr_mov_b32 a51, a243
v_cvt_pk_bf16_f32 v80, v196, v197
v_cvt_pk_bf16_f32 v81, v198, v199
v_mfma_f32_16x16x32_bf16 v[220:223], a[152:155], v[116:119], v[220:223]
v_cvt_pk_bf16_f32 v82, v204, v205
v_cvt_pk_bf16_f32 v83, v206, v207
s_mov_b32 s34, 12288
buffer_store_dwordx4 v[80:83], v19, s[60:63], s34 offen offset:0 sc1
v_mfma_f32_16x16x32_bf16 v[220:223], a[156:159], v[124:127], v[220:223]
v_accvgpr_mov_b32 a20, a212
v_accvgpr_mov_b32 a21, a213
v_accvgpr_mov_b32 a22, a214
v_accvgpr_mov_b32 a23, a215
s_waitcnt lgkmcnt(0)
v_mfma_f32_16x16x32_bf16 v[224:227], a[160:163], v[112:115], v[224:227]
v_mfma_f32_16x16x32_bf16 v[224:227], a[164:167], v[120:123], v[224:227]
v_mfma_f32_16x16x32_bf16 v[228:231], a[160:163], v[116:119], v[228:231]
v_mfma_f32_16x16x32_bf16 v[228:231], a[164:167], v[124:127], v[228:231]
v_cvt_pk_bf16_f32 v52, v208, v209
v_cvt_pk_bf16_f32 v53, v210, v211
v_cvt_pk_bf16_f32 v54, v216, v217
v_cvt_pk_bf16_f32 v55, v218, v219
v_mfma_f32_16x16x32_bf16 v[232:235], a[168:171], v[112:115], v[232:235]
s_mov_b32 s34, 4096
buffer_store_dwordx4 v[52:55], v19, s[60:63], s34 offen offset:1024 sc1
v_accvgpr_mov_b32 a52, a244
v_accvgpr_mov_b32 a53, a245
v_mfma_f32_16x16x32_bf16 v[232:235], a[172:175], v[120:123], v[232:235]
v_accvgpr_mov_b32 a54, a246
v_accvgpr_mov_b32 a55, a247
v_cvt_pk_bf16_f32 v84, v212, v213
v_cvt_pk_bf16_f32 v85, v214, v215
v_mfma_f32_16x16x32_bf16 v[236:239], a[168:171], v[116:119], v[236:239]
v_cvt_pk_bf16_f32 v86, v220, v221
v_cvt_pk_bf16_f32 v87, v222, v223
s_mov_b32 s34, 12288
buffer_store_dwordx4 v[84:87], v19, s[60:63], s34 offen offset:1024 sc1
v_mfma_f32_16x16x32_bf16 v[236:239], a[172:175], v[124:127], v[236:239]
v_accvgpr_mov_b32 a24, a216
v_accvgpr_mov_b32 a25, a217
v_accvgpr_mov_b32 a26, a218
v_accvgpr_mov_b32 a27, a219
v_mfma_f32_16x16x32_bf16 v[240:243], a[176:179], v[112:115], v[240:243]
v_mfma_f32_16x16x32_bf16 v[240:243], a[180:183], v[120:123], v[240:243]
v_mfma_f32_16x16x32_bf16 v[244:247], a[176:179], v[116:119], v[244:247]
v_mfma_f32_16x16x32_bf16 v[244:247], a[180:183], v[124:127], v[244:247]
v_cvt_pk_bf16_f32 v56, v224, v225
v_cvt_pk_bf16_f32 v57, v226, v227
v_cvt_pk_bf16_f32 v58, v232, v233
v_cvt_pk_bf16_f32 v59, v234, v235
v_mfma_f32_16x16x32_bf16 v[248:251], a[184:187], v[112:115], v[248:251]
s_mov_b32 s34, 4096
buffer_store_dwordx4 v[56:59], v19, s[60:63], s34 offen offset:2048 sc1
v_accvgpr_mov_b32 a56, a248
v_accvgpr_mov_b32 a57, a249
v_mfma_f32_16x16x32_bf16 v[248:251], a[188:191], v[120:123], v[248:251]
v_accvgpr_mov_b32 a58, a250
v_accvgpr_mov_b32 a59, a251
v_cvt_pk_bf16_f32 v88, v228, v229
v_cvt_pk_bf16_f32 v89, v230, v231
v_mfma_f32_16x16x32_bf16 v[252:255], a[184:187], v[116:119], v[252:255]
v_cvt_pk_bf16_f32 v90, v236, v237
v_cvt_pk_bf16_f32 v91, v238, v239
s_mov_b32 s34, 12288
buffer_store_dwordx4 v[88:91], v19, s[60:63], s34 offen offset:2048 sc1
v_mfma_f32_16x16x32_bf16 v[252:255], a[188:191], v[124:127], v[252:255]
v_accvgpr_mov_b32 a28, a220
v_accvgpr_mov_b32 a29, a221
v_accvgpr_mov_b32 a30, a222
v_accvgpr_mov_b32 a31, a223
v_accvgpr_mov_b32 a60, a252
v_accvgpr_mov_b32 a61, a253
v_accvgpr_mov_b32 a62, a254
v_accvgpr_mov_b32 a63, a255
s_nop 7
v_cvt_pk_bf16_f32 v60, v240, v241
v_cvt_pk_bf16_f32 v61, v242, v243
v_cvt_pk_bf16_f32 v62, v248, v249
v_cvt_pk_bf16_f32 v63, v250, v251
s_mov_b32 s34, 4096
buffer_store_dwordx4 v[60:63], v19, s[60:63], s34 offen offset:3072 sc1
v_cvt_pk_bf16_f32 v92, v244, v245
v_cvt_pk_bf16_f32 v93, v246, v247
v_cvt_pk_bf16_f32 v94, v252, v253
v_cvt_pk_bf16_f32 v95, v254, v255
s_mov_b32 s34, 12288
buffer_store_dwordx4 v[92:95], v19, s[60:63], s34 offen offset:3072 sc1
s_mov_b32 s37, 1
s_mov_b32 s26, s48
s_mov_b32 s36, 0
s_lshl_b32 s28, s26, 1
s_add_u32 s28, s28, 2
s_mov_b32 s31, 0
s_waitcnt vmcnt(33)
s_branch L_k2_job
L_k2_fin:
buffer_load_dword v12, v19, s[52:55], 0 offen sc1
s_add_u32 s16, s4, s50
s_addc_u32 s17, s5, 0
s_cmp_eq_u32 s31, 2
s_cselect_b32 s18, 32768, 0
s_mul_i32 s34, s24, 229376
s_add_u32 s8, s56, s34
s_addc_u32 s9, s57, 0
s_mov_b32 s10, 229376
s_mov_b32 s68, 0
s_mov_b32 s69, 6144
s_mov_b32 s70, 12288
s_mov_b32 s71, 18432
s_mov_b32 s72, 28672
s_mov_b32 s73, 34816
s_mov_b32 s74, 40960
s_mov_b32 s75, 47104
s_mov_b32 s32, 0
s_lshl_b32 s39, s22, 10
v_lshrrev_b32 v28, 7, v19
v_mul_u32_u24 v28, 896, v28
v_lshrrev_b32 v29, 3, v19
v_and_b32 v29, 0x60, v29
v_and_b32 v30, 0x70, v19
v_xor_b32 v29, v29, v30
v_add_u32 v28, v28, v29
s_mul_i32 s34, s22, 57344
v_add_u32 v10, s34, v28
s_mul_i32 s34, s22, 7168
v_add_u32 v0, s34, v28
s_mov_b32 s64, s4
s_mov_b32 s65, s5
s_mov_b32 s66, 117440512
s_mov_b32 s67, 0x20000
s_lshl_b32 s34, s26, 3
s_lshl_b32 s35, s22, 1
s_add_u32 s34, s34, s35
s_lshl_b32 s30, s34, 6
s_add_u32 s30, s30, 105906176
s_lshl_b32 s34, s34, 4
s_add_u32 s34, s34, s24
s_lshl_b32 s34, s34, 10
s_add_u32 s20, s34, 106954752
s_waitcnt lgkmcnt(8)
v_mfma_f32_16x16x32_bf16 v[64:67], a[64:67], a[0:3], v[20:23]
v_exp_f32 v2, v48
v_mfma_f32_16x16x32_bf16 v[64:67], a[68:71], a[4:7], v[64:67]
v_exp_f32 v3, v49
v_mfma_f32_16x16x32_bf16 v[64:67], a[72:75], a[8:11], v[64:67]
ds_read_b128 a[128:131], v19 offset:49152
s_add_u32 m0, s23, 102400
v_mfma_f32_16x16x32_bf16 v[64:67], a[76:79], a[12:15], v[64:67]
ds_read_b128 a[132:135], v19 offset:50176
v_mfma_f32_16x16x32_bf16 v[64:67], a[80:83], a[16:19], v[64:67]
buffer_load_dwordx4 v11, s[12:15], s21 offen offset:0 sc1 lds
v_mfma_f32_16x16x32_bf16 v[64:67], a[84:87], a[20:23], v[64:67]
ds_read_b128 a[136:139], v19 offset:51200
ds_read_b128 a[140:143], v19 offset:52224
v_mfma_f32_16x16x32_bf16 v[64:67], a[88:91], a[24:27], v[64:67]
v_exp_f32 v4, v50
v_mfma_f32_16x16x32_bf16 v[64:67], a[92:95], a[28:31], v[64:67]
ds_read_b128 a[144:147], v19 offset:53248
v_add_f32 v16, v16, v2
v_mfma_f32_16x16x32_bf16 v[68:71], a[64:67], a[32:35], v[24:27]
ds_read_b128 a[148:151], v19 offset:54272
v_add_f32 v16, v16, v3
v_mfma_f32_16x16x32_bf16 v[68:71], a[68:71], a[36:39], v[68:71]
v_exp_f32 v5, v51
v_mfma_f32_16x16x32_bf16 v[68:71], a[72:75], a[40:43], v[68:71]
buffer_load_dwordx4 v11, s[12:15], s21 offen offset:1024 sc1 lds
v_mfma_f32_16x16x32_bf16 v[68:71], a[76:79], a[44:47], v[68:71]
ds_read_b128 a[152:155], v19 offset:55296
ds_read_b128 a[156:159], v19 offset:56320
v_mfma_f32_16x16x32_bf16 v[68:71], a[80:83], a[48:51], v[68:71]
v_cvt_pk_bf16_f32 v104, v2, v3
v_mfma_f32_16x16x32_bf16 v[68:71], a[84:87], a[52:55], v[68:71]
v_exp_f32 v6, v52
v_mfma_f32_16x16x32_bf16 v[68:71], a[88:91], a[56:59], v[68:71]
ds_read_b128 a[160:163], v19 offset:57344
ds_read_b128 a[164:167], v19 offset:58368
v_mfma_f32_16x16x32_bf16 v[68:71], a[92:95], a[60:63], v[68:71]
v_add_f32 v16, v16, v4
s_waitcnt lgkmcnt(10)
v_mfma_f32_16x16x32_bf16 v[72:75], a[96:99], a[0:3], v[20:23]
buffer_load_dwordx4 v11, s[12:15], s21 offen offset:2048 sc1 lds
v_mfma_f32_16x16x32_bf16 v[72:75], a[100:103], a[4:7], v[72:75]
ds_read_b128 a[168:171], v19 offset:59392
ds_read_b128 a[172:175], v19 offset:60416
v_mfma_f32_16x16x32_bf16 v[72:75], a[104:107], a[8:11], v[72:75]
v_add_f32 v16, v16, v5
v_mfma_f32_16x16x32_bf16 v[72:75], a[108:111], a[12:15], v[72:75]
v_exp_f32 v7, v53
v_mfma_f32_16x16x32_bf16 v[72:75], a[112:115], a[16:19], v[72:75]
ds_read_b128 a[176:179], v19 offset:61440
v_cvt_pk_bf16_f32 v105, v4, v5
v_mfma_f32_16x16x32_bf16 v[72:75], a[116:119], a[20:23], v[72:75]
v_exp_f32 v8, v54
v_mfma_f32_16x16x32_bf16 v[72:75], a[120:123], a[24:27], v[72:75]
ds_read_b128 a[180:183], v19 offset:62464
v_add_f32 v17, v17, v6
v_mfma_f32_16x16x32_bf16 v[72:75], a[124:127], a[28:31], v[72:75]
buffer_load_dwordx4 v11, s[12:15], s21 offen offset:3072 sc1 lds
v_mfma_f32_16x16x32_bf16 v[76:79], a[96:99], a[32:35], v[24:27]
s_add_u32 s21, s21, 32768
ds_read_b128 a[184:187], v19 offset:63488
v_mfma_f32_16x16x32_bf16 v[76:79], a[100:103], a[36:39], v[76:79]
ds_read_b128 a[188:191], v19 offset:64512
v_add_f32 v17, v17, v7
v_mfma_f32_16x16x32_bf16 v[76:79], a[104:107], a[40:43], v[76:79]
v_exp_f32 v9, v55
v_mfma_f32_16x16x32_bf16 v[76:79], a[108:111], a[44:47], v[76:79]
v_cvt_pk_bf16_f32 v108, v6, v7
v_mfma_f32_16x16x32_bf16 v[76:79], a[112:115], a[48:51], v[76:79]
v_exp_f32 v2, v56
v_mfma_f32_16x16x32_bf16 v[76:79], a[116:119], a[52:55], v[76:79]
v_add_f32 v17, v17, v8
v_add_f32 v17, v17, v9
v_mfma_f32_16x16x32_bf16 v[76:79], a[120:123], a[56:59], v[76:79]
v_exp_f32 v3, v57
v_mfma_f32_16x16x32_bf16 v[76:79], a[124:127], a[60:63], v[76:79]
s_waitcnt vmcnt(16) lgkmcnt(0)
s_barrier
v_mfma_f32_16x16x32_bf16 v[80:83], a[128:131], a[0:3], v[20:23]
ds_read_b128 a[64:67], v13 offset:0
v_cvt_pk_bf16_f32 v109, v8, v9
v_mfma_f32_16x16x32_bf16 v[80:83], a[132:135], a[4:7], v[80:83]
v_exp_f32 v4, v58
v_mfma_f32_16x16x32_bf16 v[80:83], a[136:139], a[8:11], v[80:83]
ds_read_b128 a[68:71], v13 offset:16384
s_add_u32 m0, s23, 0
v_mfma_f32_16x16x32_bf16 v[80:83], a[140:143], a[12:15], v[80:83]
buffer_load_dwordx4 v10, s[8:11], s68 offen offset:0 lds
v_mfma_f32_16x16x32_bf16 v[80:83], a[144:147], a[16:19], v[80:83]
ds_read_b128 a[72:75], v13 offset:1024
v_add_f32 v16, v16, v2
v_mfma_f32_16x16x32_bf16 v[80:83], a[148:151], a[20:23], v[80:83]
buffer_load_dwordx4 v10, s[8:11], s69 offen offset:1024 lds
v_mfma_f32_16x16x32_bf16 v[80:83], a[152:155], a[24:27], v[80:83]
ds_read_b128 a[76:79], v13 offset:17408
v_add_f32 v16, v16, v3
v_mfma_f32_16x16x32_bf16 v[80:83], a[156:159], a[28:31], v[80:83]
v_exp_f32 v5, v59
v_mfma_f32_16x16x32_bf16 v[84:87], a[128:131], a[32:35], v[24:27]
ds_read_b128 a[80:83], v13 offset:2048
v_cvt_pk_bf16_f32 v106, v2, v3
v_mfma_f32_16x16x32_bf16 v[84:87], a[132:135], a[36:39], v[84:87]
v_exp_f32 v6, v60
v_mfma_f32_16x16x32_bf16 v[84:87], a[136:139], a[40:43], v[84:87]
buffer_load_dwordx4 v10, s[8:11], s70 offen offset:2048 lds
ds_read_b128 a[84:87], v13 offset:18432
v_mfma_f32_16x16x32_bf16 v[84:87], a[140:143], a[44:47], v[84:87]
ds_read_b128 a[88:91], v13 offset:3072
v_add_f32 v16, v16, v4
v_mfma_f32_16x16x32_bf16 v[84:87], a[144:147], a[48:51], v[84:87]
buffer_load_dwordx4 v10, s[8:11], s71 offen offset:3072 lds
v_mfma_f32_16x16x32_bf16 v[84:87], a[148:151], a[52:55], v[84:87]
s_add_u32 m0, s23, 4096
ds_read_b128 a[92:95], v13 offset:19456
v_mfma_f32_16x16x32_bf16 v[84:87], a[152:155], a[56:59], v[84:87]
buffer_load_dwordx4 v10, s[8:11], s72 offen offset:0 lds
v_mfma_f32_16x16x32_bf16 v[84:87], a[156:159], a[60:63], v[84:87]
ds_read_b128 a[96:99], v13 offset:4096
ds_read_b128 a[100:103], v13 offset:20480
v_mfma_f32_16x16x32_bf16 v[88:91], a[160:163], a[0:3], v[20:23]
v_add_f32 v16, v16, v5
v_mfma_f32_16x16x32_bf16 v[88:91], a[164:167], a[4:7], v[88:91]
v_exp_f32 v7, v61
v_mfma_f32_16x16x32_bf16 v[88:91], a[168:171], a[8:11], v[88:91]
buffer_load_dwordx4 v10, s[8:11], s73 offen offset:1024 lds
v_mfma_f32_16x16x32_bf16 v[88:91], a[172:175], a[12:15], v[88:91]
ds_read_b128 a[104:107], v13 offset:5120
ds_read_b128 a[108:111], v13 offset:21504
v_mfma_f32_16x16x32_bf16 v[88:91], a[176:179], a[16:19], v[88:91]
buffer_load_dwordx4 v10, s[8:11], s74 offen offset:2048 lds
v_mfma_f32_16x16x32_bf16 v[88:91], a[180:183], a[20:23], v[88:91]
ds_read_b128 a[112:115], v13 offset:6144
v_cvt_pk_bf16_f32 v107, v4, v5
v_mfma_f32_16x16x32_bf16 v[88:91], a[184:187], a[24:27], v[88:91]
v_exp_f32 v8, v62
v_mfma_f32_16x16x32_bf16 v[88:91], a[188:191], a[28:31], v[88:91]
ds_read_b128 a[116:119], v13 offset:22528
v_add_f32 v17, v17, v6
v_mfma_f32_16x16x32_bf16 v[92:95], a[160:163], a[32:35], v[24:27]
buffer_load_dwordx4 v10, s[8:11], s75 offen offset:3072 lds
v_mfma_f32_16x16x32_bf16 v[92:95], a[164:167], a[36:39], v[92:95]
s_add_u32 m0, s39, 131072
ds_read_b128 a[120:123], v13 offset:7168
v_mfma_f32_16x16x32_bf16 v[92:95], a[168:171], a[40:43], v[92:95]
buffer_load_dwordx4 v0, s[92:95], s32 offen lds
v_mfma_f32_16x16x32_bf16 v[92:95], a[172:175], a[44:47], v[92:95]
ds_read_b128 a[124:127], v13 offset:23552
s_add_u32 s8, s8, 128
v_mfma_f32_16x16x32_bf16 v[92:95], a[176:179], a[48:51], v[92:95]
s_addc_u32 s9, s9, 0
s_sub_u32 s10, s10, 128
v_mfma_f32_16x16x32_bf16 v[92:95], a[180:183], a[52:55], v[92:95]
s_add_u32 s32, s32, 128
v_add_f32 v17, v17, v7
v_mfma_f32_16x16x32_bf16 v[92:95], a[184:187], a[56:59], v[92:95]
v_exp_f32 v9, v63
v_mfma_f32_16x16x32_bf16 v[92:95], a[188:191], a[60:63], v[92:95]
v_cvt_pk_bf16_f32 v110, v6, v7
s_nop 0
v_add_f32 v17, v17, v8
v_add_f32 v17, v17, v9
v_cvt_pk_bf16_f32 v111, v8, v9
v_max_f32 v28, v16, v17
v_cmp_nge_f32 vcc, s33, v28
s_cbranch_vccnz L_resc_21
L_resc_21_b:
s_cmp_eq_u32 s27, 1
s_cbranch_scc1 L_mask_22
L_mask_22_b:
v_bfe_u32 v11, v19, 2, 6
v_and_b32 v11, 0x3c, v11
s_add_u32 s21, s20, 16384
s_cmp_eq_u32 s31, 2
s_cbranch_scc1 L_poll_20
L_poll_20_b:
s_waitcnt lgkmcnt(8)
v_mfma_f32_16x16x32_bf16 v[128:131], a[64:67], v[96:99], v[128:131]
ds_read_b128 a[128:131], v13 offset:8192
v_add_f32 v14, v14, v16
v_mfma_f32_16x16x32_bf16 v[128:131], a[68:71], v[104:107], v[128:131]
s_mov_b32 s49, 16384
ds_read_b128 a[132:135], v13 offset:24576
v_mfma_f32_16x16x32_bf16 v[132:135], a[64:67], v[100:103], v[132:135]
buffer_load_dwordx4 a[192:195], v19, s[16:19], s49 offen sc1
v_mfma_f32_16x16x32_bf16 v[132:135], a[68:71], v[108:111], v[132:135]
ds_read_b128 a[136:139], v13 offset:9216
v_add_f32 v15, v15, v17
v_mfma_f32_16x16x32_bf16 v[136:139], a[72:75], v[96:99], v[136:139]
v_exp_f32 v2, v64
v_mfma_f32_16x16x32_bf16 v[136:139], a[76:79], v[104:107], v[136:139]
v_exp_f32 v3, v65
v_mfma_f32_16x16x32_bf16 v[140:143], a[72:75], v[100:103], v[140:143]
ds_read_b128 a[140:143], v13 offset:25600
buffer_load_dwordx4 a[196:199], v19, s[64:67], s20 offen sc1
v_mfma_f32_16x16x32_bf16 v[140:143], a[76:79], v[108:111], v[140:143]
v_exp_f32 v4, v66
v_mfma_f32_16x16x32_bf16 v[144:147], a[80:83], v[96:99], v[144:147]
ds_read_b128 a[144:147], v13 offset:10240
v_add_f32 v16, v2, v3
v_mfma_f32_16x16x32_bf16 v[144:147], a[84:87], v[104:107], v[144:147]
buffer_load_dwordx4 a[200:203], v19, s[64:67], s21 offen sc1
v_mfma_f32_16x16x32_bf16 v[148:151], a[80:83], v[100:103], v[148:151]
ds_read_b128 a[148:151], v13 offset:26624
ds_read_b128 a[152:155], v13 offset:11264
v_mfma_f32_16x16x32_bf16 v[148:151], a[84:87], v[108:111], v[148:151]
buffer_load_dword a204, v11, s[64:67], s30 offen offset:0 sc1
v_mfma_f32_16x16x32_bf16 v[152:155], a[88:91], v[96:99], v[152:155]
ds_read_b128 a[156:159], v13 offset:27648
v_cvt_pk_bf16_f32 v112, v2, v3
v_mfma_f32_16x16x32_bf16 v[152:155], a[92:95], v[104:107], v[152:155]
v_exp_f32 v5, v67
v_mfma_f32_16x16x32_bf16 v[156:159], a[88:91], v[100:103], v[156:159]
buffer_load_dword a205, v11, s[64:67], s30 offen offset:64 sc1
v_mfma_f32_16x16x32_bf16 v[156:159], a[92:95], v[108:111], v[156:159]
ds_read_b128 a[160:163], v13 offset:12288
s_mov_b32 s49, 0
s_waitcnt lgkmcnt(9)
v_mfma_f32_16x16x32_bf16 v[160:163], a[96:99], v[96:99], v[160:163]
ds_read_b128 a[164:167], v13 offset:28672
v_mfma_f32_16x16x32_bf16 v[160:163], a[100:103], v[104:107], v[160:163]
buffer_load_dwordx4 a[0:3], v19, s[16:19], s49 offen offset:0 sc1
s_mov_b32 s49, 8192
v_mfma_f32_16x16x32_bf16 v[164:167], a[96:99], v[100:103], v[164:167]
ds_read_b128 a[168:171], v13 offset:13312
ds_read_b128 a[172:175], v13 offset:29696
v_mfma_f32_16x16x32_bf16 v[164:167], a[100:103], v[108:111], v[164:167]
buffer_load_dwordx4 a[32:35], v19, s[16:19], s49 offen offset:0 sc1
s_mov_b32 s49, 0
v_mfma_f32_16x16x32_bf16 v[168:171], a[104:107], v[96:99], v[168:171]
v_exp_f32 v6, v68
v_mfma_f32_16x16x32_bf16 v[168:171], a[108:111], v[104:107], v[168:171]
ds_read_b128 a[176:179], v13 offset:14336
v_add_f32 v16, v16, v4
v_mfma_f32_16x16x32_bf16 v[172:175], a[104:107], v[100:103], v[172:175]
buffer_load_dwordx4 a[4:7], v19, s[16:19], s49 offen offset:1024 sc1
s_mov_b32 s49, 8192
v_mfma_f32_16x16x32_bf16 v[172:175], a[108:111], v[108:111], v[172:175]
ds_read_b128 a[180:183], v13 offset:30720
ds_read_b128 a[184:187], v13 offset:15360
v_mfma_f32_16x16x32_bf16 v[176:179], a[112:115], v[96:99], v[176:179]
buffer_load_dwordx4 a[36:39], v19, s[16:19], s49 offen offset:1024 sc1
s_mov_b32 s49, 0
v_mfma_f32_16x16x32_bf16 v[176:179], a[116:119], v[104:107], v[176:179]
ds_read_b128 a[188:191], v13 offset:31744
v_add_f32 v16, v16, v5
v_mfma_f32_16x16x32_bf16 v[180:183], a[112:115], v[100:103], v[180:183]
v_exp_f32 v7, v69
v_mfma_f32_16x16x32_bf16 v[180:183], a[116:119], v[108:111], v[180:183]
buffer_load_dwordx4 a[8:11], v19, s[16:19], s49 offen offset:2048 sc1
v_mfma_f32_16x16x32_bf16 v[184:187], a[120:123], v[96:99], v[184:187]
v_cvt_pk_bf16_f32 v113, v4, v5
v_mfma_f32_16x16x32_bf16 v[184:187], a[124:127], v[104:107], v[184:187]
v_exp_f32 v8, v70
v_mfma_f32_16x16x32_bf16 v[188:191], a[120:123], v[100:103], v[188:191]
v_add_f32 v17, v6, v7
v_cvt_pk_bf16_f32 v116, v6, v7
v_mfma_f32_16x16x32_bf16 v[188:191], a[124:127], v[108:111], v[188:191]
s_waitcnt vmcnt(19) lgkmcnt(0)
s_barrier
v_mfma_f32_16x16x32_bf16 v[192:195], a[128:131], v[96:99], v[192:195]
v_exp_f32 v9, v71
v_mfma_f32_16x16x32_bf16 v[192:195], a[132:135], v[104:107], v[192:195]
v_exp_f32 v2, v72
v_mfma_f32_16x16x32_bf16 v[196:199], a[128:131], v[100:103], v[196:199]
ds_read_b128 a[64:67], v13 offset:32768
ds_read_b128 a[68:71], v13 offset:49152
v_mfma_f32_16x16x32_bf16 v[196:199], a[132:135], v[108:111], v[196:199]
s_mov_b32 s49, 8192
v_add_f32 v17, v17, v8
v_mfma_f32_16x16x32_bf16 v[200:203], a[136:139], v[96:99], v[200:203]
buffer_load_dwordx4 a[40:43], v19, s[16:19], s49 offen offset:2048 sc1
v_mfma_f32_16x16x32_bf16 v[200:203], a[140:143], v[104:107], v[200:203]
ds_read_b128 a[72:75], v13 offset:33792
s_mov_b32 s49, 0
v_mfma_f32_16x16x32_bf16 v[204:207], a[136:139], v[100:103], v[204:207]
buffer_load_dwordx4 a[12:15], v19, s[16:19], s49 offen offset:3072 sc1
v_mfma_f32_16x16x32_bf16 v[204:207], a[140:143], v[108:111], v[204:207]
ds_read_b128 a[76:79], v13 offset:50176
s_mov_b32 s49, 8192
v_mfma_f32_16x16x32_bf16 v[208:211], a[144:147], v[96:99], v[208:211]
buffer_load_dwordx4 a[44:47], v19, s[16:19], s49 offen offset:3072 sc1
v_mfma_f32_16x16x32_bf16 v[208:211], a[148:151], v[104:107], v[208:211]
ds_read_b128 a[80:83], v13 offset:34816
s_mov_b32 s49, 4096
v_mfma_f32_16x16x32_bf16 v[212:215], a[144:147], v[100:103], v[212:215]
ds_read_b128 a[84:87], v13 offset:51200
v_add_f32 v17, v17, v9
v_mfma_f32_16x16x32_bf16 v[212:215], a[148:151], v[108:111], v[212:215]
v_exp_f32 v3, v73
v_mfma_f32_16x16x32_bf16 v[216:219], a[152:155], v[96:99], v[216:219]
buffer_load_dwordx4 a[16:19], v19, s[16:19], s49 offen offset:0 sc1
ds_read_b128 a[88:91], v13 offset:35840
s_mov_b32 s49, 12288
v_mfma_f32_16x16x32_bf16 v[216:219], a[156:159], v[104:107], v[216:219]
buffer_load_dwordx4 a[48:51], v19, s[16:19], s49 offen offset:0 sc1
v_mfma_f32_16x16x32_bf16 v[220:223], a[152:155], v[100:103], v[220:223]
ds_read_b128 a[92:95], v13 offset:52224
s_mov_b32 s49, 4096
v_mfma_f32_16x16x32_bf16 v[220:223], a[156:159], v[108:111], v[220:223]
buffer_load_dwordx4 a[20:23], v19, s[16:19], s49 offen offset:1024 sc1
v_mfma_f32_16x16x32_bf16 v[224:227], a[160:163], v[96:99], v[224:227]
ds_read_b128 a[96:99], v13 offset:36864
s_mov_b32 s49, 12288
v_mfma_f32_16x16x32_bf16 v[224:227], a[164:167], v[104:107], v[224:227]
ds_read_b128 a[100:103], v13 offset:53248
v_cvt_pk_bf16_f32 v117, v8, v9
v_mfma_f32_16x16x32_bf16 v[228:231], a[160:163], v[100:103], v[228:231]
v_exp_f32 v4, v74
v_mfma_f32_16x16x32_bf16 v[228:231], a[164:167], v[108:111], v[228:231]
buffer_load_dwordx4 a[52:55], v19, s[16:19], s49 offen offset:1024 sc1
ds_read_b128 a[104:107], v13 offset:37888
s_mov_b32 s49, 4096
v_mfma_f32_16x16x32_bf16 v[232:235], a[168:171], v[96:99], v[232:235]
buffer_load_dwordx4 a[24:27], v19, s[16:19], s49 offen offset:2048 sc1
v_mfma_f32_16x16x32_bf16 v[232:235], a[172:175], v[104:107], v[232:235]
ds_read_b128 a[108:111], v13 offset:54272
s_mov_b32 s49, 12288
v_mfma_f32_16x16x32_bf16 v[236:239], a[168:171], v[100:103], v[236:239]
buffer_load_dwordx4 a[56:59], v19, s[16:19], s49 offen offset:2048 sc1
v_mfma_f32_16x16x32_bf16 v[236:239], a[172:175], v[108:111], v[236:239]
ds_read_b128 a[112:115], v13 offset:38912
s_mov_b32 s49, 4096
v_mfma_f32_16x16x32_bf16 v[240:243], a[176:179], v[96:99], v[240:243]
ds_read_b128 a[116:119], v13 offset:55296
v_add_f32 v16, v16, v2
v_mfma_f32_16x16x32_bf16 v[240:243], a[180:183], v[104:107], v[240:243]
buffer_load_dwordx4 a[28:31], v19, s[16:19], s49 offen offset:3072 sc1
v_mfma_f32_16x16x32_bf16 v[244:247], a[176:179], v[100:103], v[244:247]
ds_read_b128 a[120:123], v13 offset:39936
s_mov_b32 s49, 12288
v_mfma_f32_16x16x32_bf16 v[244:247], a[180:183], v[108:111], v[244:247]
buffer_load_dwordx4 a[60:63], v19, s[16:19], s49 offen offset:3072 sc1
v_mfma_f32_16x16x32_bf16 v[248:251], a[184:187], v[96:99], v[248:251]
ds_read_b128 a[124:127], v13 offset:56320
v_add_f32 v16, v16, v3
v_mfma_f32_16x16x32_bf16 v[248:251], a[188:191], v[104:107], v[248:251]
v_exp_f32 v5, v75
v_mfma_f32_16x16x32_bf16 v[252:255], a[184:187], v[100:103], v[252:255]
v_cvt_pk_bf16_f32 v114, v2, v3
v_mfma_f32_16x16x32_bf16 v[252:255], a[188:191], v[108:111], v[252:255]
v_exp_f32 v6, v76
v_add_f32 v16, v16, v4
v_add_f32 v16, v16, v5
v_exp_f32 v7, v77
v_cvt_pk_bf16_f32 v115, v4, v5
v_exp_f32 v8, v78
v_add_f32 v17, v17, v6
v_add_f32 v17, v17, v7
v_exp_f32 v9, v79
v_cvt_pk_bf16_f32 v118, v6, v7
s_nop 0
v_add_f32 v17, v17, v8
v_add_f32 v17, v17, v9
v_cvt_pk_bf16_f32 v119, v8, v9
v_exp_f32 v2, v80
v_exp_f32 v3, v81
v_exp_f32 v4, v82
v_add_f32 v16, v16, v2
v_add_f32 v16, v16, v3
v_exp_f32 v5, v83
v_cvt_pk_bf16_f32 v120, v2, v3
v_exp_f32 v6, v84
v_add_f32 v16, v16, v4
v_add_f32 v16, v16, v5
v_exp_f32 v7, v85
v_cvt_pk_bf16_f32 v121, v4, v5
v_exp_f32 v8, v86
v_add_f32 v17, v17, v6
v_add_f32 v17, v17, v7
v_exp_f32 v9, v87
v_cvt_pk_bf16_f32 v124, v6, v7
v_exp_f32 v2, v88
v_add_f32 v17, v17, v8
v_add_f32 v17, v17, v9
v_exp_f32 v3, v89
v_cvt_pk_bf16_f32 v125, v8, v9
v_exp_f32 v4, v90
v_add_f32 v16, v16, v2
v_add_f32 v16, v16, v3
v_exp_f32 v5, v91
v_cvt_pk_bf16_f32 v122, v2, v3
v_exp_f32 v6, v92
v_add_f32 v16, v16, v4
v_add_f32 v16, v16, v5
v_exp_f32 v7, v93
v_cvt_pk_bf16_f32 v123, v4, v5
v_exp_f32 v8, v94
v_add_f32 v17, v17, v6
v_add_f32 v17, v17, v7
v_exp_f32 v9, v95
v_cvt_pk_bf16_f32 v126, v6, v7
s_nop 0
v_add_f32 v17, v17, v8
v_add_f32 v17, v17, v9
v_cvt_pk_bf16_f32 v127, v8, v9
v_max_f32 v28, v16, v17
v_cmp_nge_f32 vcc, s33, v28
s_nop 1
s_cbranch_vccnz L_resc_23
L_resc_23_b:
v_add_f32 v14, v14, v16
v_add_f32 v15, v15, v17
s_cmp_eq_u32 s31, 2
s_cbranch_scc1 L_k2_merge
s_waitcnt lgkmcnt(8)
v_mfma_f32_16x16x32_bf16 v[128:131], a[64:67], v[112:115], v[128:131]
ds_read_b128 a[128:131], v13 offset:40960
v_lshrrev_b32 v108, 6, v19
v_and_b32 v109, 6, v108
v_lshlrev_b32 v108, 7, v108
v_bfe_u32 v110, v19, 4, 2
v_mfma_f32_16x16x32_bf16 v[128:131], a[68:71], v[120:123], v[128:131]
s_add_u32 m0, s23, 32768
ds_read_b128 a[132:135], v13 offset:57344
v_lshl_add_u32 v108, v110, 3, v108
v_xor_b32 v110, 0, v109
v_lshl_add_u32 v96, v110, 4, v108
v_mfma_f32_16x16x32_bf16 v[132:135], a[64:67], v[116:119], v[132:135]
buffer_load_dwordx4 v10, s[8:11], s68 offen offset:0 lds
v_add_u32 v100, 0x10000, v96
v_add_u32 v104, 131072, v96
v_xor_b32 v110, 2, v109
v_mfma_f32_16x16x32_bf16 v[132:135], a[68:71], v[124:127], v[132:135]
ds_read_b128 a[136:139], v13 offset:41984
v_lshl_add_u32 v97, v110, 4, v108
v_add_u32 v101, 0x10000, v97
v_add_u32 v105, 131072, v97
v_xor_b32 v110, 4, v109
v_mfma_f32_16x16x32_bf16 v[136:139], a[72:75], v[112:115], v[136:139]
ds_read_b128 a[140:143], v13 offset:58368
buffer_load_dwordx4 v10, s[8:11], s69 offen offset:1024 lds
v_lshl_add_u32 v98, v110, 4, v108
v_add_u32 v102, 0x10000, v98
v_mfma_f32_16x16x32_bf16 v[136:139], a[76:79], v[120:123], v[136:139]
v_add_u32 v106, 131072, v98
v_xor_b32 v110, 6, v109
v_lshl_add_u32 v99, v110, 4, v108
v_add_u32 v103, 0x10000, v99
v_add_u32 v107, 131072, v99
v_mfma_f32_16x16x32_bf16 v[140:143], a[72:75], v[116:119], v[140:143]
ds_read_b128 a[144:147], v13 offset:43008
v_mov_b32 v28, v14
s_nop 1
v_permlane32_swap_b32 v28, v14
v_mfma_f32_16x16x32_bf16 v[140:143], a[76:79], v[124:127], v[140:143]
buffer_load_dwordx4 v10, s[8:11], s70 offen offset:2048 lds
v_add_f32 v14, v14, v28
v_mov_b32 v28, v14
v_mfma_f32_16x16x32_bf16 v[144:147], a[80:83], v[112:115], v[144:147]
s_nop 1
ds_read_b128 a[148:151], v13 offset:59392
v_permlane16_swap_b32 v28, v14
v_add_f32 v14, v14, v28
v_mfma_f32_16x16x32_bf16 v[144:147], a[84:87], v[120:123], v[144:147]
ds_read_b128 a[152:155], v13 offset:44032
v_mov_b32 v28, v15
s_nop 1
v_permlane32_swap_b32 v28, v15
v_mfma_f32_16x16x32_bf16 v[148:151], a[80:83], v[116:119], v[148:151]
buffer_load_dwordx4 v10, s[8:11], s71 offen offset:3072 lds
v_add_f32 v15, v15, v28
v_mov_b32 v28, v15
v_mfma_f32_16x16x32_bf16 v[148:151], a[84:87], v[124:127], v[148:151]
s_nop 1
ds_read_b128 a[156:159], v13 offset:60416
s_add_u32 m0, s23, 36864
v_permlane16_swap_b32 v28, v15
v_mfma_f32_16x16x32_bf16 v[152:155], a[88:91], v[112:115], v[152:155]
v_add_f32 v15, v15, v28
s_waitcnt vmcnt(20)
v_accvgpr_read_b32 v16, a204
v_accvgpr_read_b32 v17, a205
v_mfma_f32_16x16x32_bf16 v[152:155], a[92:95], v[120:123], v[152:155]
v_rcp_f32 v28, v14
ds_read_b128 a[160:163], v13 offset:45056
buffer_load_dwordx4 v10, s[8:11], s72 offen offset:0 lds
v_mfma_f32_16x16x32_bf16 v[156:159], a[88:91], v[116:119], v[156:159]
v_rcp_f32 v29, v15
ds_read_b128 a[164:167], v13 offset:61440
s_nop 0
v_mul_f32 v28, v28, v16
v_mfma_f32_16x16x32_bf16 v[156:159], a[92:95], v[124:127], v[156:159]
v_mul_f32 v29, v29, v17
v_mul_f32 v128, v128, v28
v_mul_f32 v129, v129, v28
v_mul_f32 v130, v130, v28
s_waitcnt lgkmcnt(10)
v_mfma_f32_16x16x32_bf16 v[160:163], a[96:99], v[112:115], v[160:163]
ds_read_b128 a[168:171], v13 offset:46080
buffer_load_dwordx4 v10, s[8:11], s73 offen offset:1024 lds
v_mul_f32 v131, v131, v28
v_mul_f32 v136, v136, v28
v_mfma_f32_16x16x32_bf16 v[160:163], a[100:103], v[120:123], v[160:163]
ds_read_b128 a[172:175], v13 offset:62464
v_mul_f32 v137, v137, v28
v_mul_f32 v138, v138, v28
v_mul_f32 v139, v139, v28
v_cvt_pk_bf16_f32 v32, v128, v129
v_mfma_f32_16x16x32_bf16 v[164:167], a[96:99], v[116:119], v[164:167]
v_cvt_pk_bf16_f32 v33, v130, v131
v_cvt_pk_bf16_f32 v34, v136, v137
v_cvt_pk_bf16_f32 v35, v138, v139
v_mul_f32 v132, v132, v29
v_mul_f32 v133, v133, v29
v_mfma_f32_16x16x32_bf16 v[164:167], a[100:103], v[124:127], v[164:167]
ds_read_b128 a[176:179], v13 offset:47104
buffer_load_dwordx4 v10, s[8:11], s74 offen offset:2048 lds
v_mul_f32 v134, v134, v29
v_mul_f32 v135, v135, v29
v_mfma_f32_16x16x32_bf16 v[168:171], a[104:107], v[112:115], v[168:171]
v_mul_f32 v140, v140, v29
v_mul_f32 v141, v141, v29
v_mul_f32 v142, v142, v29
v_mul_f32 v143, v143, v29
v_cvt_pk_bf16_f32 v64, v132, v133
v_mfma_f32_16x16x32_bf16 v[168:171], a[108:111], v[120:123], v[168:171]
ds_read_b128 a[180:183], v13 offset:63488
v_cvt_pk_bf16_f32 v65, v134, v135
v_cvt_pk_bf16_f32 v66, v140, v141
v_cvt_pk_bf16_f32 v67, v142, v143
v_mul_f32 v144, v144, v28
v_mfma_f32_16x16x32_bf16 v[172:175], a[104:107], v[116:119], v[172:175]
ds_read_b128 a[184:187], v13 offset:48128
buffer_load_dwordx4 v10, s[8:11], s75 offen offset:3072 lds
v_mul_f32 v145, v145, v28
v_mul_f32 v146, v146, v28
v_mfma_f32_16x16x32_bf16 v[172:175], a[108:111], v[124:127], v[172:175]
s_add_u32 m0, s39, 135168
v_mul_f32 v147, v147, v28
v_mul_f32 v152, v152, v28
v_mul_f32 v153, v153, v28
v_mul_f32 v154, v154, v28
v_mfma_f32_16x16x32_bf16 v[176:179], a[112:115], v[112:115], v[176:179]
ds_read_b128 a[188:191], v13 offset:64512
v_mul_f32 v155, v155, v28
v_cvt_pk_bf16_f32 v36, v144, v145
v_cvt_pk_bf16_f32 v37, v146, v147
v_cvt_pk_bf16_f32 v38, v152, v153
v_mfma_f32_16x16x32_bf16 v[176:179], a[116:119], v[120:123], v[176:179]
buffer_load_dwordx4 v0, s[92:95], s32 offen lds
v_cvt_pk_bf16_f32 v39, v154, v155
v_mul_f32 v148, v148, v29
v_mul_f32 v149, v149, v29
v_mfma_f32_16x16x32_bf16 v[180:183], a[112:115], v[116:119], v[180:183]
s_add_u32 s8, s8, 128
s_addc_u32 s9, s9, 0
s_sub_u32 s10, s10, 128
s_add_u32 s32, s32, 128
v_mul_f32 v150, v150, v29
v_mfma_f32_16x16x32_bf16 v[180:183], a[116:119], v[124:127], v[180:183]
v_mul_f32 v151, v151, v29
v_mul_f32 v156, v156, v29
v_mul_f32 v157, v157, v29
v_mul_f32 v158, v158, v29
v_mul_f32 v159, v159, v29
v_mfma_f32_16x16x32_bf16 v[184:187], a[120:123], v[112:115], v[184:187]
v_cvt_pk_bf16_f32 v68, v148, v149
v_cvt_pk_bf16_f32 v69, v150, v151
v_cvt_pk_bf16_f32 v70, v156, v157
v_cvt_pk_bf16_f32 v71, v158, v159
v_mul_f32 v160, v160, v28
v_mfma_f32_16x16x32_bf16 v[184:187], a[124:127], v[120:123], v[184:187]
v_mul_f32 v161, v161, v28
v_mul_f32 v162, v162, v28
v_mul_f32 v163, v163, v28
v_mul_f32 v168, v168, v28
v_mul_f32 v169, v169, v28
v_mfma_f32_16x16x32_bf16 v[188:191], a[120:123], v[116:119], v[188:191]
v_mul_f32 v170, v170, v28
v_mul_f32 v171, v171, v28
v_cvt_pk_bf16_f32 v40, v160, v161
v_cvt_pk_bf16_f32 v41, v162, v163
v_cvt_pk_bf16_f32 v42, v168, v169
v_mfma_f32_16x16x32_bf16 v[188:191], a[124:127], v[124:127], v[188:191]
v_cvt_pk_bf16_f32 v43, v170, v171
v_mul_f32 v164, v164, v29
v_mul_f32 v165, v165, v29
v_mul_f32 v166, v166, v29
v_mul_f32 v167, v167, v29
s_waitcnt lgkmcnt(8)
v_mfma_f32_16x16x32_bf16 v[192:195], a[128:131], v[112:115], v[192:195]
v_mul_f32 v172, v172, v29
v_mul_f32 v173, v173, v29
v_mul_f32 v174, v174, v29
v_mul_f32 v175, v175, v29
v_cvt_pk_bf16_f32 v72, v164, v165
v_mfma_f32_16x16x32_bf16 v[192:195], a[132:135], v[120:123], v[192:195]
v_cvt_pk_bf16_f32 v73, v166, v167
v_cvt_pk_bf16_f32 v74, v172, v173
v_cvt_pk_bf16_f32 v75, v174, v175
v_mfma_f32_16x16x32_bf16 v[196:199], a[128:131], v[116:119], v[196:199]
s_add_u32 m0, s23, 65536
v_mfma_f32_16x16x32_bf16 v[196:199], a[132:135], v[124:127], v[196:199]
buffer_load_dwordx4 v10, s[8:11], s68 offen offset:0 lds
v_mul_f32 v176, v176, v28
v_mul_f32 v177, v177, v28
v_mul_f32 v178, v178, v28
v_mfma_f32_16x16x32_bf16 v[200:203], a[136:139], v[112:115], v[200:203]
v_mul_f32 v179, v179, v28
v_mul_f32 v184, v184, v28
v_mul_f32 v185, v185, v28
v_mul_f32 v186, v186, v28
v_mul_f32 v187, v187, v28
v_mfma_f32_16x16x32_bf16 v[200:203], a[140:143], v[120:123], v[200:203]
buffer_load_dwordx4 v10, s[8:11], s69 offen offset:1024 lds
v_cvt_pk_bf16_f32 v44, v176, v177
v_cvt_pk_bf16_f32 v45, v178, v179
v_cvt_pk_bf16_f32 v46, v184, v185
v_mfma_f32_16x16x32_bf16 v[204:207], a[136:139], v[116:119], v[204:207]
v_cvt_pk_bf16_f32 v47, v186, v187
v_mul_f32 v180, v180, v29
v_mul_f32 v181, v181, v29
v_mul_f32 v182, v182, v29
v_mul_f32 v183, v183, v29
v_mfma_f32_16x16x32_bf16 v[204:207], a[140:143], v[124:127], v[204:207]
v_mul_f32 v188, v188, v29
v_mul_f32 v189, v189, v29
v_mul_f32 v190, v190, v29
v_mul_f32 v191, v191, v29
v_cvt_pk_bf16_f32 v76, v180, v181
v_mfma_f32_16x16x32_bf16 v[208:211], a[144:147], v[112:115], v[208:211]
buffer_load_dwordx4 v10, s[8:11], s70 offen offset:2048 lds
v_cvt_pk_bf16_f32 v77, v182, v183
v_cvt_pk_bf16_f32 v78, v188, v189
v_cvt_pk_bf16_f32 v79, v190, v191
v_mfma_f32_16x16x32_bf16 v[208:211], a[148:151], v[120:123], v[208:211]
v_mfma_f32_16x16x32_bf16 v[212:215], a[144:147], v[116:119], v[212:215]
v_mfma_f32_16x16x32_bf16 v[212:215], a[148:151], v[124:127], v[212:215]
buffer_load_dwordx4 v10, s[8:11], s71 offen offset:3072 lds
v_mul_f32 v192, v192, v28
v_mul_f32 v193, v193, v28
v_mul_f32 v194, v194, v28
v_mfma_f32_16x16x32_bf16 v[216:219], a[152:155], v[112:115], v[216:219]
s_add_u32 m0, s23, 69632
v_mul_f32 v195, v195, v28
v_mul_f32 v200, v200, v28
v_mul_f32 v201, v201, v28
v_mul_f32 v202, v202, v28
v_mfma_f32_16x16x32_bf16 v[216:219], a[156:159], v[120:123], v[216:219]
v_mul_f32 v203, v203, v28
v_cvt_pk_bf16_f32 v48, v192, v193
v_cvt_pk_bf16_f32 v49, v194, v195
v_cvt_pk_bf16_f32 v50, v200, v201
v_cvt_pk_bf16_f32 v51, v202, v203
v_mfma_f32_16x16x32_bf16 v[220:223], a[152:155], v[116:119], v[220:223]
buffer_load_dwordx4 v10, s[8:11], s72 offen offset:0 lds
v_mul_f32 v196, v196, v29
v_mul_f32 v197, v197, v29
v_mul_f32 v198, v198, v29
v_mfma_f32_16x16x32_bf16 v[220:223], a[156:159], v[124:127], v[220:223]
v_mul_f32 v199, v199, v29
v_mul_f32 v204, v204, v29
v_mul_f32 v205, v205, v29
v_mul_f32 v206, v206, v29
v_mul_f32 v207, v207, v29
s_waitcnt lgkmcnt(0)
v_mfma_f32_16x16x32_bf16 v[224:227], a[160:163], v[112:115], v[224:227]
v_cvt_pk_bf16_f32 v80, v196, v197
v_cvt_pk_bf16_f32 v81, v198, v199
v_cvt_pk_bf16_f32 v82, v204, v205
v_cvt_pk_bf16_f32 v83, v206, v207
v_mfma_f32_16x16x32_bf16 v[224:227], a[164:167], v[120:123], v[224:227]
buffer_load_dwordx4 v10, s[8:11], s73 offen offset:1024 lds
v_mfma_f32_16x16x32_bf16 v[228:231], a[160:163], v[116:119], v[228:231]
v_mfma_f32_16x16x32_bf16 v[228:231], a[164:167], v[124:127], v[228:231]
v_mul_f32 v208, v208, v28
v_mul_f32 v209, v209, v28
v_mul_f32 v210, v210, v28
v_mul_f32 v211, v211, v28
v_mul_f32 v216, v216, v28
v_mfma_f32_16x16x32_bf16 v[232:235], a[168:171], v[112:115], v[232:235]
buffer_load_dwordx4 v10, s[8:11], s74 offen offset:2048 lds
v_mul_f32 v217, v217, v28
v_mul_f32 v218, v218, v28
v_mul_f32 v219, v219, v28
v_mfma_f32_16x16x32_bf16 v[232:235], a[172:175], v[120:123], v[232:235]
v_cvt_pk_bf16_f32 v52, v208, v209
v_cvt_pk_bf16_f32 v53, v210, v211
v_cvt_pk_bf16_f32 v54, v216, v217
v_cvt_pk_bf16_f32 v55, v218, v219
v_mul_f32 v212, v212, v29
v_mfma_f32_16x16x32_bf16 v[236:239], a[168:171], v[116:119], v[236:239]
v_mul_f32 v213, v213, v29
v_mul_f32 v214, v214, v29
v_mul_f32 v215, v215, v29
v_mul_f32 v220, v220, v29
v_mul_f32 v221, v221, v29
v_mfma_f32_16x16x32_bf16 v[236:239], a[172:175], v[124:127], v[236:239]
buffer_load_dwordx4 v10, s[8:11], s75 offen offset:3072 lds
v_mul_f32 v222, v222, v29
v_mul_f32 v223, v223, v29
v_cvt_pk_bf16_f32 v84, v212, v213
v_mfma_f32_16x16x32_bf16 v[240:243], a[176:179], v[112:115], v[240:243]
s_add_u32 m0, s39, 139264
v_cvt_pk_bf16_f32 v85, v214, v215
v_cvt_pk_bf16_f32 v86, v220, v221
v_cvt_pk_bf16_f32 v87, v222, v223
v_mfma_f32_16x16x32_bf16 v[240:243], a[180:183], v[120:123], v[240:243]
v_mfma_f32_16x16x32_bf16 v[244:247], a[176:179], v[116:119], v[244:247]
buffer_load_dwordx4 v0, s[92:95], s32 offen lds
v_mfma_f32_16x16x32_bf16 v[244:247], a[180:183], v[124:127], v[244:247]
s_add_u32 s8, s8, 128
s_addc_u32 s9, s9, 0
s_sub_u32 s10, s10, 128
s_add_u32 s32, s32, 128
v_mul_f32 v224, v224, v28
v_mfma_f32_16x16x32_bf16 v[248:251], a[184:187], v[112:115], v[248:251]
v_mul_f32 v225, v225, v28
v_mul_f32 v226, v226, v28
v_mul_f32 v227, v227, v28
v_mul_f32 v232, v232, v28
v_mul_f32 v233, v233, v28
v_mfma_f32_16x16x32_bf16 v[248:251], a[188:191], v[120:123], v[248:251]
v_mul_f32 v234, v234, v28
v_mul_f32 v235, v235, v28
v_cvt_pk_bf16_f32 v56, v224, v225
v_cvt_pk_bf16_f32 v57, v226, v227
v_cvt_pk_bf16_f32 v58, v232, v233
v_mfma_f32_16x16x32_bf16 v[252:255], a[184:187], v[116:119], v[252:255]
v_cvt_pk_bf16_f32 v59, v234, v235
v_mul_f32 v228, v228, v29
v_mul_f32 v229, v229, v29
v_mul_f32 v230, v230, v29
v_mul_f32 v231, v231, v29
v_mfma_f32_16x16x32_bf16 v[252:255], a[188:191], v[124:127], v[252:255]
v_mul_f32 v236, v236, v29
v_mul_f32 v237, v237, v29
v_mul_f32 v238, v238, v29
v_mul_f32 v239, v239, v29
v_cvt_pk_bf16_f32 v88, v228, v229
v_cvt_pk_bf16_f32 v89, v230, v231
v_cvt_pk_bf16_f32 v90, v236, v237
v_cvt_pk_bf16_f32 v91, v238, v239
s_waitcnt vmcnt(9)
s_barrier
ds_read_b64_tr_b16 a[64:65], v96 offset:0
ds_read_b64_tr_b16 a[66:67], v96 offset:2048
ds_read_b64_tr_b16 a[68:69], v96 offset:4096
ds_read_b64_tr_b16 a[70:71], v96 offset:6144
ds_read_b64_tr_b16 a[72:73], v96 offset:8192
ds_read_b64_tr_b16 a[74:75], v96 offset:10240
ds_read_b64_tr_b16 a[76:77], v96 offset:12288
ds_read_b64_tr_b16 a[78:79], v96 offset:14336
ds_read_b64_tr_b16 a[80:81], v96 offset:16384
ds_read_b64_tr_b16 a[82:83], v96 offset:18432
ds_read_b64_tr_b16 a[84:85], v96 offset:20480
ds_read_b64_tr_b16 a[86:87], v96 offset:22528
ds_read_b64_tr_b16 a[88:89], v96 offset:24576
ds_read_b64_tr_b16 a[90:91], v96 offset:26624
ds_read_b64_tr_b16 a[92:93], v96 offset:28672
ds_read_b64_tr_b16 a[94:95], v96 offset:30720
ds_read_b64_tr_b16 a[96:97], v104 offset:0
ds_read_b64_tr_b16 a[98:99], v104 offset:2048
ds_read_b64_tr_b16 a[100:101], v97 offset:0
ds_read_b64_tr_b16 a[102:103], v97 offset:2048
ds_read_b64_tr_b16 a[104:105], v97 offset:4096
ds_read_b64_tr_b16 a[106:107], v97 offset:6144
ds_read_b64_tr_b16 a[108:109], v97 offset:8192
ds_read_b64_tr_b16 a[110:111], v97 offset:10240
ds_read_b64_tr_b16 a[112:113], v97 offset:12288
ds_read_b64_tr_b16 a[114:115], v97 offset:14336
ds_read_b64_tr_b16 a[116:117], v97 offset:16384
v_mul_f32 v240, v240, v28
v_mul_f32 v241, v241, v28
v_mul_f32 v242, v242, v28
v_mul_f32 v243, v243, v28
v_mul_f32 v248, v248, v28
v_mul_f32 v249, v249, v28
v_mul_f32 v250, v250, v28
v_mul_f32 v251, v251, v28
v_cvt_pk_bf16_f32 v60, v240, v241
v_cvt_pk_bf16_f32 v61, v242, v243
v_cvt_pk_bf16_f32 v62, v248, v249
v_cvt_pk_bf16_f32 v63, v250, v251
v_mul_f32 v244, v244, v29
v_mul_f32 v245, v245, v29
v_mul_f32 v246, v246, v29
v_mul_f32 v247, v247, v29
v_mul_f32 v252, v252, v29
v_mul_f32 v253, v253, v29
v_mul_f32 v254, v254, v29
v_mul_f32 v255, v255, v29
v_cvt_pk_bf16_f32 v92, v244, v245
v_cvt_pk_bf16_f32 v93, v246, v247
v_cvt_pk_bf16_f32 v94, v252, v253
v_cvt_pk_bf16_f32 v95, v254, v255
s_branch L_k2_proj
L_k2_merge:
s_waitcnt lgkmcnt(8)
v_mfma_f32_16x16x32_bf16 v[128:131], a[64:67], v[112:115], v[128:131]
ds_read_b128 a[128:131], v13 offset:40960
v_lshrrev_b32 v108, 6, v19
v_and_b32 v109, 6, v108
v_lshlrev_b32 v108, 7, v108
v_bfe_u32 v110, v19, 4, 2
v_lshl_add_u32 v108, v110, 3, v108
v_xor_b32 v110, 0, v109
v_lshl_add_u32 v96, v110, 4, v108
v_add_u32 v100, 0x10000, v96
v_add_u32 v104, 131072, v96
v_mfma_f32_16x16x32_bf16 v[128:131], a[68:71], v[120:123], v[128:131]
s_add_u32 m0, s23, 32768
ds_read_b128 a[132:135], v13 offset:57344
v_xor_b32 v110, 2, v109
v_lshl_add_u32 v97, v110, 4, v108
v_add_u32 v101, 0x10000, v97
v_add_u32 v105, 131072, v97
v_xor_b32 v110, 4, v109
v_lshl_add_u32 v98, v110, 4, v108
v_add_u32 v102, 0x10000, v98
v_add_u32 v106, 131072, v98
v_mfma_f32_16x16x32_bf16 v[132:135], a[64:67], v[116:119], v[132:135]
buffer_load_dwordx4 v10, s[8:11], s68 offen offset:0 lds
v_xor_b32 v110, 6, v109
v_lshl_add_u32 v99, v110, 4, v108
v_add_u32 v103, 0x10000, v99
v_add_u32 v107, 131072, v99
v_mov_b32 v28, v14
s_nop 1
v_permlane32_swap_b32 v28, v14
v_mfma_f32_16x16x32_bf16 v[132:135], a[68:71], v[124:127], v[132:135]
ds_read_b128 a[136:139], v13 offset:41984
v_add_f32 v14, v14, v28
v_mov_b32 v28, v14
s_nop 1
v_permlane16_swap_b32 v28, v14
v_add_f32 v14, v14, v28
v_mov_b32 v28, v15
s_nop 1
v_mfma_f32_16x16x32_bf16 v[136:139], a[72:75], v[112:115], v[136:139]
ds_read_b128 a[140:143], v13 offset:58368
buffer_load_dwordx4 v10, s[8:11], s69 offen offset:1024 lds
v_permlane32_swap_b32 v28, v15
v_add_f32 v15, v15, v28
v_mov_b32 v28, v15
s_nop 1
v_permlane16_swap_b32 v28, v15
v_add_f32 v15, v15, v28
v_mfma_f32_16x16x32_bf16 v[136:139], a[76:79], v[120:123], v[136:139]
s_waitcnt vmcnt(18)
v_accvgpr_read_b32 v16, a204
v_accvgpr_read_b32 v17, a205
v_accvgpr_read_b32 v2, a192
v_accvgpr_read_b32 v3, a193
v_accvgpr_read_b32 v4, a194
v_accvgpr_read_b32 v5, a195
v_min_f32 v6, v20, v2
v_sub_f32 v28, v6, v20
v_sub_f32 v30, v6, v2
v_mfma_f32_16x16x32_bf16 v[140:143], a[72:75], v[116:119], v[140:143]
v_exp_f32 v28, v28
ds_read_b128 a[144:147], v13 offset:43008
v_exp_f32 v30, v30
s_nop 0
v_mul_f32 v4, v30, v4
v_fma_f32 v14, v14, v28, v4
v_rcp_f32 v6, v14
v_mfma_f32_16x16x32_bf16 v[140:143], a[76:79], v[124:127], v[140:143]
buffer_load_dwordx4 v10, s[8:11], s70 offen offset:2048 lds
s_nop 0
v_mul_f32 v6, v6, v16
v_mul_f32 v28, v28, v6
v_mul_f32 v30, v30, v6
v_min_f32 v6, v24, v3
v_sub_f32 v29, v6, v24
v_sub_f32 v31, v6, v3
v_mfma_f32_16x16x32_bf16 v[144:147], a[80:83], v[112:115], v[144:147]
v_exp_f32 v29, v29
ds_read_b128 a[148:151], v13 offset:59392
v_exp_f32 v31, v31
s_nop 0
v_mul_f32 v5, v31, v5
v_fma_f32 v15, v15, v29, v5
v_rcp_f32 v6, v15
v_mfma_f32_16x16x32_bf16 v[144:147], a[84:87], v[120:123], v[144:147]
ds_read_b128 a[152:155], v13 offset:44032
s_nop 0
v_mul_f32 v6, v6, v17
v_mul_f32 v29, v29, v6
v_mul_f32 v31, v31, v6
s_mov_b32 s35, 0xffff0000
s_waitcnt vmcnt(18)
v_accvgpr_read_b32 v3, a0
v_lshlrev_b32 v2, 16, v3
v_and_b32 v3, s35, v3
v_mfma_f32_16x16x32_bf16 v[148:151], a[80:83], v[116:119], v[148:151]
buffer_load_dwordx4 v10, s[8:11], s71 offen offset:3072 lds
v_mul_f32 v2, v2, v30
v_mul_f32 v3, v3, v30
v_accvgpr_read_b32 v5, a1
v_lshlrev_b32 v4, 16, v5
v_and_b32 v5, s35, v5
v_mul_f32 v4, v4, v30
v_mul_f32 v5, v5, v30
v_accvgpr_read_b32 v7, a2
v_mfma_f32_16x16x32_bf16 v[148:151], a[84:87], v[124:127], v[148:151]
ds_read_b128 a[156:159], v13 offset:60416
s_add_u32 m0, s23, 36864
v_lshlrev_b32 v6, 16, v7
v_and_b32 v7, s35, v7
v_mul_f32 v6, v6, v30
v_mul_f32 v7, v7, v30
v_accvgpr_read_b32 v9, a3
v_lshlrev_b32 v8, 16, v9
v_and_b32 v9, s35, v9
v_mul_f32 v8, v8, v30
v_mfma_f32_16x16x32_bf16 v[152:155], a[88:91], v[112:115], v[152:155]
v_mul_f32 v9, v9, v30
v_fmac_f32 v2, v128, v28
v_fmac_f32 v3, v129, v28
v_fmac_f32 v4, v130, v28
v_fmac_f32 v5, v131, v28
v_fmac_f32 v6, v136, v28
v_fmac_f32 v7, v137, v28
v_fmac_f32 v8, v138, v28
v_fmac_f32 v9, v139, v28
v_cvt_pk_bf16_f32 v32, v2, v3
v_mfma_f32_16x16x32_bf16 v[152:155], a[92:95], v[120:123], v[152:155]
ds_read_b128 a[160:163], v13 offset:45056
buffer_load_dwordx4 v10, s[8:11], s72 offen offset:0 lds
v_cvt_pk_bf16_f32 v33, v4, v5
v_cvt_pk_bf16_f32 v34, v6, v7
v_cvt_pk_bf16_f32 v35, v8, v9
s_waitcnt vmcnt(19)
v_accvgpr_read_b32 v3, a32
v_lshlrev_b32 v2, 16, v3
v_and_b32 v3, s35, v3
v_mfma_f32_16x16x32_bf16 v[156:159], a[88:91], v[116:119], v[156:159]
ds_read_b128 a[164:167], v13 offset:61440
v_mul_f32 v2, v2, v31
v_mul_f32 v3, v3, v31
v_accvgpr_read_b32 v5, a33
v_lshlrev_b32 v4, 16, v5
v_and_b32 v5, s35, v5
v_mul_f32 v4, v4, v31
v_mul_f32 v5, v5, v31
v_accvgpr_read_b32 v7, a34
v_lshlrev_b32 v6, 16, v7
v_mfma_f32_16x16x32_bf16 v[156:159], a[92:95], v[124:127], v[156:159]
v_and_b32 v7, s35, v7
v_mul_f32 v6, v6, v31
v_mul_f32 v7, v7, v31
v_accvgpr_read_b32 v9, a35
v_lshlrev_b32 v8, 16, v9
v_and_b32 v9, s35, v9
v_mul_f32 v8, v8, v31
v_mul_f32 v9, v9, v31
v_fmac_f32 v2, v132, v29
s_waitcnt lgkmcnt(10)
v_mfma_f32_16x16x32_bf16 v[160:163], a[96:99], v[112:115], v[160:163]
ds_read_b128 a[168:171], v13 offset:46080
buffer_load_dwordx4 v10, s[8:11], s73 offen offset:1024 lds
v_fmac_f32 v3, v133, v29
v_fmac_f32 v4, v134, v29
v_fmac_f32 v5, v135, v29
v_fmac_f32 v6, v140, v29
v_fmac_f32 v7, v141, v29
v_fmac_f32 v8, v142, v29
v_fmac_f32 v9, v143, v29
v_mfma_f32_16x16x32_bf16 v[160:163], a[100:103], v[120:123], v[160:163]
ds_read_b128 a[172:175], v13 offset:62464
v_cvt_pk_bf16_f32 v64, v2, v3
v_cvt_pk_bf16_f32 v65, v4, v5
v_cvt_pk_bf16_f32 v66, v6, v7
v_cvt_pk_bf16_f32 v67, v8, v9
s_waitcnt vmcnt(19)
v_accvgpr_read_b32 v3, a4
v_lshlrev_b32 v2, 16, v3
v_and_b32 v3, s35, v3
v_mul_f32 v2, v2, v30
v_mfma_f32_16x16x32_bf16 v[164:167], a[96:99], v[116:119], v[164:167]
v_mul_f32 v3, v3, v30
v_accvgpr_read_b32 v5, a5
v_lshlrev_b32 v4, 16, v5
v_and_b32 v5, s35, v5
v_mul_f32 v4, v4, v30
v_mul_f32 v5, v5, v30
v_accvgpr_read_b32 v7, a6
v_lshlrev_b32 v6, 16, v7
v_and_b32 v7, s35, v7
v_mul_f32 v6, v6, v30
v_mfma_f32_16x16x32_bf16 v[164:167], a[100:103], v[124:127], v[164:167]
ds_read_b128 a[176:179], v13 offset:47104
buffer_load_dwordx4 v10, s[8:11], s74 offen offset:2048 lds
v_mul_f32 v7, v7, v30
v_accvgpr_read_b32 v9, a7
v_lshlrev_b32 v8, 16, v9
v_and_b32 v9, s35, v9
v_mul_f32 v8, v8, v30
v_mul_f32 v9, v9, v30
v_fmac_f32 v2, v144, v28
v_mfma_f32_16x16x32_bf16 v[168:171], a[104:107], v[112:115], v[168:171]
v_fmac_f32 v3, v145, v28
v_fmac_f32 v4, v146, v28
v_fmac_f32 v5, v147, v28
v_fmac_f32 v6, v152, v28
v_fmac_f32 v7, v153, v28
v_fmac_f32 v8, v154, v28
v_fmac_f32 v9, v155, v28
v_cvt_pk_bf16_f32 v36, v2, v3
v_cvt_pk_bf16_f32 v37, v4, v5
v_cvt_pk_bf16_f32 v38, v6, v7
v_mfma_f32_16x16x32_bf16 v[168:171], a[108:111], v[120:123], v[168:171]
ds_read_b128 a[180:183], v13 offset:63488
v_cvt_pk_bf16_f32 v39, v8, v9
s_waitcnt vmcnt(19)
v_accvgpr_read_b32 v3, a36
v_lshlrev_b32 v2, 16, v3
v_and_b32 v3, s35, v3
v_mul_f32 v2, v2, v31
v_mul_f32 v3, v3, v31
v_accvgpr_read_b32 v5, a37
v_lshlrev_b32 v4, 16, v5
v_mfma_f32_16x16x32_bf16 v[172:175], a[104:107], v[116:119], v[172:175]
ds_read_b128 a[184:187], v13 offset:48128
buffer_load_dwordx4 v10, s[8:11], s75 offen offset:3072 lds
v_and_b32 v5, s35, v5
v_mul_f32 v4, v4, v31
v_mul_f32 v5, v5, v31
v_accvgpr_read_b32 v7, a38
v_lshlrev_b32 v6, 16, v7
v_and_b32 v7, s35, v7
v_mul_f32 v6, v6, v31
v_mfma_f32_16x16x32_bf16 v[172:175], a[108:111], v[124:127], v[172:175]
s_add_u32 m0, s39, 135168
v_mul_f32 v7, v7, v31
v_accvgpr_read_b32 v9, a39
v_lshlrev_b32 v8, 16, v9
v_and_b32 v9, s35, v9
v_mul_f32 v8, v8, v31
v_mul_f32 v9, v9, v31
v_fmac_f32 v2, v148, v29
v_fmac_f32 v3, v149, v29
v_fmac_f32 v4, v150, v29
v_mfma_f32_16x16x32_bf16 v[176:179], a[112:115], v[112:115], v[176:179]
ds_read_b128 a[188:191], v13 offset:64512
v_fmac_f32 v5, v151, v29
v_fmac_f32 v6, v156, v29
v_fmac_f32 v7, v157, v29
v_fmac_f32 v8, v158, v29
v_fmac_f32 v9, v159, v29
v_cvt_pk_bf16_f32 v68, v2, v3
v_cvt_pk_bf16_f32 v69, v4, v5
v_cvt_pk_bf16_f32 v70, v6, v7
v_cvt_pk_bf16_f32 v71, v8, v9
v_mfma_f32_16x16x32_bf16 v[176:179], a[116:119], v[120:123], v[176:179]
buffer_load_dwordx4 v0, s[92:95], s32 offen lds
s_waitcnt vmcnt(20)
v_accvgpr_read_b32 v3, a8
v_lshlrev_b32 v2, 16, v3
v_and_b32 v3, s35, v3
v_mul_f32 v2, v2, v30
v_mul_f32 v3, v3, v30
v_accvgpr_read_b32 v5, a9
v_lshlrev_b32 v4, 16, v5
v_mfma_f32_16x16x32_bf16 v[180:183], a[112:115], v[116:119], v[180:183]
s_add_u32 s8, s8, 128
s_addc_u32 s9, s9, 0
s_sub_u32 s10, s10, 128
s_add_u32 s32, s32, 128
v_and_b32 v5, s35, v5
v_mul_f32 v4, v4, v30
v_mul_f32 v5, v5, v30
v_accvgpr_read_b32 v7, a10
v_lshlrev_b32 v6, 16, v7
v_and_b32 v7, s35, v7
v_mfma_f32_16x16x32_bf16 v[180:183], a[116:119], v[124:127], v[180:183]
v_mul_f32 v6, v6, v30
v_mul_f32 v7, v7, v30
v_accvgpr_read_b32 v9, a11
v_lshlrev_b32 v8, 16, v9
v_and_b32 v9, s35, v9
v_mul_f32 v8, v8, v30
v_mul_f32 v9, v9, v30
v_fmac_f32 v2, v160, v28
v_fmac_f32 v3, v161, v28
v_fmac_f32 v4, v162, v28
v_mfma_f32_16x16x32_bf16 v[184:187], a[120:123], v[112:115], v[184:187]
v_fmac_f32 v5, v163, v28
v_fmac_f32 v6, v168, v28
v_fmac_f32 v7, v169, v28
v_fmac_f32 v8, v170, v28
v_fmac_f32 v9, v171, v28
v_cvt_pk_bf16_f32 v40, v2, v3
v_cvt_pk_bf16_f32 v41, v4, v5
v_cvt_pk_bf16_f32 v42, v6, v7
v_cvt_pk_bf16_f32 v43, v8, v9
s_waitcnt vmcnt(19)
v_mfma_f32_16x16x32_bf16 v[184:187], a[124:127], v[120:123], v[184:187]
v_accvgpr_read_b32 v3, a40
v_lshlrev_b32 v2, 16, v3
v_and_b32 v3, s35, v3
v_mul_f32 v2, v2, v31
v_mul_f32 v3, v3, v31
v_accvgpr_read_b32 v5, a41
v_lshlrev_b32 v4, 16, v5
v_and_b32 v5, s35, v5
v_mul_f32 v4, v4, v31
v_mul_f32 v5, v5, v31
v_mfma_f32_16x16x32_bf16 v[188:191], a[120:123], v[116:119], v[188:191]
v_accvgpr_read_b32 v7, a42
v_lshlrev_b32 v6, 16, v7
v_and_b32 v7, s35, v7
v_mul_f32 v6, v6, v31
v_mul_f32 v7, v7, v31
v_accvgpr_read_b32 v9, a43
v_lshlrev_b32 v8, 16, v9
v_and_b32 v9, s35, v9
v_mul_f32 v8, v8, v31
v_mul_f32 v9, v9, v31
v_mfma_f32_16x16x32_bf16 v[188:191], a[124:127], v[124:127], v[188:191]
v_fmac_f32 v2, v164, v29
v_fmac_f32 v3, v165, v29
v_fmac_f32 v4, v166, v29
v_fmac_f32 v5, v167, v29
v_fmac_f32 v6, v172, v29
v_fmac_f32 v7, v173, v29
v_fmac_f32 v8, v174, v29
v_fmac_f32 v9, v175, v29
v_cvt_pk_bf16_f32 v72, v2, v3
v_cvt_pk_bf16_f32 v73, v4, v5
s_waitcnt lgkmcnt(8)
v_mfma_f32_16x16x32_bf16 v[192:195], a[128:131], v[112:115], v[192:195]
v_cvt_pk_bf16_f32 v74, v6, v7
v_cvt_pk_bf16_f32 v75, v8, v9
s_waitcnt vmcnt(18)
v_accvgpr_read_b32 v3, a12
v_lshlrev_b32 v2, 16, v3
v_and_b32 v3, s35, v3
v_mul_f32 v2, v2, v30
v_mul_f32 v3, v3, v30
v_accvgpr_read_b32 v5, a13
v_lshlrev_b32 v4, 16, v5
v_mfma_f32_16x16x32_bf16 v[192:195], a[132:135], v[120:123], v[192:195]
v_and_b32 v5, s35, v5
v_mul_f32 v4, v4, v30
v_mul_f32 v5, v5, v30
v_accvgpr_read_b32 v7, a14
v_lshlrev_b32 v6, 16, v7
v_and_b32 v7, s35, v7
v_mul_f32 v6, v6, v30
v_mul_f32 v7, v7, v30
v_accvgpr_read_b32 v9, a15
v_lshlrev_b32 v8, 16, v9
v_mfma_f32_16x16x32_bf16 v[196:199], a[128:131], v[116:119], v[196:199]
s_add_u32 m0, s23, 65536
v_and_b32 v9, s35, v9
v_mul_f32 v8, v8, v30
v_mul_f32 v9, v9, v30
v_mfma_f32_16x16x32_bf16 v[196:199], a[132:135], v[124:127], v[196:199]
buffer_load_dwordx4 v10, s[8:11], s68 offen offset:0 lds
v_fmac_f32 v2, v176, v28
v_fmac_f32 v3, v177, v28
v_fmac_f32 v4, v178, v28
v_fmac_f32 v5, v179, v28
v_fmac_f32 v6, v184, v28
v_fmac_f32 v7, v185, v28
v_fmac_f32 v8, v186, v28
v_fmac_f32 v9, v187, v28
v_mfma_f32_16x16x32_bf16 v[200:203], a[136:139], v[112:115], v[200:203]
v_cvt_pk_bf16_f32 v44, v2, v3
v_cvt_pk_bf16_f32 v45, v4, v5
v_cvt_pk_bf16_f32 v46, v6, v7
v_cvt_pk_bf16_f32 v47, v8, v9
s_waitcnt vmcnt(18)
v_accvgpr_read_b32 v3, a44
v_lshlrev_b32 v2, 16, v3
v_and_b32 v3, s35, v3
v_mul_f32 v2, v2, v31
v_mul_f32 v3, v3, v31
v_mfma_f32_16x16x32_bf16 v[200:203], a[140:143], v[120:123], v[200:203]
buffer_load_dwordx4 v10, s[8:11], s69 offen offset:1024 lds
v_accvgpr_read_b32 v5, a45
v_lshlrev_b32 v4, 16, v5
v_and_b32 v5, s35, v5
v_mul_f32 v4, v4, v31
v_mul_f32 v5, v5, v31
v_accvgpr_read_b32 v7, a46
v_lshlrev_b32 v6, 16, v7
v_and_b32 v7, s35, v7
v_mfma_f32_16x16x32_bf16 v[204:207], a[136:139], v[116:119], v[204:207]
v_mul_f32 v6, v6, v31
v_mul_f32 v7, v7, v31
v_accvgpr_read_b32 v9, a47
v_lshlrev_b32 v8, 16, v9
v_and_b32 v9, s35, v9
v_mul_f32 v8, v8, v31
v_mul_f32 v9, v9, v31
v_fmac_f32 v2, v180, v29
v_fmac_f32 v3, v181, v29
v_fmac_f32 v4, v182, v29
v_mfma_f32_16x16x32_bf16 v[204:207], a[140:143], v[124:127], v[204:207]
v_fmac_f32 v5, v183, v29
v_fmac_f32 v6, v188, v29
v_fmac_f32 v7, v189, v29
v_fmac_f32 v8, v190, v29
v_fmac_f32 v9, v191, v29
v_cvt_pk_bf16_f32 v76, v2, v3
v_cvt_pk_bf16_f32 v77, v4, v5
v_cvt_pk_bf16_f32 v78, v6, v7
v_cvt_pk_bf16_f32 v79, v8, v9
s_waitcnt vmcnt(18)
v_mfma_f32_16x16x32_bf16 v[208:211], a[144:147], v[112:115], v[208:211]
buffer_load_dwordx4 v10, s[8:11], s70 offen offset:2048 lds
v_accvgpr_read_b32 v3, a16
v_lshlrev_b32 v2, 16, v3
v_and_b32 v3, s35, v3
v_mul_f32 v2, v2, v30
v_mul_f32 v3, v3, v30
v_accvgpr_read_b32 v5, a17
v_lshlrev_b32 v4, 16, v5
v_and_b32 v5, s35, v5
v_mfma_f32_16x16x32_bf16 v[208:211], a[148:151], v[120:123], v[208:211]
v_mul_f32 v4, v4, v30
v_mul_f32 v5, v5, v30
v_accvgpr_read_b32 v7, a18
v_lshlrev_b32 v6, 16, v7
v_and_b32 v7, s35, v7
v_mul_f32 v6, v6, v30
v_mul_f32 v7, v7, v30
v_accvgpr_read_b32 v9, a19
v_lshlrev_b32 v8, 16, v9
v_and_b32 v9, s35, v9
v_mfma_f32_16x16x32_bf16 v[212:215], a[144:147], v[116:119], v[212:215]
v_mul_f32 v8, v8, v30
v_mul_f32 v9, v9, v30
v_mfma_f32_16x16x32_bf16 v[212:215], a[148:151], v[124:127], v[212:215]
buffer_load_dwordx4 v10, s[8:11], s71 offen offset:3072 lds
v_fmac_f32 v2, v192, v28
v_fmac_f32 v3, v193, v28
v_fmac_f32 v4, v194, v28
v_fmac_f32 v5, v195, v28
v_fmac_f32 v6, v200, v28
v_fmac_f32 v7, v201, v28
v_fmac_f32 v8, v202, v28
v_fmac_f32 v9, v203, v28
v_mfma_f32_16x16x32_bf16 v[216:219], a[152:155], v[112:115], v[216:219]
s_add_u32 m0, s23, 69632
v_cvt_pk_bf16_f32 v48, v2, v3
v_cvt_pk_bf16_f32 v49, v4, v5
v_cvt_pk_bf16_f32 v50, v6, v7
v_cvt_pk_bf16_f32 v51, v8, v9
s_waitcnt vmcnt(19)
v_accvgpr_read_b32 v3, a48
v_lshlrev_b32 v2, 16, v3
v_and_b32 v3, s35, v3
v_mul_f32 v2, v2, v31
v_mfma_f32_16x16x32_bf16 v[216:219], a[156:159], v[120:123], v[216:219]
v_mul_f32 v3, v3, v31
v_accvgpr_read_b32 v5, a49
v_lshlrev_b32 v4, 16, v5
v_and_b32 v5, s35, v5
v_mul_f32 v4, v4, v31
v_mul_f32 v5, v5, v31
v_accvgpr_read_b32 v7, a50
v_lshlrev_b32 v6, 16, v7
v_and_b32 v7, s35, v7
v_mul_f32 v6, v6, v31
v_mfma_f32_16x16x32_bf16 v[220:223], a[152:155], v[116:119], v[220:223]
buffer_load_dwordx4 v10, s[8:11], s72 offen offset:0 lds
v_mul_f32 v7, v7, v31
v_accvgpr_read_b32 v9, a51
v_lshlrev_b32 v8, 16, v9
v_and_b32 v9, s35, v9
v_mul_f32 v8, v8, v31
v_mul_f32 v9, v9, v31
v_fmac_f32 v2, v196, v29
v_fmac_f32 v3, v197, v29
v_mfma_f32_16x16x32_bf16 v[220:223], a[156:159], v[124:127], v[220:223]
v_fmac_f32 v4, v198, v29
v_fmac_f32 v5, v199, v29
v_fmac_f32 v6, v204, v29
v_fmac_f32 v7, v205, v29
v_fmac_f32 v8, v206, v29
v_fmac_f32 v9, v207, v29
v_cvt_pk_bf16_f32 v80, v2, v3
v_cvt_pk_bf16_f32 v81, v4, v5
v_cvt_pk_bf16_f32 v82, v6, v7
v_cvt_pk_bf16_f32 v83, v8, v9
s_waitcnt lgkmcnt(0)
v_mfma_f32_16x16x32_bf16 v[224:227], a[160:163], v[112:115], v[224:227]
s_waitcnt vmcnt(19)
v_accvgpr_read_b32 v3, a20
v_lshlrev_b32 v2, 16, v3
v_and_b32 v3, s35, v3
v_mul_f32 v2, v2, v30
v_mul_f32 v3, v3, v30
v_accvgpr_read_b32 v5, a21
v_lshlrev_b32 v4, 16, v5
v_and_b32 v5, s35, v5
v_mul_f32 v4, v4, v30
v_mfma_f32_16x16x32_bf16 v[224:227], a[164:167], v[120:123], v[224:227]
buffer_load_dwordx4 v10, s[8:11], s73 offen offset:1024 lds
v_mul_f32 v5, v5, v30
v_accvgpr_read_b32 v7, a22
v_lshlrev_b32 v6, 16, v7
v_and_b32 v7, s35, v7
v_mul_f32 v6, v6, v30
v_mul_f32 v7, v7, v30
v_accvgpr_read_b32 v9, a23
v_lshlrev_b32 v8, 16, v9
v_mfma_f32_16x16x32_bf16 v[228:231], a[160:163], v[116:119], v[228:231]
v_and_b32 v9, s35, v9
v_mul_f32 v8, v8, v30
v_mul_f32 v9, v9, v30
v_mfma_f32_16x16x32_bf16 v[228:231], a[164:167], v[124:127], v[228:231]
v_fmac_f32 v2, v208, v28
v_fmac_f32 v3, v209, v28
v_fmac_f32 v4, v210, v28
v_fmac_f32 v5, v211, v28
v_fmac_f32 v6, v216, v28
v_fmac_f32 v7, v217, v28
v_fmac_f32 v8, v218, v28
v_fmac_f32 v9, v219, v28
v_cvt_pk_bf16_f32 v52, v2, v3
v_cvt_pk_bf16_f32 v53, v4, v5
v_mfma_f32_16x16x32_bf16 v[232:235], a[168:171], v[112:115], v[232:235]
buffer_load_dwordx4 v10, s[8:11], s74 offen offset:2048 lds
v_cvt_pk_bf16_f32 v54, v6, v7
v_cvt_pk_bf16_f32 v55, v8, v9
s_waitcnt vmcnt(20)
v_accvgpr_read_b32 v3, a52
v_lshlrev_b32 v2, 16, v3
v_and_b32 v3, s35, v3
v_mul_f32 v2, v2, v31
v_mul_f32 v3, v3, v31
v_mfma_f32_16x16x32_bf16 v[232:235], a[172:175], v[120:123], v[232:235]
v_accvgpr_read_b32 v5, a53
v_lshlrev_b32 v4, 16, v5
v_and_b32 v5, s35, v5
v_mul_f32 v4, v4, v31
v_mul_f32 v5, v5, v31
v_accvgpr_read_b32 v7, a54
v_lshlrev_b32 v6, 16, v7
v_and_b32 v7, s35, v7
v_mul_f32 v6, v6, v31
v_mul_f32 v7, v7, v31
v_mfma_f32_16x16x32_bf16 v[236:239], a[168:171], v[116:119], v[236:239]
v_accvgpr_read_b32 v9, a55
v_lshlrev_b32 v8, 16, v9
v_and_b32 v9, s35, v9
v_mul_f32 v8, v8, v31
v_mul_f32 v9, v9, v31
v_fmac_f32 v2, v212, v29
v_fmac_f32 v3, v213, v29
v_fmac_f32 v4, v214, v29
v_fmac_f32 v5, v215, v29
v_fmac_f32 v6, v220, v29
v_mfma_f32_16x16x32_bf16 v[236:239], a[172:175], v[124:127], v[236:239]
buffer_load_dwordx4 v10, s[8:11], s75 offen offset:3072 lds
v_fmac_f32 v7, v221, v29
v_fmac_f32 v8, v222, v29
v_fmac_f32 v9, v223, v29
v_cvt_pk_bf16_f32 v84, v2, v3
v_cvt_pk_bf16_f32 v85, v4, v5
v_cvt_pk_bf16_f32 v86, v6, v7
v_cvt_pk_bf16_f32 v87, v8, v9
s_waitcnt vmcnt(20)
v_mfma_f32_16x16x32_bf16 v[240:243], a[176:179], v[112:115], v[240:243]
s_add_u32 m0, s39, 139264
v_accvgpr_read_b32 v3, a24
v_lshlrev_b32 v2, 16, v3
v_and_b32 v3, s35, v3
v_mul_f32 v2, v2, v30
v_mul_f32 v3, v3, v30
v_accvgpr_read_b32 v5, a25
v_lshlrev_b32 v4, 16, v5
v_and_b32 v5, s35, v5
v_mul_f32 v4, v4, v30
v_mfma_f32_16x16x32_bf16 v[240:243], a[180:183], v[120:123], v[240:243]
v_mul_f32 v5, v5, v30
v_accvgpr_read_b32 v7, a26
v_lshlrev_b32 v6, 16, v7
v_and_b32 v7, s35, v7
v_mul_f32 v6, v6, v30
v_mul_f32 v7, v7, v30
v_accvgpr_read_b32 v9, a27
v_lshlrev_b32 v8, 16, v9
v_and_b32 v9, s35, v9
v_mul_f32 v8, v8, v30
v_mfma_f32_16x16x32_bf16 v[244:247], a[176:179], v[116:119], v[244:247]
buffer_load_dwordx4 v0, s[92:95], s32 offen lds
v_mul_f32 v9, v9, v30
v_mfma_f32_16x16x32_bf16 v[244:247], a[180:183], v[124:127], v[244:247]
s_add_u32 s8, s8, 128
s_addc_u32 s9, s9, 0
s_sub_u32 s10, s10, 128
s_add_u32 s32, s32, 128
v_fmac_f32 v2, v224, v28
v_fmac_f32 v3, v225, v28
v_fmac_f32 v4, v226, v28
v_fmac_f32 v5, v227, v28
v_fmac_f32 v6, v232, v28
v_fmac_f32 v7, v233, v28
v_mfma_f32_16x16x32_bf16 v[248:251], a[184:187], v[112:115], v[248:251]
v_fmac_f32 v8, v234, v28
v_fmac_f32 v9, v235, v28
v_cvt_pk_bf16_f32 v56, v2, v3
v_cvt_pk_bf16_f32 v57, v4, v5
v_cvt_pk_bf16_f32 v58, v6, v7
v_cvt_pk_bf16_f32 v59, v8, v9
s_waitcnt vmcnt(20)
v_accvgpr_read_b32 v3, a56
v_lshlrev_b32 v2, 16, v3
v_and_b32 v3, s35, v3
v_mfma_f32_16x16x32_bf16 v[248:251], a[188:191], v[120:123], v[248:251]
v_mul_f32 v2, v2, v31
v_mul_f32 v3, v3, v31
v_accvgpr_read_b32 v5, a57
v_lshlrev_b32 v4, 16, v5
v_and_b32 v5, s35, v5
v_mul_f32 v4, v4, v31
v_mul_f32 v5, v5, v31
v_accvgpr_read_b32 v7, a58
v_lshlrev_b32 v6, 16, v7
v_and_b32 v7, s35, v7
v_mfma_f32_16x16x32_bf16 v[252:255], a[184:187], v[116:119], v[252:255]
v_mul_f32 v6, v6, v31
v_mul_f32 v7, v7, v31
v_accvgpr_read_b32 v9, a59
v_lshlrev_b32 v8, 16, v9
v_and_b32 v9, s35, v9
v_mul_f32 v8, v8, v31
v_mul_f32 v9, v9, v31
v_fmac_f32 v2, v228, v29
v_fmac_f32 v3, v229, v29
v_fmac_f32 v4, v230, v29
v_mfma_f32_16x16x32_bf16 v[252:255], a[188:191], v[124:127], v[252:255]
v_fmac_f32 v5, v231, v29
v_fmac_f32 v6, v236, v29
v_fmac_f32 v7, v237, v29
v_fmac_f32 v8, v238, v29
v_fmac_f32 v9, v239, v29
v_cvt_pk_bf16_f32 v88, v2, v3
v_cvt_pk_bf16_f32 v89, v4, v5
v_cvt_pk_bf16_f32 v90, v6, v7
v_cvt_pk_bf16_f32 v91, v8, v9
s_waitcnt vmcnt(9)
s_barrier
ds_read_b64_tr_b16 a[64:65], v96 offset:0
ds_read_b64_tr_b16 a[66:67], v96 offset:2048
ds_read_b64_tr_b16 a[68:69], v96 offset:4096
ds_read_b64_tr_b16 a[70:71], v96 offset:6144
ds_read_b64_tr_b16 a[72:73], v96 offset:8192
ds_read_b64_tr_b16 a[74:75], v96 offset:10240
ds_read_b64_tr_b16 a[76:77], v96 offset:12288
ds_read_b64_tr_b16 a[78:79], v96 offset:14336
ds_read_b64_tr_b16 a[80:81], v96 offset:16384
ds_read_b64_tr_b16 a[82:83], v96 offset:18432
ds_read_b64_tr_b16 a[84:85], v96 offset:20480
ds_read_b64_tr_b16 a[86:87], v96 offset:22528
ds_read_b64_tr_b16 a[88:89], v96 offset:24576
ds_read_b64_tr_b16 a[90:91], v96 offset:26624
ds_read_b64_tr_b16 a[92:93], v96 offset:28672
ds_read_b64_tr_b16 a[94:95], v96 offset:30720
ds_read_b64_tr_b16 a[96:97], v104 offset:0
ds_read_b64_tr_b16 a[98:99], v104 offset:2048
ds_read_b64_tr_b16 a[100:101], v97 offset:0
ds_read_b64_tr_b16 a[102:103], v97 offset:2048
ds_read_b64_tr_b16 a[104:105], v97 offset:4096
ds_read_b64_tr_b16 a[106:107], v97 offset:6144
ds_read_b64_tr_b16 a[108:109], v97 offset:8192
ds_read_b64_tr_b16 a[110:111], v97 offset:10240
ds_read_b64_tr_b16 a[112:113], v97 offset:12288
ds_read_b64_tr_b16 a[114:115], v97 offset:14336
ds_read_b64_tr_b16 a[116:117], v97 offset:16384
s_waitcnt vmcnt(19)
v_accvgpr_read_b32 v3, a28
v_lshlrev_b32 v2, 16, v3
v_and_b32 v3, s35, v3
v_mul_f32 v2, v2, v30
v_mul_f32 v3, v3, v30
v_accvgpr_read_b32 v5, a29
v_lshlrev_b32 v4, 16, v5
v_and_b32 v5, s35, v5
v_mul_f32 v4, v4, v30
v_mul_f32 v5, v5, v30
v_accvgpr_read_b32 v7, a30
v_lshlrev_b32 v6, 16, v7
v_and_b32 v7, s35, v7
v_mul_f32 v6, v6, v30
v_mul_f32 v7, v7, v30
v_accvgpr_read_b32 v9, a31
v_lshlrev_b32 v8, 16, v9
v_and_b32 v9, s35, v9
v_mul_f32 v8, v8, v30
v_mul_f32 v9, v9, v30
v_fmac_f32 v2, v240, v28
v_fmac_f32 v3, v241, v28
v_fmac_f32 v4, v242, v28
v_fmac_f32 v5, v243, v28
v_fmac_f32 v6, v248, v28
v_fmac_f32 v7, v249, v28
v_fmac_f32 v8, v250, v28
v_fmac_f32 v9, v251, v28
v_cvt_pk_bf16_f32 v60, v2, v3
v_cvt_pk_bf16_f32 v61, v4, v5
v_cvt_pk_bf16_f32 v62, v6, v7
v_cvt_pk_bf16_f32 v63, v8, v9
s_waitcnt vmcnt(18)
v_accvgpr_read_b32 v3, a60
v_lshlrev_b32 v2, 16, v3
v_and_b32 v3, s35, v3
v_mul_f32 v2, v2, v31
v_mul_f32 v3, v3, v31
v_accvgpr_read_b32 v5, a61
v_lshlrev_b32 v4, 16, v5
v_and_b32 v5, s35, v5
v_mul_f32 v4, v4, v31
v_mul_f32 v5, v5, v31
v_accvgpr_read_b32 v7, a62
v_lshlrev_b32 v6, 16, v7
v_and_b32 v7, s35, v7
v_mul_f32 v6, v6, v31
v_mul_f32 v7, v7, v31
v_accvgpr_read_b32 v9, a63
v_lshlrev_b32 v8, 16, v9
v_and_b32 v9, s35, v9
v_mul_f32 v8, v8, v31
v_mul_f32 v9, v9, v31
v_fmac_f32 v2, v244, v29
v_fmac_f32 v3, v245, v29
v_fmac_f32 v4, v246, v29
v_fmac_f32 v5, v247, v29
v_fmac_f32 v6, v252, v29
v_fmac_f32 v7, v253, v29
v_fmac_f32 v8, v254, v29
v_fmac_f32 v9, v255, v29
v_cvt_pk_bf16_f32 v92, v2, v3
v_cvt_pk_bf16_f32 v93, v4, v5
v_cvt_pk_bf16_f32 v94, v6, v7
v_cvt_pk_bf16_f32 v95, v8, v9
L_k2_proj:
s_lshl_b32 s34, s26, 4
s_add_u32 s34, s34, s24
s_mul_i32 s34, s34, 112
s_mul_i32 s35, s22, 28
s_add_u32 s34, s34, s35
s_lshl_b32 s34, s34, 10
s_add_u32 s34, s34, 117440512
s_add_u32 s60, s4, s34
s_addc_u32 s61, s5, 0
s_mov_b32 s62, 28672
s_lshl_b32 s34, s26, 2
s_add_u32 s34, s34, s22
s_lshl_b32 s34, s34, 4
s_add_u32 s34, s34, s24
s_lshl_b32 s34, s34, 4
s_add_u32 s34, s34, 104894464
s_add_u32 s16, s4, s34
s_addc_u32 s17, s5, 0
s_mov_b32 s18, 4
s_lshl_b32 s34, s26, 7
s_add_u32 s34, s34, 104914944
s_add_u32 s52, s4, s34
s_addc_u32 s53, s5, 0
v_mov_b32 v11, 1
s_waitcnt lgkmcnt(9)
v_mfma_f32_16x16x32_bf16 v[128:131], a[64:67], v[32:35], 0
ds_read_b64_tr_b16 a[118:119], v97 offset:18432
v_mfma_f32_16x16x32_bf16 v[128:131], a[68:71], v[36:39], v[128:131]
ds_read_b64_tr_b16 a[120:121], v97 offset:20480
v_mfma_f32_16x16x32_bf16 v[128:131], a[72:75], v[40:43], v[128:131]
ds_read_b64_tr_b16 a[122:123], v97 offset:22528
s_add_u32 m0, s23, 98304
v_mfma_f32_16x16x32_bf16 v[128:131], a[76:79], v[44:47], v[128:131]
buffer_load_dwordx4 v10, s[8:11], s68 offen offset:0 lds
v_mfma_f32_16x16x32_bf16 v[128:131], a[80:83], v[48:51], v[128:131]
ds_read_b64_tr_b16 a[124:125], v97 offset:24576
ds_read_b64_tr_b16 a[126:127], v97 offset:26624
v_mfma_f32_16x16x32_bf16 v[128:131], a[84:87], v[52:55], v[128:131]
ds_read_b64_tr_b16 a[128:129], v97 offset:28672
v_mfma_f32_16x16x32_bf16 v[128:131], a[88:91], v[56:59], v[128:131]
ds_read_b64_tr_b16 a[130:131], v97 offset:30720
v_mfma_f32_16x16x32_bf16 v[128:131], a[92:95], v[60:63], v[128:131]
buffer_load_dwordx4 v10, s[8:11], s69 offen offset:1024 lds
v_mfma_f32_16x16x32_bf16 v[128:131], a[96:99], a[196:199], v[128:131]
ds_read_b64_tr_b16 a[132:133], v105 offset:0
ds_read_b64_tr_b16 a[134:135], v105 offset:2048
v_mfma_f32_16x16x32_bf16 v[132:135], a[64:67], v[64:67], 0
ds_read_b64_tr_b16 a[136:137], v98 offset:0
v_mfma_f32_16x16x32_bf16 v[132:135], a[68:71], v[68:71], v[132:135]
ds_read_b64_tr_b16 a[138:139], v98 offset:2048
v_mfma_f32_16x16x32_bf16 v[132:135], a[72:75], v[72:75], v[132:135]
buffer_load_dwordx4 v10, s[8:11], s70 offen offset:2048 lds
v_mfma_f32_16x16x32_bf16 v[132:135], a[76:79], v[76:79], v[132:135]
ds_read_b64_tr_b16 a[140:141], v98 offset:4096
ds_read_b64_tr_b16 a[142:143], v98 offset:6144
v_mfma_f32_16x16x32_bf16 v[132:135], a[80:83], v[80:83], v[132:135]
ds_read_b64_tr_b16 a[144:145], v98 offset:8192
v_mfma_f32_16x16x32_bf16 v[132:135], a[84:87], v[84:87], v[132:135]
ds_read_b64_tr_b16 a[146:147], v98 offset:10240
v_mfma_f32_16x16x32_bf16 v[132:135], a[88:91], v[88:91], v[132:135]
buffer_load_dwordx4 v10, s[8:11], s71 offen offset:3072 lds
v_mfma_f32_16x16x32_bf16 v[132:135], a[92:95], v[92:95], v[132:135]
ds_read_b64_tr_b16 a[148:149], v98 offset:12288
ds_read_b64_tr_b16 a[150:151], v98 offset:14336
v_mfma_f32_16x16x32_bf16 v[132:135], a[96:99], a[200:203], v[132:135]
ds_read_b64_tr_b16 a[152:153], v98 offset:16384
s_waitcnt lgkmcnt(9)
v_mfma_f32_16x16x32_bf16 v[136:139], a[100:103], v[32:35], 0
ds_read_b64_tr_b16 a[154:155], v98 offset:18432
s_add_u32 m0, s23, 102400
v_mfma_f32_16x16x32_bf16 v[136:139], a[104:107], v[36:39], v[136:139]
buffer_load_dwordx4 v10, s[8:11], s72 offen offset:0 lds
v_mfma_f32_16x16x32_bf16 v[136:139], a[108:111], v[40:43], v[136:139]
ds_read_b64_tr_b16 a[156:157], v98 offset:20480
ds_read_b64_tr_b16 a[158:159], v98 offset:22528
v_mfma_f32_16x16x32_bf16 v[136:139], a[112:115], v[44:47], v[136:139]
ds_read_b64_tr_b16 a[160:161], v98 offset:24576
v_mfma_f32_16x16x32_bf16 v[136:139], a[116:119], v[48:51], v[136:139]
ds_read_b64_tr_b16 a[162:163], v98 offset:26624
v_mfma_f32_16x16x32_bf16 v[136:139], a[120:123], v[52:55], v[136:139]
buffer_load_dwordx4 v10, s[8:11], s73 offen offset:1024 lds
v_mfma_f32_16x16x32_bf16 v[136:139], a[124:127], v[56:59], v[136:139]
ds_read_b64_tr_b16 a[164:165], v98 offset:28672
ds_read_b64_tr_b16 a[166:167], v98 offset:30720
v_mfma_f32_16x16x32_bf16 v[136:139], a[128:131], v[60:63], v[136:139]
ds_read_b64_tr_b16 a[168:169], v106 offset:0
v_mfma_f32_16x16x32_bf16 v[136:139], a[132:135], a[196:199], v[136:139]
ds_read_b64_tr_b16 a[170:171], v106 offset:2048
v_mfma_f32_16x16x32_bf16 v[140:143], a[100:103], v[64:67], 0
buffer_load_dwordx4 v10, s[8:11], s74 offen offset:2048 lds
v_mfma_f32_16x16x32_bf16 v[140:143], a[104:107], v[68:71], v[140:143]
ds_read_b64_tr_b16 a[64:65], v99 offset:0
ds_read_b64_tr_b16 a[66:67], v99 offset:2048
v_mfma_f32_16x16x32_bf16 v[140:143], a[108:111], v[72:75], v[140:143]
ds_read_b64_tr_b16 a[68:69], v99 offset:4096
v_mfma_f32_16x16x32_bf16 v[140:143], a[112:115], v[76:79], v[140:143]
ds_read_b64_tr_b16 a[70:71], v99 offset:6144
v_mfma_f32_16x16x32_bf16 v[140:143], a[116:119], v[80:83], v[140:143]
buffer_load_dwordx4 v10, s[8:11], s75 offen offset:3072 lds
v_mfma_f32_16x16x32_bf16 v[140:143], a[120:123], v[84:87], v[140:143]
ds_read_b64_tr_b16 a[72:73], v99 offset:8192
ds_read_b64_tr_b16 a[74:75], v99 offset:10240
v_mfma_f32_16x16x32_bf16 v[140:143], a[124:127], v[88:91], v[140:143]
ds_read_b64_tr_b16 a[76:77], v99 offset:12288
v_mfma_f32_16x16x32_bf16 v[140:143], a[128:131], v[92:95], v[140:143]
ds_read_b64_tr_b16 a[78:79], v99 offset:14336
s_add_u32 m0, s39, 143360
v_mfma_f32_16x16x32_bf16 v[140:143], a[132:135], a[200:203], v[140:143]
buffer_load_dwordx4 v0, s[92:95], s32 offen lds
s_waitcnt lgkmcnt(8)
v_mfma_f32_16x16x32_bf16 v[144:147], a[136:139], v[32:35], 0
s_add_u32 s8, s8, 128
s_addc_u32 s9, s9, 0
v_mfma_f32_16x16x32_bf16 v[144:147], a[140:143], v[36:39], v[144:147]
s_sub_u32 s10, s10, 128
s_add_u32 s32, s32, 128
v_mfma_f32_16x16x32_bf16 v[144:147], a[144:147], v[40:43], v[144:147]
ds_read_b64_tr_b16 a[80:81], v99 offset:16384
ds_read_b64_tr_b16 a[82:83], v99 offset:18432
v_mfma_f32_16x16x32_bf16 v[144:147], a[148:151], v[44:47], v[144:147]
ds_read_b64_tr_b16 a[84:85], v99 offset:20480
ds_read_b64_tr_b16 a[86:87], v99 offset:22528
v_mfma_f32_16x16x32_bf16 v[144:147], a[152:155], v[48:51], v[144:147]
ds_read_b64_tr_b16 a[88:89], v99 offset:24576
ds_read_b64_tr_b16 a[90:91], v99 offset:26624
v_mfma_f32_16x16x32_bf16 v[144:147], a[156:159], v[52:55], v[144:147]
ds_read_b64_tr_b16 a[92:93], v99 offset:28672
v_mfma_f32_16x16x32_bf16 v[144:147], a[160:163], v[56:59], v[144:147]
ds_read_b64_tr_b16 a[94:95], v99 offset:30720
v_mfma_f32_16x16x32_bf16 v[144:147], a[164:167], v[60:63], v[144:147]
ds_read_b64_tr_b16 a[96:97], v107 offset:0
v_mfma_f32_16x16x32_bf16 v[144:147], a[168:171], a[196:199], v[144:147]
s_waitcnt vmcnt(18)
s_barrier
v_mfma_f32_16x16x32_bf16 v[148:151], a[136:139], v[64:67], 0
ds_read_b64_tr_b16 a[98:99], v107 offset:2048
s_mov_b32 s34, 0
v_mfma_f32_16x16x32_bf16 v[148:151], a[140:143], v[68:71], v[148:151]
ds_read_b64_tr_b16 a[100:101], v96 offset:32768
v_cvt_pk_bf16_f32 v192, v128, v129
v_mfma_f32_16x16x32_bf16 v[148:151], a[144:147], v[72:75], v[148:151]
ds_read_b64_tr_b16 a[102:103], v96 offset:34816
v_cvt_pk_bf16_f32 v193, v130, v131
v_mfma_f32_16x16x32_bf16 v[148:151], a[148:151], v[76:79], v[148:151]
ds_read_b64_tr_b16 a[104:105], v96 offset:36864
v_cvt_pk_bf16_f32 v194, v136, v137
v_mfma_f32_16x16x32_bf16 v[148:151], a[152:155], v[80:83], v[148:151]
ds_read_b64_tr_b16 a[106:107], v96 offset:38912
v_cvt_pk_bf16_f32 v195, v138, v139
v_mfma_f32_16x16x32_bf16 v[148:151], a[156:159], v[84:87], v[148:151]
buffer_store_dwordx4 v[192:195], v19, s[60:63], s34 offen offset:0 sc1
v_mfma_f32_16x16x32_bf16 v[148:151], a[160:163], v[88:91], v[148:151]
ds_read_b64_tr_b16 a[108:109], v96 offset:40960
v_cvt_pk_bf16_f32 v200, v132, v133
v_mfma_f32_16x16x32_bf16 v[148:151], a[164:167], v[92:95], v[148:151]
ds_read_b64_tr_b16 a[110:111], v96 offset:43008
v_cvt_pk_bf16_f32 v201, v134, v135
v_mfma_f32_16x16x32_bf16 v[148:151], a[168:171], a[200:203], v[148:151]
ds_read_b64_tr_b16 a[112:113], v96 offset:45056
v_cvt_pk_bf16_f32 v202, v140, v141
s_waitcnt lgkmcnt(7)
v_mfma_f32_16x16x32_bf16 v[152:155], a[64:67], v[32:35], 0
ds_read_b64_tr_b16 a[114:115], v96 offset:47104
v_cvt_pk_bf16_f32 v203, v142, v143
v_mfma_f32_16x16x32_bf16 v[152:155], a[68:71], v[36:39], v[152:155]
buffer_store_dwordx4 v[200:203], v19, s[60:63], s34 offen offset:2048 sc1
v_mfma_f32_16x16x32_bf16 v[152:155], a[72:75], v[40:43], v[152:155]
ds_read_b64_tr_b16 a[116:117], v96 offset:49152
ds_read_b64_tr_b16 a[118:119], v96 offset:51200
v_mfma_f32_16x16x32_bf16 v[152:155], a[76:79], v[44:47], v[152:155]
ds_read_b64_tr_b16 a[120:121], v96 offset:53248
ds_read_b64_tr_b16 a[122:123], v96 offset:55296
v_mfma_f32_16x16x32_bf16 v[152:155], a[80:83], v[48:51], v[152:155]
ds_read_b64_tr_b16 a[124:125], v96 offset:57344
ds_read_b64_tr_b16 a[126:127], v96 offset:59392
v_mfma_f32_16x16x32_bf16 v[152:155], a[84:87], v[52:55], v[152:155]
ds_read_b64_tr_b16 a[128:129], v96 offset:61440
v_mfma_f32_16x16x32_bf16 v[152:155], a[88:91], v[56:59], v[152:155]
ds_read_b64_tr_b16 a[130:131], v96 offset:63488
v_mfma_f32_16x16x32_bf16 v[152:155], a[92:95], v[60:63], v[152:155]
ds_read_b64_tr_b16 a[132:133], v104 offset:4096
v_mfma_f32_16x16x32_bf16 v[152:155], a[96:99], a[196:199], v[152:155]
ds_read_b64_tr_b16 a[134:135], v104 offset:6144
v_mfma_f32_16x16x32_bf16 v[156:159], a[64:67], v[64:67], 0
ds_read_b64_tr_b16 a[136:137], v97 offset:32768
v_mfma_f32_16x16x32_bf16 v[156:159], a[68:71], v[68:71], v[156:159]
ds_read_b64_tr_b16 a[138:139], v97 offset:34816
v_mfma_f32_16x16x32_bf16 v[156:159], a[72:75], v[72:75], v[156:159]
ds_read_b64_tr_b16 a[140:141], v97 offset:36864
v_mfma_f32_16x16x32_bf16 v[156:159], a[76:79], v[76:79], v[156:159]
ds_read_b64_tr_b16 a[142:143], v97 offset:38912
v_mfma_f32_16x16x32_bf16 v[156:159], a[80:83], v[80:83], v[156:159]
ds_read_b64_tr_b16 a[144:145], v97 offset:40960
v_mfma_f32_16x16x32_bf16 v[156:159], a[84:87], v[84:87], v[156:159]
ds_read_b64_tr_b16 a[146:147], v97 offset:43008
v_mfma_f32_16x16x32_bf16 v[156:159], a[88:91], v[88:91], v[156:159]
ds_read_b64_tr_b16 a[148:149], v97 offset:45056
v_mfma_f32_16x16x32_bf16 v[156:159], a[92:95], v[92:95], v[156:159]
ds_read_b64_tr_b16 a[150:151], v97 offset:47104
v_mfma_f32_16x16x32_bf16 v[156:159], a[96:99], a[200:203], v[156:159]
ds_read_b64_tr_b16 a[152:153], v97 offset:49152
s_waitcnt lgkmcnt(9)
v_mfma_f32_16x16x32_bf16 v[160:163], a[100:103], v[32:35], 0
ds_read_b64_tr_b16 a[154:155], v97 offset:51200
v_mfma_f32_16x16x32_bf16 v[160:163], a[104:107], v[36:39], v[160:163]
ds_read_b64_tr_b16 a[156:157], v97 offset:53248
v_mfma_f32_16x16x32_bf16 v[160:163], a[108:111], v[40:43], v[160:163]
ds_read_b64_tr_b16 a[158:159], v97 offset:55296
v_mfma_f32_16x16x32_bf16 v[160:163], a[112:115], v[44:47], v[160:163]
ds_read_b64_tr_b16 a[160:161], v97 offset:57344
v_mfma_f32_16x16x32_bf16 v[160:163], a[116:119], v[48:51], v[160:163]
ds_read_b64_tr_b16 a[162:163], v97 offset:59392
s_mov_b32 s34, 0
v_mfma_f32_16x16x32_bf16 v[160:163], a[120:123], v[52:55], v[160:163]
ds_read_b64_tr_b16 a[164:165], v97 offset:61440
v_cvt_pk_bf16_f32 v196, v144, v145
v_mfma_f32_16x16x32_bf16 v[160:163], a[124:127], v[56:59], v[160:163]
ds_read_b64_tr_b16 a[166:167], v97 offset:63488
v_cvt_pk_bf16_f32 v197, v146, v147
v_mfma_f32_16x16x32_bf16 v[160:163], a[128:131], v[60:63], v[160:163]
ds_read_b64_tr_b16 a[168:169], v105 offset:4096
v_cvt_pk_bf16_f32 v198, v152, v153
v_mfma_f32_16x16x32_bf16 v[160:163], a[132:135], a[196:199], v[160:163]
ds_read_b64_tr_b16 a[170:171], v105 offset:6144
v_cvt_pk_bf16_f32 v199, v154, v155
v_mfma_f32_16x16x32_bf16 v[164:167], a[100:103], v[64:67], 0
buffer_store_dwordx4 v[196:199], v19, s[60:63], s34 offen offset:1024 sc1
v_mfma_f32_16x16x32_bf16 v[164:167], a[104:107], v[68:71], v[164:167]
ds_read_b64_tr_b16 a[64:65], v98 offset:32768
v_cvt_pk_bf16_f32 v204, v148, v149
v_mfma_f32_16x16x32_bf16 v[164:167], a[108:111], v[72:75], v[164:167]
ds_read_b64_tr_b16 a[66:67], v98 offset:34816
v_cvt_pk_bf16_f32 v205, v150, v151
v_mfma_f32_16x16x32_bf16 v[164:167], a[112:115], v[76:79], v[164:167]
ds_read_b64_tr_b16 a[68:69], v98 offset:36864
v_cvt_pk_bf16_f32 v206, v156, v157
v_mfma_f32_16x16x32_bf16 v[164:167], a[116:119], v[80:83], v[164:167]
ds_read_b64_tr_b16 a[70:71], v98 offset:38912
v_cvt_pk_bf16_f32 v207, v158, v159
v_mfma_f32_16x16x32_bf16 v[164:167], a[120:123], v[84:87], v[164:167]
buffer_store_dwordx4 v[204:207], v19, s[60:63], s34 offen offset:3072 sc1
v_mfma_f32_16x16x32_bf16 v[164:167], a[124:127], v[88:91], v[164:167]
ds_read_b64_tr_b16 a[72:73], v98 offset:40960
ds_read_b64_tr_b16 a[74:75], v98 offset:43008
v_mfma_f32_16x16x32_bf16 v[164:167], a[128:131], v[92:95], v[164:167]
ds_read_b64_tr_b16 a[76:77], v98 offset:45056
ds_read_b64_tr_b16 a[78:79], v98 offset:47104
v_mfma_f32_16x16x32_bf16 v[164:167], a[132:135], a[200:203], v[164:167]
ds_read_b64_tr_b16 a[80:81], v98 offset:49152
s_waitcnt lgkmcnt(9)
v_mfma_f32_16x16x32_bf16 v[168:171], a[136:139], v[32:35], 0
ds_read_b64_tr_b16 a[82:83], v98 offset:51200
v_mfma_f32_16x16x32_bf16 v[168:171], a[140:143], v[36:39], v[168:171]
ds_read_b64_tr_b16 a[84:85], v98 offset:53248
v_mfma_f32_16x16x32_bf16 v[168:171], a[144:147], v[40:43], v[168:171]
ds_read_b64_tr_b16 a[86:87], v98 offset:55296
v_mfma_f32_16x16x32_bf16 v[168:171], a[148:151], v[44:47], v[168:171]
ds_read_b64_tr_b16 a[88:89], v98 offset:57344
v_mfma_f32_16x16x32_bf16 v[168:171], a[152:155], v[48:51], v[168:171]
ds_read_b64_tr_b16 a[90:91], v98 offset:59392
v_mfma_f32_16x16x32_bf16 v[168:171], a[156:159], v[52:55], v[168:171]
ds_read_b64_tr_b16 a[92:93], v98 offset:61440
v_mfma_f32_16x16x32_bf16 v[168:171], a[160:163], v[56:59], v[168:171]
ds_read_b64_tr_b16 a[94:95], v98 offset:63488
v_mfma_f32_16x16x32_bf16 v[168:171], a[164:167], v[60:63], v[168:171]
ds_read_b64_tr_b16 a[96:97], v106 offset:4096
v_mfma_f32_16x16x32_bf16 v[168:171], a[168:171], a[196:199], v[168:171]
ds_read_b64_tr_b16 a[98:99], v106 offset:6144
v_mfma_f32_16x16x32_bf16 v[172:175], a[136:139], v[64:67], 0
ds_read_b64_tr_b16 a[100:101], v99 offset:32768
v_mfma_f32_16x16x32_bf16 v[172:175], a[140:143], v[68:71], v[172:175]
ds_read_b64_tr_b16 a[102:103], v99 offset:34816
v_mfma_f32_16x16x32_bf16 v[172:175], a[144:147], v[72:75], v[172:175]
ds_read_b64_tr_b16 a[104:105], v99 offset:36864
v_mfma_f32_16x16x32_bf16 v[172:175], a[148:151], v[76:79], v[172:175]
ds_read_b64_tr_b16 a[106:107], v99 offset:38912
v_mfma_f32_16x16x32_bf16 v[172:175], a[152:155], v[80:83], v[172:175]
ds_read_b64_tr_b16 a[108:109], v99 offset:40960
v_mfma_f32_16x16x32_bf16 v[172:175], a[156:159], v[84:87], v[172:175]
ds_read_b64_tr_b16 a[110:111], v99 offset:43008
v_mfma_f32_16x16x32_bf16 v[172:175], a[160:163], v[88:91], v[172:175]
ds_read_b64_tr_b16 a[112:113], v99 offset:45056
v_mfma_f32_16x16x32_bf16 v[172:175], a[164:167], v[92:95], v[172:175]
ds_read_b64_tr_b16 a[114:115], v99 offset:47104
v_mfma_f32_16x16x32_bf16 v[172:175], a[168:171], a[200:203], v[172:175]
ds_read_b64_tr_b16 a[116:117], v99 offset:49152
s_waitcnt lgkmcnt(9)
v_mfma_f32_16x16x32_bf16 v[176:179], a[64:67], v[32:35], 0
ds_read_b64_tr_b16 a[118:119], v99 offset:51200
v_mfma_f32_16x16x32_bf16 v[176:179], a[68:71], v[36:39], v[176:179]
ds_read_b64_tr_b16 a[120:121], v99 offset:53248
v_mfma_f32_16x16x32_bf16 v[176:179], a[72:75], v[40:43], v[176:179]
ds_read_b64_tr_b16 a[122:123], v99 offset:55296
v_mfma_f32_16x16x32_bf16 v[176:179], a[76:79], v[44:47], v[176:179]
ds_read_b64_tr_b16 a[124:125], v99 offset:57344
v_mfma_f32_16x16x32_bf16 v[176:179], a[80:83], v[48:51], v[176:179]
ds_read_b64_tr_b16 a[126:127], v99 offset:59392
v_mfma_f32_16x16x32_bf16 v[176:179], a[84:87], v[52:55], v[176:179]
ds_read_b64_tr_b16 a[128:129], v99 offset:61440
v_mfma_f32_16x16x32_bf16 v[176:179], a[88:91], v[56:59], v[176:179]
ds_read_b64_tr_b16 a[130:131], v99 offset:63488
v_mfma_f32_16x16x32_bf16 v[176:179], a[92:95], v[60:63], v[176:179]
ds_read_b64_tr_b16 a[132:133], v107 offset:4096
v_mfma_f32_16x16x32_bf16 v[176:179], a[96:99], a[196:199], v[176:179]
s_waitcnt vmcnt(13)
s_barrier
v_mfma_f32_16x16x32_bf16 v[180:183], a[64:67], v[64:67], 0
ds_read_b64_tr_b16 a[134:135], v107 offset:6144
s_mov_b32 s34, 4096
v_mfma_f32_16x16x32_bf16 v[180:183], a[68:71], v[68:71], v[180:183]
ds_read_b64_tr_b16 a[136:137], v100 offset:0
v_cvt_pk_bf16_f32 v192, v160, v161
v_mfma_f32_16x16x32_bf16 v[180:183], a[72:75], v[72:75], v[180:183]
ds_read_b64_tr_b16 a[138:139], v100 offset:2048
s_add_u32 m0, s23, 0
v_mfma_f32_16x16x32_bf16 v[180:183], a[76:79], v[76:79], v[180:183]
buffer_load_dwordx4 v10, s[8:11], s68 offen offset:0 lds
v_mfma_f32_16x16x32_bf16 v[180:183], a[80:83], v[80:83], v[180:183]
ds_read_b64_tr_b16 a[140:141], v100 offset:4096
v_cvt_pk_bf16_f32 v193, v162, v163
v_mfma_f32_16x16x32_bf16 v[180:183], a[84:87], v[84:87], v[180:183]
ds_read_b64_tr_b16 a[142:143], v100 offset:6144
v_cvt_pk_bf16_f32 v194, v168, v169
v_mfma_f32_16x16x32_bf16 v[180:183], a[88:91], v[88:91], v[180:183]
ds_read_b64_tr_b16 a[144:145], v100 offset:8192
v_cvt_pk_bf16_f32 v195, v170, v171
v_mfma_f32_16x16x32_bf16 v[180:183], a[92:95], v[92:95], v[180:183]
buffer_store_dwordx4 v[192:195], v19, s[60:63], s34 offen offset:0 sc1
v_mfma_f32_16x16x32_bf16 v[180:183], a[96:99], a[200:203], v[180:183]
ds_read_b64_tr_b16 a[146:147], v100 offset:10240
v_cvt_pk_bf16_f32 v200, v164, v165
s_waitcnt lgkmcnt(6)
v_mfma_f32_16x16x32_bf16 v[184:187], a[100:103], v[32:35], 0
ds_read_b64_tr_b16 a[148:149], v100 offset:12288
buffer_load_dwordx4 v10, s[8:11], s69 offen offset:1024 lds
v_mfma_f32_16x16x32_bf16 v[184:187], a[104:107], v[36:39], v[184:187]
ds_read_b64_tr_b16 a[150:151], v100 offset:14336
v_cvt_pk_bf16_f32 v201, v166, v167
v_mfma_f32_16x16x32_bf16 v[184:187], a[108:111], v[40:43], v[184:187]
ds_read_b64_tr_b16 a[152:153], v100 offset:16384
v_cvt_pk_bf16_f32 v202, v172, v173
v_mfma_f32_16x16x32_bf16 v[184:187], a[112:115], v[44:47], v[184:187]
ds_read_b64_tr_b16 a[154:155], v100 offset:18432
v_cvt_pk_bf16_f32 v203, v174, v175
v_mfma_f32_16x16x32_bf16 v[184:187], a[116:119], v[48:51], v[184:187]
ds_read_b64_tr_b16 a[156:157], v100 offset:20480
buffer_store_dwordx4 v[200:203], v19, s[60:63], s34 offen offset:2048 sc1
v_mfma_f32_16x16x32_bf16 v[184:187], a[120:123], v[52:55], v[184:187]
ds_read_b64_tr_b16 a[158:159], v100 offset:22528
ds_read_b64_tr_b16 a[160:161], v100 offset:24576
v_mfma_f32_16x16x32_bf16 v[184:187], a[124:127], v[56:59], v[184:187]
buffer_load_dwordx4 v10, s[8:11], s70 offen offset:2048 lds
v_mfma_f32_16x16x32_bf16 v[184:187], a[128:131], v[60:63], v[184:187]
ds_read_b64_tr_b16 a[162:163], v100 offset:26624
ds_read_b64_tr_b16 a[164:165], v100 offset:28672
v_mfma_f32_16x16x32_bf16 v[184:187], a[132:135], a[196:199], v[184:187]
ds_read_b64_tr_b16 a[166:167], v100 offset:30720
ds_read_b64_tr_b16 a[168:169], v104 offset:8192
v_mfma_f32_16x16x32_bf16 v[188:191], a[100:103], v[64:67], 0
ds_read_b64_tr_b16 a[170:171], v104 offset:10240
ds_read_b64_tr_b16 a[64:65], v101 offset:0
v_mfma_f32_16x16x32_bf16 v[188:191], a[104:107], v[68:71], v[188:191]
ds_read_b64_tr_b16 a[66:67], v101 offset:2048
v_mfma_f32_16x16x32_bf16 v[188:191], a[108:111], v[72:75], v[188:191]
ds_read_b64_tr_b16 a[68:69], v101 offset:4096
v_mfma_f32_16x16x32_bf16 v[188:191], a[112:115], v[76:79], v[188:191]
buffer_load_dwordx4 v10, s[8:11], s71 offen offset:3072 lds
v_mfma_f32_16x16x32_bf16 v[188:191], a[116:119], v[80:83], v[188:191]
ds_read_b64_tr_b16 a[70:71], v101 offset:6144
ds_read_b64_tr_b16 a[72:73], v101 offset:8192
v_mfma_f32_16x16x32_bf16 v[188:191], a[120:123], v[84:87], v[188:191]
ds_read_b64_tr_b16 a[74:75], v101 offset:10240
v_mfma_f32_16x16x32_bf16 v[188:191], a[124:127], v[88:91], v[188:191]
ds_read_b64_tr_b16 a[76:77], v101 offset:12288
v_mfma_f32_16x16x32_bf16 v[188:191], a[128:131], v[92:95], v[188:191]
ds_read_b64_tr_b16 a[78:79], v101 offset:14336
v_mfma_f32_16x16x32_bf16 v[188:191], a[132:135], a[200:203], v[188:191]
ds_read_b64_tr_b16 a[80:81], v101 offset:16384
s_waitcnt lgkmcnt(9)
v_mfma_f32_16x16x32_bf16 v[128:131], a[136:139], v[32:35], 0
ds_read_b64_tr_b16 a[82:83], v101 offset:18432
v_mfma_f32_16x16x32_bf16 v[128:131], a[140:143], v[36:39], v[128:131]
ds_read_b64_tr_b16 a[84:85], v101 offset:20480
v_mfma_f32_16x16x32_bf16 v[128:131], a[144:147], v[40:43], v[128:131]
ds_read_b64_tr_b16 a[86:87], v101 offset:22528
v_mfma_f32_16x16x32_bf16 v[128:131], a[148:151], v[44:47], v[128:131]
ds_read_b64_tr_b16 a[88:89], v101 offset:24576
v_mfma_f32_16x16x32_bf16 v[128:131], a[152:155], v[48:51], v[128:131]
ds_read_b64_tr_b16 a[90:91], v101 offset:26624
s_mov_b32 s34, 4096
v_mfma_f32_16x16x32_bf16 v[128:131], a[156:159], v[52:55], v[128:131]
ds_read_b64_tr_b16 a[92:93], v101 offset:28672
v_cvt_pk_bf16_f32 v196, v176, v177
v_mfma_f32_16x16x32_bf16 v[128:131], a[160:163], v[56:59], v[128:131]
ds_read_b64_tr_b16 a[94:95], v101 offset:30720
v_cvt_pk_bf16_f32 v197, v178, v179
v_mfma_f32_16x16x32_bf16 v[128:131], a[164:167], v[60:63], v[128:131]
ds_read_b64_tr_b16 a[96:97], v105 offset:8192
v_cvt_pk_bf16_f32 v198, v184, v185
v_mfma_f32_16x16x32_bf16 v[128:131], a[168:171], a[196:199], v[128:131]
ds_read_b64_tr_b16 a[98:99], v105 offset:10240
v_cvt_pk_bf16_f32 v199, v186, v187
v_mfma_f32_16x16x32_bf16 v[132:135], a[136:139], v[64:67], 0
buffer_store_dwordx4 v[196:199], v19, s[60:63], s34 offen offset:1024 sc1
v_mfma_f32_16x16x32_bf16 v[132:135], a[140:143], v[68:71], v[132:135]
ds_read_b64_tr_b16 a[100:101], v102 offset:0
v_cvt_pk_bf16_f32 v204, v180, v181
v_mfma_f32_16x16x32_bf16 v[132:135], a[144:147], v[72:75], v[132:135]
ds_read_b64_tr_b16 a[102:103], v102 offset:2048
v_cvt_pk_bf16_f32 v205, v182, v183
v_mfma_f32_16x16x32_bf16 v[132:135], a[148:151], v[76:79], v[132:135]
ds_read_b64_tr_b16 a[104:105], v102 offset:4096
v_cvt_pk_bf16_f32 v206, v188, v189
v_mfma_f32_16x16x32_bf16 v[132:135], a[152:155], v[80:83], v[132:135]
ds_read_b64_tr_b16 a[106:107], v102 offset:6144
v_cvt_pk_bf16_f32 v207, v190, v191
v_mfma_f32_16x16x32_bf16 v[132:135], a[156:159], v[84:87], v[132:135]
buffer_store_dwordx4 v[204:207], v19, s[60:63], s34 offen offset:3072 sc1
v_mfma_f32_16x16x32_bf16 v[132:135], a[160:163], v[88:91], v[132:135]
ds_read_b64_tr_b16 a[108:109], v102 offset:8192
ds_read_b64_tr_b16 a[110:111], v102 offset:10240
v_mfma_f32_16x16x32_bf16 v[132:135], a[164:167], v[92:95], v[132:135]
ds_read_b64_tr_b16 a[112:113], v102 offset:12288
ds_read_b64_tr_b16 a[114:115], v102 offset:14336
v_mfma_f32_16x16x32_bf16 v[132:135], a[168:171], a[200:203], v[132:135]
ds_read_b64_tr_b16 a[116:117], v102 offset:16384
s_waitcnt lgkmcnt(9)
v_mfma_f32_16x16x32_bf16 v[136:139], a[64:67], v[32:35], 0
ds_read_b64_tr_b16 a[118:119], v102 offset:18432
v_mfma_f32_16x16x32_bf16 v[136:139], a[68:71], v[36:39], v[136:139]
ds_read_b64_tr_b16 a[120:121], v102 offset:20480
s_add_u32 m0, s23, 4096
v_mfma_f32_16x16x32_bf16 v[136:139], a[72:75], v[40:43], v[136:139]
buffer_load_dwordx4 v10, s[8:11], s72 offen offset:0 lds
v_mfma_f32_16x16x32_bf16 v[136:139], a[76:79], v[44:47], v[136:139]
ds_read_b64_tr_b16 a[122:123], v102 offset:22528
ds_read_b64_tr_b16 a[124:125], v102 offset:24576
v_mfma_f32_16x16x32_bf16 v[136:139], a[80:83], v[48:51], v[136:139]
ds_read_b64_tr_b16 a[126:127], v102 offset:26624
v_mfma_f32_16x16x32_bf16 v[136:139], a[84:87], v[52:55], v[136:139]
ds_read_b64_tr_b16 a[128:129], v102 offset:28672
v_mfma_f32_16x16x32_bf16 v[136:139], a[88:91], v[56:59], v[136:139]
ds_read_b64_tr_b16 a[130:131], v102 offset:30720
v_mfma_f32_16x16x32_bf16 v[136:139], a[92:95], v[60:63], v[136:139]
buffer_load_dwordx4 v10, s[8:11], s73 offen offset:1024 lds
v_mfma_f32_16x16x32_bf16 v[136:139], a[96:99], a[196:199], v[136:139]
ds_read_b64_tr_b16 a[132:133], v106 offset:8192
ds_read_b64_tr_b16 a[134:135], v106 offset:10240
v_mfma_f32_16x16x32_bf16 v[140:143], a[64:67], v[64:67], 0
ds_read_b64_tr_b16 a[136:137], v103 offset:0
v_mfma_f32_16x16x32_bf16 v[140:143], a[68:71], v[68:71], v[140:143]
ds_read_b64_tr_b16 a[138:139], v103 offset:2048
v_mfma_f32_16x16x32_bf16 v[140:143], a[72:75], v[72:75], v[140:143]
ds_read_b64_tr_b16 a[140:141], v103 offset:4096
v_mfma_f32_16x16x32_bf16 v[140:143], a[76:79], v[76:79], v[140:143]
buffer_load_dwordx4 v10, s[8:11], s74 offen offset:2048 lds
v_mfma_f32_16x16x32_bf16 v[140:143], a[80:83], v[80:83], v[140:143]
ds_read_b64_tr_b16 a[142:143], v103 offset:6144
ds_read_b64_tr_b16 a[144:145], v103 offset:8192
v_mfma_f32_16x16x32_bf16 v[140:143], a[84:87], v[84:87], v[140:143]
ds_read_b64_tr_b16 a[146:147], v103 offset:10240
v_mfma_f32_16x16x32_bf16 v[140:143], a[88:91], v[88:91], v[140:143]
ds_read_b64_tr_b16 a[148:149], v103 offset:12288
v_mfma_f32_16x16x32_bf16 v[140:143], a[92:95], v[92:95], v[140:143]
ds_read_b64_tr_b16 a[150:151], v103 offset:14336
v_mfma_f32_16x16x32_bf16 v[140:143], a[96:99], a[200:203], v[140:143]
buffer_load_dwordx4 v10, s[8:11], s75 offen offset:3072 lds
s_waitcnt lgkmcnt(8)
v_mfma_f32_16x16x32_bf16 v[144:147], a[100:103], v[32:35], 0
ds_read_b64_tr_b16 a[152:153], v103 offset:16384
ds_read_b64_tr_b16 a[154:155], v103 offset:18432
v_mfma_f32_16x16x32_bf16 v[144:147], a[104:107], v[36:39], v[144:147]
ds_read_b64_tr_b16 a[156:157], v103 offset:20480
v_mfma_f32_16x16x32_bf16 v[144:147], a[108:111], v[40:43], v[144:147]
ds_read_b64_tr_b16 a[158:159], v103 offset:22528
v_mfma_f32_16x16x32_bf16 v[144:147], a[112:115], v[44:47], v[144:147]
ds_read_b64_tr_b16 a[160:161], v103 offset:24576
s_add_u32 m0, s39, 131072
v_mfma_f32_16x16x32_bf16 v[144:147], a[116:119], v[48:51], v[144:147]
buffer_load_dwordx4 v0, s[92:95], s32 offen lds
v_mfma_f32_16x16x32_bf16 v[144:147], a[120:123], v[52:55], v[144:147]
s_add_u32 s8, s8, 128
s_addc_u32 s9, s9, 0
v_mfma_f32_16x16x32_bf16 v[144:147], a[124:127], v[56:59], v[144:147]
s_sub_u32 s10, s10, 128
s_add_u32 s32, s32, 128
v_mfma_f32_16x16x32_bf16 v[144:147], a[128:131], v[60:63], v[144:147]
ds_read_b64_tr_b16 a[162:163], v103 offset:26624
ds_read_b64_tr_b16 a[164:165], v103 offset:28672
v_mfma_f32_16x16x32_bf16 v[144:147], a[132:135], a[196:199], v[144:147]
s_waitcnt vmcnt(17)
s_barrier
v_mfma_f32_16x16x32_bf16 v[148:151], a[100:103], v[64:67], 0
ds_read_b64_tr_b16 a[166:167], v103 offset:30720
s_mov_b32 s34, 8192
v_mfma_f32_16x16x32_bf16 v[148:151], a[104:107], v[68:71], v[148:151]
ds_read_b64_tr_b16 a[168:169], v107 offset:8192
v_cvt_pk_bf16_f32 v192, v128, v129
v_mfma_f32_16x16x32_bf16 v[148:151], a[108:111], v[72:75], v[148:151]
ds_read_b64_tr_b16 a[170:171], v107 offset:10240
s_add_u32 m0, s23, 32768
v_mfma_f32_16x16x32_bf16 v[148:151], a[112:115], v[76:79], v[148:151]
ds_read_b64_tr_b16 a[64:65], v100 offset:32768
buffer_load_dwordx4 v10, s[8:11], s68 offen offset:0 lds
v_mfma_f32_16x16x32_bf16 v[148:151], a[116:119], v[80:83], v[148:151]
ds_read_b64_tr_b16 a[66:67], v100 offset:34816
v_cvt_pk_bf16_f32 v193, v130, v131
v_mfma_f32_16x16x32_bf16 v[148:151], a[120:123], v[84:87], v[148:151]
ds_read_b64_tr_b16 a[68:69], v100 offset:36864
v_cvt_pk_bf16_f32 v194, v136, v137
v_mfma_f32_16x16x32_bf16 v[148:151], a[124:127], v[88:91], v[148:151]
ds_read_b64_tr_b16 a[70:71], v100 offset:38912
v_cvt_pk_bf16_f32 v195, v138, v139
v_mfma_f32_16x16x32_bf16 v[148:151], a[128:131], v[92:95], v[148:151]
ds_read_b64_tr_b16 a[72:73], v100 offset:40960
buffer_store_dwordx4 v[192:195], v19, s[60:63], s34 offen offset:0 sc1
v_mfma_f32_16x16x32_bf16 v[148:151], a[132:135], a[200:203], v[148:151]
ds_read_b64_tr_b16 a[74:75], v100 offset:43008
v_cvt_pk_bf16_f32 v200, v132, v133
s_waitcnt lgkmcnt(6)
v_mfma_f32_16x16x32_bf16 v[152:155], a[136:139], v[32:35], 0
ds_read_b64_tr_b16 a[76:77], v100 offset:45056
buffer_load_dwordx4 v10, s[8:11], s69 offen offset:1024 lds
v_mfma_f32_16x16x32_bf16 v[152:155], a[140:143], v[36:39], v[152:155]
ds_read_b64_tr_b16 a[78:79], v100 offset:47104
v_cvt_pk_bf16_f32 v201, v134, v135
v_mfma_f32_16x16x32_bf16 v[152:155], a[144:147], v[40:43], v[152:155]
ds_read_b64_tr_b16 a[80:81], v100 offset:49152
v_cvt_pk_bf16_f32 v202, v140, v141
v_mfma_f32_16x16x32_bf16 v[152:155], a[148:151], v[44:47], v[152:155]
ds_read_b64_tr_b16 a[82:83], v100 offset:51200
v_cvt_pk_bf16_f32 v203, v142, v143
v_mfma_f32_16x16x32_bf16 v[152:155], a[152:155], v[48:51], v[152:155]
ds_read_b64_tr_b16 a[84:85], v100 offset:53248
buffer_store_dwordx4 v[200:203], v19, s[60:63], s34 offen offset:2048 sc1
v_mfma_f32_16x16x32_bf16 v[152:155], a[156:159], v[52:55], v[152:155]
ds_read_b64_tr_b16 a[86:87], v100 offset:55296
ds_read_b64_tr_b16 a[88:89], v100 offset:57344
v_mfma_f32_16x16x32_bf16 v[152:155], a[160:163], v[56:59], v[152:155]
buffer_load_dwordx4 v10, s[8:11], s70 offen offset:2048 lds
v_mfma_f32_16x16x32_bf16 v[152:155], a[164:167], v[60:63], v[152:155]
ds_read_b64_tr_b16 a[90:91], v100 offset:59392
ds_read_b64_tr_b16 a[92:93], v100 offset:61440
v_mfma_f32_16x16x32_bf16 v[152:155], a[168:171], a[196:199], v[152:155]
ds_read_b64_tr_b16 a[94:95], v100 offset:63488
ds_read_b64_tr_b16 a[96:97], v104 offset:12288
v_mfma_f32_16x16x32_bf16 v[156:159], a[136:139], v[64:67], 0
ds_read_b64_tr_b16 a[98:99], v104 offset:14336
ds_read_b64_tr_b16 a[100:101], v101 offset:32768
v_mfma_f32_16x16x32_bf16 v[156:159], a[140:143], v[68:71], v[156:159]
ds_read_b64_tr_b16 a[102:103], v101 offset:34816
v_mfma_f32_16x16x32_bf16 v[156:159], a[144:147], v[72:75], v[156:159]
ds_read_b64_tr_b16 a[104:105], v101 offset:36864
v_mfma_f32_16x16x32_bf16 v[156:159], a[148:151], v[76:79], v[156:159]
buffer_load_dwordx4 v10, s[8:11], s71 offen offset:3072 lds
v_mfma_f32_16x16x32_bf16 v[156:159], a[152:155], v[80:83], v[156:159]
ds_read_b64_tr_b16 a[106:107], v101 offset:38912
ds_read_b64_tr_b16 a[108:109], v101 offset:40960
v_mfma_f32_16x16x32_bf16 v[156:159], a[156:159], v[84:87], v[156:159]
ds_read_b64_tr_b16 a[110:111], v101 offset:43008
v_mfma_f32_16x16x32_bf16 v[156:159], a[160:163], v[88:91], v[156:159]
ds_read_b64_tr_b16 a[112:113], v101 offset:45056
v_mfma_f32_16x16x32_bf16 v[156:159], a[164:167], v[92:95], v[156:159]
ds_read_b64_tr_b16 a[114:115], v101 offset:47104
v_mfma_f32_16x16x32_bf16 v[156:159], a[168:171], a[200:203], v[156:159]
ds_read_b64_tr_b16 a[116:117], v101 offset:49152
s_waitcnt lgkmcnt(9)
v_mfma_f32_16x16x32_bf16 v[160:163], a[64:67], v[32:35], 0
ds_read_b64_tr_b16 a[118:119], v101 offset:51200
v_mfma_f32_16x16x32_bf16 v[160:163], a[68:71], v[36:39], v[160:163]
ds_read_b64_tr_b16 a[120:121], v101 offset:53248
v_mfma_f32_16x16x32_bf16 v[160:163], a[72:75], v[40:43], v[160:163]
v_mov_b32 v31, 2
s_waitcnt vmcnt(11)
buffer_store_dword v31, v19, s[16:19], 0 offen sc1
v_mfma_f32_16x16x32_bf16 v[160:163], a[76:79], v[44:47], v[160:163]
ds_read_b64_tr_b16 a[122:123], v101 offset:55296
ds_read_b64_tr_b16 a[124:125], v101 offset:57344
v_mfma_f32_16x16x32_bf16 v[160:163], a[80:83], v[48:51], v[160:163]
ds_read_b64_tr_b16 a[126:127], v101 offset:59392
s_mov_b32 s34, 8192
v_mfma_f32_16x16x32_bf16 v[160:163], a[84:87], v[52:55], v[160:163]
ds_read_b64_tr_b16 a[128:129], v101 offset:61440
v_cvt_pk_bf16_f32 v196, v144, v145
v_mfma_f32_16x16x32_bf16 v[160:163], a[88:91], v[56:59], v[160:163]
ds_read_b64_tr_b16 a[130:131], v101 offset:63488
v_cvt_pk_bf16_f32 v197, v146, v147
v_mfma_f32_16x16x32_bf16 v[160:163], a[92:95], v[60:63], v[160:163]
ds_read_b64_tr_b16 a[132:133], v105 offset:12288
v_cvt_pk_bf16_f32 v198, v152, v153
v_mfma_f32_16x16x32_bf16 v[160:163], a[96:99], a[196:199], v[160:163]
ds_read_b64_tr_b16 a[134:135], v105 offset:14336
v_cvt_pk_bf16_f32 v199, v154, v155
v_mfma_f32_16x16x32_bf16 v[164:167], a[64:67], v[64:67], 0
buffer_store_dwordx4 v[196:199], v19, s[60:63], s34 offen offset:1024 sc1
v_mfma_f32_16x16x32_bf16 v[164:167], a[68:71], v[68:71], v[164:167]
ds_read_b64_tr_b16 a[136:137], v102 offset:32768
v_cvt_pk_bf16_f32 v204, v148, v149
v_mfma_f32_16x16x32_bf16 v[164:167], a[72:75], v[72:75], v[164:167]
ds_read_b64_tr_b16 a[138:139], v102 offset:34816
v_cvt_pk_bf16_f32 v205, v150, v151
v_mfma_f32_16x16x32_bf16 v[164:167], a[76:79], v[76:79], v[164:167]
ds_read_b64_tr_b16 a[140:141], v102 offset:36864
v_cvt_pk_bf16_f32 v206, v156, v157
v_mfma_f32_16x16x32_bf16 v[164:167], a[80:83], v[80:83], v[164:167]
ds_read_b64_tr_b16 a[142:143], v102 offset:38912
v_cvt_pk_bf16_f32 v207, v158, v159
v_mfma_f32_16x16x32_bf16 v[164:167], a[84:87], v[84:87], v[164:167]
buffer_store_dwordx4 v[204:207], v19, s[60:63], s34 offen offset:3072 sc1
v_mfma_f32_16x16x32_bf16 v[164:167], a[88:91], v[88:91], v[164:167]
ds_read_b64_tr_b16 a[144:145], v102 offset:40960
ds_read_b64_tr_b16 a[146:147], v102 offset:43008
v_mfma_f32_16x16x32_bf16 v[164:167], a[92:95], v[92:95], v[164:167]
ds_read_b64_tr_b16 a[148:149], v102 offset:45056
ds_read_b64_tr_b16 a[150:151], v102 offset:47104
v_mfma_f32_16x16x32_bf16 v[164:167], a[96:99], a[200:203], v[164:167]
ds_read_b64_tr_b16 a[152:153], v102 offset:49152
s_waitcnt lgkmcnt(9)
v_mfma_f32_16x16x32_bf16 v[168:171], a[100:103], v[32:35], 0
ds_read_b64_tr_b16 a[154:155], v102 offset:51200
v_mfma_f32_16x16x32_bf16 v[168:171], a[104:107], v[36:39], v[168:171]
ds_read_b64_tr_b16 a[156:157], v102 offset:53248
s_add_u32 m0, s23, 36864
v_mfma_f32_16x16x32_bf16 v[168:171], a[108:111], v[40:43], v[168:171]
buffer_load_dwordx4 v10, s[8:11], s72 offen offset:0 lds
v_mfma_f32_16x16x32_bf16 v[168:171], a[112:115], v[44:47], v[168:171]
ds_read_b64_tr_b16 a[158:159], v102 offset:55296
ds_read_b64_tr_b16 a[160:161], v102 offset:57344
v_mfma_f32_16x16x32_bf16 v[168:171], a[116:119], v[48:51], v[168:171]
ds_read_b64_tr_b16 a[162:163], v102 offset:59392
v_mfma_f32_16x16x32_bf16 v[168:171], a[120:123], v[52:55], v[168:171]
ds_read_b64_tr_b16 a[164:165], v102 offset:61440
v_mfma_f32_16x16x32_bf16 v[168:171], a[124:127], v[56:59], v[168:171]
ds_read_b64_tr_b16 a[166:167], v102 offset:63488
v_mfma_f32_16x16x32_bf16 v[168:171], a[128:131], v[60:63], v[168:171]
buffer_load_dwordx4 v10, s[8:11], s73 offen offset:1024 lds
v_mfma_f32_16x16x32_bf16 v[168:171], a[132:135], a[196:199], v[168:171]
ds_read_b64_tr_b16 a[168:169], v106 offset:12288
ds_read_b64_tr_b16 a[170:171], v106 offset:14336
v_mfma_f32_16x16x32_bf16 v[172:175], a[100:103], v[64:67], 0
ds_read_b64_tr_b16 a[64:65], v103 offset:32768
v_mfma_f32_16x16x32_bf16 v[172:175], a[104:107], v[68:71], v[172:175]
ds_read_b64_tr_b16 a[66:67], v103 offset:34816
v_mfma_f32_16x16x32_bf16 v[172:175], a[108:111], v[72:75], v[172:175]
ds_read_b64_tr_b16 a[68:69], v103 offset:36864
v_mfma_f32_16x16x32_bf16 v[172:175], a[112:115], v[76:79], v[172:175]
buffer_load_dwordx4 v10, s[8:11], s74 offen offset:2048 lds
v_mfma_f32_16x16x32_bf16 v[172:175], a[116:119], v[80:83], v[172:175]
ds_read_b64_tr_b16 a[70:71], v103 offset:38912
ds_read_b64_tr_b16 a[72:73], v103 offset:40960
v_mfma_f32_16x16x32_bf16 v[172:175], a[120:123], v[84:87], v[172:175]
ds_read_b64_tr_b16 a[74:75], v103 offset:43008
v_mfma_f32_16x16x32_bf16 v[172:175], a[124:127], v[88:91], v[172:175]
ds_read_b64_tr_b16 a[76:77], v103 offset:45056
v_mfma_f32_16x16x32_bf16 v[172:175], a[128:131], v[92:95], v[172:175]
ds_read_b64_tr_b16 a[78:79], v103 offset:47104
v_mfma_f32_16x16x32_bf16 v[172:175], a[132:135], a[200:203], v[172:175]
buffer_load_dwordx4 v10, s[8:11], s75 offen offset:3072 lds
s_waitcnt lgkmcnt(8)
v_mfma_f32_16x16x32_bf16 v[176:179], a[136:139], v[32:35], 0
ds_read_b64_tr_b16 a[80:81], v103 offset:49152
ds_read_b64_tr_b16 a[82:83], v103 offset:51200
v_mfma_f32_16x16x32_bf16 v[176:179], a[140:143], v[36:39], v[176:179]
ds_read_b64_tr_b16 a[84:85], v103 offset:53248
v_mfma_f32_16x16x32_bf16 v[176:179], a[144:147], v[40:43], v[176:179]
ds_read_b64_tr_b16 a[86:87], v103 offset:55296
v_mfma_f32_16x16x32_bf16 v[176:179], a[148:151], v[44:47], v[176:179]
ds_read_b64_tr_b16 a[88:89], v103 offset:57344
s_add_u32 m0, s39, 135168
v_mfma_f32_16x16x32_bf16 v[176:179], a[152:155], v[48:51], v[176:179]
buffer_load_dwordx4 v0, s[92:95], s32 offen lds
v_mfma_f32_16x16x32_bf16 v[176:179], a[156:159], v[52:55], v[176:179]
s_add_u32 s8, s8, 128
s_addc_u32 s9, s9, 0
v_mfma_f32_16x16x32_bf16 v[176:179], a[160:163], v[56:59], v[176:179]
s_sub_u32 s10, s10, 128
s_add_u32 s32, s32, 128
v_mfma_f32_16x16x32_bf16 v[176:179], a[164:167], v[60:63], v[176:179]
ds_read_b64_tr_b16 a[90:91], v103 offset:59392
ds_read_b64_tr_b16 a[92:93], v103 offset:61440
v_mfma_f32_16x16x32_bf16 v[176:179], a[168:171], a[196:199], v[176:179]
s_waitcnt vmcnt(14)
s_barrier
v_mfma_f32_16x16x32_bf16 v[180:183], a[136:139], v[64:67], 0
ds_read_b64_tr_b16 a[94:95], v103 offset:63488
s_mov_b32 s34, 12288
v_mfma_f32_16x16x32_bf16 v[180:183], a[140:143], v[68:71], v[180:183]
ds_read_b64_tr_b16 a[96:97], v107 offset:12288
v_cvt_pk_bf16_f32 v192, v160, v161
v_mfma_f32_16x16x32_bf16 v[180:183], a[144:147], v[72:75], v[180:183]
ds_read_b64_tr_b16 a[98:99], v107 offset:14336
s_add_u32 m0, s23, 65536
v_mfma_f32_16x16x32_bf16 v[180:183], a[148:151], v[76:79], v[180:183]
ds_read_b64_tr_b16 a[100:101], v96 offset:0
buffer_load_dwordx4 v10, s[8:11], s68 offen offset:0 lds
v_mfma_f32_16x16x32_bf16 v[180:183], a[152:155], v[80:83], v[180:183]
ds_read_b64_tr_b16 a[102:103], v96 offset:2048
v_cvt_pk_bf16_f32 v193, v162, v163
v_mfma_f32_16x16x32_bf16 v[180:183], a[156:159], v[84:87], v[180:183]
ds_read_b64_tr_b16 a[104:105], v96 offset:4096
v_cvt_pk_bf16_f32 v194, v168, v169
v_mfma_f32_16x16x32_bf16 v[180:183], a[160:163], v[88:91], v[180:183]
ds_read_b64_tr_b16 a[106:107], v96 offset:6144
v_cvt_pk_bf16_f32 v195, v170, v171
v_mfma_f32_16x16x32_bf16 v[180:183], a[164:167], v[92:95], v[180:183]
ds_read_b64_tr_b16 a[108:109], v96 offset:8192
buffer_store_dwordx4 v[192:195], v19, s[60:63], s34 offen offset:0 sc1
v_mfma_f32_16x16x32_bf16 v[180:183], a[168:171], a[200:203], v[180:183]
ds_read_b64_tr_b16 a[110:111], v96 offset:10240
v_cvt_pk_bf16_f32 v200, v164, v165
s_waitcnt lgkmcnt(6)
v_mfma_f32_16x16x32_bf16 v[184:187], a[64:67], v[32:35], 0
ds_read_b64_tr_b16 a[112:113], v96 offset:12288
buffer_load_dwordx4 v10, s[8:11], s69 offen offset:1024 lds
v_mfma_f32_16x16x32_bf16 v[184:187], a[68:71], v[36:39], v[184:187]
ds_read_b64_tr_b16 a[114:115], v96 offset:14336
v_cvt_pk_bf16_f32 v201, v166, v167
v_mfma_f32_16x16x32_bf16 v[184:187], a[72:75], v[40:43], v[184:187]
ds_read_b64_tr_b16 a[116:117], v96 offset:16384
v_cvt_pk_bf16_f32 v202, v172, v173
v_mfma_f32_16x16x32_bf16 v[184:187], a[76:79], v[44:47], v[184:187]
ds_read_b64_tr_b16 a[118:119], v96 offset:18432
v_cvt_pk_bf16_f32 v203, v174, v175
v_mfma_f32_16x16x32_bf16 v[184:187], a[80:83], v[48:51], v[184:187]
ds_read_b64_tr_b16 a[120:121], v96 offset:20480
buffer_store_dwordx4 v[200:203], v19, s[60:63], s34 offen offset:2048 sc1
v_mfma_f32_16x16x32_bf16 v[184:187], a[84:87], v[52:55], v[184:187]
ds_read_b64_tr_b16 a[122:123], v96 offset:22528
ds_read_b64_tr_b16 a[124:125], v96 offset:24576
v_mfma_f32_16x16x32_bf16 v[184:187], a[88:91], v[56:59], v[184:187]
buffer_load_dwordx4 v10, s[8:11], s70 offen offset:2048 lds
v_mfma_f32_16x16x32_bf16 v[184:187], a[92:95], v[60:63], v[184:187]
ds_read_b64_tr_b16 a[126:127], v96 offset:26624
ds_read_b64_tr_b16 a[128:129], v96 offset:28672
v_mfma_f32_16x16x32_bf16 v[184:187], a[96:99], a[196:199], v[184:187]
ds_read_b64_tr_b16 a[130:131], v96 offset:30720
ds_read_b64_tr_b16 a[132:133], v104 offset:0
v_mfma_f32_16x16x32_bf16 v[188:191], a[64:67], v[64:67], 0
ds_read_b64_tr_b16 a[134:135], v104 offset:2048
ds_read_b64_tr_b16 a[136:137], v97 offset:0
v_mfma_f32_16x16x32_bf16 v[188:191], a[68:71], v[68:71], v[188:191]
ds_read_b64_tr_b16 a[138:139], v97 offset:2048
v_mfma_f32_16x16x32_bf16 v[188:191], a[72:75], v[72:75], v[188:191]
ds_read_b64_tr_b16 a[140:141], v97 offset:4096
v_mfma_f32_16x16x32_bf16 v[188:191], a[76:79], v[76:79], v[188:191]
buffer_load_dwordx4 v10, s[8:11], s71 offen offset:3072 lds
v_mfma_f32_16x16x32_bf16 v[188:191], a[80:83], v[80:83], v[188:191]
ds_read_b64_tr_b16 a[142:143], v97 offset:6144
ds_read_b64_tr_b16 a[144:145], v97 offset:8192
v_mfma_f32_16x16x32_bf16 v[188:191], a[84:87], v[84:87], v[188:191]
ds_read_b64_tr_b16 a[146:147], v97 offset:10240
v_mfma_f32_16x16x32_bf16 v[188:191], a[88:91], v[88:91], v[188:191]
ds_read_b64_tr_b16 a[148:149], v97 offset:12288
v_mfma_f32_16x16x32_bf16 v[188:191], a[92:95], v[92:95], v[188:191]
ds_read_b64_tr_b16 a[150:151], v97 offset:14336
v_mfma_f32_16x16x32_bf16 v[188:191], a[96:99], a[200:203], v[188:191]
ds_read_b64_tr_b16 a[152:153], v97 offset:16384
s_waitcnt lgkmcnt(9)
v_mfma_f32_16x16x32_bf16 v[128:131], a[100:103], v[32:35], 0
ds_read_b64_tr_b16 a[154:155], v97 offset:18432
v_mfma_f32_16x16x32_bf16 v[128:131], a[104:107], v[36:39], v[128:131]
ds_read_b64_tr_b16 a[156:157], v97 offset:20480
v_mfma_f32_16x16x32_bf16 v[128:131], a[108:111], v[40:43], v[128:131]
ds_read_b64_tr_b16 a[158:159], v97 offset:22528
v_mfma_f32_16x16x32_bf16 v[128:131], a[112:115], v[44:47], v[128:131]
ds_read_b64_tr_b16 a[160:161], v97 offset:24576
v_mfma_f32_16x16x32_bf16 v[128:131], a[116:119], v[48:51], v[128:131]
ds_read_b64_tr_b16 a[162:163], v97 offset:26624
s_mov_b32 s34, 12288
v_mfma_f32_16x16x32_bf16 v[128:131], a[120:123], v[52:55], v[128:131]
ds_read_b64_tr_b16 a[164:165], v97 offset:28672
v_cvt_pk_bf16_f32 v196, v176, v177
v_mfma_f32_16x16x32_bf16 v[128:131], a[124:127], v[56:59], v[128:131]
ds_read_b64_tr_b16 a[166:167], v97 offset:30720
v_cvt_pk_bf16_f32 v197, v178, v179
v_mfma_f32_16x16x32_bf16 v[128:131], a[128:131], v[60:63], v[128:131]
ds_read_b64_tr_b16 a[168:169], v105 offset:0
v_cvt_pk_bf16_f32 v198, v184, v185
v_mfma_f32_16x16x32_bf16 v[128:131], a[132:135], a[196:199], v[128:131]
ds_read_b64_tr_b16 a[170:171], v105 offset:2048
v_cvt_pk_bf16_f32 v199, v186, v187
v_mfma_f32_16x16x32_bf16 v[132:135], a[100:103], v[64:67], 0
buffer_store_dwordx4 v[196:199], v19, s[60:63], s34 offen offset:1024 sc1
v_mfma_f32_16x16x32_bf16 v[132:135], a[104:107], v[68:71], v[132:135]
ds_read_b64_tr_b16 a[64:65], v98 offset:0
v_cvt_pk_bf16_f32 v204, v180, v181
v_mfma_f32_16x16x32_bf16 v[132:135], a[108:111], v[72:75], v[132:135]
ds_read_b64_tr_b16 a[66:67], v98 offset:2048
v_cvt_pk_bf16_f32 v205, v182, v183
v_mfma_f32_16x16x32_bf16 v[132:135], a[112:115], v[76:79], v[132:135]
ds_read_b64_tr_b16 a[68:69], v98 offset:4096
v_cvt_pk_bf16_f32 v206, v188, v189
v_mfma_f32_16x16x32_bf16 v[132:135], a[116:119], v[80:83], v[132:135]
ds_read_b64_tr_b16 a[70:71], v98 offset:6144
v_cvt_pk_bf16_f32 v207, v190, v191
v_mfma_f32_16x16x32_bf16 v[132:135], a[120:123], v[84:87], v[132:135]
buffer_store_dwordx4 v[204:207], v19, s[60:63], s34 offen offset:3072 sc1
v_mfma_f32_16x16x32_bf16 v[132:135], a[124:127], v[88:91], v[132:135]
ds_read_b64_tr_b16 a[72:73], v98 offset:8192
ds_read_b64_tr_b16 a[74:75], v98 offset:10240
v_mfma_f32_16x16x32_bf16 v[132:135], a[128:131], v[92:95], v[132:135]
ds_read_b64_tr_b16 a[76:77], v98 offset:12288
ds_read_b64_tr_b16 a[78:79], v98 offset:14336
v_mfma_f32_16x16x32_bf16 v[132:135], a[132:135], a[200:203], v[132:135]
ds_read_b64_tr_b16 a[80:81], v98 offset:16384
s_waitcnt lgkmcnt(9)
v_mfma_f32_16x16x32_bf16 v[136:139], a[136:139], v[32:35], 0
ds_read_b64_tr_b16 a[82:83], v98 offset:18432
v_mfma_f32_16x16x32_bf16 v[136:139], a[140:143], v[36:39], v[136:139]
ds_read_b64_tr_b16 a[84:85], v98 offset:20480
s_add_u32 m0, s23, 69632
v_mfma_f32_16x16x32_bf16 v[136:139], a[144:147], v[40:43], v[136:139]
buffer_load_dwordx4 v10, s[8:11], s72 offen offset:0 lds
v_mfma_f32_16x16x32_bf16 v[136:139], a[148:151], v[44:47], v[136:139]
ds_read_b64_tr_b16 a[86:87], v98 offset:22528
ds_read_b64_tr_b16 a[88:89], v98 offset:24576
v_mfma_f32_16x16x32_bf16 v[136:139], a[152:155], v[48:51], v[136:139]
ds_read_b64_tr_b16 a[90:91], v98 offset:26624
v_mfma_f32_16x16x32_bf16 v[136:139], a[156:159], v[52:55], v[136:139]
ds_read_b64_tr_b16 a[92:93], v98 offset:28672
v_mfma_f32_16x16x32_bf16 v[136:139], a[160:163], v[56:59], v[136:139]
ds_read_b64_tr_b16 a[94:95], v98 offset:30720
v_mfma_f32_16x16x32_bf16 v[136:139], a[164:167], v[60:63], v[136:139]
buffer_load_dwordx4 v10, s[8:11], s73 offen offset:1024 lds
v_mfma_f32_16x16x32_bf16 v[136:139], a[168:171], a[196:199], v[136:139]
ds_read_b64_tr_b16 a[96:97], v106 offset:0
ds_read_b64_tr_b16 a[98:99], v106 offset:2048
v_mfma_f32_16x16x32_bf16 v[140:143], a[136:139], v[64:67], 0
ds_read_b64_tr_b16 a[100:101], v99 offset:0
v_mfma_f32_16x16x32_bf16 v[140:143], a[140:143], v[68:71], v[140:143]
ds_read_b64_tr_b16 a[102:103], v99 offset:2048
v_mfma_f32_16x16x32_bf16 v[140:143], a[144:147], v[72:75], v[140:143]
ds_read_b64_tr_b16 a[104:105], v99 offset:4096
v_mfma_f32_16x16x32_bf16 v[140:143], a[148:151], v[76:79], v[140:143]
buffer_load_dwordx4 v10, s[8:11], s74 offen offset:2048 lds
v_mfma_f32_16x16x32_bf16 v[140:143], a[152:155], v[80:83], v[140:143]
ds_read_b64_tr_b16 a[106:107], v99 offset:6144
ds_read_b64_tr_b16 a[108:109], v99 offset:8192
v_mfma_f32_16x16x32_bf16 v[140:143], a[156:159], v[84:87], v[140:143]
ds_read_b64_tr_b16 a[110:111], v99 offset:10240
v_mfma_f32_16x16x32_bf16 v[140:143], a[160:163], v[88:91], v[140:143]
ds_read_b64_tr_b16 a[112:113], v99 offset:12288
v_mfma_f32_16x16x32_bf16 v[140:143], a[164:167], v[92:95], v[140:143]
ds_read_b64_tr_b16 a[114:115], v99 offset:14336
v_mfma_f32_16x16x32_bf16 v[140:143], a[168:171], a[200:203], v[140:143]
buffer_load_dwordx4 v10, s[8:11], s75 offen offset:3072 lds
s_waitcnt lgkmcnt(8)
v_mfma_f32_16x16x32_bf16 v[144:147], a[64:67], v[32:35], 0
ds_read_b64_tr_b16 a[116:117], v99 offset:16384
ds_read_b64_tr_b16 a[118:119], v99 offset:18432
v_mfma_f32_16x16x32_bf16 v[144:147], a[68:71], v[36:39], v[144:147]
ds_read_b64_tr_b16 a[120:121], v99 offset:20480
v_mfma_f32_16x16x32_bf16 v[144:147], a[72:75], v[40:43], v[144:147]
ds_read_b64_tr_b16 a[122:123], v99 offset:22528
v_mfma_f32_16x16x32_bf16 v[144:147], a[76:79], v[44:47], v[144:147]
ds_read_b64_tr_b16 a[124:125], v99 offset:24576
s_add_u32 m0, s39, 139264
v_mfma_f32_16x16x32_bf16 v[144:147], a[80:83], v[48:51], v[144:147]
buffer_load_dwordx4 v0, s[92:95], s32 offen lds
v_mfma_f32_16x16x32_bf16 v[144:147], a[84:87], v[52:55], v[144:147]
s_add_u32 s8, s8, 128
s_addc_u32 s9, s9, 0
v_mfma_f32_16x16x32_bf16 v[144:147], a[88:91], v[56:59], v[144:147]
s_sub_u32 s10, s10, 128
s_add_u32 s32, s32, 128
v_mfma_f32_16x16x32_bf16 v[144:147], a[92:95], v[60:63], v[144:147]
ds_read_b64_tr_b16 a[126:127], v99 offset:26624
ds_read_b64_tr_b16 a[128:129], v99 offset:28672
v_mfma_f32_16x16x32_bf16 v[144:147], a[96:99], a[196:199], v[144:147]
s_waitcnt vmcnt(13)
s_barrier
v_mfma_f32_16x16x32_bf16 v[148:151], a[64:67], v[64:67], 0
ds_read_b64_tr_b16 a[130:131], v99 offset:30720
s_mov_b32 s34, 16384
v_mfma_f32_16x16x32_bf16 v[148:151], a[68:71], v[68:71], v[148:151]
ds_read_b64_tr_b16 a[132:133], v107 offset:0
v_cvt_pk_bf16_f32 v192, v128, v129
v_mfma_f32_16x16x32_bf16 v[148:151], a[72:75], v[72:75], v[148:151]
ds_read_b64_tr_b16 a[134:135], v107 offset:2048
v_cvt_pk_bf16_f32 v193, v130, v131
v_mfma_f32_16x16x32_bf16 v[148:151], a[76:79], v[76:79], v[148:151]
ds_read_b64_tr_b16 a[136:137], v96 offset:32768
v_cvt_pk_bf16_f32 v194, v136, v137
v_mfma_f32_16x16x32_bf16 v[148:151], a[80:83], v[80:83], v[148:151]
ds_read_b64_tr_b16 a[138:139], v96 offset:34816
v_cvt_pk_bf16_f32 v195, v138, v139
v_mfma_f32_16x16x32_bf16 v[148:151], a[84:87], v[84:87], v[148:151]
ds_read_b64_tr_b16 a[140:141], v96 offset:36864
buffer_store_dwordx4 v[192:195], v19, s[60:63], s34 offen offset:0 sc1
v_mfma_f32_16x16x32_bf16 v[148:151], a[88:91], v[88:91], v[148:151]
ds_read_b64_tr_b16 a[142:143], v96 offset:38912
v_cvt_pk_bf16_f32 v200, v132, v133
v_mfma_f32_16x16x32_bf16 v[148:151], a[92:95], v[92:95], v[148:151]
ds_read_b64_tr_b16 a[144:145], v96 offset:40960
v_cvt_pk_bf16_f32 v201, v134, v135
v_mfma_f32_16x16x32_bf16 v[148:151], a[96:99], a[200:203], v[148:151]
ds_read_b64_tr_b16 a[146:147], v96 offset:43008
v_cvt_pk_bf16_f32 v202, v140, v141
s_waitcnt lgkmcnt(6)
v_mfma_f32_16x16x32_bf16 v[152:155], a[100:103], v[32:35], 0
ds_read_b64_tr_b16 a[148:149], v96 offset:45056
v_cvt_pk_bf16_f32 v203, v142, v143
v_mfma_f32_16x16x32_bf16 v[152:155], a[104:107], v[36:39], v[152:155]
ds_read_b64_tr_b16 a[150:151], v96 offset:47104
buffer_store_dwordx4 v[200:203], v19, s[60:63], s34 offen offset:2048 sc1
v_mfma_f32_16x16x32_bf16 v[152:155], a[108:111], v[40:43], v[152:155]
ds_read_b64_tr_b16 a[152:153], v96 offset:49152
ds_read_b64_tr_b16 a[154:155], v96 offset:51200
v_mfma_f32_16x16x32_bf16 v[152:155], a[112:115], v[44:47], v[152:155]
ds_read_b64_tr_b16 a[156:157], v96 offset:53248
ds_read_b64_tr_b16 a[158:159], v96 offset:55296
v_mfma_f32_16x16x32_bf16 v[152:155], a[116:119], v[48:51], v[152:155]
ds_read_b64_tr_b16 a[160:161], v96 offset:57344
ds_read_b64_tr_b16 a[162:163], v96 offset:59392
v_mfma_f32_16x16x32_bf16 v[152:155], a[120:123], v[52:55], v[152:155]
ds_read_b64_tr_b16 a[164:165], v96 offset:61440
v_mfma_f32_16x16x32_bf16 v[152:155], a[124:127], v[56:59], v[152:155]
ds_read_b64_tr_b16 a[166:167], v96 offset:63488
v_mfma_f32_16x16x32_bf16 v[152:155], a[128:131], v[60:63], v[152:155]
ds_read_b64_tr_b16 a[168:169], v104 offset:4096
v_mfma_f32_16x16x32_bf16 v[152:155], a[132:135], a[196:199], v[152:155]
ds_read_b64_tr_b16 a[170:171], v104 offset:6144
v_mfma_f32_16x16x32_bf16 v[156:159], a[100:103], v[64:67], 0
ds_read_b64_tr_b16 a[64:65], v97 offset:32768
v_mfma_f32_16x16x32_bf16 v[156:159], a[104:107], v[68:71], v[156:159]
ds_read_b64_tr_b16 a[66:67], v97 offset:34816
v_mfma_f32_16x16x32_bf16 v[156:159], a[108:111], v[72:75], v[156:159]
ds_read_b64_tr_b16 a[68:69], v97 offset:36864
v_mfma_f32_16x16x32_bf16 v[156:159], a[112:115], v[76:79], v[156:159]
ds_read_b64_tr_b16 a[70:71], v97 offset:38912
v_mfma_f32_16x16x32_bf16 v[156:159], a[116:119], v[80:83], v[156:159]
ds_read_b64_tr_b16 a[72:73], v97 offset:40960
v_mfma_f32_16x16x32_bf16 v[156:159], a[120:123], v[84:87], v[156:159]
ds_read_b64_tr_b16 a[74:75], v97 offset:43008
v_mfma_f32_16x16x32_bf16 v[156:159], a[124:127], v[88:91], v[156:159]
ds_read_b64_tr_b16 a[76:77], v97 offset:45056
v_mfma_f32_16x16x32_bf16 v[156:159], a[128:131], v[92:95], v[156:159]
ds_read_b64_tr_b16 a[78:79], v97 offset:47104
v_mfma_f32_16x16x32_bf16 v[156:159], a[132:135], a[200:203], v[156:159]
ds_read_b64_tr_b16 a[80:81], v97 offset:49152
s_waitcnt lgkmcnt(9)
v_mfma_f32_16x16x32_bf16 v[160:163], a[136:139], v[32:35], 0
ds_read_b64_tr_b16 a[82:83], v97 offset:51200
v_mfma_f32_16x16x32_bf16 v[160:163], a[140:143], v[36:39], v[160:163]
ds_read_b64_tr_b16 a[84:85], v97 offset:53248
v_mfma_f32_16x16x32_bf16 v[160:163], a[144:147], v[40:43], v[160:163]
v_mov_b32 v31, 4
s_waitcnt vmcnt(7)
buffer_store_dword v31, v19, s[16:19], 0 offen sc1
v_mfma_f32_16x16x32_bf16 v[160:163], a[148:151], v[44:47], v[160:163]
ds_read_b64_tr_b16 a[86:87], v97 offset:55296
ds_read_b64_tr_b16 a[88:89], v97 offset:57344
v_mfma_f32_16x16x32_bf16 v[160:163], a[152:155], v[48:51], v[160:163]
ds_read_b64_tr_b16 a[90:91], v97 offset:59392
s_mov_b32 s34, 16384
v_mfma_f32_16x16x32_bf16 v[160:163], a[156:159], v[52:55], v[160:163]
ds_read_b64_tr_b16 a[92:93], v97 offset:61440
v_cvt_pk_bf16_f32 v196, v144, v145
v_mfma_f32_16x16x32_bf16 v[160:163], a[160:163], v[56:59], v[160:163]
ds_read_b64_tr_b16 a[94:95], v97 offset:63488
v_cvt_pk_bf16_f32 v197, v146, v147
v_mfma_f32_16x16x32_bf16 v[160:163], a[164:167], v[60:63], v[160:163]
ds_read_b64_tr_b16 a[96:97], v105 offset:4096
v_cvt_pk_bf16_f32 v198, v152, v153
v_mfma_f32_16x16x32_bf16 v[160:163], a[168:171], a[196:199], v[160:163]
ds_read_b64_tr_b16 a[98:99], v105 offset:6144
v_cvt_pk_bf16_f32 v199, v154, v155
v_mfma_f32_16x16x32_bf16 v[164:167], a[136:139], v[64:67], 0
buffer_store_dwordx4 v[196:199], v19, s[60:63], s34 offen offset:1024 sc1
v_mfma_f32_16x16x32_bf16 v[164:167], a[140:143], v[68:71], v[164:167]
ds_read_b64_tr_b16 a[100:101], v98 offset:32768
v_cvt_pk_bf16_f32 v204, v148, v149
v_mfma_f32_16x16x32_bf16 v[164:167], a[144:147], v[72:75], v[164:167]
ds_read_b64_tr_b16 a[102:103], v98 offset:34816
v_cvt_pk_bf16_f32 v205, v150, v151
v_mfma_f32_16x16x32_bf16 v[164:167], a[148:151], v[76:79], v[164:167]
ds_read_b64_tr_b16 a[104:105], v98 offset:36864
v_cvt_pk_bf16_f32 v206, v156, v157
v_mfma_f32_16x16x32_bf16 v[164:167], a[152:155], v[80:83], v[164:167]
ds_read_b64_tr_b16 a[106:107], v98 offset:38912
v_cvt_pk_bf16_f32 v207, v158, v159
v_mfma_f32_16x16x32_bf16 v[164:167], a[156:159], v[84:87], v[164:167]
buffer_store_dwordx4 v[204:207], v19, s[60:63], s34 offen offset:3072 sc1
v_mfma_f32_16x16x32_bf16 v[164:167], a[160:163], v[88:91], v[164:167]
ds_read_b64_tr_b16 a[108:109], v98 offset:40960
ds_read_b64_tr_b16 a[110:111], v98 offset:43008
v_mfma_f32_16x16x32_bf16 v[164:167], a[164:167], v[92:95], v[164:167]
ds_read_b64_tr_b16 a[112:113], v98 offset:45056
ds_read_b64_tr_b16 a[114:115], v98 offset:47104
v_mfma_f32_16x16x32_bf16 v[164:167], a[168:171], a[200:203], v[164:167]
ds_read_b64_tr_b16 a[116:117], v98 offset:49152
s_waitcnt lgkmcnt(9)
v_mfma_f32_16x16x32_bf16 v[168:171], a[64:67], v[32:35], 0
ds_read_b64_tr_b16 a[118:119], v98 offset:51200
v_mfma_f32_16x16x32_bf16 v[168:171], a[68:71], v[36:39], v[168:171]
ds_read_b64_tr_b16 a[120:121], v98 offset:53248
v_mfma_f32_16x16x32_bf16 v[168:171], a[72:75], v[40:43], v[168:171]
ds_read_b64_tr_b16 a[122:123], v98 offset:55296
v_mfma_f32_16x16x32_bf16 v[168:171], a[76:79], v[44:47], v[168:171]
ds_read_b64_tr_b16 a[124:125], v98 offset:57344
v_mfma_f32_16x16x32_bf16 v[168:171], a[80:83], v[48:51], v[168:171]
ds_read_b64_tr_b16 a[126:127], v98 offset:59392
v_mfma_f32_16x16x32_bf16 v[168:171], a[84:87], v[52:55], v[168:171]
ds_read_b64_tr_b16 a[128:129], v98 offset:61440
v_mfma_f32_16x16x32_bf16 v[168:171], a[88:91], v[56:59], v[168:171]
ds_read_b64_tr_b16 a[130:131], v98 offset:63488
v_mfma_f32_16x16x32_bf16 v[168:171], a[92:95], v[60:63], v[168:171]
ds_read_b64_tr_b16 a[132:133], v106 offset:4096
v_mfma_f32_16x16x32_bf16 v[168:171], a[96:99], a[196:199], v[168:171]
ds_read_b64_tr_b16 a[134:135], v106 offset:6144
v_mfma_f32_16x16x32_bf16 v[172:175], a[64:67], v[64:67], 0
ds_read_b64_tr_b16 a[136:137], v99 offset:32768
v_mfma_f32_16x16x32_bf16 v[172:175], a[68:71], v[68:71], v[172:175]
ds_read_b64_tr_b16 a[138:139], v99 offset:34816
v_mfma_f32_16x16x32_bf16 v[172:175], a[72:75], v[72:75], v[172:175]
ds_read_b64_tr_b16 a[140:141], v99 offset:36864
v_mfma_f32_16x16x32_bf16 v[172:175], a[76:79], v[76:79], v[172:175]
ds_read_b64_tr_b16 a[142:143], v99 offset:38912
v_mfma_f32_16x16x32_bf16 v[172:175], a[80:83], v[80:83], v[172:175]
ds_read_b64_tr_b16 a[144:145], v99 offset:40960
v_mfma_f32_16x16x32_bf16 v[172:175], a[84:87], v[84:87], v[172:175]
ds_read_b64_tr_b16 a[146:147], v99 offset:43008
v_mfma_f32_16x16x32_bf16 v[172:175], a[88:91], v[88:91], v[172:175]
ds_read_b64_tr_b16 a[148:149], v99 offset:45056
v_mfma_f32_16x16x32_bf16 v[172:175], a[92:95], v[92:95], v[172:175]
ds_read_b64_tr_b16 a[150:151], v99 offset:47104
v_mfma_f32_16x16x32_bf16 v[172:175], a[96:99], a[200:203], v[172:175]
ds_read_b64_tr_b16 a[152:153], v99 offset:49152
s_waitcnt lgkmcnt(9)
v_mfma_f32_16x16x32_bf16 v[176:179], a[100:103], v[32:35], 0
ds_read_b64_tr_b16 a[154:155], v99 offset:51200
v_mfma_f32_16x16x32_bf16 v[176:179], a[104:107], v[36:39], v[176:179]
ds_read_b64_tr_b16 a[156:157], v99 offset:53248
v_mfma_f32_16x16x32_bf16 v[176:179], a[108:111], v[40:43], v[176:179]
ds_read_b64_tr_b16 a[158:159], v99 offset:55296
v_mfma_f32_16x16x32_bf16 v[176:179], a[112:115], v[44:47], v[176:179]
ds_read_b64_tr_b16 a[160:161], v99 offset:57344
v_mfma_f32_16x16x32_bf16 v[176:179], a[116:119], v[48:51], v[176:179]
ds_read_b64_tr_b16 a[162:163], v99 offset:59392
v_mfma_f32_16x16x32_bf16 v[176:179], a[120:123], v[52:55], v[176:179]
ds_read_b64_tr_b16 a[164:165], v99 offset:61440
v_mfma_f32_16x16x32_bf16 v[176:179], a[124:127], v[56:59], v[176:179]
ds_read_b64_tr_b16 a[166:167], v99 offset:63488
v_mfma_f32_16x16x32_bf16 v[176:179], a[128:131], v[60:63], v[176:179]
ds_read_b64_tr_b16 a[168:169], v107 offset:4096
v_mfma_f32_16x16x32_bf16 v[176:179], a[132:135], a[196:199], v[176:179]
s_waitcnt vmcnt(5)
s_barrier
v_mfma_f32_16x16x32_bf16 v[180:183], a[100:103], v[64:67], 0
ds_read_b64_tr_b16 a[170:171], v107 offset:6144
s_mov_b32 s34, 20480
v_mfma_f32_16x16x32_bf16 v[180:183], a[104:107], v[68:71], v[180:183]
ds_read_b64_tr_b16 a[64:65], v100 offset:0
v_cvt_pk_bf16_f32 v192, v160, v161
v_mfma_f32_16x16x32_bf16 v[180:183], a[108:111], v[72:75], v[180:183]
ds_read_b64_tr_b16 a[66:67], v100 offset:2048
v_cvt_pk_bf16_f32 v193, v162, v163
v_mfma_f32_16x16x32_bf16 v[180:183], a[112:115], v[76:79], v[180:183]
ds_read_b64_tr_b16 a[68:69], v100 offset:4096
v_cvt_pk_bf16_f32 v194, v168, v169
v_mfma_f32_16x16x32_bf16 v[180:183], a[116:119], v[80:83], v[180:183]
ds_read_b64_tr_b16 a[70:71], v100 offset:6144
v_cvt_pk_bf16_f32 v195, v170, v171
v_mfma_f32_16x16x32_bf16 v[180:183], a[120:123], v[84:87], v[180:183]
buffer_store_dwordx4 v[192:195], v19, s[60:63], s34 offen offset:0 sc1
v_mfma_f32_16x16x32_bf16 v[180:183], a[124:127], v[88:91], v[180:183]
ds_read_b64_tr_b16 a[72:73], v100 offset:8192
v_cvt_pk_bf16_f32 v200, v164, v165
v_mfma_f32_16x16x32_bf16 v[180:183], a[128:131], v[92:95], v[180:183]
ds_read_b64_tr_b16 a[74:75], v100 offset:10240
v_cvt_pk_bf16_f32 v201, v166, v167
v_mfma_f32_16x16x32_bf16 v[180:183], a[132:135], a[200:203], v[180:183]
ds_read_b64_tr_b16 a[76:77], v100 offset:12288
v_cvt_pk_bf16_f32 v202, v172, v173
s_waitcnt lgkmcnt(7)
v_mfma_f32_16x16x32_bf16 v[184:187], a[136:139], v[32:35], 0
ds_read_b64_tr_b16 a[78:79], v100 offset:14336
v_cvt_pk_bf16_f32 v203, v174, v175
v_mfma_f32_16x16x32_bf16 v[184:187], a[140:143], v[36:39], v[184:187]
buffer_store_dwordx4 v[200:203], v19, s[60:63], s34 offen offset:2048 sc1
v_mfma_f32_16x16x32_bf16 v[184:187], a[144:147], v[40:43], v[184:187]
ds_read_b64_tr_b16 a[80:81], v100 offset:16384
ds_read_b64_tr_b16 a[82:83], v100 offset:18432
v_mfma_f32_16x16x32_bf16 v[184:187], a[148:151], v[44:47], v[184:187]
ds_read_b64_tr_b16 a[84:85], v100 offset:20480
ds_read_b64_tr_b16 a[86:87], v100 offset:22528
v_mfma_f32_16x16x32_bf16 v[184:187], a[152:155], v[48:51], v[184:187]
ds_read_b64_tr_b16 a[88:89], v100 offset:24576
ds_read_b64_tr_b16 a[90:91], v100 offset:26624
v_mfma_f32_16x16x32_bf16 v[184:187], a[156:159], v[52:55], v[184:187]
ds_read_b64_tr_b16 a[92:93], v100 offset:28672
v_mfma_f32_16x16x32_bf16 v[184:187], a[160:163], v[56:59], v[184:187]
ds_read_b64_tr_b16 a[94:95], v100 offset:30720
v_mfma_f32_16x16x32_bf16 v[184:187], a[164:167], v[60:63], v[184:187]
ds_read_b64_tr_b16 a[96:97], v104 offset:8192
v_mfma_f32_16x16x32_bf16 v[184:187], a[168:171], a[196:199], v[184:187]
ds_read_b64_tr_b16 a[98:99], v104 offset:10240
v_mfma_f32_16x16x32_bf16 v[188:191], a[136:139], v[64:67], 0
ds_read_b64_tr_b16 a[100:101], v101 offset:0
v_mfma_f32_16x16x32_bf16 v[188:191], a[140:143], v[68:71], v[188:191]
ds_read_b64_tr_b16 a[102:103], v101 offset:2048
v_mfma_f32_16x16x32_bf16 v[188:191], a[144:147], v[72:75], v[188:191]
ds_read_b64_tr_b16 a[104:105], v101 offset:4096
v_mfma_f32_16x16x32_bf16 v[188:191], a[148:151], v[76:79], v[188:191]
ds_read_b64_tr_b16 a[106:107], v101 offset:6144
v_mfma_f32_16x16x32_bf16 v[188:191], a[152:155], v[80:83], v[188:191]
ds_read_b64_tr_b16 a[108:109], v101 offset:8192
v_mfma_f32_16x16x32_bf16 v[188:191], a[156:159], v[84:87], v[188:191]
ds_read_b64_tr_b16 a[110:111], v101 offset:10240
v_mfma_f32_16x16x32_bf16 v[188:191], a[160:163], v[88:91], v[188:191]
ds_read_b64_tr_b16 a[112:113], v101 offset:12288
v_mfma_f32_16x16x32_bf16 v[188:191], a[164:167], v[92:95], v[188:191]
ds_read_b64_tr_b16 a[114:115], v101 offset:14336
v_mfma_f32_16x16x32_bf16 v[188:191], a[168:171], a[200:203], v[188:191]
ds_read_b64_tr_b16 a[116:117], v101 offset:16384
s_waitcnt lgkmcnt(9)
v_mfma_f32_16x16x32_bf16 v[128:131], a[64:67], v[32:35], 0
ds_read_b64_tr_b16 a[118:119], v101 offset:18432
v_mfma_f32_16x16x32_bf16 v[128:131], a[68:71], v[36:39], v[128:131]
ds_read_b64_tr_b16 a[120:121], v101 offset:20480
v_mfma_f32_16x16x32_bf16 v[128:131], a[72:75], v[40:43], v[128:131]
ds_read_b64_tr_b16 a[122:123], v101 offset:22528
v_mfma_f32_16x16x32_bf16 v[128:131], a[76:79], v[44:47], v[128:131]
ds_read_b64_tr_b16 a[124:125], v101 offset:24576
v_mfma_f32_16x16x32_bf16 v[128:131], a[80:83], v[48:51], v[128:131]
ds_read_b64_tr_b16 a[126:127], v101 offset:26624
s_mov_b32 s34, 20480
v_mfma_f32_16x16x32_bf16 v[128:131], a[84:87], v[52:55], v[128:131]
ds_read_b64_tr_b16 a[128:129], v101 offset:28672
v_cvt_pk_bf16_f32 v196, v176, v177
v_mfma_f32_16x16x32_bf16 v[128:131], a[88:91], v[56:59], v[128:131]
ds_read_b64_tr_b16 a[130:131], v101 offset:30720
v_cvt_pk_bf16_f32 v197, v178, v179
v_mfma_f32_16x16x32_bf16 v[128:131], a[92:95], v[60:63], v[128:131]
ds_read_b64_tr_b16 a[132:133], v105 offset:8192
v_cvt_pk_bf16_f32 v198, v184, v185
v_mfma_f32_16x16x32_bf16 v[128:131], a[96:99], a[196:199], v[128:131]
ds_read_b64_tr_b16 a[134:135], v105 offset:10240
v_cvt_pk_bf16_f32 v199, v186, v187
v_mfma_f32_16x16x32_bf16 v[132:135], a[64:67], v[64:67], 0
buffer_store_dwordx4 v[196:199], v19, s[60:63], s34 offen offset:1024 sc1
v_mfma_f32_16x16x32_bf16 v[132:135], a[68:71], v[68:71], v[132:135]
ds_read_b64_tr_b16 a[136:137], v102 offset:0
v_cvt_pk_bf16_f32 v204, v180, v181
v_mfma_f32_16x16x32_bf16 v[132:135], a[72:75], v[72:75], v[132:135]
ds_read_b64_tr_b16 a[138:139], v102 offset:2048
v_cvt_pk_bf16_f32 v205, v182, v183
v_mfma_f32_16x16x32_bf16 v[132:135], a[76:79], v[76:79], v[132:135]
ds_read_b64_tr_b16 a[140:141], v102 offset:4096
v_cvt_pk_bf16_f32 v206, v188, v189
v_mfma_f32_16x16x32_bf16 v[132:135], a[80:83], v[80:83], v[132:135]
ds_read_b64_tr_b16 a[142:143], v102 offset:6144
v_cvt_pk_bf16_f32 v207, v190, v191
v_mfma_f32_16x16x32_bf16 v[132:135], a[84:87], v[84:87], v[132:135]
buffer_store_dwordx4 v[204:207], v19, s[60:63], s34 offen offset:3072 sc1
v_mfma_f32_16x16x32_bf16 v[132:135], a[88:91], v[88:91], v[132:135]
ds_read_b64_tr_b16 a[144:145], v102 offset:8192
ds_read_b64_tr_b16 a[146:147], v102 offset:10240
v_mfma_f32_16x16x32_bf16 v[132:135], a[92:95], v[92:95], v[132:135]
ds_read_b64_tr_b16 a[148:149], v102 offset:12288
ds_read_b64_tr_b16 a[150:151], v102 offset:14336
v_mfma_f32_16x16x32_bf16 v[132:135], a[96:99], a[200:203], v[132:135]
ds_read_b64_tr_b16 a[152:153], v102 offset:16384
s_waitcnt lgkmcnt(9)
v_mfma_f32_16x16x32_bf16 v[136:139], a[100:103], v[32:35], 0
ds_read_b64_tr_b16 a[154:155], v102 offset:18432
v_mfma_f32_16x16x32_bf16 v[136:139], a[104:107], v[36:39], v[136:139]
ds_read_b64_tr_b16 a[156:157], v102 offset:20480
v_mfma_f32_16x16x32_bf16 v[136:139], a[108:111], v[40:43], v[136:139]
ds_read_b64_tr_b16 a[158:159], v102 offset:22528
v_mfma_f32_16x16x32_bf16 v[136:139], a[112:115], v[44:47], v[136:139]
ds_read_b64_tr_b16 a[160:161], v102 offset:24576
v_mfma_f32_16x16x32_bf16 v[136:139], a[116:119], v[48:51], v[136:139]
ds_read_b64_tr_b16 a[162:163], v102 offset:26624
v_mfma_f32_16x16x32_bf16 v[136:139], a[120:123], v[52:55], v[136:139]
ds_read_b64_tr_b16 a[164:165], v102 offset:28672
v_mfma_f32_16x16x32_bf16 v[136:139], a[124:127], v[56:59], v[136:139]
ds_read_b64_tr_b16 a[166:167], v102 offset:30720
v_mfma_f32_16x16x32_bf16 v[136:139], a[128:131], v[60:63], v[136:139]
ds_read_b64_tr_b16 a[168:169], v106 offset:8192
v_mfma_f32_16x16x32_bf16 v[136:139], a[132:135], a[196:199], v[136:139]
ds_read_b64_tr_b16 a[170:171], v106 offset:10240
v_mfma_f32_16x16x32_bf16 v[140:143], a[100:103], v[64:67], 0
ds_read_b64_tr_b16 a[64:65], v103 offset:0
v_mfma_f32_16x16x32_bf16 v[140:143], a[104:107], v[68:71], v[140:143]
ds_read_b64_tr_b16 a[66:67], v103 offset:2048
v_mfma_f32_16x16x32_bf16 v[140:143], a[108:111], v[72:75], v[140:143]
ds_read_b64_tr_b16 a[68:69], v103 offset:4096
v_mfma_f32_16x16x32_bf16 v[140:143], a[112:115], v[76:79], v[140:143]
ds_read_b64_tr_b16 a[70:71], v103 offset:6144
v_mfma_f32_16x16x32_bf16 v[140:143], a[116:119], v[80:83], v[140:143]
ds_read_b64_tr_b16 a[72:73], v103 offset:8192
v_mfma_f32_16x16x32_bf16 v[140:143], a[120:123], v[84:87], v[140:143]
ds_read_b64_tr_b16 a[74:75], v103 offset:10240
v_mfma_f32_16x16x32_bf16 v[140:143], a[124:127], v[88:91], v[140:143]
ds_read_b64_tr_b16 a[76:77], v103 offset:12288
v_mfma_f32_16x16x32_bf16 v[140:143], a[128:131], v[92:95], v[140:143]
ds_read_b64_tr_b16 a[78:79], v103 offset:14336
v_mfma_f32_16x16x32_bf16 v[140:143], a[132:135], a[200:203], v[140:143]
ds_read_b64_tr_b16 a[80:81], v103 offset:16384
s_waitcnt lgkmcnt(9)
v_mfma_f32_16x16x32_bf16 v[144:147], a[136:139], v[32:35], 0
ds_read_b64_tr_b16 a[82:83], v103 offset:18432
v_mfma_f32_16x16x32_bf16 v[144:147], a[140:143], v[36:39], v[144:147]
ds_read_b64_tr_b16 a[84:85], v103 offset:20480
v_mfma_f32_16x16x32_bf16 v[144:147], a[144:147], v[40:43], v[144:147]
ds_read_b64_tr_b16 a[86:87], v103 offset:22528
v_mfma_f32_16x16x32_bf16 v[144:147], a[148:151], v[44:47], v[144:147]
ds_read_b64_tr_b16 a[88:89], v103 offset:24576
v_mfma_f32_16x16x32_bf16 v[144:147], a[152:155], v[48:51], v[144:147]
ds_read_b64_tr_b16 a[90:91], v103 offset:26624
v_mfma_f32_16x16x32_bf16 v[144:147], a[156:159], v[52:55], v[144:147]
ds_read_b64_tr_b16 a[92:93], v103 offset:28672
v_mfma_f32_16x16x32_bf16 v[144:147], a[160:163], v[56:59], v[144:147]
ds_read_b64_tr_b16 a[94:95], v103 offset:30720
v_mfma_f32_16x16x32_bf16 v[144:147], a[164:167], v[60:63], v[144:147]
ds_read_b64_tr_b16 a[96:97], v107 offset:8192
v_mfma_f32_16x16x32_bf16 v[144:147], a[168:171], a[196:199], v[144:147]
ds_read_b64_tr_b16 a[98:99], v107 offset:10240
v_mfma_f32_16x16x32_bf16 v[148:151], a[136:139], v[64:67], 0
s_mov_b32 s34, 24576
v_mfma_f32_16x16x32_bf16 v[148:151], a[140:143], v[68:71], v[148:151]
v_cvt_pk_bf16_f32 v192, v128, v129
v_mfma_f32_16x16x32_bf16 v[148:151], a[144:147], v[72:75], v[148:151]
v_cvt_pk_bf16_f32 v193, v130, v131
v_mfma_f32_16x16x32_bf16 v[148:151], a[148:151], v[76:79], v[148:151]
v_cvt_pk_bf16_f32 v194, v136, v137
v_mfma_f32_16x16x32_bf16 v[148:151], a[152:155], v[80:83], v[148:151]
v_cvt_pk_bf16_f32 v195, v138, v139
v_mfma_f32_16x16x32_bf16 v[148:151], a[156:159], v[84:87], v[148:151]
buffer_store_dwordx4 v[192:195], v19, s[60:63], s34 offen offset:0 sc1
v_mfma_f32_16x16x32_bf16 v[148:151], a[160:163], v[88:91], v[148:151]
v_cvt_pk_bf16_f32 v200, v132, v133
v_mfma_f32_16x16x32_bf16 v[148:151], a[164:167], v[92:95], v[148:151]
v_cvt_pk_bf16_f32 v201, v134, v135
v_mfma_f32_16x16x32_bf16 v[148:151], a[168:171], a[200:203], v[148:151]
v_cvt_pk_bf16_f32 v202, v140, v141
s_waitcnt lgkmcnt(0)
v_mfma_f32_16x16x32_bf16 v[152:155], a[64:67], v[32:35], 0
v_cvt_pk_bf16_f32 v203, v142, v143
v_mfma_f32_16x16x32_bf16 v[152:155], a[68:71], v[36:39], v[152:155]
buffer_store_dwordx4 v[200:203], v19, s[60:63], s34 offen offset:2048 sc1
v_mfma_f32_16x16x32_bf16 v[152:155], a[72:75], v[40:43], v[152:155]
v_mfma_f32_16x16x32_bf16 v[152:155], a[76:79], v[44:47], v[152:155]
v_mfma_f32_16x16x32_bf16 v[152:155], a[80:83], v[48:51], v[152:155]
v_mfma_f32_16x16x32_bf16 v[152:155], a[84:87], v[52:55], v[152:155]
v_mfma_f32_16x16x32_bf16 v[152:155], a[88:91], v[56:59], v[152:155]
v_mfma_f32_16x16x32_bf16 v[152:155], a[92:95], v[60:63], v[152:155]
v_mfma_f32_16x16x32_bf16 v[152:155], a[96:99], a[196:199], v[152:155]
v_mfma_f32_16x16x32_bf16 v[156:159], a[64:67], v[64:67], 0
v_mfma_f32_16x16x32_bf16 v[156:159], a[68:71], v[68:71], v[156:159]
v_mfma_f32_16x16x32_bf16 v[156:159], a[72:75], v[72:75], v[156:159]
v_mfma_f32_16x16x32_bf16 v[156:159], a[76:79], v[76:79], v[156:159]
v_mfma_f32_16x16x32_bf16 v[156:159], a[80:83], v[80:83], v[156:159]
v_mfma_f32_16x16x32_bf16 v[156:159], a[84:87], v[84:87], v[156:159]
v_mfma_f32_16x16x32_bf16 v[156:159], a[88:91], v[88:91], v[156:159]
v_mfma_f32_16x16x32_bf16 v[156:159], a[92:95], v[92:95], v[156:159]
v_mov_b32 v31, 6
s_waitcnt vmcnt(2)
buffer_store_dword v31, v19, s[16:19], 0 offen sc1
v_mfma_f32_16x16x32_bf16 v[156:159], a[96:99], a[200:203], v[156:159]
s_nop 6
s_mov_b32 s34, 24576
v_cvt_pk_bf16_f32 v196, v144, v145
v_cvt_pk_bf16_f32 v197, v146, v147
v_cvt_pk_bf16_f32 v198, v152, v153
v_cvt_pk_bf16_f32 v199, v154, v155
buffer_store_dwordx4 v[196:199], v19, s[60:63], s34 offen offset:1024 sc1
v_cvt_pk_bf16_f32 v204, v148, v149
v_cvt_pk_bf16_f32 v205, v150, v151
v_cvt_pk_bf16_f32 v206, v156, v157
v_cvt_pk_bf16_f32 v207, v158, v159
buffer_store_dwordx4 v[204:207], v19, s[60:63], s34 offen offset:3072 sc1
buffer_atomic_add v11, v19, s[52:55], 0 offen sc0 sc1
s_mov_b32 s64, s6
s_mov_b32 s65, s7
s_mov_b32 s66, 1835008
v_bfe_u32 v28, v19, 4, 4
v_mul_u32_u24 v28, 896, v28
v_lshrrev_b32 v29, 8, v19
v_lshl_add_u32 v28, v29, 3, v28
s_mov_b32 s33, 0xffff0000
v_mov_b32 v31, 7
s_mov_b32 s46, 256
s_mov_b32 s47, 0x20000
s_mov_b32 s14, 1835008
s_waitcnt vmcnt(1)
buffer_store_dword v31, v19, s[16:19], 0 offen sc1
s_waitcnt vmcnt(1)
L_k2_nt:
v_readfirstlane_b32 s24, v11
s_nop 3
s_cmp_ge_u32 s24, 64
s_cbranch_scc1 L_k2_fin2
s_lshr_b32 s22, s24, 4
s_and_b32 s24, s24, 15
s_lshr_b32 s36, s24, 2
s_lshl_b32 s34, s26, 2
s_add_u32 s34, s34, s36
s_lshl_b32 s34, s34, 8
s_add_u32 s34, s34, 104894464
s_add_u32 s44, s4, s34
s_addc_u32 s45, s5, 0
buffer_load_dword v12, v19, s[44:47], 0 offen sc1
s_lshl_b32 s38, s22, 1
s_add_u32 s31, s38, 2
s_min_u32 s31, s31, 7
s_mul_i32 s34, s26, 1792
s_mul_i32 s35, s36, 28
s_add_u32 s34, s34, s35
s_lshl_b32 s35, s38, 2
s_add_u32 s34, s34, s35
s_and_b32 s35, s24, 3
s_add_u32 s34, s34, s35
s_lshl_b32 s34, s34, 10
s_add_u32 s34, s34, 117440512
s_add_u32 s12, s4, s34
s_addc_u32 s13, s5, 0
s_lshl_b32 s34, s26, 3
s_lshr_b32 s29, s24, 1
s_add_u32 s34, s34, s29
s_mul_i32 s34, s34, 14336
s_lshl_b32 s29, s38, 7
s_add_u32 s34, s34, s29
s_and_b32 s29, s24, 1
s_lshl_b32 s29, s29, 6
s_add_u32 s40, s34, s29
s_add_u32 s41, s40, 128
s_cmp_eq_u32 s22, 3
s_cselect_b32 s41, 0x40000000, s41
s_cselect_b32 s34, 0x40000000, 0
s_add_u32 s34, s34, 0x1000
v_add_u32 v30, s34, v19
v_mov_b64 v[160:161], 0
v_mov_b64 v[162:163], 0
v_mov_b64 v[164:165], 0
v_mov_b64 v[166:167], 0
v_mov_b64 v[168:169], 0
v_mov_b64 v[170:171], 0
v_mov_b64 v[172:173], 0
v_mov_b64 v[174:175], 0
s_mov_b32 s30, 0
s_mov_b32 s27, 0
L_k2_fl:
s_waitcnt vmcnt(0)
s_andn2_b32 s28, s30, s27
s_mov_b32 s27, s30
v_cmp_le_u32 vcc, s31, v12
s_nop 3
s_and_b32 s35, vcc_lo, 0xffff
s_andn2_b32 s35, s35, s30
s_cbranch_scc0 L_k2_a15
s_or_b32 s30, s30, s35
s_bitcmp1_b32 s35, 0
s_cbranch_scc0 L_k2_a0
s_mov_b32 s29, 0
buffer_load_dwordx4 v[32:35], v19, s[12:15], s29 offen sc1
buffer_load_dwordx4 v[36:39], v30, s[12:15], s29 offen sc1
L_k2_a0:
s_bitcmp1_b32 s35, 1
s_cbranch_scc0 L_k2_a1
s_mov_b32 s29, 114688
buffer_load_dwordx4 v[40:43], v19, s[12:15], s29 offen sc1
buffer_load_dwordx4 v[44:47], v30, s[12:15], s29 offen sc1
L_k2_a1:
s_bitcmp1_b32 s35, 2
s_cbranch_scc0 L_k2_a2
s_mov_b32 s29, 229376
buffer_load_dwordx4 v[48:51], v19, s[12:15], s29 offen sc1
buffer_load_dwordx4 v[52:55], v30, s[12:15], s29 offen sc1
L_k2_a2:
s_bitcmp1_b32 s35, 3
s_cbranch_scc0 L_k2_a3
s_mov_b32 s29, 344064
buffer_load_dwordx4 v[56:59], v19, s[12:15], s29 offen sc1
buffer_load_dwordx4 v[60:63], v30, s[12:15], s29 offen sc1
L_k2_a3:
s_bitcmp1_b32 s35, 4
s_cbranch_scc0 L_k2_a4
s_mov_b32 s29, 458752
buffer_load_dwordx4 v[64:67], v19, s[12:15], s29 offen sc1
buffer_load_dwordx4 v[68:71], v30, s[12:15], s29 offen sc1
L_k2_a4:
s_bitcmp1_b32 s35, 5
s_cbranch_scc0 L_k2_a5
s_mov_b32 s29, 573440
buffer_load_dwordx4 v[72:75], v19, s[12:15], s29 offen sc1
buffer_load_dwordx4 v[76:79], v30, s[12:15], s29 offen sc1
L_k2_a5:
s_bitcmp1_b32 s35, 6
s_cbranch_scc0 L_k2_a6
s_mov_b32 s29, 688128
buffer_load_dwordx4 v[80:83], v19, s[12:15], s29 offen sc1
buffer_load_dwordx4 v[84:87], v30, s[12:15], s29 offen sc1
L_k2_a6:
s_bitcmp1_b32 s35, 7
s_cbranch_scc0 L_k2_a7
s_mov_b32 s29, 802816
buffer_load_dwordx4 v[88:91], v19, s[12:15], s29 offen sc1
buffer_load_dwordx4 v[92:95], v30, s[12:15], s29 offen sc1
L_k2_a7:
s_bitcmp1_b32 s35, 8
s_cbranch_scc0 L_k2_a8
s_mov_b32 s29, 917504
buffer_load_dwordx4 v[96:99], v19, s[12:15], s29 offen sc1
buffer_load_dwordx4 v[100:103], v30, s[12:15], s29 offen sc1
L_k2_a8:
s_bitcmp1_b32 s35, 9
s_cbranch_scc0 L_k2_a9
s_mov_b32 s29, 1032192
buffer_load_dwordx4 v[104:107], v19, s[12:15], s29 offen sc1
buffer_load_dwordx4 v[108:111], v30, s[12:15], s29 offen sc1
L_k2_a9:
s_bitcmp1_b32 s35, 10
s_cbranch_scc0 L_k2_a10
s_mov_b32 s29, 1146880
buffer_load_dwordx4 v[112:115], v19, s[12:15], s29 offen sc1
buffer_load_dwordx4 v[116:119], v30, s[12:15], s29 offen sc1
L_k2_a10:
s_bitcmp1_b32 s35, 11
s_cbranch_scc0 L_k2_a11
s_mov_b32 s29, 1261568
buffer_load_dwordx4 v[120:123], v19, s[12:15], s29 offen sc1
buffer_load_dwordx4 v[124:127], v30, s[12:15], s29 offen sc1
L_k2_a11:
s_bitcmp1_b32 s35, 12
s_cbranch_scc0 L_k2_a12
s_mov_b32 s29, 1376256
buffer_load_dwordx4 v[128:131], v19, s[12:15], s29 offen sc1
buffer_load_dwordx4 v[132:135], v30, s[12:15], s29 offen sc1
L_k2_a12:
s_bitcmp1_b32 s35, 13
s_cbranch_scc0 L_k2_a13
s_mov_b32 s29, 1490944
buffer_load_dwordx4 v[136:139], v19, s[12:15], s29 offen sc1
buffer_load_dwordx4 v[140:143], v30, s[12:15], s29 offen sc1
L_k2_a13:
s_bitcmp1_b32 s35, 14
s_cbranch_scc0 L_k2_a14
s_mov_b32 s29, 1605632
buffer_load_dwordx4 v[144:147], v19, s[12:15], s29 offen sc1
buffer_load_dwordx4 v[148:151], v30, s[12:15], s29 offen sc1
L_k2_a14:
s_bitcmp1_b32 s35, 15
s_cbranch_scc0 L_k2_a15
s_mov_b32 s29, 1720320
buffer_load_dwordx4 v[152:155], v19, s[12:15], s29 offen sc1
buffer_load_dwordx4 v[156:159], v30, s[12:15], s29 offen sc1
L_k2_a15:
s_cmp_eq_u32 s27, 0xffff
s_cbranch_scc1 L_k2_c
s_cmp_eq_u32 s30, 0xffff
s_cbranch_scc1 L_k2_d
s_add_u32 s3, s3, 1
s_cmp_gt_u32 s3, 0x80000
s_cbranch_scc1 L_k1_end
buffer_load_dword v12, v19, s[44:47], 0 offen sc1
s_branch L_k2_c
L_k2_d:
v_mov_b32 v11, 1
buffer_atomic_add v11, v19, s[52:55], 0 offen sc0 sc1
L_k2_c:
s_cmp_eq_u32 s28, 0
s_cbranch_scc1 L_k2_b15
s_bitcmp1_b32 s28, 0
s_cbranch_scc0 L_k2_b0
v_lshlrev_b32 v192, 16, v32
v_and_b32 v193, s33, v32
v_lshlrev_b32 v194, 16, v33
v_and_b32 v195, s33, v33
v_lshlrev_b32 v196, 16, v34
v_and_b32 v197, s33, v34
v_lshlrev_b32 v198, 16, v35
v_and_b32 v199, s33, v35
v_lshlrev_b32 v200, 16, v36
v_and_b32 v201, s33, v36
v_lshlrev_b32 v202, 16, v37
v_and_b32 v203, s33, v37
v_lshlrev_b32 v204, 16, v38
v_and_b32 v205, s33, v38
v_lshlrev_b32 v206, 16, v39
v_and_b32 v207, s33, v39
v_pk_add_f32 v[160:161], v[160:161], v[192:193]
v_pk_add_f32 v[162:163], v[162:163], v[194:195]
v_pk_add_f32 v[164:165], v[164:165], v[196:197]
v_pk_add_f32 v[166:167], v[166:167], v[198:199]
v_pk_add_f32 v[168:169], v[168:169], v[200:201]
v_pk_add_f32 v[170:171], v[170:171], v[202:203]
v_pk_add_f32 v[172:173], v[172:173], v[204:205]
v_pk_add_f32 v[174:175], v[174:175], v[206:207]
L_k2_b0:
s_bitcmp1_b32 s28, 1
s_cbranch_scc0 L_k2_b1
v_lshlrev_b32 v192, 16, v40
v_and_b32 v193, s33, v40
v_lshlrev_b32 v194, 16, v41
v_and_b32 v195, s33, v41
v_lshlrev_b32 v196, 16, v42
v_and_b32 v197, s33, v42
v_lshlrev_b32 v198, 16, v43
v_and_b32 v199, s33, v43
v_lshlrev_b32 v200, 16, v44
v_and_b32 v201, s33, v44
v_lshlrev_b32 v202, 16, v45
v_and_b32 v203, s33, v45
v_lshlrev_b32 v204, 16, v46
v_and_b32 v205, s33, v46
v_lshlrev_b32 v206, 16, v47
v_and_b32 v207, s33, v47
v_pk_add_f32 v[160:161], v[160:161], v[192:193]
v_pk_add_f32 v[162:163], v[162:163], v[194:195]
v_pk_add_f32 v[164:165], v[164:165], v[196:197]
v_pk_add_f32 v[166:167], v[166:167], v[198:199]
v_pk_add_f32 v[168:169], v[168:169], v[200:201]
v_pk_add_f32 v[170:171], v[170:171], v[202:203]
v_pk_add_f32 v[172:173], v[172:173], v[204:205]
v_pk_add_f32 v[174:175], v[174:175], v[206:207]
L_k2_b1:
s_bitcmp1_b32 s28, 2
s_cbranch_scc0 L_k2_b2
v_lshlrev_b32 v192, 16, v48
v_and_b32 v193, s33, v48
v_lshlrev_b32 v194, 16, v49
v_and_b32 v195, s33, v49
v_lshlrev_b32 v196, 16, v50
v_and_b32 v197, s33, v50
v_lshlrev_b32 v198, 16, v51
v_and_b32 v199, s33, v51
v_lshlrev_b32 v200, 16, v52
v_and_b32 v201, s33, v52
v_lshlrev_b32 v202, 16, v53
v_and_b32 v203, s33, v53
v_lshlrev_b32 v204, 16, v54
v_and_b32 v205, s33, v54
v_lshlrev_b32 v206, 16, v55
v_and_b32 v207, s33, v55
v_pk_add_f32 v[160:161], v[160:161], v[192:193]
v_pk_add_f32 v[162:163], v[162:163], v[194:195]
v_pk_add_f32 v[164:165], v[164:165], v[196:197]
v_pk_add_f32 v[166:167], v[166:167], v[198:199]
v_pk_add_f32 v[168:169], v[168:169], v[200:201]
v_pk_add_f32 v[170:171], v[170:171], v[202:203]
v_pk_add_f32 v[172:173], v[172:173], v[204:205]
v_pk_add_f32 v[174:175], v[174:175], v[206:207]
L_k2_b2:
s_bitcmp1_b32 s28, 3
s_cbranch_scc0 L_k2_b3
v_lshlrev_b32 v192, 16, v56
v_and_b32 v193, s33, v56
v_lshlrev_b32 v194, 16, v57
v_and_b32 v195, s33, v57
v_lshlrev_b32 v196, 16, v58
v_and_b32 v197, s33, v58
v_lshlrev_b32 v198, 16, v59
v_and_b32 v199, s33, v59
v_lshlrev_b32 v200, 16, v60
v_and_b32 v201, s33, v60
v_lshlrev_b32 v202, 16, v61
v_and_b32 v203, s33, v61
v_lshlrev_b32 v204, 16, v62
v_and_b32 v205, s33, v62
v_lshlrev_b32 v206, 16, v63
v_and_b32 v207, s33, v63
v_pk_add_f32 v[160:161], v[160:161], v[192:193]
v_pk_add_f32 v[162:163], v[162:163], v[194:195]
v_pk_add_f32 v[164:165], v[164:165], v[196:197]
v_pk_add_f32 v[166:167], v[166:167], v[198:199]
v_pk_add_f32 v[168:169], v[168:169], v[200:201]
v_pk_add_f32 v[170:171], v[170:171], v[202:203]
v_pk_add_f32 v[172:173], v[172:173], v[204:205]
v_pk_add_f32 v[174:175], v[174:175], v[206:207]
L_k2_b3:
s_bitcmp1_b32 s28, 4
s_cbranch_scc0 L_k2_b4
v_lshlrev_b32 v192, 16, v64
v_and_b32 v193, s33, v64
v_lshlrev_b32 v194, 16, v65
v_and_b32 v195, s33, v65
v_lshlrev_b32 v196, 16, v66
v_and_b32 v197, s33, v66
v_lshlrev_b32 v198, 16, v67
v_and_b32 v199, s33, v67
v_lshlrev_b32 v200, 16, v68
v_and_b32 v201, s33, v68
v_lshlrev_b32 v202, 16, v69
v_and_b32 v203, s33, v69
v_lshlrev_b32 v204, 16, v70
v_and_b32 v205, s33, v70
v_lshlrev_b32 v206, 16, v71
v_and_b32 v207, s33, v71
v_pk_add_f32 v[160:161], v[160:161], v[192:193]
v_pk_add_f32 v[162:163], v[162:163], v[194:195]
v_pk_add_f32 v[164:165], v[164:165], v[196:197]
v_pk_add_f32 v[166:167], v[166:167], v[198:199]
v_pk_add_f32 v[168:169], v[168:169], v[200:201]
v_pk_add_f32 v[170:171], v[170:171], v[202:203]
v_pk_add_f32 v[172:173], v[172:173], v[204:205]
v_pk_add_f32 v[174:175], v[174:175], v[206:207]
L_k2_b4:
s_bitcmp1_b32 s28, 5
s_cbranch_scc0 L_k2_b5
v_lshlrev_b32 v192, 16, v72
v_and_b32 v193, s33, v72
v_lshlrev_b32 v194, 16, v73
v_and_b32 v195, s33, v73
v_lshlrev_b32 v196, 16, v74
v_and_b32 v197, s33, v74
v_lshlrev_b32 v198, 16, v75
v_and_b32 v199, s33, v75
v_lshlrev_b32 v200, 16, v76
v_and_b32 v201, s33, v76
v_lshlrev_b32 v202, 16, v77
v_and_b32 v203, s33, v77
v_lshlrev_b32 v204, 16, v78
v_and_b32 v205, s33, v78
v_lshlrev_b32 v206, 16, v79
v_and_b32 v207, s33, v79
v_pk_add_f32 v[160:161], v[160:161], v[192:193]
v_pk_add_f32 v[162:163], v[162:163], v[194:195]
v_pk_add_f32 v[164:165], v[164:165], v[196:197]
v_pk_add_f32 v[166:167], v[166:167], v[198:199]
v_pk_add_f32 v[168:169], v[168:169], v[200:201]
v_pk_add_f32 v[170:171], v[170:171], v[202:203]
v_pk_add_f32 v[172:173], v[172:173], v[204:205]
v_pk_add_f32 v[174:175], v[174:175], v[206:207]
L_k2_b5:
s_bitcmp1_b32 s28, 6
s_cbranch_scc0 L_k2_b6
v_lshlrev_b32 v192, 16, v80
v_and_b32 v193, s33, v80
v_lshlrev_b32 v194, 16, v81
v_and_b32 v195, s33, v81
v_lshlrev_b32 v196, 16, v82
v_and_b32 v197, s33, v82
v_lshlrev_b32 v198, 16, v83
v_and_b32 v199, s33, v83
v_lshlrev_b32 v200, 16, v84
v_and_b32 v201, s33, v84
v_lshlrev_b32 v202, 16, v85
v_and_b32 v203, s33, v85
v_lshlrev_b32 v204, 16, v86
v_and_b32 v205, s33, v86
v_lshlrev_b32 v206, 16, v87
v_and_b32 v207, s33, v87
v_pk_add_f32 v[160:161], v[160:161], v[192:193]
v_pk_add_f32 v[162:163], v[162:163], v[194:195]
v_pk_add_f32 v[164:165], v[164:165], v[196:197]
v_pk_add_f32 v[166:167], v[166:167], v[198:199]
v_pk_add_f32 v[168:169], v[168:169], v[200:201]
v_pk_add_f32 v[170:171], v[170:171], v[202:203]
v_pk_add_f32 v[172:173], v[172:173], v[204:205]
v_pk_add_f32 v[174:175], v[174:175], v[206:207]
L_k2_b6:
s_bitcmp1_b32 s28, 7
s_cbranch_scc0 L_k2_b7
v_lshlrev_b32 v192, 16, v88
v_and_b32 v193, s33, v88
v_lshlrev_b32 v194, 16, v89
v_and_b32 v195, s33, v89
v_lshlrev_b32 v196, 16, v90
v_and_b32 v197, s33, v90
v_lshlrev_b32 v198, 16, v91
v_and_b32 v199, s33, v91
v_lshlrev_b32 v200, 16, v92
v_and_b32 v201, s33, v92
v_lshlrev_b32 v202, 16, v93
v_and_b32 v203, s33, v93
v_lshlrev_b32 v204, 16, v94
v_and_b32 v205, s33, v94
v_lshlrev_b32 v206, 16, v95
v_and_b32 v207, s33, v95
v_pk_add_f32 v[160:161], v[160:161], v[192:193]
v_pk_add_f32 v[162:163], v[162:163], v[194:195]
v_pk_add_f32 v[164:165], v[164:165], v[196:197]
v_pk_add_f32 v[166:167], v[166:167], v[198:199]
v_pk_add_f32 v[168:169], v[168:169], v[200:201]
v_pk_add_f32 v[170:171], v[170:171], v[202:203]
v_pk_add_f32 v[172:173], v[172:173], v[204:205]
v_pk_add_f32 v[174:175], v[174:175], v[206:207]
L_k2_b7:
s_bitcmp1_b32 s28, 8
s_cbranch_scc0 L_k2_b8
v_lshlrev_b32 v192, 16, v96
v_and_b32 v193, s33, v96
v_lshlrev_b32 v194, 16, v97
v_and_b32 v195, s33, v97
v_lshlrev_b32 v196, 16, v98
v_and_b32 v197, s33, v98
v_lshlrev_b32 v198, 16, v99
v_and_b32 v199, s33, v99
v_lshlrev_b32 v200, 16, v100
v_and_b32 v201, s33, v100
v_lshlrev_b32 v202, 16, v101
v_and_b32 v203, s33, v101
v_lshlrev_b32 v204, 16, v102
v_and_b32 v205, s33, v102
v_lshlrev_b32 v206, 16, v103
v_and_b32 v207, s33, v103
v_pk_add_f32 v[160:161], v[160:161], v[192:193]
v_pk_add_f32 v[162:163], v[162:163], v[194:195]
v_pk_add_f32 v[164:165], v[164:165], v[196:197]
v_pk_add_f32 v[166:167], v[166:167], v[198:199]
v_pk_add_f32 v[168:169], v[168:169], v[200:201]
v_pk_add_f32 v[170:171], v[170:171], v[202:203]
v_pk_add_f32 v[172:173], v[172:173], v[204:205]
v_pk_add_f32 v[174:175], v[174:175], v[206:207]
L_k2_b8:
s_bitcmp1_b32 s28, 9
s_cbranch_scc0 L_k2_b9
v_lshlrev_b32 v192, 16, v104
v_and_b32 v193, s33, v104
v_lshlrev_b32 v194, 16, v105
v_and_b32 v195, s33, v105
v_lshlrev_b32 v196, 16, v106
v_and_b32 v197, s33, v106
v_lshlrev_b32 v198, 16, v107
v_and_b32 v199, s33, v107
v_lshlrev_b32 v200, 16, v108
v_and_b32 v201, s33, v108
v_lshlrev_b32 v202, 16, v109
v_and_b32 v203, s33, v109
v_lshlrev_b32 v204, 16, v110
v_and_b32 v205, s33, v110
v_lshlrev_b32 v206, 16, v111
v_and_b32 v207, s33, v111
v_pk_add_f32 v[160:161], v[160:161], v[192:193]
v_pk_add_f32 v[162:163], v[162:163], v[194:195]
v_pk_add_f32 v[164:165], v[164:165], v[196:197]
v_pk_add_f32 v[166:167], v[166:167], v[198:199]
v_pk_add_f32 v[168:169], v[168:169], v[200:201]
v_pk_add_f32 v[170:171], v[170:171], v[202:203]
v_pk_add_f32 v[172:173], v[172:173], v[204:205]
v_pk_add_f32 v[174:175], v[174:175], v[206:207]
L_k2_b9:
s_bitcmp1_b32 s28, 10
s_cbranch_scc0 L_k2_b10
v_lshlrev_b32 v192, 16, v112
v_and_b32 v193, s33, v112
v_lshlrev_b32 v194, 16, v113
v_and_b32 v195, s33, v113
v_lshlrev_b32 v196, 16, v114
v_and_b32 v197, s33, v114
v_lshlrev_b32 v198, 16, v115
v_and_b32 v199, s33, v115
v_lshlrev_b32 v200, 16, v116
v_and_b32 v201, s33, v116
v_lshlrev_b32 v202, 16, v117
v_and_b32 v203, s33, v117
v_lshlrev_b32 v204, 16, v118
v_and_b32 v205, s33, v118
v_lshlrev_b32 v206, 16, v119
v_and_b32 v207, s33, v119
v_pk_add_f32 v[160:161], v[160:161], v[192:193]
v_pk_add_f32 v[162:163], v[162:163], v[194:195]
v_pk_add_f32 v[164:165], v[164:165], v[196:197]
v_pk_add_f32 v[166:167], v[166:167], v[198:199]
v_pk_add_f32 v[168:169], v[168:169], v[200:201]
v_pk_add_f32 v[170:171], v[170:171], v[202:203]
v_pk_add_f32 v[172:173], v[172:173], v[204:205]
v_pk_add_f32 v[174:175], v[174:175], v[206:207]
L_k2_b10:
s_bitcmp1_b32 s28, 11
s_cbranch_scc0 L_k2_b11
v_lshlrev_b32 v192, 16, v120
v_and_b32 v193, s33, v120
v_lshlrev_b32 v194, 16, v121
v_and_b32 v195, s33, v121
v_lshlrev_b32 v196, 16, v122
v_and_b32 v197, s33, v122
v_lshlrev_b32 v198, 16, v123
v_and_b32 v199, s33, v123
v_lshlrev_b32 v200, 16, v124
v_and_b32 v201, s33, v124
v_lshlrev_b32 v202, 16, v125
v_and_b32 v203, s33, v125
v_lshlrev_b32 v204, 16, v126
v_and_b32 v205, s33, v126
v_lshlrev_b32 v206, 16, v127
v_and_b32 v207, s33, v127
v_pk_add_f32 v[160:161], v[160:161], v[192:193]
v_pk_add_f32 v[162:163], v[162:163], v[194:195]
v_pk_add_f32 v[164:165], v[164:165], v[196:197]
v_pk_add_f32 v[166:167], v[166:167], v[198:199]
v_pk_add_f32 v[168:169], v[168:169], v[200:201]
v_pk_add_f32 v[170:171], v[170:171], v[202:203]
v_pk_add_f32 v[172:173], v[172:173], v[204:205]
v_pk_add_f32 v[174:175], v[174:175], v[206:207]
L_k2_b11:
s_bitcmp1_b32 s28, 12
s_cbranch_scc0 L_k2_b12
v_lshlrev_b32 v192, 16, v128
v_and_b32 v193, s33, v128
v_lshlrev_b32 v194, 16, v129
v_and_b32 v195, s33, v129
v_lshlrev_b32 v196, 16, v130
v_and_b32 v197, s33, v130
v_lshlrev_b32 v198, 16, v131
v_and_b32 v199, s33, v131
v_lshlrev_b32 v200, 16, v132
v_and_b32 v201, s33, v132
v_lshlrev_b32 v202, 16, v133
v_and_b32 v203, s33, v133
v_lshlrev_b32 v204, 16, v134
v_and_b32 v205, s33, v134
v_lshlrev_b32 v206, 16, v135
v_and_b32 v207, s33, v135
v_pk_add_f32 v[160:161], v[160:161], v[192:193]
v_pk_add_f32 v[162:163], v[162:163], v[194:195]
v_pk_add_f32 v[164:165], v[164:165], v[196:197]
v_pk_add_f32 v[166:167], v[166:167], v[198:199]
v_pk_add_f32 v[168:169], v[168:169], v[200:201]
v_pk_add_f32 v[170:171], v[170:171], v[202:203]
v_pk_add_f32 v[172:173], v[172:173], v[204:205]
v_pk_add_f32 v[174:175], v[174:175], v[206:207]
L_k2_b12:
s_bitcmp1_b32 s28, 13
s_cbranch_scc0 L_k2_b13
v_lshlrev_b32 v192, 16, v136
v_and_b32 v193, s33, v136
v_lshlrev_b32 v194, 16, v137
v_and_b32 v195, s33, v137
v_lshlrev_b32 v196, 16, v138
v_and_b32 v197, s33, v138
v_lshlrev_b32 v198, 16, v139
v_and_b32 v199, s33, v139
v_lshlrev_b32 v200, 16, v140
v_and_b32 v201, s33, v140
v_lshlrev_b32 v202, 16, v141
v_and_b32 v203, s33, v141
v_lshlrev_b32 v204, 16, v142
v_and_b32 v205, s33, v142
v_lshlrev_b32 v206, 16, v143
v_and_b32 v207, s33, v143
v_pk_add_f32 v[160:161], v[160:161], v[192:193]
v_pk_add_f32 v[162:163], v[162:163], v[194:195]
v_pk_add_f32 v[164:165], v[164:165], v[196:197]
v_pk_add_f32 v[166:167], v[166:167], v[198:199]
v_pk_add_f32 v[168:169], v[168:169], v[200:201]
v_pk_add_f32 v[170:171], v[170:171], v[202:203]
v_pk_add_f32 v[172:173], v[172:173], v[204:205]
v_pk_add_f32 v[174:175], v[174:175], v[206:207]
L_k2_b13:
s_bitcmp1_b32 s28, 14
s_cbranch_scc0 L_k2_b14
v_lshlrev_b32 v192, 16, v144
v_and_b32 v193, s33, v144
v_lshlrev_b32 v194, 16, v145
v_and_b32 v195, s33, v145
v_lshlrev_b32 v196, 16, v146
v_and_b32 v197, s33, v146
v_lshlrev_b32 v198, 16, v147
v_and_b32 v199, s33, v147
v_lshlrev_b32 v200, 16, v148
v_and_b32 v201, s33, v148
v_lshlrev_b32 v202, 16, v149
v_and_b32 v203, s33, v149
v_lshlrev_b32 v204, 16, v150
v_and_b32 v205, s33, v150
v_lshlrev_b32 v206, 16, v151
v_and_b32 v207, s33, v151
v_pk_add_f32 v[160:161], v[160:161], v[192:193]
v_pk_add_f32 v[162:163], v[162:163], v[194:195]
v_pk_add_f32 v[164:165], v[164:165], v[196:197]
v_pk_add_f32 v[166:167], v[166:167], v[198:199]
v_pk_add_f32 v[168:169], v[168:169], v[200:201]
v_pk_add_f32 v[170:171], v[170:171], v[202:203]
v_pk_add_f32 v[172:173], v[172:173], v[204:205]
v_pk_add_f32 v[174:175], v[174:175], v[206:207]
L_k2_b14:
s_bitcmp1_b32 s28, 15
s_cbranch_scc0 L_k2_b15
v_lshlrev_b32 v192, 16, v152
v_and_b32 v193, s33, v152
v_lshlrev_b32 v194, 16, v153
v_and_b32 v195, s33, v153
v_lshlrev_b32 v196, 16, v154
v_and_b32 v197, s33, v154
v_lshlrev_b32 v198, 16, v155
v_and_b32 v199, s33, v155
v_lshlrev_b32 v200, 16, v156
v_and_b32 v201, s33, v156
v_lshlrev_b32 v202, 16, v157
v_and_b32 v203, s33, v157
v_lshlrev_b32 v204, 16, v158
v_and_b32 v205, s33, v158
v_lshlrev_b32 v206, 16, v159
v_and_b32 v207, s33, v159
v_pk_add_f32 v[160:161], v[160:161], v[192:193]
v_pk_add_f32 v[162:163], v[162:163], v[194:195]
v_pk_add_f32 v[164:165], v[164:165], v[196:197]
v_pk_add_f32 v[166:167], v[166:167], v[198:199]
v_pk_add_f32 v[168:169], v[168:169], v[200:201]
v_pk_add_f32 v[170:171], v[170:171], v[202:203]
v_pk_add_f32 v[172:173], v[172:173], v[204:205]
v_pk_add_f32 v[174:175], v[174:175], v[206:207]
L_k2_b15:
s_cmp_eq_u32 s27, 0xffff
s_cbranch_scc0 L_k2_fl
v_cvt_pk_bf16_f32 v176, v160, v161
v_cvt_pk_bf16_f32 v177, v162, v163
v_cvt_pk_bf16_f32 v178, v164, v165
v_cvt_pk_bf16_f32 v179, v166, v167
buffer_store_dwordx2 v[176:177], v28, s[64:67], s40 offen offset:0
buffer_store_dwordx2 v[178:179], v28, s[64:67], s40 offen offset:32
v_cvt_pk_bf16_f32 v180, v168, v169
v_cvt_pk_bf16_f32 v181, v170, v171
v_cvt_pk_bf16_f32 v182, v172, v173
v_cvt_pk_bf16_f32 v183, v174, v175
buffer_store_dwordx2 v[180:181], v28, s[64:67], s41 offen offset:0
buffer_store_dwordx2 v[182:183], v28, s[64:67], s41 offen offset:32
s_branch L_k2_nt
L_k2_fin2:
L_k1_end:
s_endpgm
L_swA_3:
v_mov_b32 v2, v96
v_mov_b32 v3, v97
v_mov_b32 v4, v98
v_mov_b32 v5, v99
v_mov_b32 v6, v100
v_mov_b32 v7, v101
v_mov_b32 v8, v102
v_mov_b32 v9, v103
s_mul_i32 s28, s43, 114688
s_add_u32 s12, s4, s28
s_addc_u32 s13, s5, 0
s_mov_b32 s14, 114688
s_sub_u32 s28, s72, s41
s_add_u32 s44, s48, s28
s_addc_u32 s45, s49, 0
s_sub_u32 s46, 1204224, s28
s_mov_b32 s24, 0
s_mov_b32 s56, 0
s_mov_b32 s57, 172032
s_mov_b32 s30, s58
s_add_u32 s31, s58, 16384
s_mul_i32 s28, s2, 1568
s_add_u32 s52, s50, s28
s_addc_u32 s53, s51, 0
s_mov_b32 s54, 1568
s_mov_b32 s70, 0
s_branch L_swA_3_b
L_swB_4:
s_lshl_b32 s28, s38, 9
s_add_u32 s16, s68, s28
s_addc_u32 s17, s69, 0
s_sub_u32 s18, 3670016, s28
s_mov_b32 s25, 0
s_branch L_swB_4_b
L_swA_6:
v_mov_b32 v2, v96
v_mov_b32 v3, v97
v_mov_b32 v4, v98
v_mov_b32 v5, v99
v_mov_b32 v6, v100
v_mov_b32 v7, v101
v_mov_b32 v8, v102
v_mov_b32 v9, v103
s_mul_i32 s28, s43, 114688
s_add_u32 s12, s4, s28
s_addc_u32 s13, s5, 0
s_mov_b32 s14, 114688
s_sub_u32 s28, s72, s41
s_add_u32 s44, s48, s28
s_addc_u32 s45, s49, 0
s_sub_u32 s46, 1204224, s28
s_mov_b32 s24, 0
s_mov_b32 s56, 0
s_mov_b32 s57, 172032
s_mov_b32 s30, s58
s_add_u32 s31, s58, 16384
s_mul_i32 s28, s2, 1568
s_add_u32 s52, s50, s28
s_addc_u32 s53, s51, 0
s_mov_b32 s54, 1568
s_mov_b32 s70, 0
s_branch L_swA_6_b
L_swB_7:
s_lshl_b32 s28, s38, 9
s_add_u32 s16, s68, s28
s_addc_u32 s17, s69, 0
s_sub_u32 s18, 3670016, s28
s_mov_b32 s25, 0
s_branch L_swB_7_b
L_p16_8:
v_cmp_le_u32 vcc, 16, v12
s_nop 3
s_and_b32 s35, vcc_lo, 0xffff
s_cmp_eq_u32 s35, 0xffff
s_cbranch_scc1 L_p16_8_b
s_sleep 8
s_add_u32 s3, s3, 1
s_cmp_gt_u32 s3, 0x80000
s_cbranch_scc1 L_k1_end
buffer_load_dword v12, v19, s[92:95], 0 offen sc1
s_waitcnt vmcnt(0)
s_branch L_p16_8
L_p16_9:
v_cmp_le_u32 vcc, 1, v12
s_nop 3
s_and_b32 s35, vcc_lo, 0xffff
s_cmp_eq_u32 s35, 0xffff
s_cbranch_scc1 L_p16_9_b
s_sleep 8
s_add_u32 s3, s3, 1
s_cmp_gt_u32 s3, 0x80000
s_cbranch_scc1 L_k1_end
buffer_load_dword v12, v19, s[44:47], 0 offen sc1
s_waitcnt vmcnt(0)
s_branch L_p16_9
L_qpoll_10:
L_qpoll_10_l:
v_readfirstlane_b32 s35, v12
s_cmp_eq_u32 s35, 1
s_cbranch_scc1 L_qpoll_10_b
s_sleep 4
s_add_u32 s3, s3, 1
s_cmp_gt_u32 s3, 0x80000
s_cbranch_scc1 L_k1_end
buffer_load_dword v12, v19, s[52:55], 0 offen sc1
s_waitcnt vmcnt(0)
s_branch L_qpoll_10_l
L_flag_11:
s_mov_b32 s37, 0
s_cmp_lg_u32 s22, 0
s_cbranch_scc1 L_flag_11_b
v_mov_b32 v28, 1
buffer_store_dword v28, v19, s[76:79], 0 offen sc1
s_nop 1
s_branch L_flag_11_b
L_mask_12:
s_nop 7
v_subrev_u32 v31, 0, v18
v_add_u32 v30, 16, v31
v_cmp_gt_i32 s[40:41], 0, v31
v_cmp_gt_i32 s[42:43], 1, v31
v_cmp_gt_i32 s[44:45], 2, v31
v_cmp_gt_i32 s[46:47], 3, v31
v_cndmask_b32 v32, v32, v1, s[40:41]
v_cndmask_b32 v33, v33, v1, s[42:43]
v_cndmask_b32 v34, v34, v1, s[44:45]
v_cndmask_b32 v35, v35, v1, s[46:47]
v_cmp_gt_i32 s[40:41], 0, v30
v_cmp_gt_i32 s[42:43], 1, v30
v_cmp_gt_i32 s[44:45], 2, v30
v_cmp_gt_i32 s[46:47], 3, v30
v_cndmask_b32 v36, v36, v1, s[40:41]
v_cndmask_b32 v37, v37, v1, s[42:43]
v_cndmask_b32 v38, v38, v1, s[44:45]
v_cndmask_b32 v39, v39, v1, s[46:47]
v_cmp_gt_i32 s[40:41], 16, v31
v_cmp_gt_i32 s[42:43], 17, v31
v_cmp_gt_i32 s[44:45], 18, v31
v_cmp_gt_i32 s[46:47], 19, v31
v_cndmask_b32 v40, v40, v1, s[40:41]
v_cndmask_b32 v41, v41, v1, s[42:43]
v_cndmask_b32 v42, v42, v1, s[44:45]
v_cndmask_b32 v43, v43, v1, s[46:47]
v_cmp_gt_i32 s[40:41], 16, v30
v_cmp_gt_i32 s[42:43], 17, v30
v_cmp_gt_i32 s[44:45], 18, v30
v_cmp_gt_i32 s[46:47], 19, v30
v_cndmask_b32 v44, v44, v1, s[40:41]
v_cndmask_b32 v45, v45, v1, s[42:43]
v_cndmask_b32 v46, v46, v1, s[44:45]
v_cndmask_b32 v47, v47, v1, s[46:47]
v_cmp_gt_i32 s[40:41], 32, v31
v_cmp_gt_i32 s[42:43], 33, v31
v_cmp_gt_i32 s[44:45], 34, v31
v_cmp_gt_i32 s[46:47], 35, v31
v_cndmask_b32 v48, v48, v1, s[40:41]
v_cndmask_b32 v49, v49, v1, s[42:43]
v_cndmask_b32 v50, v50, v1, s[44:45]
v_cndmask_b32 v51, v51, v1, s[46:47]
v_cmp_gt_i32 s[40:41], 32, v30
v_cmp_gt_i32 s[42:43], 33, v30
v_cmp_gt_i32 s[44:45], 34, v30
v_cmp_gt_i32 s[46:47], 35, v30
v_cndmask_b32 v52, v52, v1, s[40:41]
v_cndmask_b32 v53, v53, v1, s[42:43]
v_cndmask_b32 v54, v54, v1, s[44:45]
v_cndmask_b32 v55, v55, v1, s[46:47]
v_cmp_gt_i32 s[40:41], 48, v31
v_cmp_gt_i32 s[42:43], 49, v31
v_cmp_gt_i32 s[44:45], 50, v31
v_cmp_gt_i32 s[46:47], 51, v31
v_cndmask_b32 v56, v56, v1, s[40:41]
v_cndmask_b32 v57, v57, v1, s[42:43]
v_cndmask_b32 v58, v58, v1, s[44:45]
v_cndmask_b32 v59, v59, v1, s[46:47]
v_cmp_gt_i32 s[40:41], 48, v30
v_cmp_gt_i32 s[42:43], 49, v30
v_cmp_gt_i32 s[44:45], 50, v30
v_cmp_gt_i32 s[46:47], 51, v30
v_cndmask_b32 v60, v60, v1, s[40:41]
v_cndmask_b32 v61, v61, v1, s[42:43]
v_cndmask_b32 v62, v62, v1, s[44:45]
v_cndmask_b32 v63, v63, v1, s[46:47]
v_max3_f32 v28, v32, v33, v34
v_max3_f32 v28, v28, v35, v40
v_max3_f32 v28, v28, v41, v42
v_max3_f32 v28, v28, v43, v48
v_max3_f32 v28, v28, v49, v50
v_max3_f32 v28, v28, v51, v56
v_max3_f32 v28, v28, v57, v58
v_max_f32 v28, v28, v59
v_mov_b32 v30, v28
s_nop 1
v_permlane32_swap_b32 v30, v28
v_max_f32 v28, v28, v30
v_mov_b32 v30, v28
s_nop 1
v_permlane16_swap_b32 v30, v28
v_max_f32 v28, v28, v30
v_sub_f32 v32, v32, v28
v_sub_f32 v33, v33, v28
v_sub_f32 v34, v34, v28
v_sub_f32 v35, v35, v28
v_sub_f32 v40, v40, v28
v_sub_f32 v41, v41, v28
v_sub_f32 v42, v42, v28
v_sub_f32 v43, v43, v28
v_sub_f32 v48, v48, v28
v_sub_f32 v49, v49, v28
v_sub_f32 v50, v50, v28
v_sub_f32 v51, v51, v28
v_sub_f32 v56, v56, v28
v_sub_f32 v57, v57, v28
v_sub_f32 v58, v58, v28
v_sub_f32 v59, v59, v28
v_sub_f32 v20, v20, v28
v_sub_f32 v21, v21, v28
v_sub_f32 v22, v22, v28
v_sub_f32 v23, v23, v28
v_max3_f32 v29, v36, v37, v38
v_max3_f32 v29, v29, v39, v44
v_max3_f32 v29, v29, v45, v46
v_max3_f32 v29, v29, v47, v52
v_max3_f32 v29, v29, v53, v54
v_max3_f32 v29, v29, v55, v60
v_max3_f32 v29, v29, v61, v62
v_max_f32 v29, v29, v63
v_mov_b32 v30, v29
s_nop 1
v_permlane32_swap_b32 v30, v29
v_max_f32 v29, v29, v30
v_mov_b32 v30, v29
s_nop 1
v_permlane16_swap_b32 v30, v29
v_max_f32 v29, v29, v30
v_sub_f32 v36, v36, v29
v_sub_f32 v37, v37, v29
v_sub_f32 v38, v38, v29
v_sub_f32 v39, v39, v29
v_sub_f32 v44, v44, v29
v_sub_f32 v45, v45, v29
v_sub_f32 v46, v46, v29
v_sub_f32 v47, v47, v29
v_sub_f32 v52, v52, v29
v_sub_f32 v53, v53, v29
v_sub_f32 v54, v54, v29
v_sub_f32 v55, v55, v29
v_sub_f32 v60, v60, v29
v_sub_f32 v61, v61, v29
v_sub_f32 v62, v62, v29
v_sub_f32 v63, v63, v29
v_sub_f32 v24, v24, v29
v_sub_f32 v25, v25, v29
v_sub_f32 v26, v26, v29
v_sub_f32 v27, v27, v29
v_exp_f32 v2, v32
v_exp_f32 v3, v33
v_exp_f32 v4, v34
v_add_f32 v16, v2, v3
v_cvt_pk_bf16_f32 v96, v2, v3
v_exp_f32 v5, v35
v_exp_f32 v6, v36
v_add_f32 v16, v16, v4
v_add_f32 v16, v16, v5
v_exp_f32 v7, v37
v_cvt_pk_bf16_f32 v97, v4, v5
v_exp_f32 v8, v38
v_add_f32 v17, v6, v7
v_cvt_pk_bf16_f32 v100, v6, v7
v_exp_f32 v9, v39
v_exp_f32 v2, v40
v_add_f32 v17, v17, v8
v_add_f32 v17, v17, v9
v_exp_f32 v3, v41
v_cvt_pk_bf16_f32 v101, v8, v9
v_exp_f32 v4, v42
v_add_f32 v16, v16, v2
v_add_f32 v16, v16, v3
v_exp_f32 v5, v43
v_cvt_pk_bf16_f32 v98, v2, v3
v_exp_f32 v6, v44
v_add_f32 v16, v16, v4
v_add_f32 v16, v16, v5
v_exp_f32 v7, v45
v_cvt_pk_bf16_f32 v99, v4, v5
v_exp_f32 v8, v46
v_add_f32 v17, v17, v6
v_add_f32 v17, v17, v7
v_exp_f32 v9, v47
v_cvt_pk_bf16_f32 v102, v6, v7
s_nop 0
v_add_f32 v17, v17, v8
v_add_f32 v17, v17, v9
v_cvt_pk_bf16_f32 v103, v8, v9
s_nop 1
s_branch L_mask_12_b
L_resc_13:
s_nop 7
v_max3_f32 v28, v32, v33, v34
v_max3_f32 v28, v28, v35, v40
v_max3_f32 v28, v28, v41, v42
v_max3_f32 v28, v28, v43, v48
v_max3_f32 v28, v28, v49, v50
v_max3_f32 v28, v28, v51, v56
v_max3_f32 v28, v28, v57, v58
v_max_f32 v28, v28, v59
v_mov_b32 v30, v28
s_nop 1
v_permlane32_swap_b32 v30, v28
v_max_f32 v28, v28, v30
v_mov_b32 v30, v28
s_nop 1
v_permlane16_swap_b32 v30, v28
v_max_f32 v28, v28, v30
v_max_f32 v28, 0, v28
v_sub_f32 v32, v32, v28
v_sub_f32 v33, v33, v28
v_sub_f32 v34, v34, v28
v_sub_f32 v35, v35, v28
v_sub_f32 v40, v40, v28
v_sub_f32 v41, v41, v28
v_sub_f32 v42, v42, v28
v_sub_f32 v43, v43, v28
v_sub_f32 v48, v48, v28
v_sub_f32 v49, v49, v28
v_sub_f32 v50, v50, v28
v_sub_f32 v51, v51, v28
v_sub_f32 v56, v56, v28
v_sub_f32 v57, v57, v28
v_sub_f32 v58, v58, v28
v_sub_f32 v59, v59, v28
v_sub_f32 v64, v64, v28
v_sub_f32 v65, v65, v28
v_sub_f32 v66, v66, v28
v_sub_f32 v67, v67, v28
v_sub_f32 v72, v72, v28
v_sub_f32 v73, v73, v28
v_sub_f32 v74, v74, v28
v_sub_f32 v75, v75, v28
v_sub_f32 v80, v80, v28
v_sub_f32 v81, v81, v28
v_sub_f32 v82, v82, v28
v_sub_f32 v83, v83, v28
v_sub_f32 v88, v88, v28
v_sub_f32 v89, v89, v28
v_sub_f32 v90, v90, v28
v_sub_f32 v91, v91, v28
v_sub_f32 v20, v20, v28
v_sub_f32 v21, v21, v28
v_sub_f32 v22, v22, v28
v_sub_f32 v23, v23, v28
v_max3_f32 v29, v36, v37, v38
v_max3_f32 v29, v29, v39, v44
v_max3_f32 v29, v29, v45, v46
v_max3_f32 v29, v29, v47, v52
v_max3_f32 v29, v29, v53, v54
v_max3_f32 v29, v29, v55, v60
v_max3_f32 v29, v29, v61, v62
v_max_f32 v29, v29, v63
v_mov_b32 v30, v29
s_nop 1
v_permlane32_swap_b32 v30, v29
v_max_f32 v29, v29, v30
v_mov_b32 v30, v29
s_nop 1
v_permlane16_swap_b32 v30, v29
v_max_f32 v29, v29, v30
v_max_f32 v29, 0, v29
v_sub_f32 v36, v36, v29
v_sub_f32 v37, v37, v29
v_sub_f32 v38, v38, v29
v_sub_f32 v39, v39, v29
v_sub_f32 v44, v44, v29
v_sub_f32 v45, v45, v29
v_sub_f32 v46, v46, v29
v_sub_f32 v47, v47, v29
v_sub_f32 v52, v52, v29
v_sub_f32 v53, v53, v29
v_sub_f32 v54, v54, v29
v_sub_f32 v55, v55, v29
v_sub_f32 v60, v60, v29
v_sub_f32 v61, v61, v29
v_sub_f32 v62, v62, v29
v_sub_f32 v63, v63, v29
v_sub_f32 v68, v68, v29
v_sub_f32 v69, v69, v29
v_sub_f32 v70, v70, v29
v_sub_f32 v71, v71, v29
v_sub_f32 v76, v76, v29
v_sub_f32 v77, v77, v29
v_sub_f32 v78, v78, v29
v_sub_f32 v79, v79, v29
v_sub_f32 v84, v84, v29
v_sub_f32 v85, v85, v29
v_sub_f32 v86, v86, v29
v_sub_f32 v87, v87, v29
v_sub_f32 v92, v92, v29
v_sub_f32 v93, v93, v29
v_sub_f32 v94, v94, v29
v_sub_f32 v95, v95, v29
v_sub_f32 v24, v24, v29
v_sub_f32 v25, v25, v29
v_sub_f32 v26, v26, v29
v_sub_f32 v27, v27, v29
v_sub_f32 v28, 0, v28
v_exp_f32 v28, v28
v_sub_f32 v29, 0, v29
v_exp_f32 v29, v29
s_nop 0
v_mul_f32 v14, v14, v28
v_mul_f32 v15, v15, v29
v_mul_f32 v128, v128, v28
v_mul_f32 v129, v129, v28
v_mul_f32 v130, v130, v28
v_mul_f32 v131, v131, v28
v_mul_f32 v132, v132, v29
v_mul_f32 v133, v133, v29
v_mul_f32 v134, v134, v29
v_mul_f32 v135, v135, v29
v_mul_f32 v136, v136, v28
v_mul_f32 v137, v137, v28
v_mul_f32 v138, v138, v28
v_mul_f32 v139, v139, v28
v_mul_f32 v140, v140, v29
v_mul_f32 v141, v141, v29
v_mul_f32 v142, v142, v29
v_mul_f32 v143, v143, v29
v_mul_f32 v144, v144, v28
v_mul_f32 v145, v145, v28
v_mul_f32 v146, v146, v28
v_mul_f32 v147, v147, v28
v_mul_f32 v148, v148, v29
v_mul_f32 v149, v149, v29
v_mul_f32 v150, v150, v29
v_mul_f32 v151, v151, v29
v_mul_f32 v152, v152, v28
v_mul_f32 v153, v153, v28
v_mul_f32 v154, v154, v28
v_mul_f32 v155, v155, v28
v_mul_f32 v156, v156, v29
v_mul_f32 v157, v157, v29
v_mul_f32 v158, v158, v29
v_mul_f32 v159, v159, v29
v_mul_f32 v160, v160, v28
v_mul_f32 v161, v161, v28
v_mul_f32 v162, v162, v28
v_mul_f32 v163, v163, v28
v_mul_f32 v164, v164, v29
v_mul_f32 v165, v165, v29
v_mul_f32 v166, v166, v29
v_mul_f32 v167, v167, v29
v_mul_f32 v168, v168, v28
v_mul_f32 v169, v169, v28
v_mul_f32 v170, v170, v28
v_mul_f32 v171, v171, v28
v_mul_f32 v172, v172, v29
v_mul_f32 v173, v173, v29
v_mul_f32 v174, v174, v29
v_mul_f32 v175, v175, v29
v_mul_f32 v176, v176, v28
v_mul_f32 v177, v177, v28
v_mul_f32 v178, v178, v28
v_mul_f32 v179, v179, v28
v_mul_f32 v180, v180, v29
v_mul_f32 v181, v181, v29
v_mul_f32 v182, v182, v29
v_mul_f32 v183, v183, v29
v_mul_f32 v184, v184, v28
v_mul_f32 v185, v185, v28
v_mul_f32 v186, v186, v28
v_mul_f32 v187, v187, v28
v_mul_f32 v188, v188, v29
v_mul_f32 v189, v189, v29
v_mul_f32 v190, v190, v29
v_mul_f32 v191, v191, v29
v_mul_f32 v192, v192, v28
v_mul_f32 v193, v193, v28
v_mul_f32 v194, v194, v28
v_mul_f32 v195, v195, v28
v_mul_f32 v196, v196, v29
v_mul_f32 v197, v197, v29
v_mul_f32 v198, v198, v29
v_mul_f32 v199, v199, v29
v_mul_f32 v200, v200, v28
v_mul_f32 v201, v201, v28
v_mul_f32 v202, v202, v28
v_mul_f32 v203, v203, v28
v_mul_f32 v204, v204, v29
v_mul_f32 v205, v205, v29
v_mul_f32 v206, v206, v29
v_mul_f32 v207, v207, v29
v_mul_f32 v208, v208, v28
v_mul_f32 v209, v209, v28
v_mul_f32 v210, v210, v28
v_mul_f32 v211, v211, v28
v_mul_f32 v212, v212, v29
v_mul_f32 v213, v213, v29
v_mul_f32 v214, v214, v29
v_mul_f32 v215, v215, v29
v_mul_f32 v216, v216, v28
v_mul_f32 v217, v217, v28
v_mul_f32 v218, v218, v28
v_mul_f32 v219, v219, v28
v_mul_f32 v220, v220, v29
v_mul_f32 v221, v221, v29
v_mul_f32 v222, v222, v29
v_mul_f32 v223, v223, v29
v_mul_f32 v224, v224, v28
v_mul_f32 v225, v225, v28
v_mul_f32 v226, v226, v28
v_mul_f32 v227, v227, v28
v_mul_f32 v228, v228, v29
v_mul_f32 v229, v229, v29
v_mul_f32 v230, v230, v29
v_mul_f32 v231, v231, v29
v_mul_f32 v232, v232, v28
v_mul_f32 v233, v233, v28
v_mul_f32 v234, v234, v28
v_mul_f32 v235, v235, v28
v_mul_f32 v236, v236, v29
v_mul_f32 v237, v237, v29
v_mul_f32 v238, v238, v29
v_mul_f32 v239, v239, v29
v_mul_f32 v240, v240, v28
v_mul_f32 v241, v241, v28
v_mul_f32 v242, v242, v28
v_mul_f32 v243, v243, v28
v_mul_f32 v244, v244, v29
v_mul_f32 v245, v245, v29
v_mul_f32 v246, v246, v29
v_mul_f32 v247, v247, v29
v_mul_f32 v248, v248, v28
v_mul_f32 v249, v249, v28
v_mul_f32 v250, v250, v28
v_mul_f32 v251, v251, v28
v_mul_f32 v252, v252, v29
v_mul_f32 v253, v253, v29
v_mul_f32 v254, v254, v29
v_mul_f32 v255, v255, v29
v_exp_f32 v2, v32
v_exp_f32 v3, v33
v_exp_f32 v4, v34
v_add_f32 v16, v2, v3
v_cvt_pk_bf16_f32 v96, v2, v3
v_exp_f32 v5, v35
v_exp_f32 v6, v36
v_add_f32 v16, v16, v4
v_add_f32 v16, v16, v5
v_exp_f32 v7, v37
v_cvt_pk_bf16_f32 v97, v4, v5
v_exp_f32 v8, v38
v_add_f32 v17, v6, v7
v_cvt_pk_bf16_f32 v100, v6, v7
v_exp_f32 v9, v39
v_exp_f32 v2, v40
v_add_f32 v17, v17, v8
v_add_f32 v17, v17, v9
v_exp_f32 v3, v41
v_cvt_pk_bf16_f32 v101, v8, v9
v_exp_f32 v4, v42
v_add_f32 v16, v16, v2
v_add_f32 v16, v16, v3
v_exp_f32 v5, v43
v_cvt_pk_bf16_f32 v98, v2, v3
v_exp_f32 v6, v44
v_add_f32 v16, v16, v4
v_add_f32 v16, v16, v5
v_exp_f32 v7, v45
v_cvt_pk_bf16_f32 v99, v4, v5
v_exp_f32 v8, v46
v_add_f32 v17, v17, v6
v_add_f32 v17, v17, v7
v_exp_f32 v9, v47
v_cvt_pk_bf16_f32 v102, v6, v7
v_exp_f32 v2, v48
v_add_f32 v17, v17, v8
v_add_f32 v17, v17, v9
v_exp_f32 v3, v49
v_cvt_pk_bf16_f32 v103, v8, v9
v_exp_f32 v4, v50
v_add_f32 v16, v16, v2
v_add_f32 v16, v16, v3
v_exp_f32 v5, v51
v_cvt_pk_bf16_f32 v104, v2, v3
v_exp_f32 v6, v52
v_add_f32 v16, v16, v4
v_add_f32 v16, v16, v5
v_exp_f32 v7, v53
v_cvt_pk_bf16_f32 v105, v4, v5
v_exp_f32 v8, v54
v_add_f32 v17, v17, v6
v_add_f32 v17, v17, v7
v_exp_f32 v9, v55
v_cvt_pk_bf16_f32 v108, v6, v7
v_exp_f32 v2, v56
v_add_f32 v17, v17, v8
v_add_f32 v17, v17, v9
v_exp_f32 v3, v57
v_cvt_pk_bf16_f32 v109, v8, v9
v_exp_f32 v4, v58
v_add_f32 v16, v16, v2
v_add_f32 v16, v16, v3
v_exp_f32 v5, v59
v_cvt_pk_bf16_f32 v106, v2, v3
v_exp_f32 v6, v60
v_add_f32 v16, v16, v4
v_add_f32 v16, v16, v5
v_exp_f32 v7, v61
v_cvt_pk_bf16_f32 v107, v4, v5
v_exp_f32 v8, v62
v_add_f32 v17, v17, v6
v_add_f32 v17, v17, v7
v_exp_f32 v9, v63
v_cvt_pk_bf16_f32 v110, v6, v7
s_nop 0
v_add_f32 v17, v17, v8
v_add_f32 v17, v17, v9
v_cvt_pk_bf16_f32 v111, v8, v9
s_nop 1
s_branch L_resc_13_b
L_resc_14:
s_nop 7
v_max3_f32 v28, v64, v65, v66
v_max3_f32 v28, v28, v67, v72
v_max3_f32 v28, v28, v73, v74
v_max3_f32 v28, v28, v75, v80
v_max3_f32 v28, v28, v81, v82
v_max3_f32 v28, v28, v83, v88
v_max3_f32 v28, v28, v89, v90
v_max_f32 v28, v28, v91
v_mov_b32 v30, v28
s_nop 1
v_permlane32_swap_b32 v30, v28
v_max_f32 v28, v28, v30
v_mov_b32 v30, v28
s_nop 1
v_permlane16_swap_b32 v30, v28
v_max_f32 v28, v28, v30
v_max_f32 v28, 0, v28
v_sub_f32 v64, v64, v28
v_sub_f32 v65, v65, v28
v_sub_f32 v66, v66, v28
v_sub_f32 v67, v67, v28
v_sub_f32 v72, v72, v28
v_sub_f32 v73, v73, v28
v_sub_f32 v74, v74, v28
v_sub_f32 v75, v75, v28
v_sub_f32 v80, v80, v28
v_sub_f32 v81, v81, v28
v_sub_f32 v82, v82, v28
v_sub_f32 v83, v83, v28
v_sub_f32 v88, v88, v28
v_sub_f32 v89, v89, v28
v_sub_f32 v90, v90, v28
v_sub_f32 v91, v91, v28
v_sub_f32 v32, v32, v28
v_sub_f32 v33, v33, v28
v_sub_f32 v34, v34, v28
v_sub_f32 v35, v35, v28
v_sub_f32 v40, v40, v28
v_sub_f32 v41, v41, v28
v_sub_f32 v42, v42, v28
v_sub_f32 v43, v43, v28
v_sub_f32 v48, v48, v28
v_sub_f32 v49, v49, v28
v_sub_f32 v50, v50, v28
v_sub_f32 v51, v51, v28
v_sub_f32 v56, v56, v28
v_sub_f32 v57, v57, v28
v_sub_f32 v58, v58, v28
v_sub_f32 v59, v59, v28
v_sub_f32 v20, v20, v28
v_sub_f32 v21, v21, v28
v_sub_f32 v22, v22, v28
v_sub_f32 v23, v23, v28
v_max3_f32 v29, v68, v69, v70
v_max3_f32 v29, v29, v71, v76
v_max3_f32 v29, v29, v77, v78
v_max3_f32 v29, v29, v79, v84
v_max3_f32 v29, v29, v85, v86
v_max3_f32 v29, v29, v87, v92
v_max3_f32 v29, v29, v93, v94
v_max_f32 v29, v29, v95
v_mov_b32 v30, v29
s_nop 1
v_permlane32_swap_b32 v30, v29
v_max_f32 v29, v29, v30
v_mov_b32 v30, v29
s_nop 1
v_permlane16_swap_b32 v30, v29
v_max_f32 v29, v29, v30
v_max_f32 v29, 0, v29
v_sub_f32 v68, v68, v29
v_sub_f32 v69, v69, v29
v_sub_f32 v70, v70, v29
v_sub_f32 v71, v71, v29
v_sub_f32 v76, v76, v29
v_sub_f32 v77, v77, v29
v_sub_f32 v78, v78, v29
v_sub_f32 v79, v79, v29
v_sub_f32 v84, v84, v29
v_sub_f32 v85, v85, v29
v_sub_f32 v86, v86, v29
v_sub_f32 v87, v87, v29
v_sub_f32 v92, v92, v29
v_sub_f32 v93, v93, v29
v_sub_f32 v94, v94, v29
v_sub_f32 v95, v95, v29
v_sub_f32 v36, v36, v29
v_sub_f32 v37, v37, v29
v_sub_f32 v38, v38, v29
v_sub_f32 v39, v39, v29
v_sub_f32 v44, v44, v29
v_sub_f32 v45, v45, v29
v_sub_f32 v46, v46, v29
v_sub_f32 v47, v47, v29
v_sub_f32 v52, v52, v29
v_sub_f32 v53, v53, v29
v_sub_f32 v54, v54, v29
v_sub_f32 v55, v55, v29
v_sub_f32 v60, v60, v29
v_sub_f32 v61, v61, v29
v_sub_f32 v62, v62, v29
v_sub_f32 v63, v63, v29
v_sub_f32 v24, v24, v29
v_sub_f32 v25, v25, v29
v_sub_f32 v26, v26, v29
v_sub_f32 v27, v27, v29
v_sub_f32 v28, 0, v28
v_exp_f32 v28, v28
v_sub_f32 v29, 0, v29
v_exp_f32 v29, v29
s_nop 0
v_mul_f32 v14, v14, v28
v_mul_f32 v15, v15, v29
v_mul_f32 v128, v128, v28
v_mul_f32 v129, v129, v28
v_mul_f32 v130, v130, v28
v_mul_f32 v131, v131, v28
v_mul_f32 v132, v132, v29
v_mul_f32 v133, v133, v29
v_mul_f32 v134, v134, v29
v_mul_f32 v135, v135, v29
v_mul_f32 v136, v136, v28
v_mul_f32 v137, v137, v28
v_mul_f32 v138, v138, v28
v_mul_f32 v139, v139, v28
v_mul_f32 v140, v140, v29
v_mul_f32 v141, v141, v29
v_mul_f32 v142, v142, v29
v_mul_f32 v143, v143, v29
v_mul_f32 v144, v144, v28
v_mul_f32 v145, v145, v28
v_mul_f32 v146, v146, v28
v_mul_f32 v147, v147, v28
v_mul_f32 v148, v148, v29
v_mul_f32 v149, v149, v29
v_mul_f32 v150, v150, v29
v_mul_f32 v151, v151, v29
v_mul_f32 v152, v152, v28
v_mul_f32 v153, v153, v28
v_mul_f32 v154, v154, v28
v_mul_f32 v155, v155, v28
v_mul_f32 v156, v156, v29
v_mul_f32 v157, v157, v29
v_mul_f32 v158, v158, v29
v_mul_f32 v159, v159, v29
v_mul_f32 v160, v160, v28
v_mul_f32 v161, v161, v28
v_mul_f32 v162, v162, v28
v_mul_f32 v163, v163, v28
v_mul_f32 v164, v164, v29
v_mul_f32 v165, v165, v29
v_mul_f32 v166, v166, v29
v_mul_f32 v167, v167, v29
v_mul_f32 v168, v168, v28
v_mul_f32 v169, v169, v28
v_mul_f32 v170, v170, v28
v_mul_f32 v171, v171, v28
v_mul_f32 v172, v172, v29
v_mul_f32 v173, v173, v29
v_mul_f32 v174, v174, v29
v_mul_f32 v175, v175, v29
v_mul_f32 v176, v176, v28
v_mul_f32 v177, v177, v28
v_mul_f32 v178, v178, v28
v_mul_f32 v179, v179, v28
v_mul_f32 v180, v180, v29
v_mul_f32 v181, v181, v29
v_mul_f32 v182, v182, v29
v_mul_f32 v183, v183, v29
v_mul_f32 v184, v184, v28
v_mul_f32 v185, v185, v28
v_mul_f32 v186, v186, v28
v_mul_f32 v187, v187, v28
v_mul_f32 v188, v188, v29
v_mul_f32 v189, v189, v29
v_mul_f32 v190, v190, v29
v_mul_f32 v191, v191, v29
v_mul_f32 v192, v192, v28
v_mul_f32 v193, v193, v28
v_mul_f32 v194, v194, v28
v_mul_f32 v195, v195, v28
v_mul_f32 v196, v196, v29
v_mul_f32 v197, v197, v29
v_mul_f32 v198, v198, v29
v_mul_f32 v199, v199, v29
v_mul_f32 v200, v200, v28
v_mul_f32 v201, v201, v28
v_mul_f32 v202, v202, v28
v_mul_f32 v203, v203, v28
v_mul_f32 v204, v204, v29
v_mul_f32 v205, v205, v29
v_mul_f32 v206, v206, v29
v_mul_f32 v207, v207, v29
v_mul_f32 v208, v208, v28
v_mul_f32 v209, v209, v28
v_mul_f32 v210, v210, v28
v_mul_f32 v211, v211, v28
v_mul_f32 v212, v212, v29
v_mul_f32 v213, v213, v29
v_mul_f32 v214, v214, v29
v_mul_f32 v215, v215, v29
v_mul_f32 v216, v216, v28
v_mul_f32 v217, v217, v28
v_mul_f32 v218, v218, v28
v_mul_f32 v219, v219, v28
v_mul_f32 v220, v220, v29
v_mul_f32 v221, v221, v29
v_mul_f32 v222, v222, v29
v_mul_f32 v223, v223, v29
v_mul_f32 v224, v224, v28
v_mul_f32 v225, v225, v28
v_mul_f32 v226, v226, v28
v_mul_f32 v227, v227, v28
v_mul_f32 v228, v228, v29
v_mul_f32 v229, v229, v29
v_mul_f32 v230, v230, v29
v_mul_f32 v231, v231, v29
v_mul_f32 v232, v232, v28
v_mul_f32 v233, v233, v28
v_mul_f32 v234, v234, v28
v_mul_f32 v235, v235, v28
v_mul_f32 v236, v236, v29
v_mul_f32 v237, v237, v29
v_mul_f32 v238, v238, v29
v_mul_f32 v239, v239, v29
v_mul_f32 v240, v240, v28
v_mul_f32 v241, v241, v28
v_mul_f32 v242, v242, v28
v_mul_f32 v243, v243, v28
v_mul_f32 v244, v244, v29
v_mul_f32 v245, v245, v29
v_mul_f32 v246, v246, v29
v_mul_f32 v247, v247, v29
v_mul_f32 v248, v248, v28
v_mul_f32 v249, v249, v28
v_mul_f32 v250, v250, v28
v_mul_f32 v251, v251, v28
v_mul_f32 v252, v252, v29
v_mul_f32 v253, v253, v29
v_mul_f32 v254, v254, v29
v_mul_f32 v255, v255, v29
v_exp_f32 v2, v64
v_exp_f32 v3, v65
v_exp_f32 v4, v66
v_add_f32 v16, v2, v3
v_cvt_pk_bf16_f32 v112, v2, v3
v_exp_f32 v5, v67
v_exp_f32 v6, v68
v_add_f32 v16, v16, v4
v_add_f32 v16, v16, v5
v_exp_f32 v7, v69
v_cvt_pk_bf16_f32 v113, v4, v5
v_exp_f32 v8, v70
v_add_f32 v17, v6, v7
v_cvt_pk_bf16_f32 v116, v6, v7
v_exp_f32 v9, v71
v_exp_f32 v2, v72
v_add_f32 v17, v17, v8
v_add_f32 v17, v17, v9
v_exp_f32 v3, v73
v_cvt_pk_bf16_f32 v117, v8, v9
v_exp_f32 v4, v74
v_add_f32 v16, v16, v2
v_add_f32 v16, v16, v3
v_exp_f32 v5, v75
v_cvt_pk_bf16_f32 v114, v2, v3
v_exp_f32 v6, v76
v_add_f32 v16, v16, v4
v_add_f32 v16, v16, v5
v_exp_f32 v7, v77
v_cvt_pk_bf16_f32 v115, v4, v5
v_exp_f32 v8, v78
v_add_f32 v17, v17, v6
v_add_f32 v17, v17, v7
v_exp_f32 v9, v79
v_cvt_pk_bf16_f32 v118, v6, v7
v_exp_f32 v2, v80
v_add_f32 v17, v17, v8
v_add_f32 v17, v17, v9
v_exp_f32 v3, v81
v_cvt_pk_bf16_f32 v119, v8, v9
v_exp_f32 v4, v82
v_add_f32 v16, v16, v2
v_add_f32 v16, v16, v3
v_exp_f32 v5, v83
v_cvt_pk_bf16_f32 v120, v2, v3
v_exp_f32 v6, v84
v_add_f32 v16, v16, v4
v_add_f32 v16, v16, v5
v_exp_f32 v7, v85
v_cvt_pk_bf16_f32 v121, v4, v5
v_exp_f32 v8, v86
v_add_f32 v17, v17, v6
v_add_f32 v17, v17, v7
v_exp_f32 v9, v87
v_cvt_pk_bf16_f32 v124, v6, v7
v_exp_f32 v2, v88
v_add_f32 v17, v17, v8
v_add_f32 v17, v17, v9
v_exp_f32 v3, v89
v_cvt_pk_bf16_f32 v125, v8, v9
v_exp_f32 v4, v90
v_add_f32 v16, v16, v2
v_add_f32 v16, v16, v3
v_exp_f32 v5, v91
v_cvt_pk_bf16_f32 v122, v2, v3
v_exp_f32 v6, v92
v_add_f32 v16, v16, v4
v_add_f32 v16, v16, v5
v_exp_f32 v7, v93
v_cvt_pk_bf16_f32 v123, v4, v5
v_exp_f32 v8, v94
v_add_f32 v17, v17, v6
v_add_f32 v17, v17, v7
v_exp_f32 v9, v95
v_cvt_pk_bf16_f32 v126, v6, v7
s_nop 0
v_add_f32 v17, v17, v8
v_add_f32 v17, v17, v9
v_cvt_pk_bf16_f32 v127, v8, v9
s_nop 1
s_branch L_resc_14_b
L_mask_15:
s_nop 7
v_subrev_u32 v31, 0, v18
v_add_u32 v30, 16, v31
v_cmp_gt_i32 s[40:41], 0, v31
v_cmp_gt_i32 s[42:43], 1, v31
v_cmp_gt_i32 s[44:45], 2, v31
v_cmp_gt_i32 s[46:47], 3, v31
v_cndmask_b32 v32, v32, v1, s[40:41]
v_cndmask_b32 v33, v33, v1, s[42:43]
v_cndmask_b32 v34, v34, v1, s[44:45]
v_cndmask_b32 v35, v35, v1, s[46:47]
v_cmp_gt_i32 s[40:41], 0, v30
v_cmp_gt_i32 s[42:43], 1, v30
v_cmp_gt_i32 s[44:45], 2, v30
v_cmp_gt_i32 s[46:47], 3, v30
v_cndmask_b32 v36, v36, v1, s[40:41]
v_cndmask_b32 v37, v37, v1, s[42:43]
v_cndmask_b32 v38, v38, v1, s[44:45]
v_cndmask_b32 v39, v39, v1, s[46:47]
v_cmp_gt_i32 s[40:41], 16, v31
v_cmp_gt_i32 s[42:43], 17, v31
v_cmp_gt_i32 s[44:45], 18, v31
v_cmp_gt_i32 s[46:47], 19, v31
v_cndmask_b32 v40, v40, v1, s[40:41]
v_cndmask_b32 v41, v41, v1, s[42:43]
v_cndmask_b32 v42, v42, v1, s[44:45]
v_cndmask_b32 v43, v43, v1, s[46:47]
v_cmp_gt_i32 s[40:41], 16, v30
v_cmp_gt_i32 s[42:43], 17, v30
v_cmp_gt_i32 s[44:45], 18, v30
v_cmp_gt_i32 s[46:47], 19, v30
v_cndmask_b32 v44, v44, v1, s[40:41]
v_cndmask_b32 v45, v45, v1, s[42:43]
v_cndmask_b32 v46, v46, v1, s[44:45]
v_cndmask_b32 v47, v47, v1, s[46:47]
v_cmp_gt_i32 s[40:41], 32, v31
v_cmp_gt_i32 s[42:43], 33, v31
v_cmp_gt_i32 s[44:45], 34, v31
v_cmp_gt_i32 s[46:47], 35, v31
v_cndmask_b32 v48, v48, v1, s[40:41]
v_cndmask_b32 v49, v49, v1, s[42:43]
v_cndmask_b32 v50, v50, v1, s[44:45]
v_cndmask_b32 v51, v51, v1, s[46:47]
v_cmp_gt_i32 s[40:41], 32, v30
v_cmp_gt_i32 s[42:43], 33, v30
v_cmp_gt_i32 s[44:45], 34, v30
v_cmp_gt_i32 s[46:47], 35, v30
v_cndmask_b32 v52, v52, v1, s[40:41]
v_cndmask_b32 v53, v53, v1, s[42:43]
v_cndmask_b32 v54, v54, v1, s[44:45]
v_cndmask_b32 v55, v55, v1, s[46:47]
v_cmp_gt_i32 s[40:41], 48, v31
v_cmp_gt_i32 s[42:43], 49, v31
v_cmp_gt_i32 s[44:45], 50, v31
v_cmp_gt_i32 s[46:47], 51, v31
v_cndmask_b32 v56, v56, v1, s[40:41]
v_cndmask_b32 v57, v57, v1, s[42:43]
v_cndmask_b32 v58, v58, v1, s[44:45]
v_cndmask_b32 v59, v59, v1, s[46:47]
v_cmp_gt_i32 s[40:41], 48, v30
v_cmp_gt_i32 s[42:43], 49, v30
v_cmp_gt_i32 s[44:45], 50, v30
v_cmp_gt_i32 s[46:47], 51, v30
v_cndmask_b32 v60, v60, v1, s[40:41]
v_cndmask_b32 v61, v61, v1, s[42:43]
v_cndmask_b32 v62, v62, v1, s[44:45]
v_cndmask_b32 v63, v63, v1, s[46:47]
s_branch L_mask_15_b
L_resc_17:
s_nop 7
v_max3_f32 v28, v32, v33, v34
v_max3_f32 v28, v28, v35, v40
v_max3_f32 v28, v28, v41, v42
v_max3_f32 v28, v28, v43, v48
v_max3_f32 v28, v28, v49, v50
v_max3_f32 v28, v28, v51, v56
v_max3_f32 v28, v28, v57, v58
v_max_f32 v28, v28, v59
v_mov_b32 v30, v28
s_nop 1
v_permlane32_swap_b32 v30, v28
v_max_f32 v28, v28, v30
v_mov_b32 v30, v28
s_nop 1
v_permlane16_swap_b32 v30, v28
v_max_f32 v28, v28, v30
v_max_f32 v28, 0, v28
v_sub_f32 v32, v32, v28
v_sub_f32 v33, v33, v28
v_sub_f32 v34, v34, v28
v_sub_f32 v35, v35, v28
v_sub_f32 v40, v40, v28
v_sub_f32 v41, v41, v28
v_sub_f32 v42, v42, v28
v_sub_f32 v43, v43, v28
v_sub_f32 v48, v48, v28
v_sub_f32 v49, v49, v28
v_sub_f32 v50, v50, v28
v_sub_f32 v51, v51, v28
v_sub_f32 v56, v56, v28
v_sub_f32 v57, v57, v28
v_sub_f32 v58, v58, v28
v_sub_f32 v59, v59, v28
v_sub_f32 v64, v64, v28
v_sub_f32 v65, v65, v28
v_sub_f32 v66, v66, v28
v_sub_f32 v67, v67, v28
v_sub_f32 v72, v72, v28
v_sub_f32 v73, v73, v28
v_sub_f32 v74, v74, v28
v_sub_f32 v75, v75, v28
v_sub_f32 v80, v80, v28
v_sub_f32 v81, v81, v28
v_sub_f32 v82, v82, v28
v_sub_f32 v83, v83, v28
v_sub_f32 v88, v88, v28
v_sub_f32 v89, v89, v28
v_sub_f32 v90, v90, v28
v_sub_f32 v91, v91, v28
v_sub_f32 v20, v20, v28
v_sub_f32 v21, v21, v28
v_sub_f32 v22, v22, v28
v_sub_f32 v23, v23, v28
v_max3_f32 v29, v36, v37, v38
v_max3_f32 v29, v29, v39, v44
v_max3_f32 v29, v29, v45, v46
v_max3_f32 v29, v29, v47, v52
v_max3_f32 v29, v29, v53, v54
v_max3_f32 v29, v29, v55, v60
v_max3_f32 v29, v29, v61, v62
v_max_f32 v29, v29, v63
v_mov_b32 v30, v29
s_nop 1
v_permlane32_swap_b32 v30, v29
v_max_f32 v29, v29, v30
v_mov_b32 v30, v29
s_nop 1
v_permlane16_swap_b32 v30, v29
v_max_f32 v29, v29, v30
v_max_f32 v29, 0, v29
v_sub_f32 v36, v36, v29
v_sub_f32 v37, v37, v29
v_sub_f32 v38, v38, v29
v_sub_f32 v39, v39, v29
v_sub_f32 v44, v44, v29
v_sub_f32 v45, v45, v29
v_sub_f32 v46, v46, v29
v_sub_f32 v47, v47, v29
v_sub_f32 v52, v52, v29
v_sub_f32 v53, v53, v29
v_sub_f32 v54, v54, v29
v_sub_f32 v55, v55, v29
v_sub_f32 v60, v60, v29
v_sub_f32 v61, v61, v29
v_sub_f32 v62, v62, v29
v_sub_f32 v63, v63, v29
v_sub_f32 v68, v68, v29
v_sub_f32 v69, v69, v29
v_sub_f32 v70, v70, v29
v_sub_f32 v71, v71, v29
v_sub_f32 v76, v76, v29
v_sub_f32 v77, v77, v29
v_sub_f32 v78, v78, v29
v_sub_f32 v79, v79, v29
v_sub_f32 v84, v84, v29
v_sub_f32 v85, v85, v29
v_sub_f32 v86, v86, v29
v_sub_f32 v87, v87, v29
v_sub_f32 v92, v92, v29
v_sub_f32 v93, v93, v29
v_sub_f32 v94, v94, v29
v_sub_f32 v95, v95, v29
v_sub_f32 v24, v24, v29
v_sub_f32 v25, v25, v29
v_sub_f32 v26, v26, v29
v_sub_f32 v27, v27, v29
v_sub_f32 v28, 0, v28
v_exp_f32 v28, v28
v_sub_f32 v29, 0, v29
v_exp_f32 v29, v29
s_nop 0
v_mul_f32 v14, v14, v28
v_mul_f32 v15, v15, v29
v_mul_f32 v128, v128, v28
v_mul_f32 v129, v129, v28
v_mul_f32 v130, v130, v28
v_mul_f32 v131, v131, v28
v_mul_f32 v132, v132, v29
v_mul_f32 v133, v133, v29
v_mul_f32 v134, v134, v29
v_mul_f32 v135, v135, v29
v_mul_f32 v136, v136, v28
v_mul_f32 v137, v137, v28
v_mul_f32 v138, v138, v28
v_mul_f32 v139, v139, v28
v_mul_f32 v140, v140, v29
v_mul_f32 v141, v141, v29
v_mul_f32 v142, v142, v29
v_mul_f32 v143, v143, v29
v_mul_f32 v144, v144, v28
v_mul_f32 v145, v145, v28
v_mul_f32 v146, v146, v28
v_mul_f32 v147, v147, v28
v_mul_f32 v148, v148, v29
v_mul_f32 v149, v149, v29
v_mul_f32 v150, v150, v29
v_mul_f32 v151, v151, v29
v_mul_f32 v152, v152, v28
v_mul_f32 v153, v153, v28
v_mul_f32 v154, v154, v28
v_mul_f32 v155, v155, v28
v_mul_f32 v156, v156, v29
v_mul_f32 v157, v157, v29
v_mul_f32 v158, v158, v29
v_mul_f32 v159, v159, v29
v_mul_f32 v160, v160, v28
v_mul_f32 v161, v161, v28
v_mul_f32 v162, v162, v28
v_mul_f32 v163, v163, v28
v_mul_f32 v164, v164, v29
v_mul_f32 v165, v165, v29
v_mul_f32 v166, v166, v29
v_mul_f32 v167, v167, v29
v_mul_f32 v168, v168, v28
v_mul_f32 v169, v169, v28
v_mul_f32 v170, v170, v28
v_mul_f32 v171, v171, v28
v_mul_f32 v172, v172, v29
v_mul_f32 v173, v173, v29
v_mul_f32 v174, v174, v29
v_mul_f32 v175, v175, v29
v_mul_f32 v176, v176, v28
v_mul_f32 v177, v177, v28
v_mul_f32 v178, v178, v28
v_mul_f32 v179, v179, v28
v_mul_f32 v180, v180, v29
v_mul_f32 v181, v181, v29
v_mul_f32 v182, v182, v29
v_mul_f32 v183, v183, v29
v_mul_f32 v184, v184, v28
v_mul_f32 v185, v185, v28
v_mul_f32 v186, v186, v28
v_mul_f32 v187, v187, v28
v_mul_f32 v188, v188, v29
v_mul_f32 v189, v189, v29
v_mul_f32 v190, v190, v29
v_mul_f32 v191, v191, v29
v_mul_f32 v192, v192, v28
v_mul_f32 v193, v193, v28
v_mul_f32 v194, v194, v28
v_mul_f32 v195, v195, v28
v_mul_f32 v196, v196, v29
v_mul_f32 v197, v197, v29
v_mul_f32 v198, v198, v29
v_mul_f32 v199, v199, v29
v_mul_f32 v200, v200, v28
v_mul_f32 v201, v201, v28
v_mul_f32 v202, v202, v28
v_mul_f32 v203, v203, v28
v_mul_f32 v204, v204, v29
v_mul_f32 v205, v205, v29
v_mul_f32 v206, v206, v29
v_mul_f32 v207, v207, v29
v_mul_f32 v208, v208, v28
v_mul_f32 v209, v209, v28
v_mul_f32 v210, v210, v28
v_mul_f32 v211, v211, v28
v_mul_f32 v212, v212, v29
v_mul_f32 v213, v213, v29
v_mul_f32 v214, v214, v29
v_mul_f32 v215, v215, v29
v_mul_f32 v216, v216, v28
v_mul_f32 v217, v217, v28
v_mul_f32 v218, v218, v28
v_mul_f32 v219, v219, v28
v_mul_f32 v220, v220, v29
v_mul_f32 v221, v221, v29
v_mul_f32 v222, v222, v29
v_mul_f32 v223, v223, v29
v_mul_f32 v224, v224, v28
v_mul_f32 v225, v225, v28
v_mul_f32 v226, v226, v28
v_mul_f32 v227, v227, v28
v_mul_f32 v228, v228, v29
v_mul_f32 v229, v229, v29
v_mul_f32 v230, v230, v29
v_mul_f32 v231, v231, v29
v_mul_f32 v232, v232, v28
v_mul_f32 v233, v233, v28
v_mul_f32 v234, v234, v28
v_mul_f32 v235, v235, v28
v_mul_f32 v236, v236, v29
v_mul_f32 v237, v237, v29
v_mul_f32 v238, v238, v29
v_mul_f32 v239, v239, v29
v_mul_f32 v240, v240, v28
v_mul_f32 v241, v241, v28
v_mul_f32 v242, v242, v28
v_mul_f32 v243, v243, v28
v_mul_f32 v244, v244, v29
v_mul_f32 v245, v245, v29
v_mul_f32 v246, v246, v29
v_mul_f32 v247, v247, v29
v_mul_f32 v248, v248, v28
v_mul_f32 v249, v249, v28
v_mul_f32 v250, v250, v28
v_mul_f32 v251, v251, v28
v_mul_f32 v252, v252, v29
v_mul_f32 v253, v253, v29
v_mul_f32 v254, v254, v29
v_mul_f32 v255, v255, v29
v_exp_f32 v2, v32
v_exp_f32 v3, v33
v_exp_f32 v4, v34
v_add_f32 v16, v2, v3
v_cvt_pk_bf16_f32 v96, v2, v3
v_exp_f32 v5, v35
v_exp_f32 v6, v36
v_add_f32 v16, v16, v4
v_add_f32 v16, v16, v5
v_exp_f32 v7, v37
v_cvt_pk_bf16_f32 v97, v4, v5
v_exp_f32 v8, v38
v_add_f32 v17, v6, v7
v_cvt_pk_bf16_f32 v100, v6, v7
v_exp_f32 v9, v39
v_exp_f32 v2, v40
v_add_f32 v17, v17, v8
v_add_f32 v17, v17, v9
v_exp_f32 v3, v41
v_cvt_pk_bf16_f32 v101, v8, v9
v_exp_f32 v4, v42
v_add_f32 v16, v16, v2
v_add_f32 v16, v16, v3
v_exp_f32 v5, v43
v_cvt_pk_bf16_f32 v98, v2, v3
v_exp_f32 v6, v44
v_add_f32 v16, v16, v4
v_add_f32 v16, v16, v5
v_exp_f32 v7, v45
v_cvt_pk_bf16_f32 v99, v4, v5
v_exp_f32 v8, v46
v_add_f32 v17, v17, v6
v_add_f32 v17, v17, v7
v_exp_f32 v9, v47
v_cvt_pk_bf16_f32 v102, v6, v7
v_exp_f32 v2, v48
v_add_f32 v17, v17, v8
v_add_f32 v17, v17, v9
v_exp_f32 v3, v49
v_cvt_pk_bf16_f32 v103, v8, v9
v_exp_f32 v4, v50
v_add_f32 v16, v16, v2
v_add_f32 v16, v16, v3
v_exp_f32 v5, v51
v_cvt_pk_bf16_f32 v104, v2, v3
v_exp_f32 v6, v52
v_add_f32 v16, v16, v4
v_add_f32 v16, v16, v5
v_exp_f32 v7, v53
v_cvt_pk_bf16_f32 v105, v4, v5
v_exp_f32 v8, v54
v_add_f32 v17, v17, v6
v_add_f32 v17, v17, v7
v_exp_f32 v9, v55
v_cvt_pk_bf16_f32 v108, v6, v7
v_exp_f32 v2, v56
v_add_f32 v17, v17, v8
v_add_f32 v17, v17, v9
v_exp_f32 v3, v57
v_cvt_pk_bf16_f32 v109, v8, v9
v_exp_f32 v4, v58
v_add_f32 v16, v16, v2
v_add_f32 v16, v16, v3
v_exp_f32 v5, v59
v_cvt_pk_bf16_f32 v106, v2, v3
v_exp_f32 v6, v60
v_add_f32 v16, v16, v4
v_add_f32 v16, v16, v5
v_exp_f32 v7, v61
v_cvt_pk_bf16_f32 v107, v4, v5
v_exp_f32 v8, v62
v_add_f32 v17, v17, v6
v_add_f32 v17, v17, v7
v_exp_f32 v9, v63
v_cvt_pk_bf16_f32 v110, v6, v7
s_nop 0
v_add_f32 v17, v17, v8
v_add_f32 v17, v17, v9
v_cvt_pk_bf16_f32 v111, v8, v9
s_nop 1
s_branch L_resc_17_b
L_mask_18:
s_nop 7
v_subrev_u32 v31, 64, v18
v_add_u32 v30, 16, v31
v_cmp_gt_i32 s[40:41], 0, v31
v_cmp_gt_i32 s[42:43], 1, v31
v_cmp_gt_i32 s[44:45], 2, v31
v_cmp_gt_i32 s[46:47], 3, v31
v_cndmask_b32 v64, v64, v1, s[40:41]
v_cndmask_b32 v65, v65, v1, s[42:43]
v_cndmask_b32 v66, v66, v1, s[44:45]
v_cndmask_b32 v67, v67, v1, s[46:47]
v_cmp_gt_i32 s[40:41], 0, v30
v_cmp_gt_i32 s[42:43], 1, v30
v_cmp_gt_i32 s[44:45], 2, v30
v_cmp_gt_i32 s[46:47], 3, v30
v_cndmask_b32 v68, v68, v1, s[40:41]
v_cndmask_b32 v69, v69, v1, s[42:43]
v_cndmask_b32 v70, v70, v1, s[44:45]
v_cndmask_b32 v71, v71, v1, s[46:47]
v_cmp_gt_i32 s[40:41], 16, v31
v_cmp_gt_i32 s[42:43], 17, v31
v_cmp_gt_i32 s[44:45], 18, v31
v_cmp_gt_i32 s[46:47], 19, v31
v_cndmask_b32 v72, v72, v1, s[40:41]
v_cndmask_b32 v73, v73, v1, s[42:43]
v_cndmask_b32 v74, v74, v1, s[44:45]
v_cndmask_b32 v75, v75, v1, s[46:47]
v_cmp_gt_i32 s[40:41], 16, v30
v_cmp_gt_i32 s[42:43], 17, v30
v_cmp_gt_i32 s[44:45], 18, v30
v_cmp_gt_i32 s[46:47], 19, v30
v_cndmask_b32 v76, v76, v1, s[40:41]
v_cndmask_b32 v77, v77, v1, s[42:43]
v_cndmask_b32 v78, v78, v1, s[44:45]
v_cndmask_b32 v79, v79, v1, s[46:47]
v_cmp_gt_i32 s[40:41], 32, v31
v_cmp_gt_i32 s[42:43], 33, v31
v_cmp_gt_i32 s[44:45], 34, v31
v_cmp_gt_i32 s[46:47], 35, v31
v_cndmask_b32 v80, v80, v1, s[40:41]
v_cndmask_b32 v81, v81, v1, s[42:43]
v_cndmask_b32 v82, v82, v1, s[44:45]
v_cndmask_b32 v83, v83, v1, s[46:47]
v_cmp_gt_i32 s[40:41], 32, v30
v_cmp_gt_i32 s[42:43], 33, v30
v_cmp_gt_i32 s[44:45], 34, v30
v_cmp_gt_i32 s[46:47], 35, v30
v_cndmask_b32 v84, v84, v1, s[40:41]
v_cndmask_b32 v85, v85, v1, s[42:43]
v_cndmask_b32 v86, v86, v1, s[44:45]
v_cndmask_b32 v87, v87, v1, s[46:47]
v_cmp_gt_i32 s[40:41], 48, v31
v_cmp_gt_i32 s[42:43], 49, v31
v_cmp_gt_i32 s[44:45], 50, v31
v_cmp_gt_i32 s[46:47], 51, v31
v_cndmask_b32 v88, v88, v1, s[40:41]
v_cndmask_b32 v89, v89, v1, s[42:43]
v_cndmask_b32 v90, v90, v1, s[44:45]
v_cndmask_b32 v91, v91, v1, s[46:47]
v_cmp_gt_i32 s[40:41], 48, v30
v_cmp_gt_i32 s[42:43], 49, v30
v_cmp_gt_i32 s[44:45], 50, v30
v_cmp_gt_i32 s[46:47], 51, v30
v_cndmask_b32 v92, v92, v1, s[40:41]
v_cndmask_b32 v93, v93, v1, s[42:43]
v_cndmask_b32 v94, v94, v1, s[44:45]
v_cndmask_b32 v95, v95, v1, s[46:47]
s_branch L_mask_18_b
L_resc_19:
s_nop 7
v_max3_f32 v28, v64, v65, v66
v_max3_f32 v28, v28, v67, v72
v_max3_f32 v28, v28, v73, v74
v_max3_f32 v28, v28, v75, v80
v_max3_f32 v28, v28, v81, v82
v_max3_f32 v28, v28, v83, v88
v_max3_f32 v28, v28, v89, v90
v_max_f32 v28, v28, v91
v_mov_b32 v30, v28
s_nop 1
v_permlane32_swap_b32 v30, v28
v_max_f32 v28, v28, v30
v_mov_b32 v30, v28
s_nop 1
v_permlane16_swap_b32 v30, v28
v_max_f32 v28, v28, v30
v_max_f32 v28, 0, v28
v_sub_f32 v64, v64, v28
v_sub_f32 v65, v65, v28
v_sub_f32 v66, v66, v28
v_sub_f32 v67, v67, v28
v_sub_f32 v72, v72, v28
v_sub_f32 v73, v73, v28
v_sub_f32 v74, v74, v28
v_sub_f32 v75, v75, v28
v_sub_f32 v80, v80, v28
v_sub_f32 v81, v81, v28
v_sub_f32 v82, v82, v28
v_sub_f32 v83, v83, v28
v_sub_f32 v88, v88, v28
v_sub_f32 v89, v89, v28
v_sub_f32 v90, v90, v28
v_sub_f32 v91, v91, v28
v_sub_f32 v20, v20, v28
v_sub_f32 v21, v21, v28
v_sub_f32 v22, v22, v28
v_sub_f32 v23, v23, v28
v_max3_f32 v29, v68, v69, v70
v_max3_f32 v29, v29, v71, v76
v_max3_f32 v29, v29, v77, v78
v_max3_f32 v29, v29, v79, v84
v_max3_f32 v29, v29, v85, v86
v_max3_f32 v29, v29, v87, v92
v_max3_f32 v29, v29, v93, v94
v_max_f32 v29, v29, v95
v_mov_b32 v30, v29
s_nop 1
v_permlane32_swap_b32 v30, v29
v_max_f32 v29, v29, v30
v_mov_b32 v30, v29
s_nop 1
v_permlane16_swap_b32 v30, v29
v_max_f32 v29, v29, v30
v_max_f32 v29, 0, v29
v_sub_f32 v68, v68, v29
v_sub_f32 v69, v69, v29
v_sub_f32 v70, v70, v29
v_sub_f32 v71, v71, v29
v_sub_f32 v76, v76, v29
v_sub_f32 v77, v77, v29
v_sub_f32 v78, v78, v29
v_sub_f32 v79, v79, v29
v_sub_f32 v84, v84, v29
v_sub_f32 v85, v85, v29
v_sub_f32 v86, v86, v29
v_sub_f32 v87, v87, v29
v_sub_f32 v92, v92, v29
v_sub_f32 v93, v93, v29
v_sub_f32 v94, v94, v29
v_sub_f32 v95, v95, v29
v_sub_f32 v24, v24, v29
v_sub_f32 v25, v25, v29
v_sub_f32 v26, v26, v29
v_sub_f32 v27, v27, v29
v_sub_f32 v28, 0, v28
v_exp_f32 v28, v28
v_sub_f32 v29, 0, v29
v_exp_f32 v29, v29
s_nop 0
v_mul_f32 v14, v14, v28
v_mul_f32 v15, v15, v29
v_mul_f32 v128, v128, v28
v_mul_f32 v129, v129, v28
v_mul_f32 v130, v130, v28
v_mul_f32 v131, v131, v28
v_mul_f32 v132, v132, v29
v_mul_f32 v133, v133, v29
v_mul_f32 v134, v134, v29
v_mul_f32 v135, v135, v29
v_mul_f32 v136, v136, v28
v_mul_f32 v137, v137, v28
v_mul_f32 v138, v138, v28
v_mul_f32 v139, v139, v28
v_mul_f32 v140, v140, v29
v_mul_f32 v141, v141, v29
v_mul_f32 v142, v142, v29
v_mul_f32 v143, v143, v29
v_mul_f32 v144, v144, v28
v_mul_f32 v145, v145, v28
v_mul_f32 v146, v146, v28
v_mul_f32 v147, v147, v28
v_mul_f32 v148, v148, v29
v_mul_f32 v149, v149, v29
v_mul_f32 v150, v150, v29
v_mul_f32 v151, v151, v29
v_mul_f32 v152, v152, v28
v_mul_f32 v153, v153, v28
v_mul_f32 v154, v154, v28
v_mul_f32 v155, v155, v28
v_mul_f32 v156, v156, v29
v_mul_f32 v157, v157, v29
v_mul_f32 v158, v158, v29
v_mul_f32 v159, v159, v29
v_mul_f32 v160, v160, v28
v_mul_f32 v161, v161, v28
v_mul_f32 v162, v162, v28
v_mul_f32 v163, v163, v28
v_mul_f32 v164, v164, v29
v_mul_f32 v165, v165, v29
v_mul_f32 v166, v166, v29
v_mul_f32 v167, v167, v29
v_mul_f32 v168, v168, v28
v_mul_f32 v169, v169, v28
v_mul_f32 v170, v170, v28
v_mul_f32 v171, v171, v28
v_mul_f32 v172, v172, v29
v_mul_f32 v173, v173, v29
v_mul_f32 v174, v174, v29
v_mul_f32 v175, v175, v29
v_mul_f32 v176, v176, v28
v_mul_f32 v177, v177, v28
v_mul_f32 v178, v178, v28
v_mul_f32 v179, v179, v28
v_mul_f32 v180, v180, v29
v_mul_f32 v181, v181, v29
v_mul_f32 v182, v182, v29
v_mul_f32 v183, v183, v29
v_mul_f32 v184, v184, v28
v_mul_f32 v185, v185, v28
v_mul_f32 v186, v186, v28
v_mul_f32 v187, v187, v28
v_mul_f32 v188, v188, v29
v_mul_f32 v189, v189, v29
v_mul_f32 v190, v190, v29
v_mul_f32 v191, v191, v29
v_mul_f32 v192, v192, v28
v_mul_f32 v193, v193, v28
v_mul_f32 v194, v194, v28
v_mul_f32 v195, v195, v28
v_mul_f32 v196, v196, v29
v_mul_f32 v197, v197, v29
v_mul_f32 v198, v198, v29
v_mul_f32 v199, v199, v29
v_mul_f32 v200, v200, v28
v_mul_f32 v201, v201, v28
v_mul_f32 v202, v202, v28
v_mul_f32 v203, v203, v28
v_mul_f32 v204, v204, v29
v_mul_f32 v205, v205, v29
v_mul_f32 v206, v206, v29
v_mul_f32 v207, v207, v29
v_mul_f32 v208, v208, v28
v_mul_f32 v209, v209, v28
v_mul_f32 v210, v210, v28
v_mul_f32 v211, v211, v28
v_mul_f32 v212, v212, v29
v_mul_f32 v213, v213, v29
v_mul_f32 v214, v214, v29
v_mul_f32 v215, v215, v29
v_mul_f32 v216, v216, v28
v_mul_f32 v217, v217, v28
v_mul_f32 v218, v218, v28
v_mul_f32 v219, v219, v28
v_mul_f32 v220, v220, v29
v_mul_f32 v221, v221, v29
v_mul_f32 v222, v222, v29
v_mul_f32 v223, v223, v29
v_mul_f32 v224, v224, v28
v_mul_f32 v225, v225, v28
v_mul_f32 v226, v226, v28
v_mul_f32 v227, v227, v28
v_mul_f32 v228, v228, v29
v_mul_f32 v229, v229, v29
v_mul_f32 v230, v230, v29
v_mul_f32 v231, v231, v29
v_mul_f32 v232, v232, v28
v_mul_f32 v233, v233, v28
v_mul_f32 v234, v234, v28
v_mul_f32 v235, v235, v28
v_mul_f32 v236, v236, v29
v_mul_f32 v237, v237, v29
v_mul_f32 v238, v238, v29
v_mul_f32 v239, v239, v29
v_mul_f32 v240, v240, v28
v_mul_f32 v241, v241, v28
v_mul_f32 v242, v242, v28
v_mul_f32 v243, v243, v28
v_mul_f32 v244, v244, v29
v_mul_f32 v245, v245, v29
v_mul_f32 v246, v246, v29
v_mul_f32 v247, v247, v29
v_mul_f32 v248, v248, v28
v_mul_f32 v249, v249, v28
v_mul_f32 v250, v250, v28
v_mul_f32 v251, v251, v28
v_mul_f32 v252, v252, v29
v_mul_f32 v253, v253, v29
v_mul_f32 v254, v254, v29
v_mul_f32 v255, v255, v29
v_exp_f32 v2, v64
v_exp_f32 v3, v65
v_exp_f32 v4, v66
v_add_f32 v16, v2, v3
v_cvt_pk_bf16_f32 v112, v2, v3
v_exp_f32 v5, v67
v_exp_f32 v6, v68
v_add_f32 v16, v16, v4
v_add_f32 v16, v16, v5
v_exp_f32 v7, v69
v_cvt_pk_bf16_f32 v113, v4, v5
v_exp_f32 v8, v70
v_add_f32 v17, v6, v7
v_cvt_pk_bf16_f32 v116, v6, v7
v_exp_f32 v9, v71
v_exp_f32 v2, v72
v_add_f32 v17, v17, v8
v_add_f32 v17, v17, v9
v_exp_f32 v3, v73
v_cvt_pk_bf16_f32 v117, v8, v9
v_exp_f32 v4, v74
v_add_f32 v16, v16, v2
v_add_f32 v16, v16, v3
v_exp_f32 v5, v75
v_cvt_pk_bf16_f32 v114, v2, v3
v_exp_f32 v6, v76
v_add_f32 v16, v16, v4
v_add_f32 v16, v16, v5
v_exp_f32 v7, v77
v_cvt_pk_bf16_f32 v115, v4, v5
v_exp_f32 v8, v78
v_add_f32 v17, v17, v6
v_add_f32 v17, v17, v7
v_exp_f32 v9, v79
v_cvt_pk_bf16_f32 v118, v6, v7
v_exp_f32 v2, v80
v_add_f32 v17, v17, v8
v_add_f32 v17, v17, v9
v_exp_f32 v3, v81
v_cvt_pk_bf16_f32 v119, v8, v9
v_exp_f32 v4, v82
v_add_f32 v16, v16, v2
v_add_f32 v16, v16, v3
v_exp_f32 v5, v83
v_cvt_pk_bf16_f32 v120, v2, v3
v_exp_f32 v6, v84
v_add_f32 v16, v16, v4
v_add_f32 v16, v16, v5
v_exp_f32 v7, v85
v_cvt_pk_bf16_f32 v121, v4, v5
v_exp_f32 v8, v86
v_add_f32 v17, v17, v6
v_add_f32 v17, v17, v7
v_exp_f32 v9, v87
v_cvt_pk_bf16_f32 v124, v6, v7
v_exp_f32 v2, v88
v_add_f32 v17, v17, v8
v_add_f32 v17, v17, v9
v_exp_f32 v3, v89
v_cvt_pk_bf16_f32 v125, v8, v9
v_exp_f32 v4, v90
v_add_f32 v16, v16, v2
v_add_f32 v16, v16, v3
v_exp_f32 v5, v91
v_cvt_pk_bf16_f32 v122, v2, v3
v_exp_f32 v6, v92
v_add_f32 v16, v16, v4
v_add_f32 v16, v16, v5
v_exp_f32 v7, v93
v_cvt_pk_bf16_f32 v123, v4, v5
v_exp_f32 v8, v94
v_add_f32 v17, v17, v6
v_add_f32 v17, v17, v7
v_exp_f32 v9, v95
v_cvt_pk_bf16_f32 v126, v6, v7
s_nop 0
v_add_f32 v17, v17, v8
v_add_f32 v17, v17, v9
v_cvt_pk_bf16_f32 v127, v8, v9
s_nop 1
s_branch L_resc_19_b
L_poll_20:
s_waitcnt vmcnt(13)
L_poll_20_l:
v_readfirstlane_b32 s35, v12
s_cmp_eq_u32 s35, 1
s_cbranch_scc1 L_poll_20_b
s_sleep 4
s_add_u32 s3, s3, 1
s_cmp_gt_u32 s3, 0x80000
s_cbranch_scc1 L_k1_end
buffer_load_dword v12, v19, s[52:55], 0 offen sc1
s_waitcnt vmcnt(0)
s_branch L_poll_20_l
L_resc_21:
s_nop 7
v_max3_f32 v28, v32, v33, v34
v_max3_f32 v28, v28, v35, v40
v_max3_f32 v28, v28, v41, v42
v_max3_f32 v28, v28, v43, v48
v_max3_f32 v28, v28, v49, v50
v_max3_f32 v28, v28, v51, v56
v_max3_f32 v28, v28, v57, v58
v_max_f32 v28, v28, v59
v_mov_b32 v30, v28
s_nop 1
v_permlane32_swap_b32 v30, v28
v_max_f32 v28, v28, v30
v_mov_b32 v30, v28
s_nop 1
v_permlane16_swap_b32 v30, v28
v_max_f32 v28, v28, v30
v_max_f32 v28, 0, v28
v_sub_f32 v32, v32, v28
v_sub_f32 v33, v33, v28
v_sub_f32 v34, v34, v28
v_sub_f32 v35, v35, v28
v_sub_f32 v40, v40, v28
v_sub_f32 v41, v41, v28
v_sub_f32 v42, v42, v28
v_sub_f32 v43, v43, v28
v_sub_f32 v48, v48, v28
v_sub_f32 v49, v49, v28
v_sub_f32 v50, v50, v28
v_sub_f32 v51, v51, v28
v_sub_f32 v56, v56, v28
v_sub_f32 v57, v57, v28
v_sub_f32 v58, v58, v28
v_sub_f32 v59, v59, v28
v_sub_f32 v64, v64, v28
v_sub_f32 v65, v65, v28
v_sub_f32 v66, v66, v28
v_sub_f32 v67, v67, v28
v_sub_f32 v72, v72, v28
v_sub_f32 v73, v73, v28
v_sub_f32 v74, v74, v28
v_sub_f32 v75, v75, v28
v_sub_f32 v80, v80, v28
v_sub_f32 v81, v81, v28
v_sub_f32 v82, v82, v28
v_sub_f32 v83, v83, v28
v_sub_f32 v88, v88, v28
v_sub_f32 v89, v89, v28
v_sub_f32 v90, v90, v28
v_sub_f32 v91, v91, v28
v_sub_f32 v20, v20, v28
v_sub_f32 v21, v21, v28
v_sub_f32 v22, v22, v28
v_sub_f32 v23, v23, v28
v_max3_f32 v29, v36, v37, v38
v_max3_f32 v29, v29, v39, v44
v_max3_f32 v29, v29, v45, v46
v_max3_f32 v29, v29, v47, v52
v_max3_f32 v29, v29, v53, v54
v_max3_f32 v29, v29, v55, v60
v_max3_f32 v29, v29, v61, v62
v_max_f32 v29, v29, v63
v_mov_b32 v30, v29
s_nop 1
v_permlane32_swap_b32 v30, v29
v_max_f32 v29, v29, v30
v_mov_b32 v30, v29
s_nop 1
v_permlane16_swap_b32 v30, v29
v_max_f32 v29, v29, v30
v_max_f32 v29, 0, v29
v_sub_f32 v36, v36, v29
v_sub_f32 v37, v37, v29
v_sub_f32 v38, v38, v29
v_sub_f32 v39, v39, v29
v_sub_f32 v44, v44, v29
v_sub_f32 v45, v45, v29
v_sub_f32 v46, v46, v29
v_sub_f32 v47, v47, v29
v_sub_f32 v52, v52, v29
v_sub_f32 v53, v53, v29
v_sub_f32 v54, v54, v29
v_sub_f32 v55, v55, v29
v_sub_f32 v60, v60, v29
v_sub_f32 v61, v61, v29
v_sub_f32 v62, v62, v29
v_sub_f32 v63, v63, v29
v_sub_f32 v68, v68, v29
v_sub_f32 v69, v69, v29
v_sub_f32 v70, v70, v29
v_sub_f32 v71, v71, v29
v_sub_f32 v76, v76, v29
v_sub_f32 v77, v77, v29
v_sub_f32 v78, v78, v29
v_sub_f32 v79, v79, v29
v_sub_f32 v84, v84, v29
v_sub_f32 v85, v85, v29
v_sub_f32 v86, v86, v29
v_sub_f32 v87, v87, v29
v_sub_f32 v92, v92, v29
v_sub_f32 v93, v93, v29
v_sub_f32 v94, v94, v29
v_sub_f32 v95, v95, v29
v_sub_f32 v24, v24, v29
v_sub_f32 v25, v25, v29
v_sub_f32 v26, v26, v29
v_sub_f32 v27, v27, v29
v_sub_f32 v28, 0, v28
v_exp_f32 v28, v28
v_sub_f32 v29, 0, v29
v_exp_f32 v29, v29
s_nop 0
v_mul_f32 v14, v14, v28
v_mul_f32 v15, v15, v29
v_mul_f32 v128, v128, v28
v_mul_f32 v129, v129, v28
v_mul_f32 v130, v130, v28
v_mul_f32 v131, v131, v28
v_mul_f32 v132, v132, v29
v_mul_f32 v133, v133, v29
v_mul_f32 v134, v134, v29
v_mul_f32 v135, v135, v29
v_mul_f32 v136, v136, v28
v_mul_f32 v137, v137, v28
v_mul_f32 v138, v138, v28
v_mul_f32 v139, v139, v28
v_mul_f32 v140, v140, v29
v_mul_f32 v141, v141, v29
v_mul_f32 v142, v142, v29
v_mul_f32 v143, v143, v29
v_mul_f32 v144, v144, v28
v_mul_f32 v145, v145, v28
v_mul_f32 v146, v146, v28
v_mul_f32 v147, v147, v28
v_mul_f32 v148, v148, v29
v_mul_f32 v149, v149, v29
v_mul_f32 v150, v150, v29
v_mul_f32 v151, v151, v29
v_mul_f32 v152, v152, v28
v_mul_f32 v153, v153, v28
v_mul_f32 v154, v154, v28
v_mul_f32 v155, v155, v28
v_mul_f32 v156, v156, v29
v_mul_f32 v157, v157, v29
v_mul_f32 v158, v158, v29
v_mul_f32 v159, v159, v29
v_mul_f32 v160, v160, v28
v_mul_f32 v161, v161, v28
v_mul_f32 v162, v162, v28
v_mul_f32 v163, v163, v28
v_mul_f32 v164, v164, v29
v_mul_f32 v165, v165, v29
v_mul_f32 v166, v166, v29
v_mul_f32 v167, v167, v29
v_mul_f32 v168, v168, v28
v_mul_f32 v169, v169, v28
v_mul_f32 v170, v170, v28
v_mul_f32 v171, v171, v28
v_mul_f32 v172, v172, v29
v_mul_f32 v173, v173, v29
v_mul_f32 v174, v174, v29
v_mul_f32 v175, v175, v29
v_mul_f32 v176, v176, v28
v_mul_f32 v177, v177, v28
v_mul_f32 v178, v178, v28
v_mul_f32 v179, v179, v28
v_mul_f32 v180, v180, v29
v_mul_f32 v181, v181, v29
v_mul_f32 v182, v182, v29
v_mul_f32 v183, v183, v29
v_mul_f32 v184, v184, v28
v_mul_f32 v185, v185, v28
v_mul_f32 v186, v186, v28
v_mul_f32 v187, v187, v28
v_mul_f32 v188, v188, v29
v_mul_f32 v189, v189, v29
v_mul_f32 v190, v190, v29
v_mul_f32 v191, v191, v29
v_mul_f32 v192, v192, v28
v_mul_f32 v193, v193, v28
v_mul_f32 v194, v194, v28
v_mul_f32 v195, v195, v28
v_mul_f32 v196, v196, v29
v_mul_f32 v197, v197, v29
v_mul_f32 v198, v198, v29
v_mul_f32 v199, v199, v29
v_mul_f32 v200, v200, v28
v_mul_f32 v201, v201, v28
v_mul_f32 v202, v202, v28
v_mul_f32 v203, v203, v28
v_mul_f32 v204, v204, v29
v_mul_f32 v205, v205, v29
v_mul_f32 v206, v206, v29
v_mul_f32 v207, v207, v29
v_mul_f32 v208, v208, v28
v_mul_f32 v209, v209, v28
v_mul_f32 v210, v210, v28
v_mul_f32 v211, v211, v28
v_mul_f32 v212, v212, v29
v_mul_f32 v213, v213, v29
v_mul_f32 v214, v214, v29
v_mul_f32 v215, v215, v29
v_mul_f32 v216, v216, v28
v_mul_f32 v217, v217, v28
v_mul_f32 v218, v218, v28
v_mul_f32 v219, v219, v28
v_mul_f32 v220, v220, v29
v_mul_f32 v221, v221, v29
v_mul_f32 v222, v222, v29
v_mul_f32 v223, v223, v29
v_mul_f32 v224, v224, v28
v_mul_f32 v225, v225, v28
v_mul_f32 v226, v226, v28
v_mul_f32 v227, v227, v28
v_mul_f32 v228, v228, v29
v_mul_f32 v229, v229, v29
v_mul_f32 v230, v230, v29
v_mul_f32 v231, v231, v29
v_mul_f32 v232, v232, v28
v_mul_f32 v233, v233, v28
v_mul_f32 v234, v234, v28
v_mul_f32 v235, v235, v28
v_mul_f32 v236, v236, v29
v_mul_f32 v237, v237, v29
v_mul_f32 v238, v238, v29
v_mul_f32 v239, v239, v29
v_mul_f32 v240, v240, v28
v_mul_f32 v241, v241, v28
v_mul_f32 v242, v242, v28
v_mul_f32 v243, v243, v28
v_mul_f32 v244, v244, v29
v_mul_f32 v245, v245, v29
v_mul_f32 v246, v246, v29
v_mul_f32 v247, v247, v29
v_mul_f32 v248, v248, v28
v_mul_f32 v249, v249, v28
v_mul_f32 v250, v250, v28
v_mul_f32 v251, v251, v28
v_mul_f32 v252, v252, v29
v_mul_f32 v253, v253, v29
v_mul_f32 v254, v254, v29
v_mul_f32 v255, v255, v29
v_exp_f32 v2, v32
v_exp_f32 v3, v33
v_exp_f32 v4, v34
v_add_f32 v16, v2, v3
v_cvt_pk_bf16_f32 v96, v2, v3
v_exp_f32 v5, v35
v_exp_f32 v6, v36
v_add_f32 v16, v16, v4
v_add_f32 v16, v16, v5
v_exp_f32 v7, v37
v_cvt_pk_bf16_f32 v97, v4, v5
v_exp_f32 v8, v38
v_add_f32 v17, v6, v7
v_cvt_pk_bf16_f32 v100, v6, v7
v_exp_f32 v9, v39
v_exp_f32 v2, v40
v_add_f32 v17, v17, v8
v_add_f32 v17, v17, v9
v_exp_f32 v3, v41
v_cvt_pk_bf16_f32 v101, v8, v9
v_exp_f32 v4, v42
v_add_f32 v16, v16, v2
v_add_f32 v16, v16, v3
v_exp_f32 v5, v43
v_cvt_pk_bf16_f32 v98, v2, v3
v_exp_f32 v6, v44
v_add_f32 v16, v16, v4
v_add_f32 v16, v16, v5
v_exp_f32 v7, v45
v_cvt_pk_bf16_f32 v99, v4, v5
v_exp_f32 v8, v46
v_add_f32 v17, v17, v6
v_add_f32 v17, v17, v7
v_exp_f32 v9, v47
v_cvt_pk_bf16_f32 v102, v6, v7
v_exp_f32 v2, v48
v_add_f32 v17, v17, v8
v_add_f32 v17, v17, v9
v_exp_f32 v3, v49
v_cvt_pk_bf16_f32 v103, v8, v9
v_exp_f32 v4, v50
v_add_f32 v16, v16, v2
v_add_f32 v16, v16, v3
v_exp_f32 v5, v51
v_cvt_pk_bf16_f32 v104, v2, v3
v_exp_f32 v6, v52
v_add_f32 v16, v16, v4
v_add_f32 v16, v16, v5
v_exp_f32 v7, v53
v_cvt_pk_bf16_f32 v105, v4, v5
v_exp_f32 v8, v54
v_add_f32 v17, v17, v6
v_add_f32 v17, v17, v7
v_exp_f32 v9, v55
v_cvt_pk_bf16_f32 v108, v6, v7
v_exp_f32 v2, v56
v_add_f32 v17, v17, v8
v_add_f32 v17, v17, v9
v_exp_f32 v3, v57
v_cvt_pk_bf16_f32 v109, v8, v9
v_exp_f32 v4, v58
v_add_f32 v16, v16, v2
v_add_f32 v16, v16, v3
v_exp_f32 v5, v59
v_cvt_pk_bf16_f32 v106, v2, v3
v_exp_f32 v6, v60
v_add_f32 v16, v16, v4
v_add_f32 v16, v16, v5
v_exp_f32 v7, v61
v_cvt_pk_bf16_f32 v107, v4, v5
v_exp_f32 v8, v62
v_add_f32 v17, v17, v6
v_add_f32 v17, v17, v7
v_exp_f32 v9, v63
v_cvt_pk_bf16_f32 v110, v6, v7
s_nop 0
v_add_f32 v17, v17, v8
v_add_f32 v17, v17, v9
v_cvt_pk_bf16_f32 v111, v8, v9
s_nop 1
s_branch L_resc_21_b
L_mask_22:
s_nop 7
v_subrev_u32 v31, 64, v18
v_add_u32 v30, 16, v31
v_cmp_gt_i32 s[40:41], 0, v31
v_cmp_gt_i32 s[42:43], 1, v31
v_cmp_gt_i32 s[44:45], 2, v31
v_cmp_gt_i32 s[46:47], 3, v31
v_cndmask_b32 v64, v64, v1, s[40:41]
v_cndmask_b32 v65, v65, v1, s[42:43]
v_cndmask_b32 v66, v66, v1, s[44:45]
v_cndmask_b32 v67, v67, v1, s[46:47]
v_cmp_gt_i32 s[40:41], 0, v30
v_cmp_gt_i32 s[42:43], 1, v30
v_cmp_gt_i32 s[44:45], 2, v30
v_cmp_gt_i32 s[46:47], 3, v30
v_cndmask_b32 v68, v68, v1, s[40:41]
v_cndmask_b32 v69, v69, v1, s[42:43]
v_cndmask_b32 v70, v70, v1, s[44:45]
v_cndmask_b32 v71, v71, v1, s[46:47]
v_cmp_gt_i32 s[40:41], 16, v31
v_cmp_gt_i32 s[42:43], 17, v31
v_cmp_gt_i32 s[44:45], 18, v31
v_cmp_gt_i32 s[46:47], 19, v31
v_cndmask_b32 v72, v72, v1, s[40:41]
v_cndmask_b32 v73, v73, v1, s[42:43]
v_cndmask_b32 v74, v74, v1, s[44:45]
v_cndmask_b32 v75, v75, v1, s[46:47]
v_cmp_gt_i32 s[40:41], 16, v30
v_cmp_gt_i32 s[42:43], 17, v30
v_cmp_gt_i32 s[44:45], 18, v30
v_cmp_gt_i32 s[46:47], 19, v30
v_cndmask_b32 v76, v76, v1, s[40:41]
v_cndmask_b32 v77, v77, v1, s[42:43]
v_cndmask_b32 v78, v78, v1, s[44:45]
v_cndmask_b32 v79, v79, v1, s[46:47]
v_cmp_gt_i32 s[40:41], 32, v31
v_cmp_gt_i32 s[42:43], 33, v31
v_cmp_gt_i32 s[44:45], 34, v31
v_cmp_gt_i32 s[46:47], 35, v31
v_cndmask_b32 v80, v80, v1, s[40:41]
v_cndmask_b32 v81, v81, v1, s[42:43]
v_cndmask_b32 v82, v82, v1, s[44:45]
v_cndmask_b32 v83, v83, v1, s[46:47]
v_cmp_gt_i32 s[40:41], 32, v30
v_cmp_gt_i32 s[42:43], 33, v30
v_cmp_gt_i32 s[44:45], 34, v30
v_cmp_gt_i32 s[46:47], 35, v30
v_cndmask_b32 v84, v84, v1, s[40:41]
v_cndmask_b32 v85, v85, v1, s[42:43]
v_cndmask_b32 v86, v86, v1, s[44:45]
v_cndmask_b32 v87, v87, v1, s[46:47]
v_cmp_gt_i32 s[40:41], 48, v31
v_cmp_gt_i32 s[42:43], 49, v31
v_cmp_gt_i32 s[44:45], 50, v31
v_cmp_gt_i32 s[46:47], 51, v31
v_cndmask_b32 v88, v88, v1, s[40:41]
v_cndmask_b32 v89, v89, v1, s[42:43]
v_cndmask_b32 v90, v90, v1, s[44:45]
v_cndmask_b32 v91, v91, v1, s[46:47]
v_cmp_gt_i32 s[40:41], 48, v30
v_cmp_gt_i32 s[42:43], 49, v30
v_cmp_gt_i32 s[44:45], 50, v30
v_cmp_gt_i32 s[46:47], 51, v30
v_cndmask_b32 v92, v92, v1, s[40:41]
v_cndmask_b32 v93, v93, v1, s[42:43]
v_cndmask_b32 v94, v94, v1, s[44:45]
v_cndmask_b32 v95, v95, v1, s[46:47]
s_branch L_mask_22_b
L_resc_23:
s_nop 7
v_max3_f32 v28, v64, v65, v66
v_max3_f32 v28, v28, v67, v72
v_max3_f32 v28, v28, v73, v74
v_max3_f32 v28, v28, v75, v80
v_max3_f32 v28, v28, v81, v82
v_max3_f32 v28, v28, v83, v88
v_max3_f32 v28, v28, v89, v90
v_max_f32 v28, v28, v91
v_mov_b32 v30, v28
s_nop 1
v_permlane32_swap_b32 v30, v28
v_max_f32 v28, v28, v30
v_mov_b32 v30, v28
s_nop 1
v_permlane16_swap_b32 v30, v28
v_max_f32 v28, v28, v30
v_max_f32 v28, 0, v28
v_sub_f32 v64, v64, v28
v_sub_f32 v65, v65, v28
v_sub_f32 v66, v66, v28
v_sub_f32 v67, v67, v28
v_sub_f32 v72, v72, v28
v_sub_f32 v73, v73, v28
v_sub_f32 v74, v74, v28
v_sub_f32 v75, v75, v28
v_sub_f32 v80, v80, v28
v_sub_f32 v81, v81, v28
v_sub_f32 v82, v82, v28
v_sub_f32 v83, v83, v28
v_sub_f32 v88, v88, v28
v_sub_f32 v89, v89, v28
v_sub_f32 v90, v90, v28
v_sub_f32 v91, v91, v28
v_sub_f32 v20, v20, v28
v_sub_f32 v21, v21, v28
v_sub_f32 v22, v22, v28
v_sub_f32 v23, v23, v28
v_max3_f32 v29, v68, v69, v70
v_max3_f32 v29, v29, v71, v76
v_max3_f32 v29, v29, v77, v78
v_max3_f32 v29, v29, v79, v84
v_max3_f32 v29, v29, v85, v86
v_max3_f32 v29, v29, v87, v92
v_max3_f32 v29, v29, v93, v94
v_max_f32 v29, v29, v95
v_mov_b32 v30, v29
s_nop 1
v_permlane32_swap_b32 v30, v29
v_max_f32 v29, v29, v30
v_mov_b32 v30, v29
s_nop 1
v_permlane16_swap_b32 v30, v29
v_max_f32 v29, v29, v30
v_max_f32 v29, 0, v29
v_sub_f32 v68, v68, v29
v_sub_f32 v69, v69, v29
v_sub_f32 v70, v70, v29
v_sub_f32 v71, v71, v29
v_sub_f32 v76, v76, v29
v_sub_f32 v77, v77, v29
v_sub_f32 v78, v78, v29
v_sub_f32 v79, v79, v29
v_sub_f32 v84, v84, v29
v_sub_f32 v85, v85, v29
v_sub_f32 v86, v86, v29
v_sub_f32 v87, v87, v29
v_sub_f32 v92, v92, v29
v_sub_f32 v93, v93, v29
v_sub_f32 v94, v94, v29
v_sub_f32 v95, v95, v29
v_sub_f32 v24, v24, v29
v_sub_f32 v25, v25, v29
v_sub_f32 v26, v26, v29
v_sub_f32 v27, v27, v29
v_sub_f32 v28, 0, v28
v_exp_f32 v28, v28
v_sub_f32 v29, 0, v29
v_exp_f32 v29, v29
s_nop 0
v_mul_f32 v14, v14, v28
v_mul_f32 v15, v15, v29
v_mul_f32 v128, v128, v28
v_mul_f32 v129, v129, v28
v_mul_f32 v130, v130, v28
v_mul_f32 v131, v131, v28
v_mul_f32 v132, v132, v29
v_mul_f32 v133, v133, v29
v_mul_f32 v134, v134, v29
v_mul_f32 v135, v135, v29
v_mul_f32 v136, v136, v28
v_mul_f32 v137, v137, v28
v_mul_f32 v138, v138, v28
v_mul_f32 v139, v139, v28
v_mul_f32 v140, v140, v29
v_mul_f32 v141, v141, v29
v_mul_f32 v142, v142, v29
v_mul_f32 v143, v143, v29
v_mul_f32 v144, v144, v28
v_mul_f32 v145, v145, v28
v_mul_f32 v146, v146, v28
v_mul_f32 v147, v147, v28
v_mul_f32 v148, v148, v29
v_mul_f32 v149, v149, v29
v_mul_f32 v150, v150, v29
v_mul_f32 v151, v151, v29
v_mul_f32 v152, v152, v28
v_mul_f32 v153, v153, v28
v_mul_f32 v154, v154, v28
v_mul_f32 v155, v155, v28
v_mul_f32 v156, v156, v29
v_mul_f32 v157, v157, v29
v_mul_f32 v158, v158, v29
v_mul_f32 v159, v159, v29
v_mul_f32 v160, v160, v28
v_mul_f32 v161, v161, v28
v_mul_f32 v162, v162, v28
v_mul_f32 v163, v163, v28
v_mul_f32 v164, v164, v29
v_mul_f32 v165, v165, v29
v_mul_f32 v166, v166, v29
v_mul_f32 v167, v167, v29
v_mul_f32 v168, v168, v28
v_mul_f32 v169, v169, v28
v_mul_f32 v170, v170, v28
v_mul_f32 v171, v171, v28
v_mul_f32 v172, v172, v29
v_mul_f32 v173, v173, v29
v_mul_f32 v174, v174, v29
v_mul_f32 v175, v175, v29
v_mul_f32 v176, v176, v28
v_mul_f32 v177, v177, v28
v_mul_f32 v178, v178, v28
v_mul_f32 v179, v179, v28
v_mul_f32 v180, v180, v29
v_mul_f32 v181, v181, v29
v_mul_f32 v182, v182, v29
v_mul_f32 v183, v183, v29
v_mul_f32 v184, v184, v28
v_mul_f32 v185, v185, v28
v_mul_f32 v186, v186, v28
v_mul_f32 v187, v187, v28
v_mul_f32 v188, v188, v29
v_mul_f32 v189, v189, v29
v_mul_f32 v190, v190, v29
v_mul_f32 v191, v191, v29
v_mul_f32 v192, v192, v28
v_mul_f32 v193, v193, v28
v_mul_f32 v194, v194, v28
v_mul_f32 v195, v195, v28
v_mul_f32 v196, v196, v29
v_mul_f32 v197, v197, v29
v_mul_f32 v198, v198, v29
v_mul_f32 v199, v199, v29
v_mul_f32 v200, v200, v28
v_mul_f32 v201, v201, v28
v_mul_f32 v202, v202, v28
v_mul_f32 v203, v203, v28
v_mul_f32 v204, v204, v29
v_mul_f32 v205, v205, v29
v_mul_f32 v206, v206, v29
v_mul_f32 v207, v207, v29
v_mul_f32 v208, v208, v28
v_mul_f32 v209, v209, v28
v_mul_f32 v210, v210, v28
v_mul_f32 v211, v211, v28
v_mul_f32 v212, v212, v29
v_mul_f32 v213, v213, v29
v_mul_f32 v214, v214, v29
v_mul_f32 v215, v215, v29
v_mul_f32 v216, v216, v28
v_mul_f32 v217, v217, v28
v_mul_f32 v218, v218, v28
v_mul_f32 v219, v219, v28
v_mul_f32 v220, v220, v29
v_mul_f32 v221, v221, v29
v_mul_f32 v222, v222, v29
v_mul_f32 v223, v223, v29
v_mul_f32 v224, v224, v28
v_mul_f32 v225, v225, v28
v_mul_f32 v226, v226, v28
v_mul_f32 v227, v227, v28
v_mul_f32 v228, v228, v29
v_mul_f32 v229, v229, v29
v_mul_f32 v230, v230, v29
v_mul_f32 v231, v231, v29
v_mul_f32 v232, v232, v28
v_mul_f32 v233, v233, v28
v_mul_f32 v234, v234, v28
v_mul_f32 v235, v235, v28
v_mul_f32 v236, v236, v29
v_mul_f32 v237, v237, v29
v_mul_f32 v238, v238, v29
v_mul_f32 v239, v239, v29
v_mul_f32 v240, v240, v28
v_mul_f32 v241, v241, v28
v_mul_f32 v242, v242, v28
v_mul_f32 v243, v243, v28
v_mul_f32 v244, v244, v29
v_mul_f32 v245, v245, v29
v_mul_f32 v246, v246, v29
v_mul_f32 v247, v247, v29
v_mul_f32 v248, v248, v28
v_mul_f32 v249, v249, v28
v_mul_f32 v250, v250, v28
v_mul_f32 v251, v251, v28
v_mul_f32 v252, v252, v29
v_mul_f32 v253, v253, v29
v_mul_f32 v254, v254, v29
v_mul_f32 v255, v255, v29
v_exp_f32 v2, v64
v_exp_f32 v3, v65
v_exp_f32 v4, v66
v_add_f32 v16, v2, v3
v_cvt_pk_bf16_f32 v112, v2, v3
v_exp_f32 v5, v67
v_exp_f32 v6, v68
v_add_f32 v16, v16, v4
v_add_f32 v16, v16, v5
v_exp_f32 v7, v69
v_cvt_pk_bf16_f32 v113, v4, v5
v_exp_f32 v8, v70
v_add_f32 v17, v6, v7
v_cvt_pk_bf16_f32 v116, v6, v7
v_exp_f32 v9, v71
v_exp_f32 v2, v72
v_add_f32 v17, v17, v8
v_add_f32 v17, v17, v9
v_exp_f32 v3, v73
v_cvt_pk_bf16_f32 v117, v8, v9
v_exp_f32 v4, v74
v_add_f32 v16, v16, v2
v_add_f32 v16, v16, v3
v_exp_f32 v5, v75
v_cvt_pk_bf16_f32 v114, v2, v3
v_exp_f32 v6, v76
v_add_f32 v16, v16, v4
v_add_f32 v16, v16, v5
v_exp_f32 v7, v77
v_cvt_pk_bf16_f32 v115, v4, v5
v_exp_f32 v8, v78
v_add_f32 v17, v17, v6
v_add_f32 v17, v17, v7
v_exp_f32 v9, v79
v_cvt_pk_bf16_f32 v118, v6, v7
v_exp_f32 v2, v80
v_add_f32 v17, v17, v8
v_add_f32 v17, v17, v9
v_exp_f32 v3, v81
v_cvt_pk_bf16_f32 v119, v8, v9
v_exp_f32 v4, v82
v_add_f32 v16, v16, v2
v_add_f32 v16, v16, v3
v_exp_f32 v5, v83
v_cvt_pk_bf16_f32 v120, v2, v3
v_exp_f32 v6, v84
v_add_f32 v16, v16, v4
v_add_f32 v16, v16, v5
v_exp_f32 v7, v85
v_cvt_pk_bf16_f32 v121, v4, v5
v_exp_f32 v8, v86
v_add_f32 v17, v17, v6
v_add_f32 v17, v17, v7
v_exp_f32 v9, v87
v_cvt_pk_bf16_f32 v124, v6, v7
v_exp_f32 v2, v88
v_add_f32 v17, v17, v8
v_add_f32 v17, v17, v9
v_exp_f32 v3, v89
v_cvt_pk_bf16_f32 v125, v8, v9
v_exp_f32 v4, v90
v_add_f32 v16, v16, v2
v_add_f32 v16, v16, v3
v_exp_f32 v5, v91
v_cvt_pk_bf16_f32 v122, v2, v3
v_exp_f32 v6, v92
v_add_f32 v16, v16, v4
v_add_f32 v16, v16, v5
v_exp_f32 v7, v93
v_cvt_pk_bf16_f32 v123, v4, v5
v_exp_f32 v8, v94
v_add_f32 v17, v17, v6
v_add_f32 v17, v17, v7
v_exp_f32 v9, v95
v_cvt_pk_bf16_f32 v126, v6, v7
s_nop 0
v_add_f32 v17, v17, v8
v_add_f32 v17, v17, v9
v_cvt_pk_bf16_f32 v127, v8, v9
s_nop 1
s_branch L_resc_23_b
L_code_end:
s_endpgm
.section .rodata,"a"
.p2align 6
.amdhsa_kernel gated_mix__compressed_kv_cla__sliding_local_dilated__prompt_kernel
  .amdhsa_next_free_vgpr 512
  .amdhsa_next_free_sgpr 102
  .amdhsa_accum_offset 256
  .amdhsa_group_segment_fixed_size 0
  .amdhsa_kernarg_size 104
  .amdhsa_user_sgpr_count 2
  .amdhsa_user_sgpr_kernarg_segment_ptr 1
  .amdhsa_system_sgpr_workgroup_id_x 1
.end_amdhsa_kernel
```
